```python
import torch

def _softmax(x, axis=-1):
    return torch.softmax(x, dim=axis)
def _gelu(x):
    return torch.nn.functional.gelu(x, approximate="tanh")
def _silu(x):
    return torch.nn.functional.silu(x)
def _sigmoid(x):
    return torch.sigmoid(x)
def _layernorm(x, axis=-1, eps=1e-5):
    m = x.mean(dim=axis, keepdim=True)
    v = x.var(dim=axis, keepdim=True, unbiased=False)
    return (x - m) / torch.sqrt(v + eps)
def _scatter_add(tgt, idx, src, axis=0):
    return tgt.clone().index_add_(axis, idx, src)
def _segment_sum(src, seg, n):
    out = torch.zeros((n,) + src.shape[1:], dtype=src.dtype)
    return out.index_add_(0, seg, src)
def _pad(x, pw):
    flat = tuple(v for pair in reversed(pw) for v in pair)
    return torch.nn.functional.pad(x, flat)

kernel_name = 'gated_mix__ssm_conv_s5__dense_activation_gelu__prompt'

def setup_inputs():

    _w = (lambda a: (lambda t: t.to(torch.bfloat16) if t.is_floating_point() else t)(torch.as_tensor(a)))
    def _A_setup():
        B, S, D = 1, 2048, 1024
        P = D
        Lambda_re = -0.5 * (lambda _x: torch.exp(torch.as_tensor(_x)))((lambda *s: torch.randn(*s, dtype=torch.bfloat16) * 0.2)(P))
        Lambda_im = (lambda *s: torch.randn(*s, dtype=torch.bfloat16) * 0.8)(P) * 1.0
        B_re = (lambda *s: torch.randn(*s, dtype=torch.bfloat16) * 0.2)(P, D) * (D ** -0.5)
        B_im = (lambda *s: torch.randn(*s, dtype=torch.bfloat16) * 0.2)(P, D) * (D ** -0.5)
        C_re = (lambda *s: torch.randn(*s, dtype=torch.bfloat16) * 0.2)(D, P) * (P ** -0.5)
        C_im = (lambda *s: torch.randn(*s, dtype=torch.bfloat16) * 0.2)(D, P) * (P ** -0.5)
        log_dt = (lambda *s: torch.randn(*s, dtype=torch.bfloat16) * 0.2)(P) * 0.3 - 2.0
        Dskip = (lambda *s: torch.randn(*s, dtype=torch.bfloat16) * 0.05)(D)
        return {
            "x": _w((lambda *s: torch.randn(*s, dtype=torch.bfloat16) * 0.05)(B, S, D)),
            "Lambda_re": _w(Lambda_re),
            "Lambda_im": _w(Lambda_im),
            "B_re": _w(B_re),
            "B_im": _w(B_im),
            "C_re": _w(C_re),
            "C_im": _w(C_im),
            "log_dt": _w(log_dt),
            "Dskip": _w(Dskip),
        }
    _A_in = _A_setup()

    def _B_setup():
        B, S, D, F = 1, 2048, 1024, 3584
        return {
            "x": _w((lambda *s: torch.randn(*s, dtype=torch.bfloat16) * 0.05)(B, S, D)),
            "w1": _w((lambda *s: torch.randn(*s, dtype=torch.bfloat16) * 3.2)(D, F) * (D ** -0.5)),
            "b1": _w((lambda *s: torch.randn(*s, dtype=torch.bfloat16) * 3.2)(F) * 0.01),
            "w2": _w((lambda *s: torch.randn(*s, dtype=torch.bfloat16) * 0.1)(F, D) * (F ** -0.5)),
            "b2": _w((lambda *s: torch.randn(*s, dtype=torch.bfloat16) * 0.2)(D) * 0.01),
        }
    _B_in = _B_setup()

    return {
        "A_x": _A_in["x"],
        "A_Lambda_re": _A_in["Lambda_re"],
        "A_Lambda_im": _A_in["Lambda_im"],
        "A_B_re": _A_in["B_re"],
        "A_B_im": _A_in["B_im"],
        "A_C_re": _A_in["C_re"],
        "A_C_im": _A_in["C_im"],
        "A_log_dt": _A_in["log_dt"],
        "A_Dskip": _A_in["Dskip"],
        "B_x": _B_in["x"],
        "B_w1": _B_in["w1"],
        "B_b1": _B_in["b1"],
        "B_w2": _B_in["w2"],
        "B_b2": _B_in["b2"],
        "gate_w": _w((lambda *s: torch.randn(*s, dtype=torch.bfloat16) * 0.05)(1024) * 16.0),
    }

def reference(A_x, A_Lambda_re, A_Lambda_im, A_B_re, A_B_im, A_C_re, A_C_im, A_log_dt, A_Dskip, B_x, B_w1, B_b1, B_w2, B_b2, gate_w):
    def _A_ref(x, Lambda_re, Lambda_im, B_re, B_im, C_re, C_im, log_dt, Dskip):
        Bsz, L, H = x.shape
        Lam = Lambda_re + 1j * Lambda_im
        Bmat = B_re + 1j * B_im
        Cmat = C_re + 1j * C_im
        dt = torch.exp(log_dt)
        Lam_bar = torch.exp(dt * Lam)
        B_bar = ((Lam_bar - 1.0) / Lam)[:, None] * Bmat
        Bu = torch.einsum("bld,pd->blp", x + 0j, B_bar)
        h = torch.zeros_like(Bu[:, 0, :])
        hs = []
        for t in range(L):
            h = Lam_bar[None, :] * h + Bu[:, t, :]
            hs.append(h)
        hseq = torch.stack(hs, 1)
        y = 2.0 * torch.einsum("blp,dp->bld", hseq, Cmat).real + x * Dskip[None, None, :]
        return y

    def _B_ref(x, w1, b1, w2, b2):
        h = torch.einsum("bsd,df->bsf", x, w1) + b1
        h = _gelu(h)
        return torch.einsum("bsf,fd->bsd", h, w2) + b2

    x = A_x
    g = _sigmoid((x * gate_w).sum(-1, keepdims=True))
    a = _A_ref(x, A_Lambda_re, A_Lambda_im, A_B_re, A_B_im, A_C_re, A_C_im, A_log_dt, A_Dskip)
    b = _B_ref(x, B_w1, B_b1, B_w2, B_b2)
    return g * a + (1 - g) * b
```

```asm
; @launch grid=(256,1,1) block=(256,1,1) lds=163840
.amdgcn_target "amdgcn-amd-amdhsa--gfx950"
.text
.globl gated_mix__ssm_conv_s5__dense_activation_gelu__prompt_kernel
.p2align 8
.type gated_mix__ssm_conv_s5__dense_activation_gelu__prompt_kernel,@function
gated_mix__ssm_conv_s5__dense_activation_gelu__prompt_kernel:
 s_cmp_ge_u32 s2, 0x100
 s_cbranch_scc1 L_exit
 s_load_dwordx2 s[24:25], s[0:1], 0
 s_load_dwordx8 s[4:11], s[0:1], 8
 s_load_dwordx2 s[32:33], s[0:1], 80
 s_load_dwordx2 s[16:17], s[0:1], 88
 s_getpc_b64 s[18:19]
L_pc:
 v_lshrrev_b32 v1, 6, v0
 v_lshrrev_b32 v2, 2, v0
 v_and_b32 v3, 3, v0
 v_lshlrev_b32 v2, 5, v2
 v_add_lshl_u32 v2, v2, v3, 7
 v_add_u32 v2, L_main-L_pc, v2
 v_min_u32 v2, L_end-L_pc-4, v2
 global_load_dword v79, v2, s[18:19]
 v_and_b32 v0, 63, v0
 v_readfirstlane_b32 s60, v1
 s_and_b32 s61, s2, 3
 s_bfe_u32 s65, s2, 131075
 s_lshr_b32 s63, s2, 5
 s_and_b32 s68, s2, 4
 s_add_u32 s62, s68, s65
 s_lshl_b32 s64, s61, 3
 s_add_u32 s64, s64, s63
 s_xor_b32 s3, s65, s63
 s_and_b32 s80, s3, 1
 s_lshr_b32 s68, s68, 2
 s_xor_b32 s68, s68, s61
 s_lshl_b32 s68, s68, 1
 s_and_b32 s68, s68, 6
 s_or_b32 s80, s80, s68
 s_mov_b32 s26, 4194304
 s_mov_b32 s27, 0x20000
 s_mov_b32 s30, 2097152
 s_mov_b32 s31, 0x20000
 s_mov_b32 s34, 7340032
 s_mov_b32 s35, 0x20000
 v_lshrrev_b32 v193, 4, v0
 v_and_b32 v194, 7, v0
 v_xor_b32 v194, v194, v193
 v_lshlrev_b32 v194, 4, v194
 v_lshrrev_b32 v196, 5, v0
 v_lshlrev_b32 v196, 4, v196
 v_and_b32 v1, 1, v193
 v_and_b32 v195, 8, v0
 v_add3_u32 v195, v195, v196, v1
 s_lshl_b32 s68, s62, 2
 s_add_u32 s68, s68, s60
 s_lshl_b32 s68, s68, 6
 v_add_u32 v195, s68, v195
 v_lshl_add_u32 v2, v195, 11, v194
 v_xor_b32 v3, 64, v2
 v_add_u32 v3, 64512, v3
 s_lshl_b32 s76, s60, 13
 s_add_u32 s76, s76, 75264
 v_lshrrev_b32 v192, 3, v0
 s_lshr_b32 s70, s60, 1
 s_lshl_b32 s68, s70, 4
 s_lshl_b32 s69, s64, 5
 s_add_u32 s68, s68, s69
 v_add_u32 v195, s68, v192
 v_lshl_add_u32 v4, v195, 11, v194
 v_xor_b32 v5, 64, v4
 v_add_u32 v5, 15360, v5
 s_lshl_b32 s68, s70, 5
 s_and_b32 s69, s60, 1
 s_lshl_b32 s69, s69, 3
 s_add_u32 s68, s68, s69
 v_lshl_add_u32 v195, v1, 2, v196
 v_add_u32 v195, s68, v195
 v_mul_u32_u24 v195, 7168, v195
 v_and_b32 v197, 15, v0
 s_and_b32 s69, s64, 1
 s_lshl_b32 s69, s69, 1
 v_add_u32 v194, s69, v197
 v_subrev_u32 v1, 14, v194
 v_min_u32 v194, v194, v1
 s_mul_i32 s68, s64, 224
 v_lshl_add_u32 v195, v194, 4, v195
 v_add_u32 v6, s68, v195
 v_add_u32 v7, 6112, v6
 v_add_u32 v8, 12224, v6
 v_add_u32 v9, 18336, v6
 s_mul_i32 s74, s60, 4224
 s_lshl_b32 s75, s60, 11
 s_add_u32 s75, s75, 50688
 s_waitcnt lgkmcnt(0)
 s_bitcmp1_b32 s60, 0
 s_cselect_b32 s28, s10, s8
 s_cselect_b32 s29, s11, s9
 s_and_b32 s77, s80, 15
 s_xor_b32 s77, s77, 0
 s_lshl_b32 s77, s77, 7
 s_add_u32 m0, s76, 0
 s_add_u32 s79, s77, 0
 buffer_load_dwordx4 v2, s[24:27], s79 offen offset:0 lds
 buffer_load_dwordx4 v3, s[24:27], s79 offen offset:1024 lds
 s_add_u32 m0, s76, 2048
 s_add_u32 s79, s77, 4096
 buffer_load_dwordx4 v2, s[24:27], s79 offen offset:0 lds
 buffer_load_dwordx4 v3, s[24:27], s79 offen offset:1024 lds
 s_add_u32 m0, s76, 4096
 s_add_u32 s79, s77, 8192
 buffer_load_dwordx4 v2, s[24:27], s79 offen offset:0 lds
 buffer_load_dwordx4 v3, s[24:27], s79 offen offset:1024 lds
 s_add_u32 m0, s76, 6144
 s_add_u32 s79, s77, 12288
 buffer_load_dwordx4 v2, s[24:27], s79 offen offset:0 lds
 buffer_load_dwordx4 v3, s[24:27], s79 offen offset:1024 lds
 s_add_u32 m0, s74, 0
 s_mul_i32 s78, s77, 3584
 buffer_load_dwordx4 v6, s[32:35], s78 offen offset:0 lds
 buffer_load_dwordx4 v7, s[32:35], s78 offen offset:1056 lds
 buffer_load_dwordx4 v8, s[32:35], s78 offen offset:2112 lds
 buffer_load_dwordx4 v9, s[32:35], s78 offen offset:3168 lds
 s_add_u32 m0, s75, 0
 s_nop 0
 buffer_load_dwordx4 v4, s[28:31], s77 offen offset:0 lds
 buffer_load_dwordx4 v5, s[28:31], s77 offen offset:1024 lds
 v_lshl_add_u32 v193, v193, 3, s68
 s_lshl_b32 s69, s69, 4
 v_add_u32 v192, s69, v193
 s_cmp_eq_u32 s69, 0
 s_cselect_b32 s69, 192, 0
 v_add_u32 v193, s69, v193
 global_load_dwordx2 v[200:201], v192, s[16:17] offset:0
 global_load_dwordx2 v[202:203], v192, s[16:17] offset:32
 global_load_dwordx2 v[204:205], v192, s[16:17] offset:64
 global_load_dwordx2 v[206:207], v192, s[16:17] offset:96
 global_load_dwordx2 v[208:209], v192, s[16:17] offset:128
 global_load_dwordx2 v[210:211], v192, s[16:17] offset:160
 global_load_dwordx2 v[212:213], v193, s[16:17] offset:0
 s_load_dwordx4 s[12:15], s[0:1], 56
 s_load_dwordx2 s[48:49], s[0:1], 136
 s_load_dwordx2 s[56:57], s[0:1], 128
 s_load_dwordx2 s[40:41], s[0:1], 40
 s_load_dwordx2 s[44:45], s[0:1], 48
 s_load_dwordx2 s[36:37], s[0:1], 96
 s_load_dwordx4 s[20:23], s[0:1], 104
 s_load_dwordx2 s[52:53], s[0:1], 120
 s_mov_b32 s50, 42450944
 s_mov_b32 s51, 0x20000
 s_mov_b32 s58, 256
 s_mov_b32 s59, 0x20000
 s_mov_b32 s38, 7340032
 s_mov_b32 s39, 0x20000
 s_mov_b32 s42, 2097152
 s_mov_b32 s43, 0x20000
 s_mov_b32 s46, 2097152
 s_mov_b32 s47, 0x20000
 s_mov_b32 s54, 8388608
 s_mov_b32 s55, 0x20000
 s_lshr_b32 s68, s2, 3
 s_lshl_b32 s68, s68, 2
 s_add_u32 s68, s68, s60
 s_lshl_b32 s68, s68, 9
 v_lshlrev_b32 v194, 7, v0
 v_min_u32 v194, 384, v194
 v_add_u32 v194, s68, v194
 v_min_u32 v194, L_end-L_pc-4, v194
 global_load_dword v15, v194, s[18:19]
 v_lshrrev_b32 v193, 4, v0
 v_lshrrev_b32 v194, 1, v197
 v_xor_b32 v194, v194, v193
 v_lshlrev_b32 v194, 4, v194
 v_lshl_add_u32 v194, v197, 7, v194
 v_add_u32 v10, s76, v194
 v_xor_b32 v11, 64, v10
 v_add_u32 v12, 50688, v194
 v_xor_b32 v13, 64, v12
 v_bfe_u32 v194, v0, 2, 3
 v_mul_u32_u24 v194, 1056, v194
 v_lshl_add_u32 v194, v196, 5, v194
 v_and_b32 v193, 3, v0
 v_lshl_add_u32 v14, v193, 3, v194
 s_and_b32 s77, s80, 15
 s_xor_b32 s77, s77, 1
 s_lshl_b32 s77, s77, 7
 s_add_u32 m0, s76, 32768
 s_add_u32 s79, s77, 0
 buffer_load_dwordx4 v2, s[24:27], s79 offen offset:0 lds
 buffer_load_dwordx4 v3, s[24:27], s79 offen offset:1024 lds
 s_add_u32 m0, s76, 34816
 s_add_u32 s79, s77, 4096
 buffer_load_dwordx4 v2, s[24:27], s79 offen offset:0 lds
 buffer_load_dwordx4 v3, s[24:27], s79 offen offset:1024 lds
 s_add_u32 m0, s76, 36864
 s_add_u32 s79, s77, 8192
 buffer_load_dwordx4 v2, s[24:27], s79 offen offset:0 lds
 buffer_load_dwordx4 v3, s[24:27], s79 offen offset:1024 lds
 s_add_u32 m0, s76, 38912
 s_add_u32 s79, s77, 12288
 buffer_load_dwordx4 v2, s[24:27], s79 offen offset:0 lds
 buffer_load_dwordx4 v3, s[24:27], s79 offen offset:1024 lds
 s_waitcnt lgkmcnt(0)
 s_mov_b64 exec, 0
 s_cmp_eq_u32 s60, 0
 s_cbranch_scc1 L_pad0
 s_cmp_eq_u32 s60, 1
 s_cbranch_scc1 L_pad1
 s_cmp_eq_u32 s60, 2
 s_cbranch_scc1 L_pad2
 s_branch L_pad3
.p2align 12
L_main:
 s_mov_b64 exec, -1
 s_waitcnt vmcnt(22) lgkmcnt(0)
 ds_read_b128 a[24:27], v10 offset:0
 ds_read_b128 a[28:31], v11 offset:0
 ds_read_b128 a[32:35], v10 offset:2048
 ds_read_b128 a[36:39], v11 offset:2048
 ds_read_b128 a[40:43], v10 offset:4096
 ds_read_b128 a[44:47], v11 offset:4096
 ds_read_b128 a[48:51], v10 offset:6144
 ds_read_b128 a[52:55], v11 offset:6144
 s_waitcnt vmcnt(9)
 s_barrier
 ds_read_b64_tr_b16 a[0:1], v14 offset:0
 ds_read_b64_tr_b16 a[2:3], v14 offset:256
 ds_read_b64_tr_b16 a[4:5], v14 offset:8448
 ds_read_b64_tr_b16 a[6:7], v14 offset:8704
 ds_read_b64_tr_b16 a[8:9], v14 offset:32
 ds_read_b64_tr_b16 a[10:11], v14 offset:288
 ds_read_b64_tr_b16 a[12:13], v14 offset:8480
 ds_read_b64_tr_b16 a[14:15], v14 offset:8736
 v_lshlrev_b32 v32, 16, v200
 v_and_b32 v33, 0xffff0000, v200
 v_lshlrev_b32 v34, 16, v201
 v_and_b32 v35, 0xffff0000, v201
 v_lshlrev_b32 v36, 16, v202
 v_and_b32 v37, 0xffff0000, v202
 v_lshlrev_b32 v38, 16, v203
 v_and_b32 v39, 0xffff0000, v203
 v_lshlrev_b32 v40, 16, v204
 v_and_b32 v41, 0xffff0000, v204
 v_lshlrev_b32 v42, 16, v205
 v_and_b32 v43, 0xffff0000, v205
 v_lshlrev_b32 v44, 16, v206
 v_and_b32 v45, 0xffff0000, v206
 v_lshlrev_b32 v46, 16, v207
 v_and_b32 v47, 0xffff0000, v207
 v_lshlrev_b32 v48, 16, v208
 v_and_b32 v49, 0xffff0000, v208
 v_lshlrev_b32 v50, 16, v209
 v_and_b32 v51, 0xffff0000, v209
 v_lshlrev_b32 v52, 16, v210
 v_and_b32 v53, 0xffff0000, v210
 v_lshlrev_b32 v54, 16, v211
 v_and_b32 v55, 0xffff0000, v211
 v_lshlrev_b32 v56, 16, v212
 v_and_b32 v57, 0xffff0000, v212
 v_lshlrev_b32 v58, 16, v213
 v_and_b32 v59, 0xffff0000, v213
 s_waitcnt lgkmcnt(4)
 v_mfma_f32_16x16x32_bf16 v[80:83], a[0:3], a[24:27], v[32:35]
 ds_read_b64_tr_b16 a[16:17], v14 offset:64
 s_add_u32 m0, s74, 16896
 v_mfma_f32_16x16x32_bf16 v[80:83], a[4:7], a[28:31], v[80:83]
 ds_read_b64_tr_b16 a[18:19], v14 offset:320
 s_mul_i32 s78, s77, 3584
 v_mfma_f32_16x16x32_bf16 v[84:87], a[4:7], a[36:39], v[32:35]
 ds_read_b64_tr_b16 a[20:21], v14 offset:8512
 buffer_load_dwordx4 v6, s[32:35], s78 offen offset:0 lds
 v_mfma_f32_16x16x32_bf16 v[84:87], a[0:3], a[32:35], v[84:87]
 ds_read_b64_tr_b16 a[22:23], v14 offset:8768
 v_mfma_f32_16x16x32_bf16 v[88:91], a[0:3], a[40:43], v[32:35]
 v_mfma_f32_16x16x32_bf16 v[88:91], a[4:7], a[44:47], v[88:91]
 v_mfma_f32_16x16x32_bf16 v[92:95], a[4:7], a[52:55], v[32:35]
 buffer_load_dwordx4 v7, s[32:35], s78 offen offset:1056 lds
 v_mfma_f32_16x16x32_bf16 v[92:95], a[0:3], a[48:51], v[92:95]
 s_waitcnt lgkmcnt(4)
 v_mfma_f32_16x16x32_bf16 v[128:131], a[8:11], a[24:27], v[36:39]
 ds_read_b64_tr_b16 a[0:1], v14 offset:96
 v_mfma_f32_16x16x32_bf16 v[128:131], a[12:15], a[28:31], v[128:131]
 ds_read_b64_tr_b16 a[2:3], v14 offset:352
 v_mfma_f32_16x16x32_bf16 v[132:135], a[12:15], a[36:39], v[36:39]
 ds_read_b64_tr_b16 a[4:5], v14 offset:8544
 buffer_load_dwordx4 v8, s[32:35], s78 offen offset:2112 lds
 v_mfma_f32_16x16x32_bf16 v[132:135], a[8:11], a[32:35], v[132:135]
 ds_read_b64_tr_b16 a[6:7], v14 offset:8800
 v_mfma_f32_16x16x32_bf16 v[136:139], a[8:11], a[40:43], v[36:39]
 v_mfma_f32_16x16x32_bf16 v[136:139], a[12:15], a[44:47], v[136:139]
 v_mfma_f32_16x16x32_bf16 v[140:143], a[12:15], a[52:55], v[36:39]
 v_mfma_f32_16x16x32_bf16 v[140:143], a[8:11], a[48:51], v[140:143]
 buffer_load_dwordx4 v9, s[32:35], s78 offen offset:3168 lds
 s_waitcnt lgkmcnt(4)
 v_mfma_f32_16x16x32_bf16 v[96:99], a[16:19], a[24:27], v[40:43]
 ds_read_b64_tr_b16 a[8:9], v14 offset:128
 s_add_u32 m0, s75, 8192
 v_mfma_f32_16x16x32_bf16 v[96:99], a[20:23], a[28:31], v[96:99]
 ds_read_b64_tr_b16 a[10:11], v14 offset:384
 s_nop 0
 v_mfma_f32_16x16x32_bf16 v[100:103], a[20:23], a[36:39], v[40:43]
 ds_read_b64_tr_b16 a[12:13], v14 offset:8576
 v_mfma_f32_16x16x32_bf16 v[100:103], a[16:19], a[32:35], v[100:103]
 ds_read_b64_tr_b16 a[14:15], v14 offset:8832
 buffer_load_dwordx4 v4, s[28:31], s77 offen offset:0 lds
 v_mfma_f32_16x16x32_bf16 v[104:107], a[16:19], a[40:43], v[40:43]
 v_mfma_f32_16x16x32_bf16 v[104:107], a[20:23], a[44:47], v[104:107]
 v_mfma_f32_16x16x32_bf16 v[108:111], a[20:23], a[52:55], v[40:43]
 v_mfma_f32_16x16x32_bf16 v[108:111], a[16:19], a[48:51], v[108:111]
 buffer_load_dwordx4 v5, s[28:31], s77 offen offset:1024 lds
 s_waitcnt lgkmcnt(4)
 v_mfma_f32_16x16x32_bf16 v[144:147], a[0:3], a[24:27], v[44:47]
 ds_read_b64_tr_b16 a[16:17], v14 offset:160
 s_and_b32 s77, s80, 15
 v_mfma_f32_16x16x32_bf16 v[144:147], a[4:7], a[28:31], v[144:147]
 ds_read_b64_tr_b16 a[18:19], v14 offset:416
 s_xor_b32 s77, s77, 2
 v_mfma_f32_16x16x32_bf16 v[148:151], a[4:7], a[36:39], v[44:47]
 ds_read_b64_tr_b16 a[20:21], v14 offset:8608
 s_lshl_b32 s77, s77, 7
 v_mfma_f32_16x16x32_bf16 v[148:151], a[0:3], a[32:35], v[148:151]
 ds_read_b64_tr_b16 a[22:23], v14 offset:8864
 s_add_u32 m0, s76, 0
 v_mfma_f32_16x16x32_bf16 v[152:155], a[0:3], a[40:43], v[44:47]
 s_add_u32 s79, s77, 0
 buffer_load_dwordx4 v2, s[24:27], s79 offen offset:0 lds
 v_mfma_f32_16x16x32_bf16 v[152:155], a[4:7], a[44:47], v[152:155]
 v_mfma_f32_16x16x32_bf16 v[156:159], a[4:7], a[52:55], v[44:47]
 v_mfma_f32_16x16x32_bf16 v[156:159], a[0:3], a[48:51], v[156:159]
 s_waitcnt lgkmcnt(4)
 v_mfma_f32_16x16x32_bf16 v[112:115], a[8:11], a[24:27], v[48:51]
 ds_read_b64_tr_b16 a[0:1], v14 offset:192
 buffer_load_dwordx4 v3, s[24:27], s79 offen offset:1024 lds
 v_mfma_f32_16x16x32_bf16 v[112:115], a[12:15], a[28:31], v[112:115]
 ds_read_b64_tr_b16 a[2:3], v14 offset:448
 s_add_u32 m0, s76, 2048
 v_mfma_f32_16x16x32_bf16 v[116:119], a[12:15], a[36:39], v[48:51]
 ds_read_b64_tr_b16 a[4:5], v14 offset:8640
 s_add_u32 s79, s77, 4096
 v_mfma_f32_16x16x32_bf16 v[116:119], a[8:11], a[32:35], v[116:119]
 ds_read_b64_tr_b16 a[6:7], v14 offset:8896
 v_mfma_f32_16x16x32_bf16 v[120:123], a[8:11], a[40:43], v[48:51]
 v_mfma_f32_16x16x32_bf16 v[120:123], a[12:15], a[44:47], v[120:123]
 buffer_load_dwordx4 v2, s[24:27], s79 offen offset:0 lds
 v_mfma_f32_16x16x32_bf16 v[124:127], a[12:15], a[52:55], v[48:51]
 v_mfma_f32_16x16x32_bf16 v[124:127], a[8:11], a[48:51], v[124:127]
 s_waitcnt vmcnt(15) lgkmcnt(4)
 v_mfma_f32_16x16x32_bf16 v[160:163], a[16:19], a[24:27], v[52:55]
 ds_read_b128 a[8:11], v12 offset:0
 v_mfma_f32_16x16x32_bf16 v[160:163], a[20:23], a[28:31], v[160:163]
 ds_read_b128 a[12:15], v13 offset:0
 buffer_load_dwordx4 v3, s[24:27], s79 offen offset:1024 lds
 v_mfma_f32_16x16x32_bf16 v[164:167], a[20:23], a[36:39], v[52:55]
 ds_read_b128 a[56:59], v10 offset:32768
 s_add_u32 m0, s76, 4096
 v_mfma_f32_16x16x32_bf16 v[164:167], a[16:19], a[32:35], v[164:167]
 ds_read_b128 a[60:63], v11 offset:32768
 s_add_u32 s79, s77, 8192
 v_mfma_f32_16x16x32_bf16 v[168:171], a[16:19], a[40:43], v[52:55]
 v_mfma_f32_16x16x32_bf16 v[168:171], a[20:23], a[44:47], v[168:171]
 buffer_load_dwordx4 v2, s[24:27], s79 offen offset:0 lds
 v_mfma_f32_16x16x32_bf16 v[172:175], a[20:23], a[52:55], v[52:55]
 v_mfma_f32_16x16x32_bf16 v[172:175], a[16:19], a[48:51], v[172:175]
 s_waitcnt vmcnt(15) lgkmcnt(4)
 v_mfma_f32_16x16x32_bf16 v[176:179], a[0:3], a[24:27], v[56:59]
 ds_read_b128 a[16:19], v12 offset:2048
 v_mfma_f32_16x16x32_bf16 v[176:179], a[4:7], a[28:31], v[176:179]
 ds_read_b128 a[20:23], v13 offset:2048
 v_mfma_f32_16x16x32_bf16 v[180:183], a[4:7], a[36:39], v[56:59]
 ds_read_b128 a[64:67], v10 offset:34816
 buffer_load_dwordx4 v3, s[24:27], s79 offen offset:1024 lds
 v_mfma_f32_16x16x32_bf16 v[180:183], a[0:3], a[32:35], v[180:183]
 ds_read_b128 a[68:71], v11 offset:34816
 s_add_u32 m0, s76, 6144
 v_mfma_f32_16x16x32_bf16 v[184:187], a[0:3], a[40:43], v[56:59]
 s_add_u32 s79, s77, 12288
 v_mfma_f32_16x16x32_bf16 v[184:187], a[4:7], a[44:47], v[184:187]
 v_mfma_f32_16x16x32_bf16 v[188:191], a[4:7], a[52:55], v[56:59]
 buffer_load_dwordx4 v2, s[24:27], s79 offen offset:0 lds
 v_mfma_f32_16x16x32_bf16 v[188:191], a[0:3], a[48:51], v[188:191]
 s_waitcnt vmcnt(15) lgkmcnt(6)
 v_mfma_f32_16x16x32_bf16 v[192:195], a[24:27], a[8:11], 0
 ds_read_b128 a[0:3], v12 offset:4096
 v_mfma_f32_16x16x32_bf16 v[192:195], a[28:31], a[12:15], v[192:195]
 ds_read_b128 a[4:7], v13 offset:4096
 v_mfma_f32_16x16x32_bf16 v[196:199], a[36:39], a[12:15], 0
 ds_read_b128 a[72:75], v10 offset:36864
 buffer_load_dwordx4 v3, s[24:27], s79 offen offset:1024 lds
 v_mfma_f32_16x16x32_bf16 v[196:199], a[32:35], a[8:11], v[196:199]
 ds_read_b128 a[76:79], v11 offset:36864
 s_add_u32 m0, s74, 33792
 v_mfma_f32_16x16x32_bf16 v[200:203], a[40:43], a[8:11], 0
 s_mul_i32 s78, s77, 3584
 v_mfma_f32_16x16x32_bf16 v[200:203], a[44:47], a[12:15], v[200:203]
 v_mfma_f32_16x16x32_bf16 v[204:207], a[52:55], a[12:15], 0
 v_mfma_f32_16x16x32_bf16 v[204:207], a[48:51], a[8:11], v[204:207]
 buffer_load_dwordx4 v6, s[32:35], s78 offen offset:0 lds
 s_waitcnt vmcnt(15) lgkmcnt(6)
 v_mfma_f32_16x16x32_bf16 v[208:211], a[24:27], a[16:19], 0
 ds_read_b128 a[8:11], v12 offset:6144
 v_mfma_f32_16x16x32_bf16 v[208:211], a[28:31], a[20:23], v[208:211]
 ds_read_b128 a[12:15], v13 offset:6144
 v_mfma_f32_16x16x32_bf16 v[212:215], a[36:39], a[20:23], 0
 ds_read_b128 a[80:83], v10 offset:38912
 v_mfma_f32_16x16x32_bf16 v[212:215], a[32:35], a[16:19], v[212:215]
 ds_read_b128 a[84:87], v11 offset:38912
 buffer_load_dwordx4 v7, s[32:35], s78 offen offset:1056 lds
 v_mfma_f32_16x16x32_bf16 v[216:219], a[40:43], a[16:19], 0
 v_mfma_f32_16x16x32_bf16 v[216:219], a[44:47], a[20:23], v[216:219]
 v_mfma_f32_16x16x32_bf16 v[220:223], a[52:55], a[20:23], 0
 v_mfma_f32_16x16x32_bf16 v[220:223], a[48:51], a[16:19], v[220:223]
 s_waitcnt vmcnt(10) lgkmcnt(2)
 s_barrier
 v_mfma_f32_16x16x32_bf16 v[224:227], a[24:27], a[0:3], 0
 ds_read_b64_tr_b16 a[16:17], v14 offset:16896
 buffer_load_dwordx4 v8, s[32:35], s78 offen offset:2112 lds
 v_mfma_f32_16x16x32_bf16 v[224:227], a[28:31], a[4:7], v[224:227]
 ds_read_b64_tr_b16 a[18:19], v14 offset:17152
 v_mfma_f32_16x16x32_bf16 v[228:231], a[36:39], a[4:7], 0
 ds_read_b64_tr_b16 a[20:21], v14 offset:25344
 v_mfma_f32_16x16x32_bf16 v[228:231], a[32:35], a[0:3], v[228:231]
 ds_read_b64_tr_b16 a[22:23], v14 offset:25600
 v_mfma_f32_16x16x32_bf16 v[232:235], a[40:43], a[0:3], 0
 buffer_load_dwordx4 v9, s[32:35], s78 offen offset:3168 lds
 s_add_u32 m0, s75, 16384
 v_mfma_f32_16x16x32_bf16 v[232:235], a[44:47], a[4:7], v[232:235]
 s_nop 0
 v_mfma_f32_16x16x32_bf16 v[236:239], a[52:55], a[4:7], 0
 v_mfma_f32_16x16x32_bf16 v[236:239], a[48:51], a[0:3], v[236:239]
 s_waitcnt lgkmcnt(6)
 v_mfma_f32_16x16x32_bf16 v[240:243], a[24:27], a[8:11], 0
 ds_read_b64_tr_b16 a[0:1], v14 offset:16928
 buffer_load_dwordx4 v4, s[28:31], s77 offen offset:0 lds
 v_mfma_f32_16x16x32_bf16 v[240:243], a[28:31], a[12:15], v[240:243]
 ds_read_b64_tr_b16 a[2:3], v14 offset:17184
 v_mfma_f32_16x16x32_bf16 v[244:247], a[36:39], a[12:15], 0
 ds_read_b64_tr_b16 a[4:5], v14 offset:25376
 v_mfma_f32_16x16x32_bf16 v[244:247], a[32:35], a[8:11], v[244:247]
 ds_read_b64_tr_b16 a[6:7], v14 offset:25632
 v_mfma_f32_16x16x32_bf16 v[248:251], a[40:43], a[8:11], 0
 v_mfma_f32_16x16x32_bf16 v[248:251], a[44:47], a[12:15], v[248:251]
 buffer_load_dwordx4 v5, s[28:31], s77 offen offset:1024 lds
 s_and_b32 s77, s80, 15
 v_mfma_f32_16x16x32_bf16 v[252:255], a[52:55], a[12:15], 0
 s_xor_b32 s77, s77, 3
 s_lshl_b32 s77, s77, 7
 s_add_u32 m0, s76, 32768
 v_mfma_f32_16x16x32_bf16 v[252:255], a[48:51], a[8:11], v[252:255]
 s_add_u32 s79, s77, 0
 s_waitcnt lgkmcnt(4)
 v_mfma_f32_16x16x32_bf16 v[80:83], a[16:19], a[56:59], v[80:83]
 ds_read_b64_tr_b16 a[8:9], v14 offset:16960
 s_lshl_b32 s72, s62, 2
 v_mfma_f32_16x16x32_bf16 v[80:83], a[20:23], a[60:63], v[80:83]
 ds_read_b64_tr_b16 a[10:11], v14 offset:17216
 buffer_load_dwordx4 v2, s[24:27], s79 offen offset:0 lds
 v_mfma_f32_16x16x32_bf16 v[84:87], a[20:23], a[68:71], v[84:87]
 ds_read_b64_tr_b16 a[12:13], v14 offset:25408
 s_add_u32 s72, s72, s60
 v_mfma_f32_16x16x32_bf16 v[84:87], a[16:19], a[64:67], v[84:87]
 ds_read_b64_tr_b16 a[14:15], v14 offset:25664
 s_lshl_b32 s72, s72, 2
 v_mfma_f32_16x16x32_bf16 v[88:91], a[16:19], a[72:75], v[88:91]
 s_add_u32 s72, s72, s61
 s_lshl_b32 s101, s72, 7
 s_add_u32 s101, s101, 42024960
 v_mfma_f32_16x16x32_bf16 v[88:91], a[20:23], a[76:79], v[88:91]
 buffer_load_dwordx4 v3, s[24:27], s79 offen offset:1024 lds
 s_add_u32 m0, s76, 34816
 v_mfma_f32_16x16x32_bf16 v[92:95], a[20:23], a[84:87], v[92:95]
 s_add_u32 s79, s77, 4096
 s_lshl_b32 s72, s62, 3
 s_add_u32 s72, s72, s63
 v_mfma_f32_16x16x32_bf16 v[92:95], a[16:19], a[80:83], v[92:95]
 s_lshl_b32 s72, s72, 2
 s_add_u32 s72, s72, s60
 s_waitcnt lgkmcnt(4)
 v_mfma_f32_16x16x32_bf16 v[128:131], a[0:3], a[56:59], v[128:131]
 ds_read_b64_tr_b16 a[16:17], v14 offset:16992
 s_lshl_b32 s72, s72, 2
 v_mfma_f32_16x16x32_bf16 v[128:131], a[4:7], a[60:63], v[128:131]
 ds_read_b64_tr_b16 a[18:19], v14 offset:17248
 s_add_u32 s100, s72, s61
 v_mfma_f32_16x16x32_bf16 v[132:135], a[4:7], a[68:71], v[132:135]
 ds_read_b64_tr_b16 a[20:21], v14 offset:25440
 buffer_load_dwordx4 v2, s[24:27], s79 offen offset:0 lds
 v_mfma_f32_16x16x32_bf16 v[132:135], a[0:3], a[64:67], v[132:135]
 ds_read_b64_tr_b16 a[22:23], v14 offset:25696
 v_xor_b32 v76, s100, v0
 v_mfma_f32_16x16x32_bf16 v[136:139], a[0:3], a[72:75], v[136:139]
 v_lshlrev_b32 v76, 7, v76
 v_lshl_add_u32 v76, v0, 2, v76
 v_mfma_f32_16x16x32_bf16 v[136:139], a[4:7], a[76:79], v[136:139]
 v_add_u32 v76, 42041344, v76
 v_lshrrev_b32 v77, 2, v0
 v_mfma_f32_16x16x32_bf16 v[140:143], a[4:7], a[84:87], v[140:143]
 buffer_load_dwordx4 v3, s[24:27], s79 offen offset:1024 lds
 s_add_u32 m0, s76, 36864
 v_mfma_f32_16x16x32_bf16 v[140:143], a[0:3], a[80:83], v[140:143]
 s_add_u32 s79, s77, 8192
 v_lshl_add_u32 v76, v77, 26, v76
 s_waitcnt lgkmcnt(4)
 v_mfma_f32_16x16x32_bf16 v[96:99], a[8:11], a[56:59], v[96:99]
 ds_read_b64_tr_b16 a[0:1], v14 offset:17024
 s_lshl_b32 s72, s63, 2
 v_mfma_f32_16x16x32_bf16 v[96:99], a[12:15], a[60:63], v[96:99]
 ds_read_b64_tr_b16 a[2:3], v14 offset:17280
 s_add_u32 s72, s72, s101
 v_mfma_f32_16x16x32_bf16 v[100:103], a[12:15], a[68:71], v[100:103]
 ds_read_b64_tr_b16 a[4:5], v14 offset:25472
 v_writelane_b32 v76, s72, 0
 v_mfma_f32_16x16x32_bf16 v[100:103], a[8:11], a[64:67], v[100:103]
 ds_read_b64_tr_b16 a[6:7], v14 offset:25728
 buffer_load_dwordx4 v2, s[24:27], s79 offen offset:0 lds
 v_mfma_f32_16x16x32_bf16 v[104:107], a[8:11], a[72:75], v[104:107]
 v_mov_b32 v77, 0
 v_mfma_f32_16x16x32_bf16 v[104:107], a[12:15], a[76:79], v[104:107]
 v_mfma_f32_16x16x32_bf16 v[108:111], a[12:15], a[84:87], v[108:111]
 v_mfma_f32_16x16x32_bf16 v[108:111], a[8:11], a[80:83], v[108:111]
 buffer_store_dword v77, v76, s[48:51], 0 offen sc1
 s_waitcnt lgkmcnt(4)
 v_mfma_f32_16x16x32_bf16 v[144:147], a[16:19], a[56:59], v[144:147]
 ds_read_b64_tr_b16 a[8:9], v14 offset:17056
 s_lshl_b32 s72, s64, 3
 v_mfma_f32_16x16x32_bf16 v[144:147], a[20:23], a[60:63], v[144:147]
 ds_read_b64_tr_b16 a[10:11], v14 offset:17312
 buffer_load_dwordx4 v3, s[24:27], s79 offen offset:1024 lds
 v_mfma_f32_16x16x32_bf16 v[148:151], a[20:23], a[68:71], v[148:151]
 ds_read_b64_tr_b16 a[12:13], v14 offset:25504
 s_add_u32 m0, s76, 38912
 v_mfma_f32_16x16x32_bf16 v[148:151], a[16:19], a[64:67], v[148:151]
 ds_read_b64_tr_b16 a[14:15], v14 offset:25760
 s_add_u32 s79, s77, 12288
 v_mfma_f32_16x16x32_bf16 v[152:155], a[16:19], a[72:75], v[152:155]
 s_sub_u32 s72, s72, s62
 s_lshl_b32 s72, s72, 8
 s_add_u32 s72, s72, 41944832
 v_mfma_f32_16x16x32_bf16 v[152:155], a[20:23], a[76:79], v[152:155]
 buffer_load_dwordx4 v2, s[24:27], s79 offen offset:0 lds
 s_lshl_b32 s73, s60, 26
 v_mfma_f32_16x16x32_bf16 v[156:159], a[20:23], a[84:87], v[156:159]
 s_add_u32 s72, s72, s73
 v_lshlrev_b32 v78, 2, v0
 v_mov_b32 v79, -1
 v_mfma_f32_16x16x32_bf16 v[156:159], a[16:19], a[80:83], v[156:159]
 s_waitcnt lgkmcnt(4)
 v_mfma_f32_16x16x32_bf16 v[112:115], a[0:3], a[56:59], v[112:115]
 ds_read_b64_tr_b16 a[16:17], v14 offset:17088
 v_mfma_f32_16x16x32_bf16 v[112:115], a[4:7], a[60:63], v[112:115]
 ds_read_b64_tr_b16 a[18:19], v14 offset:17344
 v_mfma_f32_16x16x32_bf16 v[116:119], a[4:7], a[68:71], v[116:119]
 ds_read_b64_tr_b16 a[20:21], v14 offset:25536
 buffer_store_dword v79, v78, s[48:51], s72 offen sc1
 v_mfma_f32_16x16x32_bf16 v[116:119], a[0:3], a[64:67], v[116:119]
 ds_read_b64_tr_b16 a[22:23], v14 offset:25792
 v_mfma_f32_16x16x32_bf16 v[120:123], a[0:3], a[72:75], v[120:123]
 buffer_load_dwordx4 v3, s[24:27], s79 offen offset:1024 lds
 s_add_u32 m0, s74, 0
 v_mfma_f32_16x16x32_bf16 v[120:123], a[4:7], a[76:79], v[120:123]
 s_mul_i32 s78, s77, 3584
 v_mfma_f32_16x16x32_bf16 v[124:127], a[4:7], a[84:87], v[124:127]
 v_mfma_f32_16x16x32_bf16 v[124:127], a[0:3], a[80:83], v[124:127]
 s_waitcnt vmcnt(22) lgkmcnt(4)
 v_mfma_f32_16x16x32_bf16 v[160:163], a[8:11], a[56:59], v[160:163]
 ds_read_b128 a[0:3], v12 offset:8192
 buffer_load_dwordx4 v6, s[32:35], s78 offen offset:0 lds
 v_mfma_f32_16x16x32_bf16 v[160:163], a[12:15], a[60:63], v[160:163]
 ds_read_b128 a[4:7], v13 offset:8192
 v_mfma_f32_16x16x32_bf16 v[164:167], a[12:15], a[68:71], v[164:167]
 ds_read_b128 a[24:27], v10 offset:0
 v_mfma_f32_16x16x32_bf16 v[164:167], a[8:11], a[64:67], v[164:167]
 ds_read_b128 a[28:31], v11 offset:0
 v_mfma_f32_16x16x32_bf16 v[168:171], a[8:11], a[72:75], v[168:171]
 buffer_load_dwordx4 v7, s[32:35], s78 offen offset:1056 lds
 v_mfma_f32_16x16x32_bf16 v[168:171], a[12:15], a[76:79], v[168:171]
 v_mfma_f32_16x16x32_bf16 v[172:175], a[12:15], a[84:87], v[172:175]
 v_mfma_f32_16x16x32_bf16 v[172:175], a[8:11], a[80:83], v[172:175]
 s_waitcnt vmcnt(22) lgkmcnt(4)
 v_mfma_f32_16x16x32_bf16 v[176:179], a[16:19], a[56:59], v[176:179]
 ds_read_b128 a[8:11], v12 offset:10240
 v_mfma_f32_16x16x32_bf16 v[176:179], a[20:23], a[60:63], v[176:179]
 ds_read_b128 a[12:15], v13 offset:10240
 buffer_load_dwordx4 v8, s[32:35], s78 offen offset:2112 lds
 v_mfma_f32_16x16x32_bf16 v[180:183], a[20:23], a[68:71], v[180:183]
 ds_read_b128 a[32:35], v10 offset:2048
 v_mfma_f32_16x16x32_bf16 v[180:183], a[16:19], a[64:67], v[180:183]
 ds_read_b128 a[36:39], v11 offset:2048
 v_mfma_f32_16x16x32_bf16 v[184:187], a[16:19], a[72:75], v[184:187]
 v_mfma_f32_16x16x32_bf16 v[184:187], a[20:23], a[76:79], v[184:187]
 buffer_load_dwordx4 v9, s[32:35], s78 offen offset:3168 lds
 s_add_u32 m0, s75, 0
 v_mfma_f32_16x16x32_bf16 v[188:191], a[20:23], a[84:87], v[188:191]
 s_nop 0
 v_mfma_f32_16x16x32_bf16 v[188:191], a[16:19], a[80:83], v[188:191]
 s_waitcnt vmcnt(22) lgkmcnt(6)
 v_mfma_f32_16x16x32_bf16 v[192:195], a[56:59], a[0:3], v[192:195]
 ds_read_b128 a[16:19], v12 offset:12288
 v_mfma_f32_16x16x32_bf16 v[192:195], a[60:63], a[4:7], v[192:195]
 ds_read_b128 a[20:23], v13 offset:12288
 v_mfma_f32_16x16x32_bf16 v[196:199], a[68:71], a[4:7], v[196:199]
 ds_read_b128 a[40:43], v10 offset:4096
 buffer_load_dwordx4 v4, s[28:31], s77 offen offset:0 lds
 v_mfma_f32_16x16x32_bf16 v[196:199], a[64:67], a[0:3], v[196:199]
 ds_read_b128 a[44:47], v11 offset:4096
 v_mfma_f32_16x16x32_bf16 v[200:203], a[72:75], a[0:3], v[200:203]
 v_mfma_f32_16x16x32_bf16 v[200:203], a[76:79], a[4:7], v[200:203]
 v_mfma_f32_16x16x32_bf16 v[204:207], a[84:87], a[4:7], v[204:207]
 buffer_load_dwordx4 v5, s[28:31], s77 offen offset:1024 lds
 v_mfma_f32_16x16x32_bf16 v[204:207], a[80:83], a[0:3], v[204:207]
 s_waitcnt vmcnt(22) lgkmcnt(6)
 v_mfma_f32_16x16x32_bf16 v[208:211], a[56:59], a[8:11], v[208:211]
 ds_read_b128 a[0:3], v12 offset:14336
 s_and_b32 s77, s80, 15
 v_mfma_f32_16x16x32_bf16 v[208:211], a[60:63], a[12:15], v[208:211]
 ds_read_b128 a[4:7], v13 offset:14336
 s_xor_b32 s77, s77, 4
 v_mfma_f32_16x16x32_bf16 v[212:215], a[68:71], a[12:15], v[212:215]
 ds_read_b128 a[48:51], v10 offset:6144
 s_lshl_b32 s77, s77, 7
 v_mfma_f32_16x16x32_bf16 v[212:215], a[64:67], a[8:11], v[212:215]
 ds_read_b128 a[52:55], v11 offset:6144
 s_add_u32 m0, s76, 0
 v_mfma_f32_16x16x32_bf16 v[216:219], a[72:75], a[8:11], v[216:219]
 s_add_u32 s79, s77, 0
 buffer_load_dwordx4 v2, s[24:27], s79 offen offset:0 lds
 v_mfma_f32_16x16x32_bf16 v[216:219], a[76:79], a[12:15], v[216:219]
 s_lshl_b32 s72, s62, 5
 s_add_u32 s72, s72, s64
 s_lshl_b32 s72, s72, 2
 v_mfma_f32_16x16x32_bf16 v[220:223], a[84:87], a[12:15], v[220:223]
 s_add_u32 s72, s72, s60
 s_lshl_b32 s72, s72, 12
 v_and_b32 v76, 31, v0
 v_mfma_f32_16x16x32_bf16 v[220:223], a[80:83], a[8:11], v[220:223]
 s_waitcnt vmcnt(17) lgkmcnt(2)
 s_barrier
 v_mfma_f32_16x16x32_bf16 v[224:227], a[56:59], a[16:19], v[224:227]
 ds_read_b64_tr_b16 a[8:9], v14 offset:33792
 buffer_load_dwordx4 v3, s[24:27], s79 offen offset:1024 lds
 v_mfma_f32_16x16x32_bf16 v[224:227], a[60:63], a[20:23], v[224:227]
 ds_read_b64_tr_b16 a[10:11], v14 offset:34048
 s_add_u32 m0, s76, 2048
 v_mfma_f32_16x16x32_bf16 v[228:231], a[68:71], a[20:23], v[228:231]
 ds_read_b64_tr_b16 a[12:13], v14 offset:42240
 s_add_u32 s79, s77, 4096
 v_mfma_f32_16x16x32_bf16 v[228:231], a[64:67], a[16:19], v[228:231]
 ds_read_b64_tr_b16 a[14:15], v14 offset:42496
 v_lshlrev_b32 v76, 4, v76
 v_mfma_f32_16x16x32_bf16 v[232:235], a[72:75], a[16:19], v[232:235]
 buffer_load_dwordx4 v2, s[24:27], s79 offen offset:0 lds
 v_lshrrev_b32 v77, 5, v0
 v_mfma_f32_16x16x32_bf16 v[232:235], a[76:79], a[20:23], v[232:235]
 v_lshl_add_u32 v77, v77, 11, v76
 v_mfma_f32_16x16x32_bf16 v[236:239], a[84:87], a[20:23], v[236:239]
 v_mfma_f32_16x16x32_bf16 v[236:239], a[80:83], a[16:19], v[236:239]
 s_waitcnt lgkmcnt(6)
 v_mfma_f32_16x16x32_bf16 v[240:243], a[56:59], a[0:3], v[240:243]
 ds_read_b64_tr_b16 a[16:17], v14 offset:33824
 v_mfma_f32_16x16x32_bf16 v[240:243], a[60:63], a[4:7], v[240:243]
 ds_read_b64_tr_b16 a[18:19], v14 offset:34080
 buffer_load_dwordx4 v[16:19], v77, s[24:27], s72 offen offset:0
 v_mfma_f32_16x16x32_bf16 v[244:247], a[68:71], a[4:7], v[244:247]
 ds_read_b64_tr_b16 a[20:21], v14 offset:42272
 v_mfma_f32_16x16x32_bf16 v[244:247], a[64:67], a[0:3], v[244:247]
 ds_read_b64_tr_b16 a[22:23], v14 offset:42528
 v_mfma_f32_16x16x32_bf16 v[248:251], a[72:75], a[0:3], v[248:251]
 v_mfma_f32_16x16x32_bf16 v[248:251], a[76:79], a[4:7], v[248:251]
 buffer_load_dwordx4 v[20:23], v77, s[24:27], s72 offen offset:512
 v_mfma_f32_16x16x32_bf16 v[252:255], a[84:87], a[4:7], v[252:255]
 v_mfma_f32_16x16x32_bf16 v[252:255], a[80:83], a[0:3], v[252:255]
 s_waitcnt lgkmcnt(4)
 v_mfma_f32_16x16x32_bf16 v[80:83], a[8:11], a[24:27], v[80:83]
 ds_read_b64_tr_b16 a[0:1], v14 offset:33856
 v_mfma_f32_16x16x32_bf16 v[80:83], a[12:15], a[28:31], v[80:83]
 ds_read_b64_tr_b16 a[2:3], v14 offset:34112
 buffer_load_dwordx4 v[24:27], v77, s[24:27], s72 offen offset:1024
 v_mfma_f32_16x16x32_bf16 v[84:87], a[12:15], a[36:39], v[84:87]
 ds_read_b64_tr_b16 a[4:5], v14 offset:42304
 v_mfma_f32_16x16x32_bf16 v[84:87], a[8:11], a[32:35], v[84:87]
 ds_read_b64_tr_b16 a[6:7], v14 offset:42560
 v_mfma_f32_16x16x32_bf16 v[88:91], a[8:11], a[40:43], v[88:91]
 v_mfma_f32_16x16x32_bf16 v[88:91], a[12:15], a[44:47], v[88:91]
 v_mfma_f32_16x16x32_bf16 v[92:95], a[12:15], a[52:55], v[92:95]
 buffer_load_dwordx4 v[28:31], v77, s[24:27], s72 offen offset:1536
 v_mfma_f32_16x16x32_bf16 v[92:95], a[8:11], a[48:51], v[92:95]
 s_waitcnt lgkmcnt(4)
 v_mfma_f32_16x16x32_bf16 v[128:131], a[16:19], a[24:27], v[128:131]
 ds_read_b64_tr_b16 a[8:9], v14 offset:33888
 v_mfma_f32_16x16x32_bf16 v[128:131], a[20:23], a[28:31], v[128:131]
 ds_read_b64_tr_b16 a[10:11], v14 offset:34144
 v_mfma_f32_16x16x32_bf16 v[132:135], a[20:23], a[36:39], v[132:135]
 ds_read_b64_tr_b16 a[12:13], v14 offset:42336
 buffer_load_dwordx4 v3, s[24:27], s79 offen offset:1024 lds
 v_mfma_f32_16x16x32_bf16 v[132:135], a[16:19], a[32:35], v[132:135]
 ds_read_b64_tr_b16 a[14:15], v14 offset:42592
 s_add_u32 m0, s76, 4096
 v_mfma_f32_16x16x32_bf16 v[136:139], a[16:19], a[40:43], v[136:139]
 s_add_u32 s79, s77, 8192
 v_mfma_f32_16x16x32_bf16 v[136:139], a[20:23], a[44:47], v[136:139]
 v_mfma_f32_16x16x32_bf16 v[140:143], a[20:23], a[52:55], v[140:143]
 v_mfma_f32_16x16x32_bf16 v[140:143], a[16:19], a[48:51], v[140:143]
 buffer_load_dwordx4 v2, s[24:27], s79 offen offset:0 lds
 s_waitcnt lgkmcnt(4)
 v_mfma_f32_16x16x32_bf16 v[96:99], a[0:3], a[24:27], v[96:99]
 ds_read_b64_tr_b16 a[16:17], v14 offset:33920
 v_mfma_f32_16x16x32_bf16 v[96:99], a[4:7], a[28:31], v[96:99]
 ds_read_b64_tr_b16 a[18:19], v14 offset:34176
 v_mfma_f32_16x16x32_bf16 v[100:103], a[4:7], a[36:39], v[100:103]
 ds_read_b64_tr_b16 a[20:21], v14 offset:42368
 v_mfma_f32_16x16x32_bf16 v[100:103], a[0:3], a[32:35], v[100:103]
 ds_read_b64_tr_b16 a[22:23], v14 offset:42624
 global_load_dwordx4 v[60:63], v76, s[22:23] offset:0
 v_mfma_f32_16x16x32_bf16 v[104:107], a[0:3], a[40:43], v[104:107]
 v_mfma_f32_16x16x32_bf16 v[104:107], a[4:7], a[44:47], v[104:107]
 v_mfma_f32_16x16x32_bf16 v[108:111], a[4:7], a[52:55], v[108:111]
 v_mfma_f32_16x16x32_bf16 v[108:111], a[0:3], a[48:51], v[108:111]
 buffer_load_dwordx4 v3, s[24:27], s79 offen offset:1024 lds
 s_waitcnt lgkmcnt(4)
 v_mfma_f32_16x16x32_bf16 v[144:147], a[8:11], a[24:27], v[144:147]
 ds_read_b64_tr_b16 a[0:1], v14 offset:33952
 s_add_u32 m0, s76, 6144
 v_mfma_f32_16x16x32_bf16 v[144:147], a[12:15], a[28:31], v[144:147]
 ds_read_b64_tr_b16 a[2:3], v14 offset:34208
 s_add_u32 s79, s77, 12288
 v_mfma_f32_16x16x32_bf16 v[148:151], a[12:15], a[36:39], v[148:151]
 ds_read_b64_tr_b16 a[4:5], v14 offset:42400
 v_mfma_f32_16x16x32_bf16 v[148:151], a[8:11], a[32:35], v[148:151]
 ds_read_b64_tr_b16 a[6:7], v14 offset:42656
 v_mfma_f32_16x16x32_bf16 v[152:155], a[8:11], a[40:43], v[152:155]
 global_load_dwordx4 v[64:67], v76, s[22:23] offset:512
 v_mfma_f32_16x16x32_bf16 v[152:155], a[12:15], a[44:47], v[152:155]
 v_mfma_f32_16x16x32_bf16 v[156:159], a[12:15], a[52:55], v[156:159]
 v_mfma_f32_16x16x32_bf16 v[156:159], a[8:11], a[48:51], v[156:159]
 s_waitcnt lgkmcnt(4)
 v_mfma_f32_16x16x32_bf16 v[112:115], a[16:19], a[24:27], v[112:115]
 ds_read_b64_tr_b16 a[8:9], v14 offset:33984
 buffer_load_dwordx4 v2, s[24:27], s79 offen offset:0 lds
 v_mfma_f32_16x16x32_bf16 v[112:115], a[20:23], a[28:31], v[112:115]
 ds_read_b64_tr_b16 a[10:11], v14 offset:34240
 v_mfma_f32_16x16x32_bf16 v[116:119], a[20:23], a[36:39], v[116:119]
 ds_read_b64_tr_b16 a[12:13], v14 offset:42432
 v_mfma_f32_16x16x32_bf16 v[116:119], a[16:19], a[32:35], v[116:119]
 ds_read_b64_tr_b16 a[14:15], v14 offset:42688
 v_mfma_f32_16x16x32_bf16 v[120:123], a[16:19], a[40:43], v[120:123]
 global_load_dwordx4 v[68:71], v76, s[22:23] offset:1024
 v_mfma_f32_16x16x32_bf16 v[120:123], a[20:23], a[44:47], v[120:123]
 v_mfma_f32_16x16x32_bf16 v[124:127], a[20:23], a[52:55], v[124:127]
 v_mfma_f32_16x16x32_bf16 v[124:127], a[16:19], a[48:51], v[124:127]
 s_waitcnt vmcnt(28) lgkmcnt(4)
 v_mfma_f32_16x16x32_bf16 v[160:163], a[0:3], a[24:27], v[160:163]
 ds_read_b128 a[16:19], v12 offset:16384
 v_mfma_f32_16x16x32_bf16 v[160:163], a[4:7], a[28:31], v[160:163]
 ds_read_b128 a[20:23], v13 offset:16384
 buffer_load_dwordx4 v3, s[24:27], s79 offen offset:1024 lds
 v_mfma_f32_16x16x32_bf16 v[164:167], a[4:7], a[36:39], v[164:167]
 ds_read_b128 a[56:59], v10 offset:32768
 s_add_u32 m0, s74, 16896
 v_mfma_f32_16x16x32_bf16 v[164:167], a[0:3], a[32:35], v[164:167]
 ds_read_b128 a[60:63], v11 offset:32768
 s_mul_i32 s78, s77, 3584
 v_mfma_f32_16x16x32_bf16 v[168:171], a[0:3], a[40:43], v[168:171]
 v_mfma_f32_16x16x32_bf16 v[168:171], a[4:7], a[44:47], v[168:171]
 buffer_load_dwordx4 v6, s[32:35], s78 offen offset:0 lds
 v_mfma_f32_16x16x32_bf16 v[172:175], a[4:7], a[52:55], v[172:175]
 v_mfma_f32_16x16x32_bf16 v[172:175], a[0:3], a[48:51], v[172:175]
 s_waitcnt vmcnt(28) lgkmcnt(4)
 v_mfma_f32_16x16x32_bf16 v[176:179], a[8:11], a[24:27], v[176:179]
 ds_read_b128 a[0:3], v12 offset:18432
 v_mfma_f32_16x16x32_bf16 v[176:179], a[12:15], a[28:31], v[176:179]
 ds_read_b128 a[4:7], v13 offset:18432
 v_mfma_f32_16x16x32_bf16 v[180:183], a[12:15], a[36:39], v[180:183]
 ds_read_b128 a[64:67], v10 offset:34816
 global_load_dwordx4 v[72:75], v76, s[22:23] offset:1536
 v_mfma_f32_16x16x32_bf16 v[180:183], a[8:11], a[32:35], v[180:183]
 ds_read_b128 a[68:71], v11 offset:34816
 v_mfma_f32_16x16x32_bf16 v[184:187], a[8:11], a[40:43], v[184:187]
L_pad0:
 s_cbranch_execz L_pad4
 v_mfma_f32_16x16x32_bf16 v[184:187], a[12:15], a[44:47], v[184:187]
 v_mfma_f32_16x16x32_bf16 v[188:191], a[12:15], a[52:55], v[188:191]
 buffer_load_dwordx4 v7, s[32:35], s78 offen offset:1056 lds
 v_mfma_f32_16x16x32_bf16 v[188:191], a[8:11], a[48:51], v[188:191]
 s_waitcnt vmcnt(27) lgkmcnt(6)
 v_mfma_f32_16x16x32_bf16 v[192:195], a[24:27], a[16:19], v[192:195]
 ds_read_b128 a[8:11], v12 offset:20480
 v_and_b32 v78, 15, v0
 v_mfma_f32_16x16x32_bf16 v[192:195], a[28:31], a[20:23], v[192:195]
 ds_read_b128 a[12:15], v13 offset:20480
 s_lshl_b32 s72, s64, 6
 v_mfma_f32_16x16x32_bf16 v[196:199], a[36:39], a[20:23], v[196:199]
 ds_read_b128 a[72:75], v10 offset:36864
 buffer_load_dwordx4 v8, s[32:35], s78 offen offset:2112 lds
 v_mfma_f32_16x16x32_bf16 v[196:199], a[32:35], a[16:19], v[196:199]
 ds_read_b128 a[76:79], v11 offset:36864
 v_lshl_add_u32 v78, v78, 1, s72
 v_mfma_f32_16x16x32_bf16 v[200:203], a[40:43], a[16:19], v[200:203]
 v_mfma_f32_16x16x32_bf16 v[200:203], a[44:47], a[20:23], v[200:203]
 v_mfma_f32_16x16x32_bf16 v[204:207], a[52:55], a[20:23], v[204:207]
 v_mfma_f32_16x16x32_bf16 v[204:207], a[48:51], a[16:19], v[204:207]
 global_load_ushort v44, v78, s[4:5] offset:0
 s_waitcnt vmcnt(26) lgkmcnt(6)
 v_mfma_f32_16x16x32_bf16 v[208:211], a[24:27], a[0:3], v[208:211]
 ds_read_b128 a[16:19], v12 offset:22528
 v_mfma_f32_16x16x32_bf16 v[208:211], a[28:31], a[4:7], v[208:211]
 ds_read_b128 a[20:23], v13 offset:22528
 global_load_ushort v45, v78, s[6:7] offset:0
 v_mfma_f32_16x16x32_bf16 v[212:215], a[36:39], a[4:7], v[212:215]
 ds_read_b128 a[80:83], v10 offset:38912
 v_mfma_f32_16x16x32_bf16 v[212:215], a[32:35], a[0:3], v[212:215]
 ds_read_b128 a[84:87], v11 offset:38912
 global_load_ushort v40, v78, s[12:13] offset:0
 v_mfma_f32_16x16x32_bf16 v[216:219], a[40:43], a[0:3], v[216:219]
 v_mfma_f32_16x16x32_bf16 v[216:219], a[44:47], a[4:7], v[216:219]
 buffer_load_dwordx4 v9, s[32:35], s78 offen offset:3168 lds
 s_add_u32 m0, s75, 8192
 v_mfma_f32_16x16x32_bf16 v[220:223], a[52:55], a[4:7], v[220:223]
 s_nop 0
 v_mfma_f32_16x16x32_bf16 v[220:223], a[48:51], a[0:3], v[220:223]
 s_waitcnt vmcnt(23) lgkmcnt(2)
 s_barrier
 v_mfma_f32_16x16x32_bf16 v[224:227], a[24:27], a[8:11], v[224:227]
 ds_read_b64_tr_b16 a[0:1], v14 offset:0
 v_mfma_f32_16x16x32_bf16 v[224:227], a[28:31], a[12:15], v[224:227]
 ds_read_b64_tr_b16 a[2:3], v14 offset:256
 global_load_ushort v46, v78, s[4:5] offset:32
 v_mfma_f32_16x16x32_bf16 v[228:231], a[36:39], a[12:15], v[228:231]
 ds_read_b64_tr_b16 a[4:5], v14 offset:8448
 v_mfma_f32_16x16x32_bf16 v[228:231], a[32:35], a[8:11], v[228:231]
 ds_read_b64_tr_b16 a[6:7], v14 offset:8704
 buffer_load_dwordx4 v4, s[28:31], s77 offen offset:0 lds
 v_mfma_f32_16x16x32_bf16 v[232:235], a[40:43], a[8:11], v[232:235]
 v_mfma_f32_16x16x32_bf16 v[232:235], a[44:47], a[12:15], v[232:235]
 v_mfma_f32_16x16x32_bf16 v[236:239], a[52:55], a[12:15], v[236:239]
 v_mfma_f32_16x16x32_bf16 v[236:239], a[48:51], a[8:11], v[236:239]
 global_load_ushort v47, v78, s[6:7] offset:32
 s_waitcnt lgkmcnt(6)
 v_mfma_f32_16x16x32_bf16 v[240:243], a[24:27], a[16:19], v[240:243]
 ds_read_b64_tr_b16 a[8:9], v14 offset:32
 v_mfma_f32_16x16x32_bf16 v[240:243], a[28:31], a[20:23], v[240:243]
 ds_read_b64_tr_b16 a[10:11], v14 offset:288
 global_load_ushort v42, v78, s[12:13] offset:32
 v_mfma_f32_16x16x32_bf16 v[244:247], a[36:39], a[20:23], v[244:247]
 ds_read_b64_tr_b16 a[12:13], v14 offset:8480
 v_mfma_f32_16x16x32_bf16 v[244:247], a[32:35], a[16:19], v[244:247]
 ds_read_b64_tr_b16 a[14:15], v14 offset:8736
 buffer_load_dwordx4 v5, s[28:31], s77 offen offset:1024 lds
 v_mfma_f32_16x16x32_bf16 v[248:251], a[40:43], a[16:19], v[248:251]
 s_and_b32 s77, s80, 15
 s_xor_b32 s77, s77, 5
 s_lshl_b32 s77, s77, 7
 v_mfma_f32_16x16x32_bf16 v[248:251], a[44:47], a[20:23], v[248:251]
 s_add_u32 m0, s76, 32768
 s_add_u32 s79, s77, 0
 v_mfma_f32_16x16x32_bf16 v[252:255], a[52:55], a[20:23], v[252:255]
 v_mfma_f32_16x16x32_bf16 v[252:255], a[48:51], a[16:19], v[252:255]
 s_waitcnt lgkmcnt(4)
 v_mfma_f32_16x16x32_bf16 v[80:83], a[0:3], a[56:59], v[80:83]
 ds_read_b64_tr_b16 a[16:17], v14 offset:64
 buffer_load_dwordx4 v2, s[24:27], s79 offen offset:0 lds
 v_mfma_f32_16x16x32_bf16 v[80:83], a[4:7], a[60:63], v[80:83]
 ds_read_b64_tr_b16 a[18:19], v14 offset:320
 v_mfma_f32_16x16x32_bf16 v[84:87], a[4:7], a[68:71], v[84:87]
 ds_read_b64_tr_b16 a[20:21], v14 offset:8512
 v_mfma_f32_16x16x32_bf16 v[84:87], a[0:3], a[64:67], v[84:87]
 ds_read_b64_tr_b16 a[22:23], v14 offset:8768
 v_mfma_f32_16x16x32_bf16 v[88:91], a[0:3], a[72:75], v[88:91]
 buffer_load_dwordx4 v3, s[24:27], s79 offen offset:1024 lds
 s_add_u32 m0, s76, 34816
 v_mfma_f32_16x16x32_bf16 v[88:91], a[4:7], a[76:79], v[88:91]
 s_add_u32 s79, s77, 4096
 v_mfma_f32_16x16x32_bf16 v[92:95], a[4:7], a[84:87], v[92:95]
 v_mfma_f32_16x16x32_bf16 v[92:95], a[0:3], a[80:83], v[92:95]
 s_waitcnt lgkmcnt(4)
 v_mfma_f32_16x16x32_bf16 v[128:131], a[8:11], a[56:59], v[128:131]
 ds_read_b64_tr_b16 a[0:1], v14 offset:96
 v_mfma_f32_16x16x32_bf16 v[128:131], a[12:15], a[60:63], v[128:131]
 ds_read_b64_tr_b16 a[2:3], v14 offset:352
 buffer_load_dwordx4 v2, s[24:27], s79 offen offset:0 lds
 v_mfma_f32_16x16x32_bf16 v[132:135], a[12:15], a[68:71], v[132:135]
 ds_read_b64_tr_b16 a[4:5], v14 offset:8544
 v_mfma_f32_16x16x32_bf16 v[132:135], a[8:11], a[64:67], v[132:135]
 ds_read_b64_tr_b16 a[6:7], v14 offset:8800
 v_mfma_f32_16x16x32_bf16 v[136:139], a[8:11], a[72:75], v[136:139]
 v_mfma_f32_16x16x32_bf16 v[136:139], a[12:15], a[76:79], v[136:139]
 buffer_load_dwordx4 v3, s[24:27], s79 offen offset:1024 lds
 s_add_u32 m0, s76, 36864
 v_mfma_f32_16x16x32_bf16 v[140:143], a[12:15], a[84:87], v[140:143]
 s_add_u32 s79, s77, 8192
 v_mfma_f32_16x16x32_bf16 v[140:143], a[8:11], a[80:83], v[140:143]
 s_waitcnt lgkmcnt(4)
 v_mfma_f32_16x16x32_bf16 v[96:99], a[16:19], a[56:59], v[96:99]
 ds_read_b64_tr_b16 a[8:9], v14 offset:128
 v_mfma_f32_16x16x32_bf16 v[96:99], a[20:23], a[60:63], v[96:99]
 ds_read_b64_tr_b16 a[10:11], v14 offset:384
 buffer_load_dwordx4 v2, s[24:27], s79 offen offset:0 lds
 v_mfma_f32_16x16x32_bf16 v[100:103], a[20:23], a[68:71], v[100:103]
 ds_read_b64_tr_b16 a[12:13], v14 offset:8576
 v_mfma_f32_16x16x32_bf16 v[100:103], a[16:19], a[64:67], v[100:103]
 ds_read_b64_tr_b16 a[14:15], v14 offset:8832
 v_mfma_f32_16x16x32_bf16 v[104:107], a[16:19], a[72:75], v[104:107]
 v_mfma_f32_16x16x32_bf16 v[104:107], a[20:23], a[76:79], v[104:107]
 v_mfma_f32_16x16x32_bf16 v[108:111], a[20:23], a[84:87], v[108:111]
 buffer_load_dwordx4 v3, s[24:27], s79 offen offset:1024 lds
 s_add_u32 m0, s76, 38912
 v_mfma_f32_16x16x32_bf16 v[108:111], a[16:19], a[80:83], v[108:111]
 s_add_u32 s79, s77, 12288
 s_waitcnt lgkmcnt(4)
 v_mfma_f32_16x16x32_bf16 v[144:147], a[0:3], a[56:59], v[144:147]
 ds_read_b64_tr_b16 a[16:17], v14 offset:160
 v_mfma_f32_16x16x32_bf16 v[144:147], a[4:7], a[60:63], v[144:147]
 ds_read_b64_tr_b16 a[18:19], v14 offset:416
 v_mfma_f32_16x16x32_bf16 v[148:151], a[4:7], a[68:71], v[148:151]
 ds_read_b64_tr_b16 a[20:21], v14 offset:8608
 buffer_load_dwordx4 v2, s[24:27], s79 offen offset:0 lds
 v_mfma_f32_16x16x32_bf16 v[148:151], a[0:3], a[64:67], v[148:151]
 ds_read_b64_tr_b16 a[22:23], v14 offset:8864
 v_mfma_f32_16x16x32_bf16 v[152:155], a[0:3], a[72:75], v[152:155]
 v_mfma_f32_16x16x32_bf16 v[152:155], a[4:7], a[76:79], v[152:155]
 v_mfma_f32_16x16x32_bf16 v[156:159], a[4:7], a[84:87], v[156:159]
 buffer_load_dwordx4 v3, s[24:27], s79 offen offset:1024 lds
 s_add_u32 m0, s74, 33792
 v_mfma_f32_16x16x32_bf16 v[156:159], a[0:3], a[80:83], v[156:159]
 s_mul_i32 s78, s77, 3584
 s_waitcnt lgkmcnt(4)
 v_mfma_f32_16x16x32_bf16 v[112:115], a[8:11], a[56:59], v[112:115]
 ds_read_b64_tr_b16 a[0:1], v14 offset:192
 v_mfma_f32_16x16x32_bf16 v[112:115], a[12:15], a[60:63], v[112:115]
 ds_read_b64_tr_b16 a[2:3], v14 offset:448
 v_mfma_f32_16x16x32_bf16 v[116:119], a[12:15], a[68:71], v[116:119]
 ds_read_b64_tr_b16 a[4:5], v14 offset:8640
 v_mfma_f32_16x16x32_bf16 v[116:119], a[8:11], a[64:67], v[116:119]
 ds_read_b64_tr_b16 a[6:7], v14 offset:8896
 buffer_load_dwordx4 v6, s[32:35], s78 offen offset:0 lds
 v_mfma_f32_16x16x32_bf16 v[120:123], a[8:11], a[72:75], v[120:123]
 v_mfma_f32_16x16x32_bf16 v[120:123], a[12:15], a[76:79], v[120:123]
 v_mfma_f32_16x16x32_bf16 v[124:127], a[12:15], a[84:87], v[124:127]
 v_mfma_f32_16x16x32_bf16 v[124:127], a[8:11], a[80:83], v[124:127]
 buffer_load_dwordx4 v7, s[32:35], s78 offen offset:1056 lds
 s_waitcnt vmcnt(36) lgkmcnt(4)
 v_mfma_f32_16x16x32_bf16 v[160:163], a[16:19], a[56:59], v[160:163]
 ds_read_b128 a[8:11], v12 offset:0
 v_mfma_f32_16x16x32_bf16 v[160:163], a[20:23], a[60:63], v[160:163]
 ds_read_b128 a[12:15], v13 offset:0
 v_mfma_f32_16x16x32_bf16 v[164:167], a[20:23], a[68:71], v[164:167]
 ds_read_b128 a[24:27], v10 offset:0
 v_mfma_f32_16x16x32_bf16 v[164:167], a[16:19], a[64:67], v[164:167]
 ds_read_b128 a[28:31], v11 offset:0
 v_mfma_f32_16x16x32_bf16 v[168:171], a[16:19], a[72:75], v[168:171]
 buffer_load_dwordx4 v8, s[32:35], s78 offen offset:2112 lds
 v_mfma_f32_16x16x32_bf16 v[168:171], a[20:23], a[76:79], v[168:171]
 v_mfma_f32_16x16x32_bf16 v[172:175], a[20:23], a[84:87], v[172:175]
 v_mfma_f32_16x16x32_bf16 v[172:175], a[16:19], a[80:83], v[172:175]
 s_waitcnt vmcnt(31) lgkmcnt(4)
 v_mfma_f32_16x16x32_bf16 v[176:179], a[0:3], a[56:59], v[176:179]
 ds_read_b128 a[16:19], v12 offset:2048
 buffer_load_dwordx4 v9, s[32:35], s78 offen offset:3168 lds
 v_mfma_f32_16x16x32_bf16 v[176:179], a[4:7], a[60:63], v[176:179]
 ds_read_b128 a[20:23], v13 offset:2048
 s_add_u32 m0, s75, 16384
 v_mfma_f32_16x16x32_bf16 v[180:183], a[4:7], a[68:71], v[180:183]
 ds_read_b128 a[32:35], v10 offset:2048
 s_nop 0
 v_mfma_f32_16x16x32_bf16 v[180:183], a[0:3], a[64:67], v[180:183]
 ds_read_b128 a[36:39], v11 offset:2048
 v_mfma_f32_16x16x32_bf16 v[184:187], a[0:3], a[72:75], v[184:187]
 buffer_load_dwordx4 v4, s[28:31], s77 offen offset:0 lds
 v_mfma_f32_16x16x32_bf16 v[184:187], a[4:7], a[76:79], v[184:187]
 v_mfma_f32_16x16x32_bf16 v[188:191], a[4:7], a[84:87], v[188:191]
 s_lshl_b32 s70, s62, 2
 s_lshr_b32 s71, s63, 1
 s_add_u32 s70, s70, s71
 v_mfma_f32_16x16x32_bf16 v[188:191], a[0:3], a[80:83], v[188:191]
 s_lshl_b32 s70, s70, 2
 s_add_u32 s70, s70, s60
 s_waitcnt vmcnt(30) lgkmcnt(6)
 v_mfma_f32_16x16x32_bf16 v[192:195], a[56:59], a[8:11], v[192:195]
 ds_read_b128 a[0:3], v12 offset:4096
 s_lshl_b32 s71, s61, 7
 v_mfma_f32_16x16x32_bf16 v[192:195], a[60:63], a[12:15], v[192:195]
 ds_read_b128 a[4:7], v13 offset:4096
 buffer_load_dwordx4 v5, s[28:31], s77 offen offset:1024 lds
 v_mfma_f32_16x16x32_bf16 v[196:199], a[68:71], a[12:15], v[196:199]
 ds_read_b128 a[40:43], v10 offset:4096
 s_add_u32 s70, s70, s71
 v_mfma_f32_16x16x32_bf16 v[196:199], a[64:67], a[8:11], v[196:199]
 ds_read_b128 a[44:47], v11 offset:4096
 s_mul_i32 s70, s70, 14336
 v_mfma_f32_16x16x32_bf16 v[200:203], a[72:75], a[8:11], v[200:203]
 s_add_u32 s70, s70, 0
 v_min_u32 v1, 55, v0
 v_lshlrev_b32 v1, 7, v1
 v_mfma_f32_16x16x32_bf16 v[200:203], a[76:79], a[12:15], v[200:203]
 s_add_u32 s71, s63, 1
 s_and_b32 s71, s71, 2
 s_lshl_b32 s71, s71, 26
 v_mfma_f32_16x16x32_bf16 v[204:207], a[84:87], a[12:15], v[204:207]
 s_add_u32 s70, s70, s71
 v_mfma_f32_16x16x32_bf16 v[204:207], a[80:83], a[8:11], v[204:207]
 s_waitcnt vmcnt(27) lgkmcnt(6)
 v_mfma_f32_16x16x32_bf16 v[208:211], a[56:59], a[16:19], v[208:211]
 ds_read_b128 a[8:11], v12 offset:6144
 s_and_b32 s77, s80, 15
 v_mfma_f32_16x16x32_bf16 v[208:211], a[60:63], a[20:23], v[208:211]
 ds_read_b128 a[12:15], v13 offset:6144
 s_xor_b32 s77, s77, 6
 v_mfma_f32_16x16x32_bf16 v[212:215], a[68:71], a[20:23], v[212:215]
 ds_read_b128 a[48:51], v10 offset:6144
 buffer_load_dword a252, v1, s[36:39], s70 offen
 v_mfma_f32_16x16x32_bf16 v[212:215], a[64:67], a[16:19], v[212:215]
 ds_read_b128 a[52:55], v11 offset:6144
 s_lshl_b32 s77, s77, 7
 v_mfma_f32_16x16x32_bf16 v[216:219], a[72:75], a[16:19], v[216:219]
 s_add_u32 m0, s76, 0
 s_add_u32 s79, s77, 0
 v_mfma_f32_16x16x32_bf16 v[216:219], a[76:79], a[20:23], v[216:219]
 v_mfma_f32_16x16x32_bf16 v[220:223], a[84:87], a[20:23], v[220:223]
 v_mfma_f32_16x16x32_bf16 v[220:223], a[80:83], a[16:19], v[220:223]
 s_waitcnt vmcnt(15) lgkmcnt(2)
 s_barrier
 v_mfma_f32_16x16x32_bf16 v[224:227], a[56:59], a[0:3], v[224:227]
 ds_read_b64_tr_b16 a[16:17], v14 offset:16896
 v_mfma_f32_16x16x32_bf16 v[224:227], a[60:63], a[4:7], v[224:227]
 ds_read_b64_tr_b16 a[18:19], v14 offset:17152
 v_mfma_f32_16x16x32_bf16 v[228:231], a[68:71], a[4:7], v[228:231]
 ds_read_b64_tr_b16 a[20:21], v14 offset:25344
 v_mfma_f32_16x16x32_bf16 v[228:231], a[64:67], a[0:3], v[228:231]
 ds_read_b64_tr_b16 a[22:23], v14 offset:25600
 v_mfma_f32_16x16x32_bf16 v[232:235], a[72:75], a[0:3], v[232:235]
 v_mfma_f32_16x16x32_bf16 v[232:235], a[76:79], a[4:7], v[232:235]
 v_mfma_f32_16x16x32_bf16 v[236:239], a[84:87], a[4:7], v[236:239]
 v_mfma_f32_16x16x32_bf16 v[236:239], a[80:83], a[0:3], v[236:239]
 s_waitcnt lgkmcnt(6)
 v_mfma_f32_16x16x32_bf16 v[240:243], a[56:59], a[8:11], v[240:243]
 ds_read_b64_tr_b16 a[0:1], v14 offset:16928
 v_mfma_f32_16x16x32_bf16 v[240:243], a[60:63], a[12:15], v[240:243]
 ds_read_b64_tr_b16 a[2:3], v14 offset:17184
 v_mfma_f32_16x16x32_bf16 v[244:247], a[68:71], a[12:15], v[244:247]
 ds_read_b64_tr_b16 a[4:5], v14 offset:25376
 v_mfma_f32_16x16x32_bf16 v[244:247], a[64:67], a[8:11], v[244:247]
 ds_read_b64_tr_b16 a[6:7], v14 offset:25632
 v_mfma_f32_16x16x32_bf16 v[248:251], a[72:75], a[8:11], v[248:251]
 v_mfma_f32_16x16x32_bf16 v[248:251], a[76:79], a[12:15], v[248:251]
 v_mfma_f32_16x16x32_bf16 v[252:255], a[84:87], a[12:15], v[252:255]
 v_mfma_f32_16x16x32_bf16 v[252:255], a[80:83], a[8:11], v[252:255]
 s_waitcnt lgkmcnt(4)
 v_mfma_f32_16x16x32_bf16 v[80:83], a[16:19], a[24:27], v[80:83]
 ds_read_b64_tr_b16 a[8:9], v14 offset:16960
 s_waitcnt vmcnt(16)
 v_mfma_f32_16x16x32_bf16 v[80:83], a[20:23], a[28:31], v[80:83]
 ds_read_b64_tr_b16 a[10:11], v14 offset:17216
 v_mov_b32 v76, 0
 v_mfma_f32_16x16x32_bf16 v[84:87], a[20:23], a[36:39], v[84:87]
 ds_read_b64_tr_b16 a[12:13], v14 offset:25408
 v_mov_b32 v77, 0
 v_mfma_f32_16x16x32_bf16 v[84:87], a[16:19], a[32:35], v[84:87]
 ds_read_b64_tr_b16 a[14:15], v14 offset:25664
 v_lshlrev_b32 v78, 16, v16
 v_mfma_f32_16x16x32_bf16 v[88:91], a[16:19], a[40:43], v[88:91]
 v_lshlrev_b32 v79, 16, v60
 v_fmac_f32 v76, v78, v79
 v_mfma_f32_16x16x32_bf16 v[88:91], a[20:23], a[44:47], v[88:91]
 v_and_b32 v16, 0xffff0000, v16
 v_and_b32 v60, 0xffff0000, v60
 v_mfma_f32_16x16x32_bf16 v[92:95], a[20:23], a[52:55], v[92:95]
 v_fmac_f32 v77, v16, v60
 v_lshlrev_b32 v78, 16, v17
 v_mfma_f32_16x16x32_bf16 v[92:95], a[16:19], a[48:51], v[92:95]
 v_lshlrev_b32 v79, 16, v61
 s_waitcnt lgkmcnt(4)
 v_mfma_f32_16x16x32_bf16 v[128:131], a[0:3], a[24:27], v[128:131]
 ds_read_b64_tr_b16 a[16:17], v14 offset:16992
 v_fmac_f32 v76, v78, v79
 v_mfma_f32_16x16x32_bf16 v[128:131], a[4:7], a[28:31], v[128:131]
 ds_read_b64_tr_b16 a[18:19], v14 offset:17248
 v_and_b32 v17, 0xffff0000, v17
 v_mfma_f32_16x16x32_bf16 v[132:135], a[4:7], a[36:39], v[132:135]
 ds_read_b64_tr_b16 a[20:21], v14 offset:25440
 v_and_b32 v61, 0xffff0000, v61
 v_mfma_f32_16x16x32_bf16 v[132:135], a[0:3], a[32:35], v[132:135]
 ds_read_b64_tr_b16 a[22:23], v14 offset:25696
 v_fmac_f32 v77, v17, v61
 v_mfma_f32_16x16x32_bf16 v[136:139], a[0:3], a[40:43], v[136:139]
 v_lshlrev_b32 v78, 16, v18
 v_lshlrev_b32 v79, 16, v62
 v_mfma_f32_16x16x32_bf16 v[136:139], a[4:7], a[44:47], v[136:139]
 v_fmac_f32 v76, v78, v79
 v_and_b32 v18, 0xffff0000, v18
 v_mfma_f32_16x16x32_bf16 v[140:143], a[4:7], a[52:55], v[140:143]
 v_and_b32 v62, 0xffff0000, v62
 v_fmac_f32 v77, v18, v62
 v_mfma_f32_16x16x32_bf16 v[140:143], a[0:3], a[48:51], v[140:143]
 v_lshlrev_b32 v78, 16, v19
 s_waitcnt lgkmcnt(4)
 v_mfma_f32_16x16x32_bf16 v[96:99], a[8:11], a[24:27], v[96:99]
 ds_read_b64_tr_b16 a[0:1], v14 offset:17024
 v_lshlrev_b32 v79, 16, v63
 v_mfma_f32_16x16x32_bf16 v[96:99], a[12:15], a[28:31], v[96:99]
 ds_read_b64_tr_b16 a[2:3], v14 offset:17280
 v_fmac_f32 v76, v78, v79
 v_mfma_f32_16x16x32_bf16 v[100:103], a[12:15], a[36:39], v[100:103]
 ds_read_b64_tr_b16 a[4:5], v14 offset:25472
 v_and_b32 v19, 0xffff0000, v19
 v_mfma_f32_16x16x32_bf16 v[100:103], a[8:11], a[32:35], v[100:103]
 ds_read_b64_tr_b16 a[6:7], v14 offset:25728
 v_and_b32 v63, 0xffff0000, v63
 v_mfma_f32_16x16x32_bf16 v[104:107], a[8:11], a[40:43], v[104:107]
 v_fmac_f32 v77, v19, v63
 v_lshlrev_b32 v78, 16, v20
 v_mfma_f32_16x16x32_bf16 v[104:107], a[12:15], a[44:47], v[104:107]
 v_lshlrev_b32 v79, 16, v64
 v_fmac_f32 v76, v78, v79
 v_mfma_f32_16x16x32_bf16 v[108:111], a[12:15], a[52:55], v[108:111]
 v_and_b32 v20, 0xffff0000, v20
 v_and_b32 v64, 0xffff0000, v64
 v_mfma_f32_16x16x32_bf16 v[108:111], a[8:11], a[48:51], v[108:111]
 v_fmac_f32 v77, v20, v64
 s_waitcnt lgkmcnt(4)
 v_mfma_f32_16x16x32_bf16 v[144:147], a[16:19], a[24:27], v[144:147]
 ds_read_b64_tr_b16 a[8:9], v14 offset:17056
 buffer_load_dwordx4 v2, s[24:27], s79 offen offset:0 lds
 v_mfma_f32_16x16x32_bf16 v[144:147], a[20:23], a[28:31], v[144:147]
 ds_read_b64_tr_b16 a[10:11], v14 offset:17312
 v_lshlrev_b32 v78, 16, v21
 v_mfma_f32_16x16x32_bf16 v[148:151], a[20:23], a[36:39], v[148:151]
 ds_read_b64_tr_b16 a[12:13], v14 offset:25504
 v_lshlrev_b32 v79, 16, v65
 v_mfma_f32_16x16x32_bf16 v[148:151], a[16:19], a[32:35], v[148:151]
 ds_read_b64_tr_b16 a[14:15], v14 offset:25760
 v_fmac_f32 v76, v78, v79
 v_mfma_f32_16x16x32_bf16 v[152:155], a[16:19], a[40:43], v[152:155]
 v_and_b32 v21, 0xffff0000, v21
 v_and_b32 v65, 0xffff0000, v65
 v_mfma_f32_16x16x32_bf16 v[152:155], a[20:23], a[44:47], v[152:155]
 buffer_load_dwordx4 v3, s[24:27], s79 offen offset:1024 lds
 s_add_u32 m0, s76, 2048
 v_mfma_f32_16x16x32_bf16 v[156:159], a[20:23], a[52:55], v[156:159]
 s_add_u32 s79, s77, 4096
 v_fmac_f32 v77, v21, v65
 v_lshlrev_b32 v78, 16, v22
 v_mfma_f32_16x16x32_bf16 v[156:159], a[16:19], a[48:51], v[156:159]
 v_lshlrev_b32 v79, 16, v66
 s_waitcnt lgkmcnt(4)
 v_mfma_f32_16x16x32_bf16 v[112:115], a[0:3], a[24:27], v[112:115]
 ds_read_b64_tr_b16 a[16:17], v14 offset:17088
 v_fmac_f32 v76, v78, v79
 v_mfma_f32_16x16x32_bf16 v[112:115], a[4:7], a[28:31], v[112:115]
 ds_read_b64_tr_b16 a[18:19], v14 offset:17344
 buffer_load_dwordx4 v2, s[24:27], s79 offen offset:0 lds
 v_mfma_f32_16x16x32_bf16 v[116:119], a[4:7], a[36:39], v[116:119]
 ds_read_b64_tr_b16 a[20:21], v14 offset:25536
 v_and_b32 v22, 0xffff0000, v22
 v_mfma_f32_16x16x32_bf16 v[116:119], a[0:3], a[32:35], v[116:119]
 ds_read_b64_tr_b16 a[22:23], v14 offset:25792
 v_and_b32 v66, 0xffff0000, v66
 v_mfma_f32_16x16x32_bf16 v[120:123], a[0:3], a[40:43], v[120:123]
 v_fmac_f32 v77, v22, v66
 v_lshlrev_b32 v78, 16, v23
 v_mfma_f32_16x16x32_bf16 v[120:123], a[4:7], a[44:47], v[120:123]
 v_lshlrev_b32 v79, 16, v67
 v_fmac_f32 v76, v78, v79
 v_mfma_f32_16x16x32_bf16 v[124:127], a[4:7], a[52:55], v[124:127]
 buffer_load_dwordx4 v3, s[24:27], s79 offen offset:1024 lds
 s_add_u32 m0, s76, 4096
 v_mfma_f32_16x16x32_bf16 v[124:127], a[0:3], a[48:51], v[124:127]
 s_add_u32 s79, s77, 8192
 v_and_b32 v23, 0xffff0000, v23
 s_waitcnt vmcnt(17) lgkmcnt(4)
 v_mfma_f32_16x16x32_bf16 v[160:163], a[8:11], a[24:27], v[160:163]
 ds_read_b128 a[0:3], v12 offset:8192
 v_and_b32 v67, 0xffff0000, v67
 v_mfma_f32_16x16x32_bf16 v[160:163], a[12:15], a[28:31], v[160:163]
 ds_read_b128 a[4:7], v13 offset:8192
 v_fmac_f32 v77, v23, v67
 v_mfma_f32_16x16x32_bf16 v[164:167], a[12:15], a[36:39], v[164:167]
 ds_read_b128 a[56:59], v10 offset:32768
 buffer_load_dwordx4 v2, s[24:27], s79 offen offset:0 lds
 v_mfma_f32_16x16x32_bf16 v[164:167], a[8:11], a[32:35], v[164:167]
 ds_read_b128 a[60:63], v11 offset:32768
 v_lshlrev_b32 v78, 16, v24
 v_mfma_f32_16x16x32_bf16 v[168:171], a[8:11], a[40:43], v[168:171]
 v_lshlrev_b32 v79, 16, v68
 v_fmac_f32 v76, v78, v79
 v_mfma_f32_16x16x32_bf16 v[168:171], a[12:15], a[44:47], v[168:171]
 v_and_b32 v24, 0xffff0000, v24
 v_and_b32 v68, 0xffff0000, v68
 v_mfma_f32_16x16x32_bf16 v[172:175], a[12:15], a[52:55], v[172:175]
 buffer_load_dwordx4 v3, s[24:27], s79 offen offset:1024 lds
 s_add_u32 m0, s76, 6144
 v_mfma_f32_16x16x32_bf16 v[172:175], a[8:11], a[48:51], v[172:175]
 s_add_u32 s79, s77, 12288
 v_fmac_f32 v77, v24, v68
 s_waitcnt vmcnt(17) lgkmcnt(4)
 v_mfma_f32_16x16x32_bf16 v[176:179], a[16:19], a[24:27], v[176:179]
 ds_read_b128 a[8:11], v12 offset:10240
 v_lshlrev_b32 v78, 16, v25
 v_mfma_f32_16x16x32_bf16 v[176:179], a[20:23], a[28:31], v[176:179]
 ds_read_b128 a[12:15], v13 offset:10240
 v_lshlrev_b32 v79, 16, v69
 v_mfma_f32_16x16x32_bf16 v[180:183], a[20:23], a[36:39], v[180:183]
 ds_read_b128 a[64:67], v10 offset:34816
 v_fmac_f32 v76, v78, v79
 v_mfma_f32_16x16x32_bf16 v[180:183], a[16:19], a[32:35], v[180:183]
 ds_read_b128 a[68:71], v11 offset:34816
 buffer_load_dwordx4 v2, s[24:27], s79 offen offset:0 lds
 v_mfma_f32_16x16x32_bf16 v[184:187], a[16:19], a[40:43], v[184:187]
 v_and_b32 v25, 0xffff0000, v25
 v_and_b32 v69, 0xffff0000, v69
 v_mfma_f32_16x16x32_bf16 v[184:187], a[20:23], a[44:47], v[184:187]
 v_fmac_f32 v77, v25, v69
 v_lshlrev_b32 v78, 16, v26
 v_mfma_f32_16x16x32_bf16 v[188:191], a[20:23], a[52:55], v[188:191]
 v_lshlrev_b32 v79, 16, v70
 v_fmac_f32 v76, v78, v79
 v_mfma_f32_16x16x32_bf16 v[188:191], a[16:19], a[48:51], v[188:191]
 buffer_load_dwordx4 v3, s[24:27], s79 offen offset:1024 lds
 s_waitcnt vmcnt(17) lgkmcnt(6)
 v_mfma_f32_16x16x32_bf16 v[192:195], a[24:27], a[0:3], v[192:195]
 ds_read_b128 a[16:19], v12 offset:12288
 s_add_u32 m0, s74, 0
 v_mfma_f32_16x16x32_bf16 v[192:195], a[28:31], a[4:7], v[192:195]
 ds_read_b128 a[20:23], v13 offset:12288
 s_mul_i32 s78, s77, 3584
 v_mfma_f32_16x16x32_bf16 v[196:199], a[36:39], a[4:7], v[196:199]
 ds_read_b128 a[72:75], v10 offset:36864
 v_and_b32 v26, 0xffff0000, v26
 v_mfma_f32_16x16x32_bf16 v[196:199], a[32:35], a[0:3], v[196:199]
 ds_read_b128 a[76:79], v11 offset:36864
 buffer_load_dwordx4 v6, s[32:35], s78 offen offset:0 lds
 v_mfma_f32_16x16x32_bf16 v[200:203], a[40:43], a[0:3], v[200:203]
 v_and_b32 v70, 0xffff0000, v70
 v_fmac_f32 v77, v26, v70
 v_mfma_f32_16x16x32_bf16 v[200:203], a[44:47], a[4:7], v[200:203]
 v_lshlrev_b32 v78, 16, v27
 v_lshlrev_b32 v79, 16, v71
 v_mfma_f32_16x16x32_bf16 v[204:207], a[52:55], a[4:7], v[204:207]
 v_fmac_f32 v76, v78, v79
 v_and_b32 v27, 0xffff0000, v27
 v_mfma_f32_16x16x32_bf16 v[204:207], a[48:51], a[0:3], v[204:207]
 v_and_b32 v71, 0xffff0000, v71
 s_waitcnt vmcnt(16) lgkmcnt(6)
 v_mfma_f32_16x16x32_bf16 v[208:211], a[24:27], a[8:11], v[208:211]
 ds_read_b128 a[0:3], v12 offset:14336
 buffer_load_dwordx4 v7, s[32:35], s78 offen offset:1056 lds
 v_mfma_f32_16x16x32_bf16 v[208:211], a[28:31], a[12:15], v[208:211]
 ds_read_b128 a[4:7], v13 offset:14336
 v_fmac_f32 v77, v27, v71
 v_mfma_f32_16x16x32_bf16 v[212:215], a[36:39], a[12:15], v[212:215]
 ds_read_b128 a[80:83], v10 offset:38912
 v_lshlrev_b32 v78, 16, v28
 v_mfma_f32_16x16x32_bf16 v[212:215], a[32:35], a[8:11], v[212:215]
 ds_read_b128 a[84:87], v11 offset:38912
 v_lshlrev_b32 v79, 16, v72
 v_mfma_f32_16x16x32_bf16 v[216:219], a[40:43], a[8:11], v[216:219]
 buffer_load_dwordx4 v8, s[32:35], s78 offen offset:2112 lds
 v_fmac_f32 v76, v78, v79
 v_mfma_f32_16x16x32_bf16 v[216:219], a[44:47], a[12:15], v[216:219]
 v_and_b32 v28, 0xffff0000, v28
 v_and_b32 v72, 0xffff0000, v72
 v_mfma_f32_16x16x32_bf16 v[220:223], a[52:55], a[12:15], v[220:223]
 v_fmac_f32 v77, v28, v72
 v_lshlrev_b32 v78, 16, v29
 v_mfma_f32_16x16x32_bf16 v[220:223], a[48:51], a[8:11], v[220:223]
 s_waitcnt vmcnt(12) lgkmcnt(2)
 s_barrier
 v_mfma_f32_16x16x32_bf16 v[224:227], a[24:27], a[16:19], v[224:227]
 ds_read_b64_tr_b16 a[8:9], v14 offset:33792
 v_lshlrev_b32 v79, 16, v73
 v_mfma_f32_16x16x32_bf16 v[224:227], a[28:31], a[20:23], v[224:227]
 ds_read_b64_tr_b16 a[10:11], v14 offset:34048
 buffer_load_dwordx4 v9, s[32:35], s78 offen offset:3168 lds
 v_mfma_f32_16x16x32_bf16 v[228:231], a[36:39], a[20:23], v[228:231]
 ds_read_b64_tr_b16 a[12:13], v14 offset:42240
 s_add_u32 m0, s75, 0
 v_mfma_f32_16x16x32_bf16 v[228:231], a[32:35], a[16:19], v[228:231]
 ds_read_b64_tr_b16 a[14:15], v14 offset:42496
 s_nop 0
 v_mfma_f32_16x16x32_bf16 v[232:235], a[40:43], a[16:19], v[232:235]
 v_fmac_f32 v76, v78, v79
 v_and_b32 v29, 0xffff0000, v29
 v_mfma_f32_16x16x32_bf16 v[232:235], a[44:47], a[20:23], v[232:235]
 buffer_load_dwordx4 v4, s[28:31], s77 offen offset:0 lds
 v_and_b32 v73, 0xffff0000, v73
 v_mfma_f32_16x16x32_bf16 v[236:239], a[52:55], a[20:23], v[236:239]
 v_fmac_f32 v77, v29, v73
 v_lshlrev_b32 v78, 16, v30
 v_mfma_f32_16x16x32_bf16 v[236:239], a[48:51], a[16:19], v[236:239]
 v_lshlrev_b32 v79, 16, v74
 s_waitcnt lgkmcnt(6)
 v_mfma_f32_16x16x32_bf16 v[240:243], a[24:27], a[0:3], v[240:243]
 ds_read_b64_tr_b16 a[16:17], v14 offset:33824
 v_fmac_f32 v76, v78, v79
 v_mfma_f32_16x16x32_bf16 v[240:243], a[28:31], a[4:7], v[240:243]
 ds_read_b64_tr_b16 a[18:19], v14 offset:34080
 buffer_load_dwordx4 v5, s[28:31], s77 offen offset:1024 lds
 v_mfma_f32_16x16x32_bf16 v[244:247], a[36:39], a[4:7], v[244:247]
 ds_read_b64_tr_b16 a[20:21], v14 offset:42272
 s_and_b32 s77, s80, 15
 v_mfma_f32_16x16x32_bf16 v[244:247], a[32:35], a[0:3], v[244:247]
 ds_read_b64_tr_b16 a[22:23], v14 offset:42528
 s_xor_b32 s77, s77, 7
 v_mfma_f32_16x16x32_bf16 v[248:251], a[40:43], a[0:3], v[248:251]
 s_lshl_b32 s77, s77, 7
 s_add_u32 m0, s76, 32768
 s_add_u32 s79, s77, 0
 v_mfma_f32_16x16x32_bf16 v[248:251], a[44:47], a[4:7], v[248:251]
 v_and_b32 v30, 0xffff0000, v30
 v_and_b32 v74, 0xffff0000, v74
 v_mfma_f32_16x16x32_bf16 v[252:255], a[52:55], a[4:7], v[252:255]
 buffer_load_dwordx4 v2, s[24:27], s79 offen offset:0 lds
 v_fmac_f32 v77, v30, v74
 v_mfma_f32_16x16x32_bf16 v[252:255], a[48:51], a[0:3], v[252:255]
 v_lshlrev_b32 v78, 16, v31
 s_waitcnt lgkmcnt(4)
 v_mfma_f32_16x16x32_bf16 v[80:83], a[8:11], a[56:59], v[80:83]
 ds_read_b64_tr_b16 a[0:1], v14 offset:33856
 v_lshlrev_b32 v79, 16, v75
 v_mfma_f32_16x16x32_bf16 v[80:83], a[12:15], a[60:63], v[80:83]
 ds_read_b64_tr_b16 a[2:3], v14 offset:34112
 v_fmac_f32 v76, v78, v79
 v_mfma_f32_16x16x32_bf16 v[84:87], a[12:15], a[68:71], v[84:87]
 ds_read_b64_tr_b16 a[4:5], v14 offset:42304
 buffer_load_dwordx4 v3, s[24:27], s79 offen offset:1024 lds
 v_mfma_f32_16x16x32_bf16 v[84:87], a[8:11], a[64:67], v[84:87]
 ds_read_b64_tr_b16 a[6:7], v14 offset:42560
 s_add_u32 m0, s76, 34816
 v_mfma_f32_16x16x32_bf16 v[88:91], a[8:11], a[72:75], v[88:91]
 s_add_u32 s79, s77, 4096
 v_and_b32 v31, 0xffff0000, v31
 v_mfma_f32_16x16x32_bf16 v[88:91], a[12:15], a[76:79], v[88:91]
 v_and_b32 v75, 0xffff0000, v75
 v_fmac_f32 v77, v31, v75
 v_mfma_f32_16x16x32_bf16 v[92:95], a[12:15], a[84:87], v[92:95]
 buffer_load_dwordx4 v2, s[24:27], s79 offen offset:0 lds
 v_add_f32 v76, v76, v77
 v_mfma_f32_16x16x32_bf16 v[92:95], a[8:11], a[80:83], v[92:95]
 s_nop 1
 v_add_f32_dpp v76, v76, v76 row_ror:8 row_mask:0xf bank_mask:0xf
 s_waitcnt lgkmcnt(4)
 v_mfma_f32_16x16x32_bf16 v[128:131], a[16:19], a[56:59], v[128:131]
 ds_read_b64_tr_b16 a[8:9], v14 offset:33888
 s_nop 1
 v_mfma_f32_16x16x32_bf16 v[128:131], a[20:23], a[60:63], v[128:131]
 ds_read_b64_tr_b16 a[10:11], v14 offset:34144
 v_add_f32_dpp v76, v76, v76 row_ror:4 row_mask:0xf bank_mask:0xf
 v_mfma_f32_16x16x32_bf16 v[132:135], a[20:23], a[68:71], v[132:135]
 ds_read_b64_tr_b16 a[12:13], v14 offset:42336
 s_nop 1
 v_mfma_f32_16x16x32_bf16 v[132:135], a[16:19], a[64:67], v[132:135]
 ds_read_b64_tr_b16 a[14:15], v14 offset:42592
 buffer_load_dwordx4 v3, s[24:27], s79 offen offset:1024 lds
 v_mfma_f32_16x16x32_bf16 v[136:139], a[16:19], a[72:75], v[136:139]
 s_add_u32 m0, s76, 36864
 s_add_u32 s79, s77, 8192
 v_mfma_f32_16x16x32_bf16 v[136:139], a[20:23], a[76:79], v[136:139]
 v_add_f32_dpp v76, v76, v76 row_ror:2 row_mask:0xf bank_mask:0xf
 s_nop 1
 v_mfma_f32_16x16x32_bf16 v[140:143], a[20:23], a[84:87], v[140:143]
L_pad1:
 s_cbranch_execz L_pad5
 v_add_f32_dpp v76, v76, v76 row_ror:1 row_mask:0xf bank_mask:0xf
 s_nop 1
 v_mfma_f32_16x16x32_bf16 v[140:143], a[16:19], a[80:83], v[140:143]
 buffer_load_dwordx4 v2, s[24:27], s79 offen offset:0 lds
 s_waitcnt lgkmcnt(4)
 v_mfma_f32_16x16x32_bf16 v[96:99], a[0:3], a[56:59], v[96:99]
 ds_read_b64_tr_b16 a[16:17], v14 offset:33920
 v_add_f32_dpp v76, v76, v76 row_bcast:15 row_mask:0xa bank_mask:0xf
 v_mfma_f32_16x16x32_bf16 v[96:99], a[4:7], a[60:63], v[96:99]
 ds_read_b64_tr_b16 a[18:19], v14 offset:34176
 v_mul_f32 v76, 0x3fb8aa3b, v76
 v_mfma_f32_16x16x32_bf16 v[100:103], a[4:7], a[68:71], v[100:103]
 ds_read_b64_tr_b16 a[20:21], v14 offset:42368
 v_mfma_f32_16x16x32_bf16 v[100:103], a[0:3], a[64:67], v[100:103]
 ds_read_b64_tr_b16 a[22:23], v14 offset:42624
 v_mfma_f32_16x16x32_bf16 v[104:107], a[0:3], a[72:75], v[104:107]
 buffer_load_dwordx4 v3, s[24:27], s79 offen offset:1024 lds
 s_add_u32 m0, s76, 38912
 v_mfma_f32_16x16x32_bf16 v[104:107], a[4:7], a[76:79], v[104:107]
 s_add_u32 s79, s77, 12288
 v_exp_f32 v77, v76
 v_mfma_f32_16x16x32_bf16 v[108:111], a[4:7], a[84:87], v[108:111]
 v_exp_f32 v76, -v76
 v_mfma_f32_16x16x32_bf16 v[108:111], a[0:3], a[80:83], v[108:111]
 v_min_f32 v77, 0x7149f2ca, v77
 s_waitcnt lgkmcnt(4)
 v_mfma_f32_16x16x32_bf16 v[144:147], a[8:11], a[56:59], v[144:147]
 ds_read_b64_tr_b16 a[0:1], v14 offset:33952
 buffer_load_dwordx4 v2, s[24:27], s79 offen offset:0 lds
 v_mfma_f32_16x16x32_bf16 v[144:147], a[12:15], a[60:63], v[144:147]
 ds_read_b64_tr_b16 a[2:3], v14 offset:34208
 v_add_f32 v76, 1.0, v76
 v_mfma_f32_16x16x32_bf16 v[148:151], a[12:15], a[68:71], v[148:151]
 ds_read_b64_tr_b16 a[4:5], v14 offset:42400
 v_mfma_f32_16x16x32_bf16 v[148:151], a[8:11], a[64:67], v[148:151]
 ds_read_b64_tr_b16 a[6:7], v14 offset:42656
 v_mfma_f32_16x16x32_bf16 v[152:155], a[8:11], a[72:75], v[152:155]
 buffer_load_dwordx4 v3, s[24:27], s79 offen offset:1024 lds
 s_add_u32 m0, s74, 16896
 v_mfma_f32_16x16x32_bf16 v[152:155], a[12:15], a[76:79], v[152:155]
 s_mul_i32 s78, s77, 3584
 v_rcp_f32 v76, v76
 v_mfma_f32_16x16x32_bf16 v[156:159], a[12:15], a[84:87], v[156:159]
 v_add_f32 v77, 1.0, v77
 s_lshr_b32 s72, s64, 1
 v_mfma_f32_16x16x32_bf16 v[156:159], a[8:11], a[80:83], v[156:159]
 s_lshl_b32 s73, s62, 4
 s_add_u32 s72, s72, s73
 s_waitcnt lgkmcnt(4)
 v_mfma_f32_16x16x32_bf16 v[112:115], a[16:19], a[56:59], v[112:115]
 ds_read_b64_tr_b16 a[8:9], v14 offset:33984
 s_lshl_b32 s72, s72, 2
 v_mfma_f32_16x16x32_bf16 v[112:115], a[20:23], a[60:63], v[112:115]
 ds_read_b64_tr_b16 a[10:11], v14 offset:34240
 buffer_load_dwordx4 v6, s[32:35], s78 offen offset:0 lds
 v_mfma_f32_16x16x32_bf16 v[116:119], a[20:23], a[68:71], v[116:119]
 ds_read_b64_tr_b16 a[12:13], v14 offset:42432
 s_add_u32 s72, s72, s60
 v_mfma_f32_16x16x32_bf16 v[116:119], a[16:19], a[64:67], v[116:119]
 ds_read_b64_tr_b16 a[14:15], v14 offset:42688
 s_lshl_b32 s72, s72, 2
 v_mfma_f32_16x16x32_bf16 v[120:123], a[16:19], a[72:75], v[120:123]
 s_and_b32 s73, s64, 1
 s_add_u32 s72, s72, s73
 s_lshl_b32 s72, s72, 2
 v_mfma_f32_16x16x32_bf16 v[120:123], a[20:23], a[76:79], v[120:123]
 buffer_load_dwordx4 v7, s[32:35], s78 offen offset:1056 lds
 s_add_u32 s72, s72, 42008576
 v_mfma_f32_16x16x32_bf16 v[124:127], a[20:23], a[84:87], v[124:127]
 s_add_u32 s73, s72, 0x2000
 v_xor_b32 v78, 16, v0
 v_and_b32 v78, 31, v78
 v_mfma_f32_16x16x32_bf16 v[124:127], a[16:19], a[80:83], v[124:127]
 v_lshlrev_b32 v78, 26, v78
 s_waitcnt vmcnt(22) lgkmcnt(4)
 v_mfma_f32_16x16x32_bf16 v[160:163], a[0:3], a[56:59], v[160:163]
 ds_read_b128 a[16:19], v12 offset:16384
 v_lshrrev_b32 v79, 5, v0
 v_mfma_f32_16x16x32_bf16 v[160:163], a[4:7], a[60:63], v[160:163]
 ds_read_b128 a[20:23], v13 offset:16384
 buffer_load_dwordx4 v8, s[32:35], s78 offen offset:2112 lds
 v_mfma_f32_16x16x32_bf16 v[164:167], a[4:7], a[68:71], v[164:167]
 ds_read_b128 a[24:27], v10 offset:0
 v_lshl_add_u32 v78, v79, 3, v78
 v_mfma_f32_16x16x32_bf16 v[164:167], a[0:3], a[64:67], v[164:167]
 ds_read_b128 a[28:31], v11 offset:0
 v_mfma_f32_16x16x32_bf16 v[168:171], a[0:3], a[72:75], v[168:171]
 v_mfma_f32_16x16x32_bf16 v[168:171], a[4:7], a[76:79], v[168:171]
 v_mfma_f32_16x16x32_bf16 v[172:175], a[4:7], a[84:87], v[172:175]
 buffer_store_dword v76, v78, s[48:51], s72 offen sc1
 v_mfma_f32_16x16x32_bf16 v[172:175], a[0:3], a[80:83], v[172:175]
 s_waitcnt vmcnt(22) lgkmcnt(4)
 v_mfma_f32_16x16x32_bf16 v[176:179], a[8:11], a[56:59], v[176:179]
 ds_read_b128 a[0:3], v12 offset:18432
 buffer_store_dword v77, v78, s[48:51], s73 offen sc1
 v_mfma_f32_16x16x32_bf16 v[176:179], a[12:15], a[60:63], v[176:179]
 ds_read_b128 a[4:7], v13 offset:18432
 s_lshl_b32 s68, s60, 3
 v_mfma_f32_16x16x32_bf16 v[180:183], a[12:15], a[68:71], v[180:183]
 ds_read_b128 a[32:35], v10 offset:2048
 buffer_load_dwordx4 v9, s[32:35], s78 offen offset:3168 lds
 v_mfma_f32_16x16x32_bf16 v[180:183], a[8:11], a[64:67], v[180:183]
 ds_read_b128 a[36:39], v11 offset:2048
 s_add_u32 m0, s75, 8192
 v_mfma_f32_16x16x32_bf16 v[184:187], a[8:11], a[72:75], v[184:187]
 s_nop 0
 s_add_u32 s68, s68, s63
 v_mov_b32 v76, 1
 v_mfma_f32_16x16x32_bf16 v[184:187], a[12:15], a[76:79], v[184:187]
 v_lshlrev_b32 v77, 8, v0
 v_mfma_f32_16x16x32_bf16 v[188:191], a[12:15], a[84:87], v[188:191]
 buffer_load_dwordx4 v4, s[28:31], s77 offen offset:0 lds
 v_mfma_f32_16x16x32_bf16 v[188:191], a[8:11], a[80:83], v[188:191]
 s_waitcnt vmcnt(23) lgkmcnt(6)
 v_mfma_f32_16x16x32_bf16 v[192:195], a[56:59], a[16:19], v[192:195]
 ds_read_b128 a[8:11], v12 offset:20480
 v_mfma_f32_16x16x32_bf16 v[192:195], a[60:63], a[20:23], v[192:195]
 ds_read_b128 a[12:15], v13 offset:20480
 v_mfma_f32_16x16x32_bf16 v[196:199], a[68:71], a[20:23], v[196:199]
 ds_read_b128 a[40:43], v10 offset:4096
 v_mfma_f32_16x16x32_bf16 v[196:199], a[64:67], a[16:19], v[196:199]
 ds_read_b128 a[44:47], v11 offset:4096
 buffer_load_dwordx4 v5, s[28:31], s77 offen offset:1024 lds
 v_mfma_f32_16x16x32_bf16 v[200:203], a[72:75], a[16:19], v[200:203]
 v_mfma_f32_16x16x32_bf16 v[200:203], a[76:79], a[20:23], v[200:203]
 v_mfma_f32_16x16x32_bf16 v[204:207], a[84:87], a[20:23], v[204:207]
 v_mfma_f32_16x16x32_bf16 v[204:207], a[80:83], a[16:19], v[204:207]
 s_waitcnt vmcnt(22) lgkmcnt(6)
 v_mfma_f32_16x16x32_bf16 v[208:211], a[56:59], a[0:3], v[208:211]
 ds_read_b128 a[16:19], v12 offset:22528
 s_and_b32 s77, s80, 15
 v_mfma_f32_16x16x32_bf16 v[208:211], a[60:63], a[4:7], v[208:211]
 ds_read_b128 a[20:23], v13 offset:22528
 s_xor_b32 s77, s77, 8
 v_mfma_f32_16x16x32_bf16 v[212:215], a[68:71], a[4:7], v[212:215]
 ds_read_b128 a[48:51], v10 offset:6144
 s_lshl_b32 s77, s77, 7
 v_mfma_f32_16x16x32_bf16 v[212:215], a[64:67], a[0:3], v[212:215]
 ds_read_b128 a[52:55], v11 offset:6144
 s_add_u32 m0, s76, 0
 v_mfma_f32_16x16x32_bf16 v[216:219], a[72:75], a[0:3], v[216:219]
 s_add_u32 s79, s77, 0
 buffer_load_dwordx4 v2, s[24:27], s79 offen offset:0 lds
 v_mfma_f32_16x16x32_bf16 v[216:219], a[76:79], a[4:7], v[216:219]
 v_mfma_f32_16x16x32_bf16 v[220:223], a[84:87], a[4:7], v[220:223]
 v_mfma_f32_16x16x32_bf16 v[220:223], a[80:83], a[0:3], v[220:223]
 s_waitcnt vmcnt(17) lgkmcnt(2)
 s_barrier
 v_mfma_f32_16x16x32_bf16 v[224:227], a[56:59], a[8:11], v[224:227]
 ds_read_b64_tr_b16 a[0:1], v14 offset:0
 buffer_load_dwordx4 v3, s[24:27], s79 offen offset:1024 lds
 v_mfma_f32_16x16x32_bf16 v[224:227], a[60:63], a[12:15], v[224:227]
 ds_read_b64_tr_b16 a[2:3], v14 offset:256
 s_add_u32 m0, s76, 2048
 v_mfma_f32_16x16x32_bf16 v[228:231], a[68:71], a[12:15], v[228:231]
 ds_read_b64_tr_b16 a[4:5], v14 offset:8448
 s_add_u32 s79, s77, 4096
 v_mfma_f32_16x16x32_bf16 v[228:231], a[64:67], a[8:11], v[228:231]
 ds_read_b64_tr_b16 a[6:7], v14 offset:8704
 v_mfma_f32_16x16x32_bf16 v[232:235], a[72:75], a[8:11], v[232:235]
 buffer_load_dwordx4 v2, s[24:27], s79 offen offset:0 lds
 v_mfma_f32_16x16x32_bf16 v[232:235], a[76:79], a[12:15], v[232:235]
 v_mfma_f32_16x16x32_bf16 v[236:239], a[84:87], a[12:15], v[236:239]
 v_mfma_f32_16x16x32_bf16 v[236:239], a[80:83], a[8:11], v[236:239]
 s_waitcnt lgkmcnt(6)
 v_mfma_f32_16x16x32_bf16 v[240:243], a[56:59], a[16:19], v[240:243]
 ds_read_b64_tr_b16 a[8:9], v14 offset:32
 v_mfma_f32_16x16x32_bf16 v[240:243], a[60:63], a[20:23], v[240:243]
 ds_read_b64_tr_b16 a[10:11], v14 offset:288
 buffer_load_dwordx4 v3, s[24:27], s79 offen offset:1024 lds
 v_mfma_f32_16x16x32_bf16 v[244:247], a[68:71], a[20:23], v[244:247]
 ds_read_b64_tr_b16 a[12:13], v14 offset:8480
 s_add_u32 m0, s76, 4096
 v_mfma_f32_16x16x32_bf16 v[244:247], a[64:67], a[16:19], v[244:247]
 ds_read_b64_tr_b16 a[14:15], v14 offset:8736
 s_add_u32 s79, s77, 8192
 v_mfma_f32_16x16x32_bf16 v[248:251], a[72:75], a[16:19], v[248:251]
 v_mfma_f32_16x16x32_bf16 v[248:251], a[76:79], a[20:23], v[248:251]
 buffer_load_dwordx4 v2, s[24:27], s79 offen offset:0 lds
 v_mfma_f32_16x16x32_bf16 v[252:255], a[84:87], a[20:23], v[252:255]
 v_mfma_f32_16x16x32_bf16 v[252:255], a[80:83], a[16:19], v[252:255]
 s_waitcnt lgkmcnt(4)
 v_mfma_f32_16x16x32_bf16 v[80:83], a[0:3], a[24:27], v[80:83]
 ds_read_b64_tr_b16 a[16:17], v14 offset:64
 v_lshlrev_b32 v44, 16, v44
 v_mfma_f32_16x16x32_bf16 v[80:83], a[4:7], a[28:31], v[80:83]
 ds_read_b64_tr_b16 a[18:19], v14 offset:320
 buffer_load_dwordx4 v3, s[24:27], s79 offen offset:1024 lds
 v_mfma_f32_16x16x32_bf16 v[84:87], a[4:7], a[36:39], v[84:87]
 ds_read_b64_tr_b16 a[20:21], v14 offset:8512
 s_add_u32 m0, s76, 6144
 v_mfma_f32_16x16x32_bf16 v[84:87], a[0:3], a[32:35], v[84:87]
 ds_read_b64_tr_b16 a[22:23], v14 offset:8768
 s_add_u32 s79, s77, 12288
 v_mfma_f32_16x16x32_bf16 v[88:91], a[0:3], a[40:43], v[88:91]
 v_lshlrev_b32 v45, 16, v45
 v_lshlrev_b32 v40, 16, v40
 v_mfma_f32_16x16x32_bf16 v[88:91], a[4:7], a[44:47], v[88:91]
 v_mul_f32 v40, 0x3fb8aa3b, v40
 v_mfma_f32_16x16x32_bf16 v[92:95], a[4:7], a[52:55], v[92:95]
 buffer_load_dwordx4 v2, s[24:27], s79 offen offset:0 lds
 v_mfma_f32_16x16x32_bf16 v[92:95], a[0:3], a[48:51], v[92:95]
 s_waitcnt lgkmcnt(4)
 v_mfma_f32_16x16x32_bf16 v[128:131], a[8:11], a[24:27], v[128:131]
 ds_read_b64_tr_b16 a[0:1], v14 offset:96
 v_mfma_f32_16x16x32_bf16 v[128:131], a[12:15], a[28:31], v[128:131]
 ds_read_b64_tr_b16 a[2:3], v14 offset:352
 v_mfma_f32_16x16x32_bf16 v[132:135], a[12:15], a[36:39], v[132:135]
 ds_read_b64_tr_b16 a[4:5], v14 offset:8544
 buffer_load_dwordx4 v3, s[24:27], s79 offen offset:1024 lds
 v_mfma_f32_16x16x32_bf16 v[132:135], a[8:11], a[32:35], v[132:135]
 ds_read_b64_tr_b16 a[6:7], v14 offset:8800
 s_add_u32 m0, s74, 33792
 v_mfma_f32_16x16x32_bf16 v[136:139], a[8:11], a[40:43], v[136:139]
 s_mul_i32 s78, s77, 3584
 s_lshl_b32 s70, s62, 2
 s_lshr_b32 s71, s63, 1
 v_mfma_f32_16x16x32_bf16 v[136:139], a[12:15], a[44:47], v[136:139]
 s_add_u32 s70, s70, s71
 s_lshl_b32 s70, s70, 2
 s_add_u32 s70, s70, s60
 v_mfma_f32_16x16x32_bf16 v[140:143], a[12:15], a[52:55], v[140:143]
 s_lshl_b32 s71, s61, 7
 s_add_u32 s70, s70, s71
 s_mul_i32 s70, s70, 14336
 v_mfma_f32_16x16x32_bf16 v[140:143], a[8:11], a[48:51], v[140:143]
 buffer_load_dwordx4 v6, s[32:35], s78 offen offset:0 lds
 s_waitcnt lgkmcnt(4)
 v_mfma_f32_16x16x32_bf16 v[96:99], a[16:19], a[24:27], v[96:99]
 ds_read_b64_tr_b16 a[8:9], v14 offset:128
 s_add_u32 s70, s70, 7168
 v_mfma_f32_16x16x32_bf16 v[96:99], a[20:23], a[28:31], v[96:99]
 ds_read_b64_tr_b16 a[10:11], v14 offset:384
 v_min_u32 v1, 55, v0
 v_mfma_f32_16x16x32_bf16 v[100:103], a[20:23], a[36:39], v[100:103]
 ds_read_b64_tr_b16 a[12:13], v14 offset:8576
 v_lshlrev_b32 v1, 7, v1
 v_mfma_f32_16x16x32_bf16 v[100:103], a[16:19], a[32:35], v[100:103]
 ds_read_b64_tr_b16 a[14:15], v14 offset:8832
 buffer_load_dwordx4 v7, s[32:35], s78 offen offset:1056 lds
 v_mfma_f32_16x16x32_bf16 v[104:107], a[16:19], a[40:43], v[104:107]
 s_add_u32 s71, s63, 1
 s_and_b32 s71, s71, 2
 s_lshl_b32 s71, s71, 26
 v_mfma_f32_16x16x32_bf16 v[104:107], a[20:23], a[44:47], v[104:107]
 s_add_u32 s70, s70, s71
 v_exp_f32 v40, v40
 v_mfma_f32_16x16x32_bf16 v[108:111], a[20:23], a[52:55], v[108:111]
 v_cvt_pk_bf16_f32 v40, v40, v40
 v_lshlrev_b32 v40, 16, v40
 v_mfma_f32_16x16x32_bf16 v[108:111], a[16:19], a[48:51], v[108:111]
 buffer_load_dword a253, v1, s[36:39], s70 offen
 s_waitcnt lgkmcnt(4)
 v_mfma_f32_16x16x32_bf16 v[144:147], a[0:3], a[24:27], v[144:147]
 ds_read_b64_tr_b16 a[16:17], v14 offset:160
 v_mul_f32 v60, v40, v44
 v_mfma_f32_16x16x32_bf16 v[144:147], a[4:7], a[28:31], v[144:147]
 ds_read_b64_tr_b16 a[18:19], v14 offset:416
 v_mul_f32 v61, v40, v45
 v_mfma_f32_16x16x32_bf16 v[148:151], a[4:7], a[36:39], v[148:151]
 ds_read_b64_tr_b16 a[20:21], v14 offset:8608
 v_mul_f32 v60, 0x3fb8aa3b, v60
 v_mfma_f32_16x16x32_bf16 v[148:151], a[0:3], a[32:35], v[148:151]
 ds_read_b64_tr_b16 a[22:23], v14 offset:8864
 v_mul_f32 v61, 0x3e22f983, v61
 v_mfma_f32_16x16x32_bf16 v[152:155], a[0:3], a[40:43], v[152:155]
 v_exp_f32 v60, v60
 v_mfma_f32_16x16x32_bf16 v[152:155], a[4:7], a[44:47], v[152:155]
 v_rndne_f32 v62, v61
 v_sub_f32 v61, v61, v62
 v_mfma_f32_16x16x32_bf16 v[156:159], a[4:7], a[52:55], v[156:159]
 v_cos_f32 v62, v61
 v_mfma_f32_16x16x32_bf16 v[156:159], a[0:3], a[48:51], v[156:159]
 s_waitcnt lgkmcnt(4)
 v_mfma_f32_16x16x32_bf16 v[112:115], a[8:11], a[24:27], v[112:115]
 ds_read_b64_tr_b16 a[0:1], v14 offset:192
 v_mfma_f32_16x16x32_bf16 v[112:115], a[12:15], a[28:31], v[112:115]
 ds_read_b64_tr_b16 a[2:3], v14 offset:448
 v_mfma_f32_16x16x32_bf16 v[116:119], a[12:15], a[36:39], v[116:119]
 ds_read_b64_tr_b16 a[4:5], v14 offset:8640
 v_mfma_f32_16x16x32_bf16 v[116:119], a[8:11], a[32:35], v[116:119]
 ds_read_b64_tr_b16 a[6:7], v14 offset:8896
 v_mfma_f32_16x16x32_bf16 v[120:123], a[8:11], a[40:43], v[120:123]
 v_sin_f32 v63, v61
 v_mfma_f32_16x16x32_bf16 v[120:123], a[12:15], a[44:47], v[120:123]
 v_mul_f32 v64, v44, v44
 v_fmac_f32 v64, v45, v45
 v_mfma_f32_16x16x32_bf16 v[124:127], a[12:15], a[52:55], v[124:127]
 v_rcp_f32 v64, v64
 v_mfma_f32_16x16x32_bf16 v[124:127], a[8:11], a[48:51], v[124:127]
 v_mul_f32 v32, v60, v62
 s_waitcnt vmcnt(25) lgkmcnt(4)
 v_mfma_f32_16x16x32_bf16 v[160:163], a[16:19], a[24:27], v[160:163]
 ds_read_b128 a[8:11], v12 offset:0
 v_mul_f32 v33, v60, v63
 v_mfma_f32_16x16x32_bf16 v[160:163], a[20:23], a[28:31], v[160:163]
 ds_read_b128 a[12:15], v13 offset:0
 v_add_f32 v64, v64, v64
 v_mfma_f32_16x16x32_bf16 v[164:167], a[20:23], a[36:39], v[164:167]
 ds_read_b128 a[56:59], v10 offset:32768
 v_add_f32 v60, -1.0, v32
 v_mfma_f32_16x16x32_bf16 v[164:167], a[16:19], a[32:35], v[164:167]
 ds_read_b128 a[60:63], v11 offset:32768
 v_mul_f32 v61, v60, v44
 v_mfma_f32_16x16x32_bf16 v[168:171], a[16:19], a[40:43], v[168:171]
 v_fmac_f32 v61, v33, v45
 v_mul_f32 v62, v33, v44
 v_mfma_f32_16x16x32_bf16 v[168:171], a[20:23], a[44:47], v[168:171]
 v_fma_f32 v62, -v60, v45, v62
 v_mul_f32 v36, v61, v64
 v_mfma_f32_16x16x32_bf16 v[172:175], a[20:23], a[52:55], v[172:175]
 v_mul_f32 v37, v62, v64
 v_mul_f32 v66, v33, v33
 v_mfma_f32_16x16x32_bf16 v[172:175], a[16:19], a[48:51], v[172:175]
 v_add_f32 v67, v32, v32
 s_waitcnt vmcnt(23) lgkmcnt(4)
 v_mfma_f32_16x16x32_bf16 v[176:179], a[0:3], a[24:27], v[176:179]
 ds_read_b128 a[16:19], v12 offset:2048
 v_fma_f32 v60, v32, v32, -v66
 v_mfma_f32_16x16x32_bf16 v[176:179], a[4:7], a[28:31], v[176:179]
 ds_read_b128 a[20:23], v13 offset:2048
 v_mul_f32 v61, v67, v33
 v_mfma_f32_16x16x32_bf16 v[180:183], a[4:7], a[36:39], v[180:183]
 ds_read_b128 a[64:67], v10 offset:34816
 v_mul_f32 v66, v61, v61
 v_mfma_f32_16x16x32_bf16 v[180:183], a[0:3], a[32:35], v[180:183]
 ds_read_b128 a[68:71], v11 offset:34816
 v_add_f32 v67, v60, v60
 v_mfma_f32_16x16x32_bf16 v[184:187], a[0:3], a[40:43], v[184:187]
 v_fma_f32 v62, v60, v60, -v66
 v_mul_f32 v63, v67, v61
 v_mfma_f32_16x16x32_bf16 v[184:187], a[4:7], a[44:47], v[184:187]
 v_mul_f32 v66, v63, v63
 v_add_f32 v67, v62, v62
 v_mfma_f32_16x16x32_bf16 v[188:191], a[4:7], a[52:55], v[188:191]
 v_fma_f32 v40, v62, v62, -v66
 v_mul_f32 v41, v67, v63
 v_mfma_f32_16x16x32_bf16 v[188:191], a[0:3], a[48:51], v[188:191]
 v_mul_f32 v66, v41, v41
 s_waitcnt vmcnt(21) lgkmcnt(6)
 v_mfma_f32_16x16x32_bf16 v[192:195], a[24:27], a[8:11], v[192:195]
 ds_read_b128 a[0:3], v12 offset:4096
 v_add_f32 v67, v40, v40
 v_mfma_f32_16x16x32_bf16 v[192:195], a[28:31], a[12:15], v[192:195]
 ds_read_b128 a[4:7], v13 offset:4096
 v_fma_f32 v44, v40, v40, -v66
 v_mfma_f32_16x16x32_bf16 v[196:199], a[36:39], a[12:15], v[196:199]
 ds_read_b128 a[72:75], v10 offset:36864
 v_mul_f32 v45, v67, v41
 v_mfma_f32_16x16x32_bf16 v[196:199], a[32:35], a[8:11], v[196:199]
 ds_read_b128 a[76:79], v11 offset:36864
 v_mul_f32 v66, v45, v45
 v_mfma_f32_16x16x32_bf16 v[200:203], a[40:43], a[8:11], v[200:203]
 v_add_f32 v67, v44, v44
 v_fma_f32 v60, v44, v44, -v66
 v_mfma_f32_16x16x32_bf16 v[200:203], a[44:47], a[12:15], v[200:203]
 v_mul_f32 v61, v67, v45
 v_mul_f32 v66, v61, v61
 v_mfma_f32_16x16x32_bf16 v[204:207], a[52:55], a[12:15], v[204:207]
 v_add_f32 v67, v60, v60
 v_fma_f32 v48, v60, v60, -v66
 v_mfma_f32_16x16x32_bf16 v[204:207], a[48:51], a[8:11], v[204:207]
 v_mul_f32 v49, v67, v61
 s_waitcnt vmcnt(19) lgkmcnt(6)
 v_mfma_f32_16x16x32_bf16 v[208:211], a[24:27], a[16:19], v[208:211]
 ds_read_b128 a[8:11], v12 offset:6144
 v_mul_f32 v66, v49, v49
 v_mfma_f32_16x16x32_bf16 v[208:211], a[28:31], a[20:23], v[208:211]
 ds_read_b128 a[12:15], v13 offset:6144
 v_add_f32 v67, v48, v48
 v_mfma_f32_16x16x32_bf16 v[212:215], a[36:39], a[20:23], v[212:215]
 ds_read_b128 a[80:83], v10 offset:38912
 v_fma_f32 v18, v48, v48, -v66
 v_mfma_f32_16x16x32_bf16 v[212:215], a[32:35], a[16:19], v[212:215]
 ds_read_b128 a[84:87], v11 offset:38912
 v_mul_f32 v19, v67, v49
 v_mfma_f32_16x16x32_bf16 v[216:219], a[40:43], a[16:19], v[216:219]
 v_mul_f32 v66, v19, v19
 v_add_f32 v67, v18, v18
 v_mfma_f32_16x16x32_bf16 v[216:219], a[44:47], a[20:23], v[216:219]
 v_fma_f32 v52, v18, v18, -v66
 v_mul_f32 v53, v67, v19
 v_mfma_f32_16x16x32_bf16 v[220:223], a[52:55], a[20:23], v[220:223]
 buffer_load_dwordx4 v8, s[32:35], s78 offen offset:2112 lds
 s_mov_b32 s82, 0xffff0000
 v_mfma_f32_16x16x32_bf16 v[220:223], a[48:51], a[16:19], v[220:223]
 s_mov_b32 s83, 0xffff0000
 s_waitcnt vmcnt(12) lgkmcnt(2)
 s_barrier
 v_mfma_f32_16x16x32_bf16 v[224:227], a[24:27], a[0:3], v[224:227]
 ds_read_b64_tr_b16 a[16:17], v14 offset:16896
 s_xor_b32 s69, s68, 0
 v_mfma_f32_16x16x32_bf16 v[224:227], a[28:31], a[4:7], v[224:227]
 ds_read_b64_tr_b16 a[18:19], v14 offset:17152
 s_lshl_b32 s69, s69, 8
 v_mfma_f32_16x16x32_bf16 v[228:231], a[36:39], a[4:7], v[228:231]
 ds_read_b64_tr_b16 a[20:21], v14 offset:25344
 v_cndmask_b32 v62, 1.0, v44, s[82:83]
 v_mfma_f32_16x16x32_bf16 v[228:231], a[32:35], a[0:3], v[228:231]
 ds_read_b64_tr_b16 a[22:23], v14 offset:25600
 buffer_atomic_add v76, v77, s[56:59], s69 offen sc1
 v_mfma_f32_16x16x32_bf16 v[232:235], a[40:43], a[0:3], v[232:235]
 v_cndmask_b32 v63, 0, v45, s[82:83]
 s_mov_b32 s82, 0
 v_mfma_f32_16x16x32_bf16 v[232:235], a[44:47], a[4:7], v[232:235]
 buffer_load_dwordx4 v9, s[32:35], s78 offen offset:3168 lds
 s_add_u32 m0, s75, 16384
 v_mfma_f32_16x16x32_bf16 v[236:239], a[52:55], a[4:7], v[236:239]
 s_nop 0
 s_mov_b32 s83, -1
 v_cndmask_b32 v60, 1.0, v60, s[82:83]
 v_mfma_f32_16x16x32_bf16 v[236:239], a[48:51], a[0:3], v[236:239]
 v_cndmask_b32 v61, 0, v61, s[82:83]
 s_waitcnt lgkmcnt(6)
 v_mfma_f32_16x16x32_bf16 v[240:243], a[24:27], a[8:11], v[240:243]
 ds_read_b64_tr_b16 a[0:1], v14 offset:16928
 v_mul_f32 v64, v61, v63
 v_mfma_f32_16x16x32_bf16 v[240:243], a[28:31], a[12:15], v[240:243]
 ds_read_b64_tr_b16 a[2:3], v14 offset:17184
 buffer_load_dwordx4 v4, s[28:31], s77 offen offset:0 lds
 v_mfma_f32_16x16x32_bf16 v[244:247], a[36:39], a[12:15], v[244:247]
 ds_read_b64_tr_b16 a[4:5], v14 offset:25376
 v_mul_f32 v65, v60, v63
 v_mfma_f32_16x16x32_bf16 v[244:247], a[32:35], a[8:11], v[244:247]
 ds_read_b64_tr_b16 a[6:7], v14 offset:25632
 v_fma_f32 v56, v60, v62, -v64
 v_mfma_f32_16x16x32_bf16 v[248:251], a[40:43], a[8:11], v[248:251]
 v_fma_f32 v57, v61, v62, v65
 s_bfe_i32 s82, s60, 65536
 v_mfma_f32_16x16x32_bf16 v[248:251], a[44:47], a[12:15], v[248:251]
 buffer_load_dwordx4 v5, s[28:31], s77 offen offset:1024 lds
 s_and_b32 s77, s80, 15
 v_mfma_f32_16x16x32_bf16 v[252:255], a[52:55], a[12:15], v[252:255]
 s_xor_b32 s77, s77, 9
 s_lshl_b32 s77, s77, 7
 s_add_u32 m0, s76, 32768
 v_mfma_f32_16x16x32_bf16 v[252:255], a[48:51], a[8:11], v[252:255]
 s_add_u32 s79, s77, 0
 s_mov_b32 s83, s82
 s_waitcnt lgkmcnt(4)
 v_mfma_f32_16x16x32_bf16 v[80:83], a[16:19], a[56:59], v[80:83]
 ds_read_b64_tr_b16 a[8:9], v14 offset:16960
 v_cndmask_b32 v60, 1.0, v48, s[82:83]
 v_mfma_f32_16x16x32_bf16 v[80:83], a[20:23], a[60:63], v[80:83]
 ds_read_b64_tr_b16 a[10:11], v14 offset:17216
 v_cndmask_b32 v61, 0, v49, s[82:83]
 v_mfma_f32_16x16x32_bf16 v[84:87], a[20:23], a[68:71], v[84:87]
 ds_read_b64_tr_b16 a[12:13], v14 offset:25408
 buffer_load_dwordx4 v2, s[24:27], s79 offen offset:0 lds
 v_mfma_f32_16x16x32_bf16 v[84:87], a[16:19], a[64:67], v[84:87]
 ds_read_b64_tr_b16 a[14:15], v14 offset:25664
 s_bfe_i32 s82, s60, 65537
 v_mfma_f32_16x16x32_bf16 v[88:91], a[16:19], a[72:75], v[88:91]
 s_mov_b32 s83, s82
 v_cndmask_b32 v62, 1.0, v18, s[82:83]
 v_cndmask_b32 v63, 0, v19, s[82:83]
 v_mfma_f32_16x16x32_bf16 v[88:91], a[20:23], a[76:79], v[88:91]
 v_mul_f32 v64, v61, v63
 v_mul_f32 v65, v60, v63
 v_mfma_f32_16x16x32_bf16 v[92:95], a[20:23], a[84:87], v[92:95]
 buffer_load_dwordx4 v3, s[24:27], s79 offen offset:1024 lds
 s_add_u32 m0, s76, 34816
 v_mfma_f32_16x16x32_bf16 v[92:95], a[16:19], a[80:83], v[92:95]
 s_add_u32 s79, s77, 4096
 v_fma_f32 v66, v60, v62, -v64
 s_waitcnt lgkmcnt(4)
 v_mfma_f32_16x16x32_bf16 v[128:131], a[0:3], a[56:59], v[128:131]
 ds_read_b64_tr_b16 a[16:17], v14 offset:16992
 v_fma_f32 v61, v61, v62, v65
 v_mfma_f32_16x16x32_bf16 v[128:131], a[4:7], a[60:63], v[128:131]
 ds_read_b64_tr_b16 a[18:19], v14 offset:17248
 v_mov_b32 v60, v66
 v_mfma_f32_16x16x32_bf16 v[132:135], a[4:7], a[68:71], v[132:135]
 ds_read_b64_tr_b16 a[20:21], v14 offset:25440
 v_mul_f32 v64, v61, v57
 v_mfma_f32_16x16x32_bf16 v[132:135], a[0:3], a[64:67], v[132:135]
 ds_read_b64_tr_b16 a[22:23], v14 offset:25696
 buffer_load_dwordx4 v2, s[24:27], s79 offen offset:0 lds
 v_mfma_f32_16x16x32_bf16 v[136:139], a[0:3], a[72:75], v[136:139]
 v_mul_f32 v65, v60, v57
 v_fma_f32 v66, v60, v56, -v64
 v_mfma_f32_16x16x32_bf16 v[136:139], a[4:7], a[76:79], v[136:139]
 v_fma_f32 v19, v61, v56, v65
 v_mov_b32 v18, v66
 v_mfma_f32_16x16x32_bf16 v[140:143], a[4:7], a[84:87], v[140:143]
 v_lshlrev_b32 v46, 16, v46
 v_lshlrev_b32 v47, 16, v47
 v_mfma_f32_16x16x32_bf16 v[140:143], a[0:3], a[80:83], v[140:143]
 buffer_load_dwordx4 v3, s[24:27], s79 offen offset:1024 lds
 s_waitcnt lgkmcnt(4)
 v_mfma_f32_16x16x32_bf16 v[96:99], a[8:11], a[56:59], v[96:99]
 ds_read_b64_tr_b16 a[0:1], v14 offset:17024
 s_add_u32 m0, s76, 36864
 v_mfma_f32_16x16x32_bf16 v[96:99], a[12:15], a[60:63], v[96:99]
 ds_read_b64_tr_b16 a[2:3], v14 offset:17280
 s_add_u32 s79, s77, 8192
 v_mfma_f32_16x16x32_bf16 v[100:103], a[12:15], a[68:71], v[100:103]
 ds_read_b64_tr_b16 a[4:5], v14 offset:25472
 s_xor_b32 s69, s68, 1
 v_mfma_f32_16x16x32_bf16 v[100:103], a[8:11], a[64:67], v[100:103]
 ds_read_b64_tr_b16 a[6:7], v14 offset:25728
 s_lshl_b32 s69, s69, 8
 v_mfma_f32_16x16x32_bf16 v[104:107], a[8:11], a[72:75], v[104:107]
 buffer_atomic_add v76, v77, s[56:59], s69 offen sc1
 v_lshlrev_b32 v42, 16, v42
 v_mfma_f32_16x16x32_bf16 v[104:107], a[12:15], a[76:79], v[104:107]
 v_mul_f32 v42, 0x3fb8aa3b, v42
 v_mfma_f32_16x16x32_bf16 v[108:111], a[12:15], a[84:87], v[108:111]
 buffer_load_dwordx4 v2, s[24:27], s79 offen offset:0 lds
 v_mfma_f32_16x16x32_bf16 v[108:111], a[8:11], a[80:83], v[108:111]
 s_waitcnt lgkmcnt(4)
 v_mfma_f32_16x16x32_bf16 v[144:147], a[16:19], a[56:59], v[144:147]
 ds_read_b64_tr_b16 a[8:9], v14 offset:17056
 v_mfma_f32_16x16x32_bf16 v[144:147], a[20:23], a[60:63], v[144:147]
 ds_read_b64_tr_b16 a[10:11], v14 offset:17312
 v_mfma_f32_16x16x32_bf16 v[148:151], a[20:23], a[68:71], v[148:151]
 ds_read_b64_tr_b16 a[12:13], v14 offset:25504
 buffer_load_dwordx4 v3, s[24:27], s79 offen offset:1024 lds
 v_mfma_f32_16x16x32_bf16 v[148:151], a[16:19], a[64:67], v[148:151]
 ds_read_b64_tr_b16 a[14:15], v14 offset:25760
 s_add_u32 m0, s76, 38912
 v_mfma_f32_16x16x32_bf16 v[152:155], a[16:19], a[72:75], v[152:155]
 s_add_u32 s79, s77, 12288
 v_exp_f32 v42, v42
 v_mfma_f32_16x16x32_bf16 v[152:155], a[20:23], a[76:79], v[152:155]
 v_cvt_pk_bf16_f32 v42, v42, v42
 v_lshlrev_b32 v42, 16, v42
 v_mfma_f32_16x16x32_bf16 v[156:159], a[20:23], a[84:87], v[156:159]
 v_mul_f32 v68, v42, v46
 v_mul_f32 v69, v42, v47
 v_mfma_f32_16x16x32_bf16 v[156:159], a[16:19], a[80:83], v[156:159]
 buffer_load_dwordx4 v2, s[24:27], s79 offen offset:0 lds
 s_waitcnt lgkmcnt(4)
 v_mfma_f32_16x16x32_bf16 v[112:115], a[0:3], a[56:59], v[112:115]
 ds_read_b64_tr_b16 a[16:17], v14 offset:17088
 v_mul_f32 v68, 0x3fb8aa3b, v68
 v_mfma_f32_16x16x32_bf16 v[112:115], a[4:7], a[60:63], v[112:115]
 ds_read_b64_tr_b16 a[18:19], v14 offset:17344
 v_mul_f32 v69, 0x3e22f983, v69
 v_mfma_f32_16x16x32_bf16 v[116:119], a[4:7], a[68:71], v[116:119]
 ds_read_b64_tr_b16 a[20:21], v14 offset:25536
 v_mfma_f32_16x16x32_bf16 v[116:119], a[0:3], a[64:67], v[116:119]
 ds_read_b64_tr_b16 a[22:23], v14 offset:25792
 buffer_load_dwordx4 v3, s[24:27], s79 offen offset:1024 lds
 v_mfma_f32_16x16x32_bf16 v[120:123], a[0:3], a[72:75], v[120:123]
 s_add_u32 m0, s74, 0
 s_mul_i32 s78, s77, 3584
 v_mfma_f32_16x16x32_bf16 v[120:123], a[4:7], a[76:79], v[120:123]
 v_exp_f32 v68, v68
 v_mfma_f32_16x16x32_bf16 v[124:127], a[4:7], a[84:87], v[124:127]
 v_rndne_f32 v70, v69
 v_sub_f32 v69, v69, v70
 v_mfma_f32_16x16x32_bf16 v[124:127], a[0:3], a[80:83], v[124:127]
 s_waitcnt vmcnt(23) lgkmcnt(4)
 v_mfma_f32_16x16x32_bf16 v[160:163], a[8:11], a[56:59], v[160:163]
 ds_read_b128 a[0:3], v12 offset:8192
 buffer_load_dwordx4 v6, s[32:35], s78 offen offset:0 lds
 v_mfma_f32_16x16x32_bf16 v[160:163], a[12:15], a[60:63], v[160:163]
 ds_read_b128 a[4:7], v13 offset:8192
 v_mfma_f32_16x16x32_bf16 v[164:167], a[12:15], a[68:71], v[164:167]
 ds_read_b128 a[24:27], v10 offset:0
 v_mfma_f32_16x16x32_bf16 v[164:167], a[8:11], a[64:67], v[164:167]
 ds_read_b128 a[28:31], v11 offset:0
 v_mfma_f32_16x16x32_bf16 v[168:171], a[8:11], a[72:75], v[168:171]
 buffer_load_dwordx4 v7, s[32:35], s78 offen offset:1056 lds
 v_mfma_f32_16x16x32_bf16 v[168:171], a[12:15], a[76:79], v[168:171]
 v_cos_f32 v70, v69
 v_mfma_f32_16x16x32_bf16 v[172:175], a[12:15], a[84:87], v[172:175]
 v_sin_f32 v71, v69
 v_mfma_f32_16x16x32_bf16 v[172:175], a[8:11], a[80:83], v[172:175]
 v_mul_f32 v72, v46, v46
 s_waitcnt vmcnt(23) lgkmcnt(4)
 v_mfma_f32_16x16x32_bf16 v[176:179], a[16:19], a[56:59], v[176:179]
 ds_read_b128 a[8:11], v12 offset:10240
 s_xor_b32 s69, s68, 2
 v_mfma_f32_16x16x32_bf16 v[176:179], a[20:23], a[60:63], v[176:179]
 ds_read_b128 a[12:15], v13 offset:10240
 buffer_load_dwordx4 v8, s[32:35], s78 offen offset:2112 lds
 v_mfma_f32_16x16x32_bf16 v[180:183], a[20:23], a[68:71], v[180:183]
 ds_read_b128 a[32:35], v10 offset:2048
 s_lshl_b32 s69, s69, 8
 v_mfma_f32_16x16x32_bf16 v[180:183], a[16:19], a[64:67], v[180:183]
 ds_read_b128 a[36:39], v11 offset:2048
 v_fmac_f32 v72, v47, v47
 v_mfma_f32_16x16x32_bf16 v[184:187], a[16:19], a[72:75], v[184:187]
 v_rcp_f32 v72, v72
 v_mfma_f32_16x16x32_bf16 v[184:187], a[20:23], a[76:79], v[184:187]
 buffer_atomic_add v76, v77, s[56:59], s69 offen sc1
 v_mul_f32 v34, v68, v70
 v_mfma_f32_16x16x32_bf16 v[188:191], a[20:23], a[84:87], v[188:191]
 v_mul_f32 v35, v68, v71
 v_add_f32 v72, v72, v72
 v_mfma_f32_16x16x32_bf16 v[188:191], a[16:19], a[80:83], v[188:191]
 buffer_load_dwordx4 v9, s[32:35], s78 offen offset:3168 lds
 s_waitcnt vmcnt(24) lgkmcnt(6)
 v_mfma_f32_16x16x32_bf16 v[192:195], a[56:59], a[0:3], v[192:195]
 ds_read_b128 a[16:19], v12 offset:12288
 s_add_u32 m0, s75, 0
 v_mfma_f32_16x16x32_bf16 v[192:195], a[60:63], a[4:7], v[192:195]
L_pad2:
 s_cbranch_execz L_pad6
 ds_read_b128 a[20:23], v13 offset:12288
 s_nop 0
 v_mfma_f32_16x16x32_bf16 v[196:199], a[68:71], a[4:7], v[196:199]
 ds_read_b128 a[40:43], v10 offset:4096
 v_add_f32 v68, -1.0, v34
 v_mfma_f32_16x16x32_bf16 v[196:199], a[64:67], a[0:3], v[196:199]
 ds_read_b128 a[44:47], v11 offset:4096
 v_mul_f32 v69, v68, v46
 v_mfma_f32_16x16x32_bf16 v[200:203], a[72:75], a[0:3], v[200:203]
 buffer_load_dwordx4 v4, s[28:31], s77 offen offset:0 lds
 v_fmac_f32 v69, v35, v47
 v_mfma_f32_16x16x32_bf16 v[200:203], a[76:79], a[4:7], v[200:203]
 v_mul_f32 v70, v35, v46
 v_fma_f32 v70, -v68, v47, v70
 v_mfma_f32_16x16x32_bf16 v[204:207], a[84:87], a[4:7], v[204:207]
 v_mul_f32 v38, v69, v72
 v_mul_f32 v39, v70, v72
 v_mfma_f32_16x16x32_bf16 v[204:207], a[80:83], a[0:3], v[204:207]
 v_mul_f32 v74, v35, v35
 s_waitcnt vmcnt(23) lgkmcnt(6)
 v_mfma_f32_16x16x32_bf16 v[208:211], a[56:59], a[8:11], v[208:211]
 ds_read_b128 a[0:3], v12 offset:14336
 buffer_load_dwordx4 v5, s[28:31], s77 offen offset:1024 lds
 v_mfma_f32_16x16x32_bf16 v[208:211], a[60:63], a[12:15], v[208:211]
 ds_read_b128 a[4:7], v13 offset:14336
 s_and_b32 s77, s80, 15
 v_mfma_f32_16x16x32_bf16 v[212:215], a[68:71], a[12:15], v[212:215]
 ds_read_b128 a[48:51], v10 offset:6144
 s_xor_b32 s77, s77, 10
 v_mfma_f32_16x16x32_bf16 v[212:215], a[64:67], a[8:11], v[212:215]
 ds_read_b128 a[52:55], v11 offset:6144
 s_lshl_b32 s77, s77, 7
 v_mfma_f32_16x16x32_bf16 v[216:219], a[72:75], a[8:11], v[216:219]
 s_add_u32 m0, s76, 0
 s_add_u32 s79, s77, 0
 v_add_f32 v75, v34, v34
 v_mfma_f32_16x16x32_bf16 v[216:219], a[76:79], a[12:15], v[216:219]
 buffer_load_dwordx4 v2, s[24:27], s79 offen offset:0 lds
 v_fma_f32 v68, v34, v34, -v74
 v_mfma_f32_16x16x32_bf16 v[220:223], a[84:87], a[12:15], v[220:223]
 v_mul_f32 v69, v75, v35
 v_mul_f32 v74, v69, v69
 v_mfma_f32_16x16x32_bf16 v[220:223], a[80:83], a[8:11], v[220:223]
 s_waitcnt vmcnt(17) lgkmcnt(2)
 s_barrier
 v_mfma_f32_16x16x32_bf16 v[224:227], a[56:59], a[16:19], v[224:227]
 ds_read_b64_tr_b16 a[8:9], v14 offset:33792
 v_add_f32 v75, v68, v68
 v_mfma_f32_16x16x32_bf16 v[224:227], a[60:63], a[20:23], v[224:227]
 ds_read_b64_tr_b16 a[10:11], v14 offset:34048
 buffer_load_dwordx4 v3, s[24:27], s79 offen offset:1024 lds
 v_mfma_f32_16x16x32_bf16 v[228:231], a[68:71], a[20:23], v[228:231]
 ds_read_b64_tr_b16 a[12:13], v14 offset:42240
 s_add_u32 m0, s76, 2048
 v_mfma_f32_16x16x32_bf16 v[228:231], a[64:67], a[16:19], v[228:231]
 ds_read_b64_tr_b16 a[14:15], v14 offset:42496
 s_add_u32 s79, s77, 4096
 v_mfma_f32_16x16x32_bf16 v[232:235], a[72:75], a[16:19], v[232:235]
 v_fma_f32 v70, v68, v68, -v74
 v_mul_f32 v71, v75, v69
 v_mfma_f32_16x16x32_bf16 v[232:235], a[76:79], a[20:23], v[232:235]
 v_mul_f32 v74, v71, v71
 v_add_f32 v75, v70, v70
 v_mfma_f32_16x16x32_bf16 v[236:239], a[84:87], a[20:23], v[236:239]
 buffer_load_dwordx4 v2, s[24:27], s79 offen offset:0 lds
 v_fma_f32 v42, v70, v70, -v74
 v_mfma_f32_16x16x32_bf16 v[236:239], a[80:83], a[16:19], v[236:239]
 v_mul_f32 v43, v75, v71
 s_waitcnt lgkmcnt(6)
 v_mfma_f32_16x16x32_bf16 v[240:243], a[56:59], a[0:3], v[240:243]
 ds_read_b64_tr_b16 a[16:17], v14 offset:33824
 s_xor_b32 s69, s68, 3
 v_mfma_f32_16x16x32_bf16 v[240:243], a[60:63], a[4:7], v[240:243]
 ds_read_b64_tr_b16 a[18:19], v14 offset:34080
 s_lshl_b32 s69, s69, 8
 v_mfma_f32_16x16x32_bf16 v[244:247], a[68:71], a[4:7], v[244:247]
 ds_read_b64_tr_b16 a[20:21], v14 offset:42272
 buffer_atomic_add v76, v77, s[56:59], s69 offen sc1
 v_mfma_f32_16x16x32_bf16 v[244:247], a[64:67], a[0:3], v[244:247]
 ds_read_b64_tr_b16 a[22:23], v14 offset:42528
 v_mul_f32 v74, v43, v43
 v_mfma_f32_16x16x32_bf16 v[248:251], a[72:75], a[0:3], v[248:251]
 buffer_load_dwordx4 v3, s[24:27], s79 offen offset:1024 lds
 s_add_u32 m0, s76, 4096
 v_mfma_f32_16x16x32_bf16 v[248:251], a[76:79], a[4:7], v[248:251]
 s_add_u32 s79, s77, 8192
 v_add_f32 v75, v42, v42
 v_fma_f32 v46, v42, v42, -v74
 v_mfma_f32_16x16x32_bf16 v[252:255], a[84:87], a[4:7], v[252:255]
 v_mul_f32 v47, v75, v43
 v_mul_f32 v74, v47, v47
 v_mfma_f32_16x16x32_bf16 v[252:255], a[80:83], a[0:3], v[252:255]
 v_add_f32 v75, v46, v46
 s_waitcnt lgkmcnt(4)
 v_mfma_f32_16x16x32_bf16 v[80:83], a[8:11], a[24:27], v[80:83]
 ds_read_b64_tr_b16 a[0:1], v14 offset:33856
 v_fma_f32 v68, v46, v46, -v74
 v_mfma_f32_16x16x32_bf16 v[80:83], a[12:15], a[28:31], v[80:83]
 ds_read_b64_tr_b16 a[2:3], v14 offset:34112
 buffer_load_dwordx4 v2, s[24:27], s79 offen offset:0 lds
 v_mfma_f32_16x16x32_bf16 v[84:87], a[12:15], a[36:39], v[84:87]
 ds_read_b64_tr_b16 a[4:5], v14 offset:42304
 v_mul_f32 v69, v75, v47
 v_mfma_f32_16x16x32_bf16 v[84:87], a[8:11], a[32:35], v[84:87]
 ds_read_b64_tr_b16 a[6:7], v14 offset:42560
 v_mul_f32 v74, v69, v69
 v_mfma_f32_16x16x32_bf16 v[88:91], a[8:11], a[40:43], v[88:91]
 v_add_f32 v75, v68, v68
 v_fma_f32 v50, v68, v68, -v74
 v_mfma_f32_16x16x32_bf16 v[88:91], a[12:15], a[44:47], v[88:91]
 buffer_load_dwordx4 v3, s[24:27], s79 offen offset:1024 lds
 s_add_u32 m0, s76, 6144
 v_mfma_f32_16x16x32_bf16 v[92:95], a[12:15], a[52:55], v[92:95]
 s_add_u32 s79, s77, 12288
 v_mul_f32 v51, v75, v69
 v_mul_f32 v74, v51, v51
 v_mfma_f32_16x16x32_bf16 v[92:95], a[8:11], a[48:51], v[92:95]
 v_add_f32 v75, v50, v50
 s_waitcnt lgkmcnt(4)
 v_mfma_f32_16x16x32_bf16 v[128:131], a[16:19], a[24:27], v[128:131]
 ds_read_b64_tr_b16 a[8:9], v14 offset:33888
 v_fma_f32 v20, v50, v50, -v74
 v_mfma_f32_16x16x32_bf16 v[128:131], a[20:23], a[28:31], v[128:131]
 ds_read_b64_tr_b16 a[10:11], v14 offset:34144
 v_mul_f32 v21, v75, v51
 v_mfma_f32_16x16x32_bf16 v[132:135], a[20:23], a[36:39], v[132:135]
 ds_read_b64_tr_b16 a[12:13], v14 offset:42336
 buffer_load_dwordx4 v2, s[24:27], s79 offen offset:0 lds
 v_mfma_f32_16x16x32_bf16 v[132:135], a[16:19], a[32:35], v[132:135]
 ds_read_b64_tr_b16 a[14:15], v14 offset:42592
 v_mul_f32 v74, v21, v21
 v_mfma_f32_16x16x32_bf16 v[136:139], a[16:19], a[40:43], v[136:139]
 v_add_f32 v75, v20, v20
 v_fma_f32 v54, v20, v20, -v74
 v_mfma_f32_16x16x32_bf16 v[136:139], a[20:23], a[44:47], v[136:139]
 v_mul_f32 v55, v75, v21
 s_mov_b32 s82, 0xffff0000
 v_mfma_f32_16x16x32_bf16 v[140:143], a[20:23], a[52:55], v[140:143]
 buffer_load_dwordx4 v3, s[24:27], s79 offen offset:1024 lds
 s_add_u32 m0, s74, 16896
 v_mfma_f32_16x16x32_bf16 v[140:143], a[16:19], a[48:51], v[140:143]
 s_mul_i32 s78, s77, 3584
 s_mov_b32 s83, 0xffff0000
 s_waitcnt lgkmcnt(4)
 v_mfma_f32_16x16x32_bf16 v[96:99], a[0:3], a[24:27], v[96:99]
 ds_read_b64_tr_b16 a[16:17], v14 offset:33920
 v_cndmask_b32 v70, 1.0, v46, s[82:83]
 v_mfma_f32_16x16x32_bf16 v[96:99], a[4:7], a[28:31], v[96:99]
 ds_read_b64_tr_b16 a[18:19], v14 offset:34176
 v_cndmask_b32 v71, 0, v47, s[82:83]
 v_mfma_f32_16x16x32_bf16 v[100:103], a[4:7], a[36:39], v[100:103]
 ds_read_b64_tr_b16 a[20:21], v14 offset:42368
 s_mov_b32 s82, 0
 v_mfma_f32_16x16x32_bf16 v[100:103], a[0:3], a[32:35], v[100:103]
 ds_read_b64_tr_b16 a[22:23], v14 offset:42624
 buffer_load_dwordx4 v6, s[32:35], s78 offen offset:0 lds
 v_mfma_f32_16x16x32_bf16 v[104:107], a[0:3], a[40:43], v[104:107]
 s_mov_b32 s83, -1
 v_cndmask_b32 v68, 1.0, v68, s[82:83]
 v_cndmask_b32 v69, 0, v69, s[82:83]
 v_mfma_f32_16x16x32_bf16 v[104:107], a[4:7], a[44:47], v[104:107]
 v_mul_f32 v72, v69, v71
 v_mul_f32 v73, v68, v71
 v_mfma_f32_16x16x32_bf16 v[108:111], a[4:7], a[52:55], v[108:111]
 v_fma_f32 v58, v68, v70, -v72
 v_fma_f32 v59, v69, v70, v73
 v_mfma_f32_16x16x32_bf16 v[108:111], a[0:3], a[48:51], v[108:111]
 buffer_load_dwordx4 v7, s[32:35], s78 offen offset:1056 lds
 s_waitcnt lgkmcnt(4)
 v_mfma_f32_16x16x32_bf16 v[144:147], a[8:11], a[24:27], v[144:147]
 ds_read_b64_tr_b16 a[0:1], v14 offset:33952
 s_xor_b32 s69, s68, 4
 v_mfma_f32_16x16x32_bf16 v[144:147], a[12:15], a[28:31], v[144:147]
 ds_read_b64_tr_b16 a[2:3], v14 offset:34208
 s_lshl_b32 s69, s69, 8
 v_mfma_f32_16x16x32_bf16 v[148:151], a[12:15], a[36:39], v[148:151]
 ds_read_b64_tr_b16 a[4:5], v14 offset:42400
 s_bfe_i32 s82, s60, 65536
 v_mfma_f32_16x16x32_bf16 v[148:151], a[8:11], a[32:35], v[148:151]
 ds_read_b64_tr_b16 a[6:7], v14 offset:42656
 s_mov_b32 s83, s82
 v_mfma_f32_16x16x32_bf16 v[152:155], a[8:11], a[40:43], v[152:155]
 buffer_atomic_add v76, v77, s[56:59], s69 offen sc1
 v_cndmask_b32 v68, 1.0, v50, s[82:83]
 v_mfma_f32_16x16x32_bf16 v[152:155], a[12:15], a[44:47], v[152:155]
 v_cndmask_b32 v69, 0, v51, s[82:83]
 s_bfe_i32 s82, s60, 65537
 v_mfma_f32_16x16x32_bf16 v[156:159], a[12:15], a[52:55], v[156:159]
 buffer_load_dwordx4 v8, s[32:35], s78 offen offset:2112 lds
 s_mov_b32 s83, s82
 v_mfma_f32_16x16x32_bf16 v[156:159], a[8:11], a[48:51], v[156:159]
 v_cndmask_b32 v70, 1.0, v20, s[82:83]
 s_waitcnt lgkmcnt(4)
 v_mfma_f32_16x16x32_bf16 v[112:115], a[16:19], a[24:27], v[112:115]
 ds_read_b64_tr_b16 a[8:9], v14 offset:33984
 v_cndmask_b32 v71, 0, v21, s[82:83]
 v_mfma_f32_16x16x32_bf16 v[112:115], a[20:23], a[28:31], v[112:115]
 ds_read_b64_tr_b16 a[10:11], v14 offset:34240
 v_mul_f32 v72, v69, v71
 v_mfma_f32_16x16x32_bf16 v[116:119], a[20:23], a[36:39], v[116:119]
 ds_read_b64_tr_b16 a[12:13], v14 offset:42432
 buffer_load_dwordx4 v9, s[32:35], s78 offen offset:3168 lds
 v_mfma_f32_16x16x32_bf16 v[116:119], a[16:19], a[32:35], v[116:119]
 ds_read_b64_tr_b16 a[14:15], v14 offset:42688
 s_add_u32 m0, s75, 8192
 v_mfma_f32_16x16x32_bf16 v[120:123], a[16:19], a[40:43], v[120:123]
 s_nop 0
 v_mul_f32 v73, v68, v71
 v_fma_f32 v74, v68, v70, -v72
 v_mfma_f32_16x16x32_bf16 v[120:123], a[20:23], a[44:47], v[120:123]
 v_fma_f32 v69, v69, v70, v73
 v_mov_b32 v68, v74
 v_mfma_f32_16x16x32_bf16 v[124:127], a[20:23], a[52:55], v[124:127]
 v_mul_f32 v72, v69, v59
 v_mul_f32 v73, v68, v59
 v_mfma_f32_16x16x32_bf16 v[124:127], a[16:19], a[48:51], v[124:127]
 buffer_load_dwordx4 v4, s[28:31], s77 offen offset:0 lds
 s_waitcnt vmcnt(29) lgkmcnt(4)
 v_mfma_f32_16x16x32_bf16 v[160:163], a[0:3], a[24:27], v[160:163]
 ds_read_b128 a[16:19], v12 offset:16384
 v_fma_f32 v74, v68, v58, -v72
 v_mfma_f32_16x16x32_bf16 v[160:163], a[4:7], a[28:31], v[160:163]
 ds_read_b128 a[20:23], v13 offset:16384
 v_fma_f32 v21, v69, v58, v73
 v_mfma_f32_16x16x32_bf16 v[164:167], a[4:7], a[36:39], v[164:167]
 ds_read_b128 a[56:59], v10 offset:32768
 v_mov_b32 v20, v74
 v_mfma_f32_16x16x32_bf16 v[164:167], a[0:3], a[32:35], v[164:167]
 ds_read_b128 a[60:63], v11 offset:32768
 buffer_load_dwordx4 v5, s[28:31], s77 offen offset:1024 lds
 v_mfma_f32_16x16x32_bf16 v[168:171], a[0:3], a[40:43], v[168:171]
 s_mul_i32 s72, s61, 896
 s_lshl_b32 s73, s60, 1
 s_add_u32 s72, s72, s73
 v_mfma_f32_16x16x32_bf16 v[168:171], a[4:7], a[44:47], v[168:171]
 v_lshrrev_b32 v69, 5, v0
 v_and_b32 v70, 16, v0
 v_mfma_f32_16x16x32_bf16 v[172:175], a[4:7], a[52:55], v[172:175]
 v_lshl_add_u32 v69, v69, 3, v70
 v_add_u32 v69, s72, v69
 v_mfma_f32_16x16x32_bf16 v[172:175], a[0:3], a[48:51], v[172:175]
 s_and_b32 s72, s61, 1
 s_lshl_b32 s72, s72, 3
 s_waitcnt vmcnt(28) lgkmcnt(4)
 v_mfma_f32_16x16x32_bf16 v[176:179], a[8:11], a[24:27], v[176:179]
 ds_read_b128 a[0:3], v12 offset:18432
 v_and_b32 v68, 15, v0
 v_mfma_f32_16x16x32_bf16 v[176:179], a[12:15], a[28:31], v[176:179]
 ds_read_b128 a[4:7], v13 offset:18432
 v_xor_b32 v70, s72, v68
 v_mfma_f32_16x16x32_bf16 v[180:183], a[12:15], a[36:39], v[180:183]
 ds_read_b128 a[64:67], v10 offset:34816
 v_lshlrev_b32 v69, 11, v69
 v_mfma_f32_16x16x32_bf16 v[180:183], a[8:11], a[32:35], v[180:183]
 ds_read_b128 a[68:71], v11 offset:34816
 v_lshl_add_u32 v69, v70, 4, v69
 v_mfma_f32_16x16x32_bf16 v[184:187], a[8:11], a[40:43], v[184:187]
 s_lshl_b32 s72, s63, 8
 v_add_u32 v16, s72, v69
 v_add_u32 v17, 992, v16
 v_mfma_f32_16x16x32_bf16 v[184:187], a[12:15], a[44:47], v[184:187]
 v_lshrrev_b32 v69, 5, v0
 v_lshl_add_u32 v69, v69, 14, v16
 v_mfma_f32_16x16x32_bf16 v[188:191], a[12:15], a[52:55], v[188:191]
 v_bfe_u32 v70, v0, 4, 1
 v_mul_u32_u24 v71, 24576, v70
 v_mfma_f32_16x16x32_bf16 v[188:191], a[8:11], a[48:51], v[188:191]
 v_sub_u32 v69, v69, v71
 s_waitcnt vmcnt(25) lgkmcnt(6)
 v_mfma_f32_16x16x32_bf16 v[192:195], a[24:27], a[16:19], v[192:195]
 ds_read_b128 a[8:11], v12 offset:20480
 s_xor_b32 s69, s68, 5
 v_mfma_f32_16x16x32_bf16 v[192:195], a[28:31], a[20:23], v[192:195]
 ds_read_b128 a[12:15], v13 offset:20480
 s_lshl_b32 s69, s69, 8
 v_mfma_f32_16x16x32_bf16 v[196:199], a[36:39], a[20:23], v[196:199]
 ds_read_b128 a[72:75], v10 offset:36864
 buffer_atomic_add v76, v77, s[56:59], s69 offen sc1
 v_mfma_f32_16x16x32_bf16 v[196:199], a[32:35], a[16:19], v[196:199]
 ds_read_b128 a[76:79], v11 offset:36864
 s_lshr_b32 s72, s60, 1
 v_mfma_f32_16x16x32_bf16 v[200:203], a[40:43], a[16:19], v[200:203]
 s_lshl_b32 s72, s72, 13
 v_add_u32 v24, s72, v69
 v_and_b32 v71, 7, v0
 v_mfma_f32_16x16x32_bf16 v[200:203], a[44:47], a[20:23], v[200:203]
 v_lshlrev_b32 v25, 2, v71
 v_add_u32 v22, 50688, v14
 v_mfma_f32_16x16x32_bf16 v[204:207], a[52:55], a[20:23], v[204:207]
 v_add_u32 v23, 101376, v14
 s_lshl_b32 s72, s62, 2
 v_mfma_f32_16x16x32_bf16 v[204:207], a[48:51], a[16:19], v[204:207]
 s_add_u32 s72, s72, s60
 s_lshl_b32 s72, s72, 2
 s_waitcnt vmcnt(24) lgkmcnt(6)
 v_mfma_f32_16x16x32_bf16 v[208:211], a[24:27], a[0:3], v[208:211]
 ds_read_b128 a[16:19], v12 offset:22528
 s_and_b32 s77, s80, 15
 v_mfma_f32_16x16x32_bf16 v[208:211], a[28:31], a[4:7], v[208:211]
 ds_read_b128 a[20:23], v13 offset:22528
 s_xor_b32 s77, s77, 11
 v_mfma_f32_16x16x32_bf16 v[212:215], a[36:39], a[4:7], v[212:215]
 ds_read_b128 a[80:83], v10 offset:38912
 s_lshl_b32 s77, s77, 7
 v_mfma_f32_16x16x32_bf16 v[212:215], a[32:35], a[0:3], v[212:215]
 ds_read_b128 a[84:87], v11 offset:38912
 s_add_u32 m0, s76, 32768
 v_mfma_f32_16x16x32_bf16 v[216:219], a[40:43], a[0:3], v[216:219]
 s_add_u32 s79, s77, 0
 buffer_load_dwordx4 v2, s[24:27], s79 offen offset:0 lds
 v_mfma_f32_16x16x32_bf16 v[216:219], a[44:47], a[4:7], v[216:219]
 s_add_u32 s72, s72, s61
 s_mul_i32 s72, s72, 180224
 v_lshl_add_u32 v15, v0, 4, s72
 v_mfma_f32_16x16x32_bf16 v[220:223], a[52:55], a[4:7], v[220:223]
 v_mul_u32_u24 v70, 768, v70
 v_add_u32 v70, v70, v15
 v_mfma_f32_16x16x32_bf16 v[220:223], a[48:51], a[0:3], v[220:223]
 s_waitcnt vmcnt(18) lgkmcnt(2)
 s_barrier
 v_mfma_f32_16x16x32_bf16 v[224:227], a[24:27], a[8:11], v[224:227]
 ds_read_b64_tr_b16 a[0:1], v14 offset:0
 buffer_load_dwordx4 v3, s[24:27], s79 offen offset:1024 lds
 v_mfma_f32_16x16x32_bf16 v[224:227], a[28:31], a[12:15], v[224:227]
 ds_read_b64_tr_b16 a[2:3], v14 offset:256
 s_add_u32 m0, s76, 34816
 v_mfma_f32_16x16x32_bf16 v[228:231], a[36:39], a[12:15], v[228:231]
 ds_read_b64_tr_b16 a[4:5], v14 offset:8448
 s_add_u32 s79, s77, 4096
 v_mfma_f32_16x16x32_bf16 v[228:231], a[32:35], a[8:11], v[228:231]
 ds_read_b64_tr_b16 a[6:7], v14 offset:8704
 v_and_b32 v71, 32, v0
 v_mfma_f32_16x16x32_bf16 v[232:235], a[40:43], a[8:11], v[232:235]
 v_lshlrev_b32 v71, 3, v71
 v_sub_u32 v31, v70, v71
 v_mfma_f32_16x16x32_bf16 v[232:235], a[44:47], a[12:15], v[232:235]
 buffer_load_dwordx4 v2, s[24:27], s79 offen offset:0 lds
 v_lshlrev_b32 v26, 4, v68
 v_mfma_f32_16x16x32_bf16 v[236:239], a[52:55], a[12:15], v[236:239]
 s_lshl_b32 s72, s60, 10
 s_add_u32 s72, s72, 140800
 v_lshl_add_u32 v27, v0, 4, s72
 v_mfma_f32_16x16x32_bf16 v[236:239], a[48:51], a[8:11], v[236:239]
 v_add_u32 v28, s72, v26
 s_waitcnt lgkmcnt(6)
 v_mfma_f32_16x16x32_bf16 v[240:243], a[24:27], a[16:19], v[240:243]
 ds_read_b64_tr_b16 a[8:9], v14 offset:32
 v_add_u32 v30, 144896, v26
 v_mfma_f32_16x16x32_bf16 v[240:243], a[28:31], a[20:23], v[240:243]
 ds_read_b64_tr_b16 a[10:11], v14 offset:288
 buffer_load_dwordx4 v3, s[24:27], s79 offen offset:1024 lds
 v_mfma_f32_16x16x32_bf16 v[244:247], a[36:39], a[20:23], v[244:247]
 ds_read_b64_tr_b16 a[12:13], v14 offset:8480
 s_add_u32 m0, s76, 36864
 v_mfma_f32_16x16x32_bf16 v[244:247], a[32:35], a[16:19], v[244:247]
 ds_read_b64_tr_b16 a[14:15], v14 offset:8736
 s_add_u32 s79, s77, 8192
 v_mfma_f32_16x16x32_bf16 v[248:251], a[40:43], a[16:19], v[248:251]
 s_lshl_b32 s72, s60, 8
 v_add_u32 v29, s72, v30
 s_mul_i32 s72, s60, 4608
 v_mfma_f32_16x16x32_bf16 v[248:251], a[44:47], a[20:23], v[248:251]
 s_min_u32 s73, s60, 1
 s_mul_i32 s73, s73, 6144
 s_add_u32 s72, s72, s73
 v_mfma_f32_16x16x32_bf16 v[252:255], a[52:55], a[20:23], v[252:255]
 buffer_load_dwordx4 v2, s[24:27], s79 offen offset:0 lds
 s_add_u32 s72, s72, 135168
 v_mfma_f32_16x16x32_bf16 v[252:255], a[48:51], a[16:19], v[252:255]
 v_lshrrev_b32 v69, 4, v0
 s_waitcnt lgkmcnt(4)
 v_mfma_f32_16x16x32_bf16 v[80:83], a[0:3], a[56:59], v[80:83]
 ds_read_b64_tr_b16 a[16:17], v14 offset:64
 s_xor_b32 s69, s68, 6
 v_mfma_f32_16x16x32_bf16 v[80:83], a[4:7], a[60:63], v[80:83]
 ds_read_b64_tr_b16 a[18:19], v14 offset:320
 s_lshl_b32 s69, s69, 8
 v_mfma_f32_16x16x32_bf16 v[84:87], a[4:7], a[68:71], v[84:87]
 ds_read_b64_tr_b16 a[20:21], v14 offset:8512
 buffer_atomic_add v76, v77, s[56:59], s69 offen sc1
 v_mfma_f32_16x16x32_bf16 v[84:87], a[0:3], a[64:67], v[84:87]
 ds_read_b64_tr_b16 a[22:23], v14 offset:8768
 v_mul_u32_u24 v70, 288, v69
 v_mfma_f32_16x16x32_bf16 v[88:91], a[0:3], a[72:75], v[88:91]
 buffer_load_dwordx4 v3, s[24:27], s79 offen offset:1024 lds
 s_add_u32 m0, s76, 38912
 v_mfma_f32_16x16x32_bf16 v[88:91], a[4:7], a[76:79], v[88:91]
 s_add_u32 s79, s77, 12288
 v_lshl_add_u32 v70, v68, 3, v70
 v_add_u32 v66, s72, v70
 v_mfma_f32_16x16x32_bf16 v[92:95], a[4:7], a[84:87], v[92:95]
 v_and_b32 v70, 3, v0
 v_mul_u32_u24 v70, 288, v70
 v_mfma_f32_16x16x32_bf16 v[92:95], a[0:3], a[80:83], v[92:95]
 v_lshl_add_u32 v70, v69, 6, v70
 s_waitcnt lgkmcnt(4)
 v_mfma_f32_16x16x32_bf16 v[128:131], a[8:11], a[56:59], v[128:131]
 ds_read_b64_tr_b16 a[0:1], v14 offset:96
 v_and_b32 v71, 12, v0
 v_mfma_f32_16x16x32_bf16 v[128:131], a[12:15], a[60:63], v[128:131]
 ds_read_b64_tr_b16 a[2:3], v14 offset:352
 buffer_load_dwordx4 v2, s[24:27], s79 offen offset:0 lds
 v_mfma_f32_16x16x32_bf16 v[132:135], a[12:15], a[68:71], v[132:135]
 ds_read_b64_tr_b16 a[4:5], v14 offset:8544
 v_lshl_add_u32 v70, v71, 1, v70
 v_mfma_f32_16x16x32_bf16 v[132:135], a[8:11], a[64:67], v[132:135]
 ds_read_b64_tr_b16 a[6:7], v14 offset:8800
 v_add_u32 v67, s72, v70
 v_mfma_f32_16x16x32_bf16 v[136:139], a[8:11], a[72:75], v[136:139]
 v_add_u32 v65, s72, v26
 v_lshlrev_b32 v64, 4, v0
 v_mfma_f32_16x16x32_bf16 v[136:139], a[12:15], a[76:79], v[136:139]
 buffer_load_dwordx4 v3, s[24:27], s79 offen offset:1024 lds
 s_add_u32 m0, s74, 33792
 v_mfma_f32_16x16x32_bf16 v[140:143], a[12:15], a[84:87], v[140:143]
 s_mul_i32 s78, s77, 3584
 v_lshlrev_b32 v72, 2, v0
 s_lshr_b32 s66, s74, 1
 v_mfma_f32_16x16x32_bf16 v[140:143], a[8:11], a[80:83], v[140:143]
 s_lshl_b32 s67, s60, 11
 s_and_b32 s3, s3, 3
 s_waitcnt lgkmcnt(4)
 v_mfma_f32_16x16x32_bf16 v[96:99], a[16:19], a[56:59], v[96:99]
 ds_read_b64_tr_b16 a[8:9], v14 offset:128
 s_mov_b32 s72, s63
 v_mfma_f32_16x16x32_bf16 v[96:99], a[20:23], a[60:63], v[96:99]
 ds_read_b64_tr_b16 a[10:11], v14 offset:384
 s_mul_i32 s72, s72, 7
 v_mfma_f32_16x16x32_bf16 v[100:103], a[20:23], a[68:71], v[100:103]
 ds_read_b64_tr_b16 a[12:13], v14 offset:8576
 buffer_load_dwordx4 v6, s[32:35], s78 offen offset:0 lds
 v_mfma_f32_16x16x32_bf16 v[100:103], a[16:19], a[64:67], v[100:103]
 ds_read_b64_tr_b16 a[14:15], v14 offset:8832
 s_add_u32 s72, s72, 1
 v_mfma_f32_16x16x32_bf16 v[104:107], a[16:19], a[72:75], v[104:107]
 s_lshr_b32 s72, s72, 1
 s_lshl_b32 s17, s72, 12
 s_mul_i32 s72, s65, 2
 v_mfma_f32_16x16x32_bf16 v[104:107], a[20:23], a[76:79], v[104:107]
 s_add_u32 s72, s72, 0
 s_sub_u32 s73, s72, 7
 s_min_u32 s72, s72, s73
 v_mfma_f32_16x16x32_bf16 v[108:111], a[20:23], a[84:87], v[108:111]
 buffer_load_dwordx4 v7, s[32:35], s78 offen offset:1056 lds
 s_add_u32 s72, s72, s63
 v_mfma_f32_16x16x32_bf16 v[108:111], a[16:19], a[80:83], v[108:111]
 s_add_u32 s72, s72, 1
 s_and_b32 s72, s72, 7
 s_waitcnt lgkmcnt(4)
 v_mfma_f32_16x16x32_bf16 v[144:147], a[0:3], a[56:59], v[144:147]
 ds_read_b64_tr_b16 a[16:17], v14 offset:160
 s_mul_i32 s72, s72, 7
 v_mfma_f32_16x16x32_bf16 v[144:147], a[4:7], a[60:63], v[144:147]
 ds_read_b64_tr_b16 a[18:19], v14 offset:416
 s_add_u32 s72, s72, 1
 v_mfma_f32_16x16x32_bf16 v[148:151], a[4:7], a[68:71], v[148:151]
 ds_read_b64_tr_b16 a[20:21], v14 offset:8608
 s_lshr_b32 s72, s72, 1
 v_mfma_f32_16x16x32_bf16 v[148:151], a[0:3], a[64:67], v[148:151]
 ds_read_b64_tr_b16 a[22:23], v14 offset:8864
 buffer_load_dwordx4 v8, s[32:35], s78 offen offset:2112 lds
 v_mfma_f32_16x16x32_bf16 v[152:155], a[0:3], a[72:75], v[152:155]
 s_lshl_b32 s4, s72, 12
 s_mul_i32 s72, s65, 2
 s_add_u32 s72, s72, 1
 v_mfma_f32_16x16x32_bf16 v[152:155], a[4:7], a[76:79], v[152:155]
 s_sub_u32 s73, s72, 7
 s_min_u32 s72, s72, s73
 s_add_u32 s72, s72, s63
 v_mfma_f32_16x16x32_bf16 v[156:159], a[4:7], a[84:87], v[156:159]
 s_add_u32 s72, s72, 1
 s_and_b32 s72, s72, 7
 s_mul_i32 s72, s72, 7
 v_mfma_f32_16x16x32_bf16 v[156:159], a[0:3], a[80:83], v[156:159]
 buffer_load_dwordx4 v9, s[32:35], s78 offen offset:3168 lds
 s_waitcnt lgkmcnt(4)
 v_mfma_f32_16x16x32_bf16 v[112:115], a[8:11], a[56:59], v[112:115]
 ds_read_b64_tr_b16 a[0:1], v14 offset:192
 s_add_u32 m0, s75, 16384
 v_mfma_f32_16x16x32_bf16 v[112:115], a[12:15], a[60:63], v[112:115]
 ds_read_b64_tr_b16 a[2:3], v14 offset:448
 s_nop 0
 v_mfma_f32_16x16x32_bf16 v[116:119], a[12:15], a[68:71], v[116:119]
 ds_read_b64_tr_b16 a[4:5], v14 offset:8640
 s_xor_b32 s69, s68, 7
 v_mfma_f32_16x16x32_bf16 v[116:119], a[8:11], a[64:67], v[116:119]
 ds_read_b64_tr_b16 a[6:7], v14 offset:8896
 s_lshl_b32 s69, s69, 8
 v_mfma_f32_16x16x32_bf16 v[120:123], a[8:11], a[72:75], v[120:123]
 buffer_atomic_add v76, v77, s[56:59], s69 offen sc1
 s_add_u32 s72, s72, 1
 v_mfma_f32_16x16x32_bf16 v[120:123], a[12:15], a[76:79], v[120:123]
 s_lshr_b32 s72, s72, 1
 s_lshl_b32 s5, s72, 12
 s_mul_i32 s72, s65, 2
 v_mfma_f32_16x16x32_bf16 v[124:127], a[12:15], a[84:87], v[124:127]
 buffer_load_dwordx4 v4, s[28:31], s77 offen offset:0 lds
 s_add_u32 s72, s72, 2
 v_mfma_f32_16x16x32_bf16 v[124:127], a[8:11], a[80:83], v[124:127]
 s_sub_u32 s73, s72, 7
 s_min_u32 s72, s72, s73
 s_waitcnt vmcnt(30) lgkmcnt(4)
 v_mfma_f32_16x16x32_bf16 v[160:163], a[16:19], a[56:59], v[160:163]
 ds_read_b128 a[8:11], v12 offset:0
 s_add_u32 s72, s72, s63
 v_mfma_f32_16x16x32_bf16 v[160:163], a[20:23], a[60:63], v[160:163]
 ds_read_b128 a[12:15], v13 offset:0
 s_add_u32 s72, s72, 1
 v_mfma_f32_16x16x32_bf16 v[164:167], a[20:23], a[68:71], v[164:167]
 ds_read_b128 a[24:27], v10 offset:0
 buffer_load_dwordx4 v5, s[28:31], s77 offen offset:1024 lds
 v_mfma_f32_16x16x32_bf16 v[164:167], a[16:19], a[64:67], v[164:167]
 ds_read_b128 a[28:31], v11 offset:0
 s_and_b32 s72, s72, 7
 v_mfma_f32_16x16x32_bf16 v[168:171], a[16:19], a[72:75], v[168:171]
 s_mul_i32 s72, s72, 7
 s_add_u32 s72, s72, 1
 s_lshr_b32 s72, s72, 1
 v_mfma_f32_16x16x32_bf16 v[168:171], a[20:23], a[76:79], v[168:171]
 s_lshl_b32 s6, s72, 12
 s_mul_i32 s72, s65, 2
 s_add_u32 s72, s72, 3
 v_mfma_f32_16x16x32_bf16 v[172:175], a[20:23], a[84:87], v[172:175]
 s_sub_u32 s73, s72, 7
 s_min_u32 s72, s72, s73
 s_add_u32 s72, s72, s63
 v_mfma_f32_16x16x32_bf16 v[172:175], a[16:19], a[80:83], v[172:175]
 s_add_u32 s72, s72, 1
 s_and_b32 s72, s72, 7
 s_waitcnt vmcnt(28) lgkmcnt(4)
 v_mfma_f32_16x16x32_bf16 v[176:179], a[0:3], a[56:59], v[176:179]
 ds_read_b128 a[16:19], v12 offset:2048
 s_mul_i32 s72, s72, 7
 v_mfma_f32_16x16x32_bf16 v[176:179], a[4:7], a[60:63], v[176:179]
 ds_read_b128 a[20:23], v13 offset:2048
 s_add_u32 s72, s72, 1
 v_mfma_f32_16x16x32_bf16 v[180:183], a[4:7], a[68:71], v[180:183]
 ds_read_b128 a[32:35], v10 offset:2048
 s_lshr_b32 s72, s72, 1
 v_mfma_f32_16x16x32_bf16 v[180:183], a[0:3], a[64:67], v[180:183]
 ds_read_b128 a[36:39], v11 offset:2048
 s_lshl_b32 s7, s72, 12
 v_mfma_f32_16x16x32_bf16 v[184:187], a[0:3], a[72:75], v[184:187]
 s_mul_i32 s72, s65, 2
 s_add_u32 s72, s72, 4
 s_sub_u32 s73, s72, 7
 v_mfma_f32_16x16x32_bf16 v[184:187], a[4:7], a[76:79], v[184:187]
 s_min_u32 s72, s72, s73
 s_add_u32 s72, s72, s63
 s_add_u32 s72, s72, 1
 v_mfma_f32_16x16x32_bf16 v[188:191], a[4:7], a[84:87], v[188:191]
 s_and_b32 s72, s72, 7
 s_mul_i32 s72, s72, 7
 s_add_u32 s72, s72, 1
 v_mfma_f32_16x16x32_bf16 v[188:191], a[0:3], a[80:83], v[188:191]
 s_lshr_b32 s72, s72, 1
 s_lshl_b32 s8, s72, 12
 s_waitcnt vmcnt(26) lgkmcnt(6)
 v_mfma_f32_16x16x32_bf16 v[192:195], a[56:59], a[8:11], v[192:195]
 ds_read_b128 a[0:3], v12 offset:4096
 s_mul_i32 s72, s65, 2
 v_mfma_f32_16x16x32_bf16 v[192:195], a[60:63], a[12:15], v[192:195]
 ds_read_b128 a[4:7], v13 offset:4096
 s_add_u32 s72, s72, 5
 v_mfma_f32_16x16x32_bf16 v[196:199], a[68:71], a[12:15], v[196:199]
 ds_read_b128 a[40:43], v10 offset:4096
 s_sub_u32 s73, s72, 7
 v_mfma_f32_16x16x32_bf16 v[196:199], a[64:67], a[8:11], v[196:199]
 ds_read_b128 a[44:47], v11 offset:4096
 s_min_u32 s72, s72, s73
 v_mfma_f32_16x16x32_bf16 v[200:203], a[72:75], a[8:11], v[200:203]
 s_add_u32 s72, s72, s63
 s_add_u32 s72, s72, 1
 s_and_b32 s72, s72, 7
 v_mfma_f32_16x16x32_bf16 v[200:203], a[76:79], a[12:15], v[200:203]
 s_mul_i32 s72, s72, 7
 s_add_u32 s72, s72, 1
 s_lshr_b32 s72, s72, 1
 v_mfma_f32_16x16x32_bf16 v[204:207], a[84:87], a[12:15], v[204:207]
 s_lshl_b32 s9, s72, 12
 s_mul_i32 s72, s65, 2
 s_add_u32 s72, s72, 6
 v_mfma_f32_16x16x32_bf16 v[204:207], a[80:83], a[8:11], v[204:207]
 s_sub_u32 s73, s72, 7
 s_min_u32 s72, s72, s73
 s_waitcnt vmcnt(24) lgkmcnt(6)
 v_mfma_f32_16x16x32_bf16 v[208:211], a[56:59], a[16:19], v[208:211]
 ds_read_b128 a[8:11], v12 offset:6144
 s_and_b32 s77, s80, 15
 v_mfma_f32_16x16x32_bf16 v[208:211], a[60:63], a[20:23], v[208:211]
 ds_read_b128 a[12:15], v13 offset:6144
 s_xor_b32 s77, s77, 12
 v_mfma_f32_16x16x32_bf16 v[212:215], a[68:71], a[20:23], v[212:215]
 ds_read_b128 a[48:51], v10 offset:6144
 s_lshl_b32 s77, s77, 7
 v_mfma_f32_16x16x32_bf16 v[212:215], a[64:67], a[16:19], v[212:215]
 ds_read_b128 a[52:55], v11 offset:6144
 s_add_u32 m0, s76, 0
 v_mfma_f32_16x16x32_bf16 v[216:219], a[72:75], a[16:19], v[216:219]
 s_add_u32 s79, s77, 0
 buffer_load_dwordx4 v2, s[24:27], s79 offen offset:0 lds
 v_mfma_f32_16x16x32_bf16 v[216:219], a[76:79], a[20:23], v[216:219]
 s_add_u32 s72, s72, s63
 s_add_u32 s72, s72, 1
 s_and_b32 s72, s72, 7
 v_mfma_f32_16x16x32_bf16 v[220:223], a[84:87], a[20:23], v[220:223]
 s_mul_i32 s72, s72, 7
 s_add_u32 s72, s72, 1
 s_lshr_b32 s72, s72, 1
 v_mfma_f32_16x16x32_bf16 v[220:223], a[80:83], a[16:19], v[220:223]
 s_lshl_b32 s10, s72, 12
 s_waitcnt vmcnt(18) lgkmcnt(2)
 s_barrier
 v_mfma_f32_16x16x32_bf16 v[224:227], a[56:59], a[0:3], v[224:227]
 ds_read_b64_tr_b16 a[16:17], v14 offset:16896
 buffer_load_dwordx4 v3, s[24:27], s79 offen offset:1024 lds
 v_mfma_f32_16x16x32_bf16 v[224:227], a[60:63], a[4:7], v[224:227]
 ds_read_b64_tr_b16 a[18:19], v14 offset:17152
 s_add_u32 m0, s76, 2048
 v_mfma_f32_16x16x32_bf16 v[228:231], a[68:71], a[4:7], v[228:231]
 ds_read_b64_tr_b16 a[20:21], v14 offset:25344
 s_add_u32 s79, s77, 4096
 v_mfma_f32_16x16x32_bf16 v[228:231], a[64:67], a[0:3], v[228:231]
L_pad3:
 s_cbranch_execz L_pad7
 ds_read_b64_tr_b16 a[22:23], v14 offset:25600
 s_xor_b32 s72, s3, 0
 v_mfma_f32_16x16x32_bf16 v[232:235], a[72:75], a[0:3], v[232:235]
 s_mul_i32 s72, s72, 28672
 s_add_u32 s11, s72, 12288
 s_xor_b32 s72, s3, 1
 v_mfma_f32_16x16x32_bf16 v[232:235], a[76:79], a[4:7], v[232:235]
 buffer_load_dwordx4 v2, s[24:27], s79 offen offset:0 lds
 s_mul_i32 s72, s72, 28672
 v_mfma_f32_16x16x32_bf16 v[236:239], a[84:87], a[4:7], v[236:239]
 s_add_u32 s12, s72, 12288
 s_xor_b32 s72, s3, 2
 s_mul_i32 s72, s72, 28672
 v_mfma_f32_16x16x32_bf16 v[236:239], a[80:83], a[0:3], v[236:239]
 s_add_u32 s13, s72, 12288
 s_xor_b32 s72, s3, 3
 s_waitcnt lgkmcnt(6)
 v_mfma_f32_16x16x32_bf16 v[240:243], a[56:59], a[8:11], v[240:243]
 ds_read_b64_tr_b16 a[0:1], v14 offset:16928
 s_mul_i32 s72, s72, 28672
 v_mfma_f32_16x16x32_bf16 v[240:243], a[60:63], a[12:15], v[240:243]
 ds_read_b64_tr_b16 a[2:3], v14 offset:17184
 buffer_load_dwordx4 v3, s[24:27], s79 offen offset:1024 lds
 v_mfma_f32_16x16x32_bf16 v[244:247], a[68:71], a[12:15], v[244:247]
 ds_read_b64_tr_b16 a[4:5], v14 offset:25376
 s_add_u32 m0, s76, 4096
 v_mfma_f32_16x16x32_bf16 v[244:247], a[64:67], a[8:11], v[244:247]
 ds_read_b64_tr_b16 a[6:7], v14 offset:25632
 s_add_u32 s79, s77, 8192
 v_mfma_f32_16x16x32_bf16 v[248:251], a[72:75], a[8:11], v[248:251]
 s_add_u32 s16, s72, 12288
 s_mov_b32 s22, 0xbdd2d3e8
 v_mfma_f32_16x16x32_bf16 v[248:251], a[76:79], a[12:15], v[248:251]
 v_mfma_f32_16x16x32_bf16 v[252:255], a[84:87], a[12:15], v[252:255]
 buffer_load_dwordx4 v2, s[24:27], s79 offen offset:0 lds
 v_mfma_f32_16x16x32_bf16 v[252:255], a[80:83], a[8:11], v[252:255]
 s_waitcnt lgkmcnt(4)
 v_mfma_f32_16x16x32_bf16 v[80:83], a[16:19], a[24:27], v[80:83]
 ds_read_b64_tr_b16 a[8:9], v14 offset:16960
 v_mfma_f32_16x16x32_bf16 v[80:83], a[20:23], a[28:31], v[80:83]
 ds_read_b64_tr_b16 a[10:11], v14 offset:17216
 v_mfma_f32_16x16x32_bf16 v[84:87], a[20:23], a[36:39], v[84:87]
 ds_read_b64_tr_b16 a[12:13], v14 offset:25408
 buffer_load_dwordx4 v3, s[24:27], s79 offen offset:1024 lds
 v_mfma_f32_16x16x32_bf16 v[84:87], a[16:19], a[32:35], v[84:87]
 ds_read_b64_tr_b16 a[14:15], v14 offset:25664
 s_add_u32 m0, s76, 6144
 v_mfma_f32_16x16x32_bf16 v[88:91], a[16:19], a[40:43], v[88:91]
 s_add_u32 s79, s77, 12288
 v_mfma_f32_16x16x32_bf16 v[88:91], a[20:23], a[44:47], v[88:91]
 v_mfma_f32_16x16x32_bf16 v[92:95], a[20:23], a[52:55], v[92:95]
 v_mfma_f32_16x16x32_bf16 v[92:95], a[16:19], a[48:51], v[92:95]
 buffer_load_dwordx4 v2, s[24:27], s79 offen offset:0 lds
 s_waitcnt lgkmcnt(4)
 v_mfma_f32_16x16x32_bf16 v[128:131], a[0:3], a[24:27], v[128:131]
 ds_read_b64_tr_b16 a[16:17], v14 offset:16992
 v_mfma_f32_16x16x32_bf16 v[128:131], a[4:7], a[28:31], v[128:131]
 ds_read_b64_tr_b16 a[18:19], v14 offset:17248
 v_mfma_f32_16x16x32_bf16 v[132:135], a[4:7], a[36:39], v[132:135]
 ds_read_b64_tr_b16 a[20:21], v14 offset:25440
 v_mfma_f32_16x16x32_bf16 v[132:135], a[0:3], a[32:35], v[132:135]
 ds_read_b64_tr_b16 a[22:23], v14 offset:25696
 buffer_load_dwordx4 v3, s[24:27], s79 offen offset:1024 lds
 v_mfma_f32_16x16x32_bf16 v[136:139], a[0:3], a[40:43], v[136:139]
 s_add_u32 m0, s74, 0
 s_mul_i32 s78, s77, 3584
 v_mfma_f32_16x16x32_bf16 v[136:139], a[4:7], a[44:47], v[136:139]
 v_mfma_f32_16x16x32_bf16 v[140:143], a[4:7], a[52:55], v[140:143]
 v_mfma_f32_16x16x32_bf16 v[140:143], a[0:3], a[48:51], v[140:143]
 s_waitcnt lgkmcnt(4)
 v_mfma_f32_16x16x32_bf16 v[96:99], a[8:11], a[24:27], v[96:99]
 ds_read_b64_tr_b16 a[0:1], v14 offset:17024
 buffer_load_dwordx4 v6, s[32:35], s78 offen offset:0 lds
 v_mfma_f32_16x16x32_bf16 v[96:99], a[12:15], a[28:31], v[96:99]
 ds_read_b64_tr_b16 a[2:3], v14 offset:17280
 v_mfma_f32_16x16x32_bf16 v[100:103], a[12:15], a[36:39], v[100:103]
 ds_read_b64_tr_b16 a[4:5], v14 offset:25472
 v_mfma_f32_16x16x32_bf16 v[100:103], a[8:11], a[32:35], v[100:103]
 ds_read_b64_tr_b16 a[6:7], v14 offset:25728
 v_mfma_f32_16x16x32_bf16 v[104:107], a[8:11], a[40:43], v[104:107]
 buffer_load_dwordx4 v7, s[32:35], s78 offen offset:1056 lds
 v_mfma_f32_16x16x32_bf16 v[104:107], a[12:15], a[44:47], v[104:107]
 v_mfma_f32_16x16x32_bf16 v[108:111], a[12:15], a[52:55], v[108:111]
 v_mfma_f32_16x16x32_bf16 v[108:111], a[8:11], a[48:51], v[108:111]
 s_waitcnt lgkmcnt(4)
 v_mfma_f32_16x16x32_bf16 v[144:147], a[16:19], a[24:27], v[144:147]
 ds_read_b64_tr_b16 a[8:9], v14 offset:17056
 v_mfma_f32_16x16x32_bf16 v[144:147], a[20:23], a[28:31], v[144:147]
 ds_read_b64_tr_b16 a[10:11], v14 offset:17312
 buffer_load_dwordx4 v8, s[32:35], s78 offen offset:2112 lds
 v_mfma_f32_16x16x32_bf16 v[148:151], a[20:23], a[36:39], v[148:151]
 ds_read_b64_tr_b16 a[12:13], v14 offset:25504
 v_mfma_f32_16x16x32_bf16 v[148:151], a[16:19], a[32:35], v[148:151]
 ds_read_b64_tr_b16 a[14:15], v14 offset:25760
 v_mfma_f32_16x16x32_bf16 v[152:155], a[16:19], a[40:43], v[152:155]
 v_mfma_f32_16x16x32_bf16 v[152:155], a[20:23], a[44:47], v[152:155]
 buffer_load_dwordx4 v9, s[32:35], s78 offen offset:3168 lds
 s_add_u32 m0, s75, 0
 v_mfma_f32_16x16x32_bf16 v[156:159], a[20:23], a[52:55], v[156:159]
 s_nop 0
 v_mfma_f32_16x16x32_bf16 v[156:159], a[16:19], a[48:51], v[156:159]
 s_waitcnt lgkmcnt(4)
 v_mfma_f32_16x16x32_bf16 v[112:115], a[0:3], a[24:27], v[112:115]
 ds_read_b64_tr_b16 a[16:17], v14 offset:17088
 v_mfma_f32_16x16x32_bf16 v[112:115], a[4:7], a[28:31], v[112:115]
 ds_read_b64_tr_b16 a[18:19], v14 offset:17344
 v_mfma_f32_16x16x32_bf16 v[116:119], a[4:7], a[36:39], v[116:119]
 ds_read_b64_tr_b16 a[20:21], v14 offset:25536
 buffer_load_dwordx4 v4, s[28:31], s77 offen offset:0 lds
 v_mfma_f32_16x16x32_bf16 v[116:119], a[0:3], a[32:35], v[116:119]
 ds_read_b64_tr_b16 a[22:23], v14 offset:25792
 v_mfma_f32_16x16x32_bf16 v[120:123], a[0:3], a[40:43], v[120:123]
 v_mfma_f32_16x16x32_bf16 v[120:123], a[4:7], a[44:47], v[120:123]
 v_mfma_f32_16x16x32_bf16 v[124:127], a[4:7], a[52:55], v[124:127]
 buffer_load_dwordx4 v5, s[28:31], s77 offen offset:1024 lds
 v_mfma_f32_16x16x32_bf16 v[124:127], a[0:3], a[48:51], v[124:127]
 s_waitcnt vmcnt(28) lgkmcnt(4)
 v_mfma_f32_16x16x32_bf16 v[160:163], a[8:11], a[24:27], v[160:163]
 ds_read_b128 a[0:3], v12 offset:8192
 v_mfma_f32_16x16x32_bf16 v[160:163], a[12:15], a[28:31], v[160:163]
 ds_read_b128 a[4:7], v13 offset:8192
 v_mfma_f32_16x16x32_bf16 v[164:167], a[12:15], a[36:39], v[164:167]
 ds_read_b128 a[56:59], v10 offset:32768
 v_mfma_f32_16x16x32_bf16 v[164:167], a[8:11], a[32:35], v[164:167]
 ds_read_b128 a[60:63], v11 offset:32768
 v_mfma_f32_16x16x32_bf16 v[168:171], a[8:11], a[40:43], v[168:171]
 v_mfma_f32_16x16x32_bf16 v[168:171], a[12:15], a[44:47], v[168:171]
 v_mfma_f32_16x16x32_bf16 v[172:175], a[12:15], a[52:55], v[172:175]
 v_mfma_f32_16x16x32_bf16 v[172:175], a[8:11], a[48:51], v[172:175]
 s_waitcnt vmcnt(26) lgkmcnt(4)
 v_mfma_f32_16x16x32_bf16 v[176:179], a[16:19], a[24:27], v[176:179]
 ds_read_b128 a[8:11], v12 offset:10240
 v_mfma_f32_16x16x32_bf16 v[176:179], a[20:23], a[28:31], v[176:179]
 ds_read_b128 a[12:15], v13 offset:10240
 v_mfma_f32_16x16x32_bf16 v[180:183], a[20:23], a[36:39], v[180:183]
 ds_read_b128 a[64:67], v10 offset:34816
 v_mfma_f32_16x16x32_bf16 v[180:183], a[16:19], a[32:35], v[180:183]
 ds_read_b128 a[68:71], v11 offset:34816
 v_mfma_f32_16x16x32_bf16 v[184:187], a[16:19], a[40:43], v[184:187]
 v_mfma_f32_16x16x32_bf16 v[184:187], a[20:23], a[44:47], v[184:187]
 v_mfma_f32_16x16x32_bf16 v[188:191], a[20:23], a[52:55], v[188:191]
 v_mfma_f32_16x16x32_bf16 v[188:191], a[16:19], a[48:51], v[188:191]
 s_waitcnt vmcnt(23) lgkmcnt(6)
 v_mfma_f32_16x16x32_bf16 v[192:195], a[24:27], a[0:3], v[192:195]
 ds_read_b128 a[16:19], v12 offset:12288
 v_mfma_f32_16x16x32_bf16 v[192:195], a[28:31], a[4:7], v[192:195]
 ds_read_b128 a[20:23], v13 offset:12288
 v_mfma_f32_16x16x32_bf16 v[196:199], a[36:39], a[4:7], v[196:199]
 ds_read_b128 a[72:75], v10 offset:36864
 v_mfma_f32_16x16x32_bf16 v[196:199], a[32:35], a[0:3], v[196:199]
 ds_read_b128 a[76:79], v11 offset:36864
 v_mfma_f32_16x16x32_bf16 v[200:203], a[40:43], a[0:3], v[200:203]
 v_mfma_f32_16x16x32_bf16 v[200:203], a[44:47], a[4:7], v[200:203]
 v_mfma_f32_16x16x32_bf16 v[204:207], a[52:55], a[4:7], v[204:207]
 v_mfma_f32_16x16x32_bf16 v[204:207], a[48:51], a[0:3], v[204:207]
 s_waitcnt vmcnt(21) lgkmcnt(6)
 v_mfma_f32_16x16x32_bf16 v[208:211], a[24:27], a[8:11], v[208:211]
 ds_read_b128 a[0:3], v12 offset:14336
 s_and_b32 s77, s80, 15
 v_mfma_f32_16x16x32_bf16 v[208:211], a[28:31], a[12:15], v[208:211]
 ds_read_b128 a[4:7], v13 offset:14336
 s_xor_b32 s77, s77, 13
 v_mfma_f32_16x16x32_bf16 v[212:215], a[36:39], a[12:15], v[212:215]
 ds_read_b128 a[80:83], v10 offset:38912
 s_lshl_b32 s77, s77, 7
 v_mfma_f32_16x16x32_bf16 v[212:215], a[32:35], a[8:11], v[212:215]
 ds_read_b128 a[84:87], v11 offset:38912
 s_add_u32 m0, s76, 32768
 v_mfma_f32_16x16x32_bf16 v[216:219], a[40:43], a[8:11], v[216:219]
 s_add_u32 s79, s77, 0
 buffer_load_dwordx4 v2, s[24:27], s79 offen offset:0 lds
 v_mfma_f32_16x16x32_bf16 v[216:219], a[44:47], a[12:15], v[216:219]
 v_mfma_f32_16x16x32_bf16 v[220:223], a[52:55], a[12:15], v[220:223]
 v_mfma_f32_16x16x32_bf16 v[220:223], a[48:51], a[8:11], v[220:223]
 s_waitcnt vmcnt(15) lgkmcnt(2)
 s_barrier
 v_mfma_f32_16x16x32_bf16 v[224:227], a[24:27], a[16:19], v[224:227]
 ds_read_b64_tr_b16 a[8:9], v14 offset:33792
 buffer_load_dwordx4 v3, s[24:27], s79 offen offset:1024 lds
 v_mfma_f32_16x16x32_bf16 v[224:227], a[28:31], a[20:23], v[224:227]
 ds_read_b64_tr_b16 a[10:11], v14 offset:34048
 s_add_u32 m0, s76, 34816
 v_mfma_f32_16x16x32_bf16 v[228:231], a[36:39], a[20:23], v[228:231]
 ds_read_b64_tr_b16 a[12:13], v14 offset:42240
 s_add_u32 s79, s77, 4096
 v_mfma_f32_16x16x32_bf16 v[228:231], a[32:35], a[16:19], v[228:231]
 ds_read_b64_tr_b16 a[14:15], v14 offset:42496
 v_mfma_f32_16x16x32_bf16 v[232:235], a[40:43], a[16:19], v[232:235]
 v_mfma_f32_16x16x32_bf16 v[232:235], a[44:47], a[20:23], v[232:235]
 buffer_load_dwordx4 v2, s[24:27], s79 offen offset:0 lds
 v_mfma_f32_16x16x32_bf16 v[236:239], a[52:55], a[20:23], v[236:239]
 v_mfma_f32_16x16x32_bf16 v[236:239], a[48:51], a[16:19], v[236:239]
 s_waitcnt lgkmcnt(6)
 v_mfma_f32_16x16x32_bf16 v[240:243], a[24:27], a[0:3], v[240:243]
 ds_read_b64_tr_b16 a[16:17], v14 offset:33824
 v_mfma_f32_16x16x32_bf16 v[240:243], a[28:31], a[4:7], v[240:243]
 ds_read_b64_tr_b16 a[18:19], v14 offset:34080
 buffer_load_dwordx4 v3, s[24:27], s79 offen offset:1024 lds
 v_mfma_f32_16x16x32_bf16 v[244:247], a[36:39], a[4:7], v[244:247]
 ds_read_b64_tr_b16 a[20:21], v14 offset:42272
 s_add_u32 m0, s76, 36864
 v_mfma_f32_16x16x32_bf16 v[244:247], a[32:35], a[0:3], v[244:247]
 ds_read_b64_tr_b16 a[22:23], v14 offset:42528
 s_add_u32 s79, s77, 8192
 v_mfma_f32_16x16x32_bf16 v[248:251], a[40:43], a[0:3], v[248:251]
 v_mfma_f32_16x16x32_bf16 v[248:251], a[44:47], a[4:7], v[248:251]
 v_mfma_f32_16x16x32_bf16 v[252:255], a[52:55], a[4:7], v[252:255]
 buffer_load_dwordx4 v2, s[24:27], s79 offen offset:0 lds
 v_mfma_f32_16x16x32_bf16 v[252:255], a[48:51], a[0:3], v[252:255]
 s_waitcnt lgkmcnt(4)
 v_mfma_f32_16x16x32_bf16 v[80:83], a[8:11], a[56:59], v[80:83]
 ds_read_b64_tr_b16 a[0:1], v14 offset:33856
 s_lshl_b32 s72, s63, 2
 v_mfma_f32_16x16x32_bf16 v[80:83], a[12:15], a[60:63], v[80:83]
 ds_read_b64_tr_b16 a[2:3], v14 offset:34112
 s_add_u32 s72, s72, s65
 v_mfma_f32_16x16x32_bf16 v[84:87], a[12:15], a[68:71], v[84:87]
 ds_read_b64_tr_b16 a[4:5], v14 offset:42304
 buffer_load_dwordx4 v3, s[24:27], s79 offen offset:1024 lds
 v_mfma_f32_16x16x32_bf16 v[84:87], a[8:11], a[64:67], v[84:87]
 ds_read_b64_tr_b16 a[6:7], v14 offset:42560
 s_add_u32 m0, s76, 38912
 v_mfma_f32_16x16x32_bf16 v[88:91], a[8:11], a[72:75], v[88:91]
 s_add_u32 s79, s77, 12288
 s_lshl_b32 s72, s72, 2
 s_add_u32 s72, s72, s60
 v_mfma_f32_16x16x32_bf16 v[88:91], a[12:15], a[76:79], v[88:91]
 s_lshl_b32 s72, s72, 8
 s_add_u32 s72, s72, L_trans-L_pc
 v_and_b32 v74, 1, v0
 v_mfma_f32_16x16x32_bf16 v[92:95], a[12:15], a[84:87], v[92:95]
 v_lshl_add_u32 v74, v74, 7, s72
 v_min_u32 v74, L_end-L_pc-4, v74
 v_mfma_f32_16x16x32_bf16 v[92:95], a[8:11], a[80:83], v[92:95]
 global_load_dword v75, v74, s[18:19]
 s_waitcnt lgkmcnt(4)
 v_mfma_f32_16x16x32_bf16 v[128:131], a[16:19], a[56:59], v[128:131]
 ds_read_b64_tr_b16 a[8:9], v14 offset:33888
 v_mfma_f32_16x16x32_bf16 v[128:131], a[20:23], a[60:63], v[128:131]
 ds_read_b64_tr_b16 a[10:11], v14 offset:34144
 buffer_load_dwordx4 v2, s[24:27], s79 offen offset:0 lds
 v_mfma_f32_16x16x32_bf16 v[132:135], a[20:23], a[68:71], v[132:135]
 ds_read_b64_tr_b16 a[12:13], v14 offset:42336
 v_mfma_f32_16x16x32_bf16 v[132:135], a[16:19], a[64:67], v[132:135]
 ds_read_b64_tr_b16 a[14:15], v14 offset:42592
 v_mfma_f32_16x16x32_bf16 v[136:139], a[16:19], a[72:75], v[136:139]
 v_mfma_f32_16x16x32_bf16 v[136:139], a[20:23], a[76:79], v[136:139]
 buffer_load_dwordx4 v3, s[24:27], s79 offen offset:1024 lds
 s_add_u32 m0, s74, 16896
 v_mfma_f32_16x16x32_bf16 v[140:143], a[20:23], a[84:87], v[140:143]
 s_mul_i32 s78, s77, 3584
 v_mfma_f32_16x16x32_bf16 v[140:143], a[16:19], a[80:83], v[140:143]
 s_waitcnt lgkmcnt(4)
 v_mfma_f32_16x16x32_bf16 v[96:99], a[0:3], a[56:59], v[96:99]
 ds_read_b64_tr_b16 a[16:17], v14 offset:33920
 v_mfma_f32_16x16x32_bf16 v[96:99], a[4:7], a[60:63], v[96:99]
 ds_read_b64_tr_b16 a[18:19], v14 offset:34176
 v_mfma_f32_16x16x32_bf16 v[100:103], a[4:7], a[68:71], v[100:103]
 ds_read_b64_tr_b16 a[20:21], v14 offset:42368
 buffer_load_dwordx4 v6, s[32:35], s78 offen offset:0 lds
 v_mfma_f32_16x16x32_bf16 v[100:103], a[0:3], a[64:67], v[100:103]
 ds_read_b64_tr_b16 a[22:23], v14 offset:42624
 v_mfma_f32_16x16x32_bf16 v[104:107], a[0:3], a[72:75], v[104:107]
 v_mfma_f32_16x16x32_bf16 v[104:107], a[4:7], a[76:79], v[104:107]
 v_mfma_f32_16x16x32_bf16 v[108:111], a[4:7], a[84:87], v[108:111]
 buffer_load_dwordx4 v7, s[32:35], s78 offen offset:1056 lds
 v_mfma_f32_16x16x32_bf16 v[108:111], a[0:3], a[80:83], v[108:111]
 s_waitcnt lgkmcnt(4)
 v_mfma_f32_16x16x32_bf16 v[144:147], a[8:11], a[56:59], v[144:147]
 ds_read_b64_tr_b16 a[0:1], v14 offset:33952
 v_mfma_f32_16x16x32_bf16 v[144:147], a[12:15], a[60:63], v[144:147]
 ds_read_b64_tr_b16 a[2:3], v14 offset:34208
 v_mfma_f32_16x16x32_bf16 v[148:151], a[12:15], a[68:71], v[148:151]
 ds_read_b64_tr_b16 a[4:5], v14 offset:42400
 v_mfma_f32_16x16x32_bf16 v[148:151], a[8:11], a[64:67], v[148:151]
 ds_read_b64_tr_b16 a[6:7], v14 offset:42656
 buffer_load_dwordx4 v8, s[32:35], s78 offen offset:2112 lds
 v_mfma_f32_16x16x32_bf16 v[152:155], a[8:11], a[72:75], v[152:155]
 v_mfma_f32_16x16x32_bf16 v[152:155], a[12:15], a[76:79], v[152:155]
 v_mfma_f32_16x16x32_bf16 v[156:159], a[12:15], a[84:87], v[156:159]
 v_mfma_f32_16x16x32_bf16 v[156:159], a[8:11], a[80:83], v[156:159]
 buffer_load_dwordx4 v9, s[32:35], s78 offen offset:3168 lds
 s_waitcnt lgkmcnt(4)
 v_mfma_f32_16x16x32_bf16 v[112:115], a[16:19], a[56:59], v[112:115]
 ds_read_b64_tr_b16 a[8:9], v14 offset:33984
 s_add_u32 m0, s75, 8192
 v_mfma_f32_16x16x32_bf16 v[112:115], a[20:23], a[60:63], v[112:115]
 ds_read_b64_tr_b16 a[10:11], v14 offset:34240
 s_nop 0
 v_mfma_f32_16x16x32_bf16 v[116:119], a[20:23], a[68:71], v[116:119]
 ds_read_b64_tr_b16 a[12:13], v14 offset:42432
 v_mfma_f32_16x16x32_bf16 v[116:119], a[16:19], a[64:67], v[116:119]
 ds_read_b64_tr_b16 a[14:15], v14 offset:42688
 v_mfma_f32_16x16x32_bf16 v[120:123], a[16:19], a[72:75], v[120:123]
 buffer_load_dwordx4 v4, s[28:31], s77 offen offset:0 lds
 v_mfma_f32_16x16x32_bf16 v[120:123], a[20:23], a[76:79], v[120:123]
 v_mfma_f32_16x16x32_bf16 v[124:127], a[20:23], a[84:87], v[124:127]
 v_mfma_f32_16x16x32_bf16 v[124:127], a[16:19], a[80:83], v[124:127]
 s_waitcnt vmcnt(26) lgkmcnt(4)
 v_mfma_f32_16x16x32_bf16 v[160:163], a[0:3], a[56:59], v[160:163]
 ds_read_b128 a[16:19], v12 offset:16384
 buffer_load_dwordx4 v5, s[28:31], s77 offen offset:1024 lds
 v_mfma_f32_16x16x32_bf16 v[160:163], a[4:7], a[60:63], v[160:163]
 ds_read_b128 a[20:23], v13 offset:16384
 v_mfma_f32_16x16x32_bf16 v[164:167], a[4:7], a[68:71], v[164:167]
 ds_read_b128 a[24:27], v10 offset:0
 v_mfma_f32_16x16x32_bf16 v[164:167], a[0:3], a[64:67], v[164:167]
 ds_read_b128 a[28:31], v11 offset:0
 v_mfma_f32_16x16x32_bf16 v[168:171], a[0:3], a[72:75], v[168:171]
 v_mfma_f32_16x16x32_bf16 v[168:171], a[4:7], a[76:79], v[168:171]
 v_mfma_f32_16x16x32_bf16 v[172:175], a[4:7], a[84:87], v[172:175]
 v_mfma_f32_16x16x32_bf16 v[172:175], a[0:3], a[80:83], v[172:175]
 s_waitcnt vmcnt(25) lgkmcnt(4)
 v_mfma_f32_16x16x32_bf16 v[176:179], a[8:11], a[56:59], v[176:179]
 ds_read_b128 a[0:3], v12 offset:18432
 v_mfma_f32_16x16x32_bf16 v[176:179], a[12:15], a[60:63], v[176:179]
 ds_read_b128 a[4:7], v13 offset:18432
 v_mfma_f32_16x16x32_bf16 v[180:183], a[12:15], a[68:71], v[180:183]
 ds_read_b128 a[32:35], v10 offset:2048
 v_mfma_f32_16x16x32_bf16 v[180:183], a[8:11], a[64:67], v[180:183]
 ds_read_b128 a[36:39], v11 offset:2048
 v_mfma_f32_16x16x32_bf16 v[184:187], a[8:11], a[72:75], v[184:187]
 v_mfma_f32_16x16x32_bf16 v[184:187], a[12:15], a[76:79], v[184:187]
 v_mfma_f32_16x16x32_bf16 v[188:191], a[12:15], a[84:87], v[188:191]
 v_mfma_f32_16x16x32_bf16 v[188:191], a[8:11], a[80:83], v[188:191]
 s_waitcnt vmcnt(23) lgkmcnt(6)
 v_mfma_f32_16x16x32_bf16 v[192:195], a[56:59], a[16:19], v[192:195]
 ds_read_b128 a[8:11], v12 offset:20480
 v_mfma_f32_16x16x32_bf16 v[192:195], a[60:63], a[20:23], v[192:195]
 ds_read_b128 a[12:15], v13 offset:20480
 v_mfma_f32_16x16x32_bf16 v[196:199], a[68:71], a[20:23], v[196:199]
 ds_read_b128 a[40:43], v10 offset:4096
 v_mfma_f32_16x16x32_bf16 v[196:199], a[64:67], a[16:19], v[196:199]
 ds_read_b128 a[44:47], v11 offset:4096
 v_mfma_f32_16x16x32_bf16 v[200:203], a[72:75], a[16:19], v[200:203]
 v_mfma_f32_16x16x32_bf16 v[200:203], a[76:79], a[20:23], v[200:203]
 v_mfma_f32_16x16x32_bf16 v[204:207], a[84:87], a[20:23], v[204:207]
 v_mfma_f32_16x16x32_bf16 v[204:207], a[80:83], a[16:19], v[204:207]
 s_waitcnt vmcnt(21) lgkmcnt(6)
 v_mfma_f32_16x16x32_bf16 v[208:211], a[56:59], a[0:3], v[208:211]
 ds_read_b128 a[16:19], v12 offset:22528
 s_and_b32 s77, s80, 15
 v_mfma_f32_16x16x32_bf16 v[208:211], a[60:63], a[4:7], v[208:211]
 ds_read_b128 a[20:23], v13 offset:22528
 s_xor_b32 s77, s77, 14
 v_mfma_f32_16x16x32_bf16 v[212:215], a[68:71], a[4:7], v[212:215]
 ds_read_b128 a[48:51], v10 offset:6144
 s_lshl_b32 s77, s77, 7
 v_mfma_f32_16x16x32_bf16 v[212:215], a[64:67], a[0:3], v[212:215]
 ds_read_b128 a[52:55], v11 offset:6144
 s_add_u32 m0, s76, 0
 v_mfma_f32_16x16x32_bf16 v[216:219], a[72:75], a[0:3], v[216:219]
 s_add_u32 s79, s77, 0
 buffer_load_dwordx4 v2, s[24:27], s79 offen offset:0 lds
 v_mfma_f32_16x16x32_bf16 v[216:219], a[76:79], a[4:7], v[216:219]
 v_mfma_f32_16x16x32_bf16 v[220:223], a[84:87], a[4:7], v[220:223]
 v_mfma_f32_16x16x32_bf16 v[220:223], a[80:83], a[0:3], v[220:223]
 s_waitcnt vmcnt(16) lgkmcnt(2)
 s_barrier
 v_mfma_f32_16x16x32_bf16 v[224:227], a[56:59], a[8:11], v[224:227]
 ds_read_b64_tr_b16 a[0:1], v14 offset:0
 buffer_load_dwordx4 v3, s[24:27], s79 offen offset:1024 lds
 v_mfma_f32_16x16x32_bf16 v[224:227], a[60:63], a[12:15], v[224:227]
 ds_read_b64_tr_b16 a[2:3], v14 offset:256
 s_add_u32 m0, s76, 2048
 v_mfma_f32_16x16x32_bf16 v[228:231], a[68:71], a[12:15], v[228:231]
 ds_read_b64_tr_b16 a[4:5], v14 offset:8448
 s_add_u32 s79, s77, 4096
 v_mfma_f32_16x16x32_bf16 v[228:231], a[64:67], a[8:11], v[228:231]
 ds_read_b64_tr_b16 a[6:7], v14 offset:8704
 v_mfma_f32_16x16x32_bf16 v[232:235], a[72:75], a[8:11], v[232:235]
 v_mfma_f32_16x16x32_bf16 v[232:235], a[76:79], a[12:15], v[232:235]
 buffer_load_dwordx4 v2, s[24:27], s79 offen offset:0 lds
 v_mfma_f32_16x16x32_bf16 v[236:239], a[84:87], a[12:15], v[236:239]
 v_mfma_f32_16x16x32_bf16 v[236:239], a[80:83], a[8:11], v[236:239]
 s_waitcnt lgkmcnt(6)
 v_mfma_f32_16x16x32_bf16 v[240:243], a[56:59], a[16:19], v[240:243]
 ds_read_b64_tr_b16 a[8:9], v14 offset:32
 v_mfma_f32_16x16x32_bf16 v[240:243], a[60:63], a[20:23], v[240:243]
 ds_read_b64_tr_b16 a[10:11], v14 offset:288
 buffer_load_dwordx4 v3, s[24:27], s79 offen offset:1024 lds
 v_mfma_f32_16x16x32_bf16 v[244:247], a[68:71], a[20:23], v[244:247]
 ds_read_b64_tr_b16 a[12:13], v14 offset:8480
 s_add_u32 m0, s76, 4096
 v_mfma_f32_16x16x32_bf16 v[244:247], a[64:67], a[16:19], v[244:247]
 ds_read_b64_tr_b16 a[14:15], v14 offset:8736
 s_add_u32 s79, s77, 8192
 v_mfma_f32_16x16x32_bf16 v[248:251], a[72:75], a[16:19], v[248:251]
 v_mfma_f32_16x16x32_bf16 v[248:251], a[76:79], a[20:23], v[248:251]
 v_mfma_f32_16x16x32_bf16 v[252:255], a[84:87], a[20:23], v[252:255]
 buffer_load_dwordx4 v2, s[24:27], s79 offen offset:0 lds
 v_mfma_f32_16x16x32_bf16 v[252:255], a[80:83], a[16:19], v[252:255]
 s_waitcnt lgkmcnt(4)
 v_mfma_f32_16x16x32_bf16 v[80:83], a[0:3], a[24:27], v[80:83]
 ds_read_b64_tr_b16 a[16:17], v14 offset:64
 v_mfma_f32_16x16x32_bf16 v[80:83], a[4:7], a[28:31], v[80:83]
 ds_read_b64_tr_b16 a[18:19], v14 offset:320
 v_mfma_f32_16x16x32_bf16 v[84:87], a[4:7], a[36:39], v[84:87]
 ds_read_b64_tr_b16 a[20:21], v14 offset:8512
 buffer_load_dword v78, off, s[56:59], 0 sc1
 v_mfma_f32_16x16x32_bf16 v[84:87], a[0:3], a[32:35], v[84:87]
 ds_read_b64_tr_b16 a[22:23], v14 offset:8768
 v_mfma_f32_16x16x32_bf16 v[88:91], a[0:3], a[40:43], v[88:91]
 buffer_load_dwordx4 v3, s[24:27], s79 offen offset:1024 lds
 s_add_u32 m0, s76, 6144
 v_mfma_f32_16x16x32_bf16 v[88:91], a[4:7], a[44:47], v[88:91]
 s_add_u32 s79, s77, 12288
 v_mfma_f32_16x16x32_bf16 v[92:95], a[4:7], a[52:55], v[92:95]
 v_mfma_f32_16x16x32_bf16 v[92:95], a[0:3], a[48:51], v[92:95]
 s_waitcnt lgkmcnt(4)
 v_mfma_f32_16x16x32_bf16 v[128:131], a[8:11], a[24:27], v[128:131]
 ds_read_b64_tr_b16 a[0:1], v14 offset:96
 v_mfma_f32_16x16x32_bf16 v[128:131], a[12:15], a[28:31], v[128:131]
 ds_read_b64_tr_b16 a[2:3], v14 offset:352
 buffer_load_dwordx4 v2, s[24:27], s79 offen offset:0 lds
 v_mfma_f32_16x16x32_bf16 v[132:135], a[12:15], a[36:39], v[132:135]
 ds_read_b64_tr_b16 a[4:5], v14 offset:8544
 v_mfma_f32_16x16x32_bf16 v[132:135], a[8:11], a[32:35], v[132:135]
 ds_read_b64_tr_b16 a[6:7], v14 offset:8800
 v_mfma_f32_16x16x32_bf16 v[136:139], a[8:11], a[40:43], v[136:139]
 v_mfma_f32_16x16x32_bf16 v[136:139], a[12:15], a[44:47], v[136:139]
 buffer_load_dwordx4 v3, s[24:27], s79 offen offset:1024 lds
 s_add_u32 m0, s74, 33792
 v_mfma_f32_16x16x32_bf16 v[140:143], a[12:15], a[52:55], v[140:143]
 s_mul_i32 s78, s77, 3584
 v_mfma_f32_16x16x32_bf16 v[140:143], a[8:11], a[48:51], v[140:143]
 s_waitcnt lgkmcnt(4)
 v_mfma_f32_16x16x32_bf16 v[96:99], a[16:19], a[24:27], v[96:99]
 ds_read_b64_tr_b16 a[8:9], v14 offset:128
 v_mfma_f32_16x16x32_bf16 v[96:99], a[20:23], a[28:31], v[96:99]
 ds_read_b64_tr_b16 a[10:11], v14 offset:384
 v_mfma_f32_16x16x32_bf16 v[100:103], a[20:23], a[36:39], v[100:103]
 ds_read_b64_tr_b16 a[12:13], v14 offset:8576
 buffer_load_dwordx4 v6, s[32:35], s78 offen offset:0 lds
 v_mfma_f32_16x16x32_bf16 v[100:103], a[16:19], a[32:35], v[100:103]
 ds_read_b64_tr_b16 a[14:15], v14 offset:8832
 v_mfma_f32_16x16x32_bf16 v[104:107], a[16:19], a[40:43], v[104:107]
 v_mfma_f32_16x16x32_bf16 v[104:107], a[20:23], a[44:47], v[104:107]
 v_mfma_f32_16x16x32_bf16 v[108:111], a[20:23], a[52:55], v[108:111]
 buffer_load_dwordx4 v7, s[32:35], s78 offen offset:1056 lds
 v_mfma_f32_16x16x32_bf16 v[108:111], a[16:19], a[48:51], v[108:111]
 s_waitcnt lgkmcnt(4)
 v_mfma_f32_16x16x32_bf16 v[144:147], a[0:3], a[24:27], v[144:147]
 ds_read_b64_tr_b16 a[16:17], v14 offset:160
 v_mfma_f32_16x16x32_bf16 v[144:147], a[4:7], a[28:31], v[144:147]
 ds_read_b64_tr_b16 a[18:19], v14 offset:416
 v_mfma_f32_16x16x32_bf16 v[148:151], a[4:7], a[36:39], v[148:151]
 ds_read_b64_tr_b16 a[20:21], v14 offset:8608
 v_mfma_f32_16x16x32_bf16 v[148:151], a[0:3], a[32:35], v[148:151]
 ds_read_b64_tr_b16 a[22:23], v14 offset:8864
 buffer_load_dwordx4 v8, s[32:35], s78 offen offset:2112 lds
 v_mfma_f32_16x16x32_bf16 v[152:155], a[0:3], a[40:43], v[152:155]
 v_mfma_f32_16x16x32_bf16 v[152:155], a[4:7], a[44:47], v[152:155]
 v_mfma_f32_16x16x32_bf16 v[156:159], a[4:7], a[52:55], v[156:159]
 v_mfma_f32_16x16x32_bf16 v[156:159], a[0:3], a[48:51], v[156:159]
 buffer_load_dwordx4 v9, s[32:35], s78 offen offset:3168 lds
 s_waitcnt lgkmcnt(4)
 v_mfma_f32_16x16x32_bf16 v[112:115], a[8:11], a[24:27], v[112:115]
 ds_read_b64_tr_b16 a[0:1], v14 offset:192
 s_add_u32 m0, s75, 16384
 v_mfma_f32_16x16x32_bf16 v[112:115], a[12:15], a[28:31], v[112:115]
 ds_read_b64_tr_b16 a[2:3], v14 offset:448
 s_nop 0
 v_mfma_f32_16x16x32_bf16 v[116:119], a[12:15], a[36:39], v[116:119]
 ds_read_b64_tr_b16 a[4:5], v14 offset:8640
 v_mfma_f32_16x16x32_bf16 v[116:119], a[8:11], a[32:35], v[116:119]
 ds_read_b64_tr_b16 a[6:7], v14 offset:8896
 v_mfma_f32_16x16x32_bf16 v[120:123], a[8:11], a[40:43], v[120:123]
 buffer_load_dwordx4 v4, s[28:31], s77 offen offset:0 lds
 v_mfma_f32_16x16x32_bf16 v[120:123], a[12:15], a[44:47], v[120:123]
 v_mfma_f32_16x16x32_bf16 v[124:127], a[12:15], a[52:55], v[124:127]
 v_mfma_f32_16x16x32_bf16 v[124:127], a[8:11], a[48:51], v[124:127]
 s_waitcnt vmcnt(27) lgkmcnt(4)
 v_mfma_f32_16x16x32_bf16 v[160:163], a[16:19], a[24:27], v[160:163]
 ds_read_b128 a[8:11], v12 offset:0
 buffer_load_dwordx4 v5, s[28:31], s77 offen offset:1024 lds
 v_mfma_f32_16x16x32_bf16 v[160:163], a[20:23], a[28:31], v[160:163]
 ds_read_b128 a[12:15], v13 offset:0
 v_mfma_f32_16x16x32_bf16 v[164:167], a[20:23], a[36:39], v[164:167]
 ds_read_b128 a[56:59], v10 offset:32768
 v_mfma_f32_16x16x32_bf16 v[164:167], a[16:19], a[32:35], v[164:167]
 ds_read_b128 a[60:63], v11 offset:32768
 v_mfma_f32_16x16x32_bf16 v[168:171], a[16:19], a[40:43], v[168:171]
 v_mfma_f32_16x16x32_bf16 v[168:171], a[20:23], a[44:47], v[168:171]
 v_mfma_f32_16x16x32_bf16 v[172:175], a[20:23], a[52:55], v[172:175]
 v_mfma_f32_16x16x32_bf16 v[172:175], a[16:19], a[48:51], v[172:175]
 s_waitcnt vmcnt(26) lgkmcnt(4)
 v_mfma_f32_16x16x32_bf16 v[176:179], a[0:3], a[24:27], v[176:179]
 ds_read_b128 a[16:19], v12 offset:2048
 v_mfma_f32_16x16x32_bf16 v[176:179], a[4:7], a[28:31], v[176:179]
 ds_read_b128 a[20:23], v13 offset:2048
 v_mfma_f32_16x16x32_bf16 v[180:183], a[4:7], a[36:39], v[180:183]
 ds_read_b128 a[64:67], v10 offset:34816
 v_mfma_f32_16x16x32_bf16 v[180:183], a[0:3], a[32:35], v[180:183]
 ds_read_b128 a[68:71], v11 offset:34816
 v_mfma_f32_16x16x32_bf16 v[184:187], a[0:3], a[40:43], v[184:187]
 v_mfma_f32_16x16x32_bf16 v[184:187], a[4:7], a[44:47], v[184:187]
 v_mfma_f32_16x16x32_bf16 v[188:191], a[4:7], a[52:55], v[188:191]
 v_mfma_f32_16x16x32_bf16 v[188:191], a[0:3], a[48:51], v[188:191]
 s_waitcnt vmcnt(24) lgkmcnt(6)
 v_mfma_f32_16x16x32_bf16 v[192:195], a[24:27], a[8:11], v[192:195]
 ds_read_b128 a[0:3], v12 offset:4096
 v_mfma_f32_16x16x32_bf16 v[192:195], a[28:31], a[12:15], v[192:195]
 ds_read_b128 a[4:7], v13 offset:4096
 v_mfma_f32_16x16x32_bf16 v[196:199], a[36:39], a[12:15], v[196:199]
 ds_read_b128 a[72:75], v10 offset:36864
 v_mfma_f32_16x16x32_bf16 v[196:199], a[32:35], a[8:11], v[196:199]
 ds_read_b128 a[76:79], v11 offset:36864
 v_mfma_f32_16x16x32_bf16 v[200:203], a[40:43], a[8:11], v[200:203]
 v_mfma_f32_16x16x32_bf16 v[200:203], a[44:47], a[12:15], v[200:203]
 v_mfma_f32_16x16x32_bf16 v[204:207], a[52:55], a[12:15], v[204:207]
 v_mfma_f32_16x16x32_bf16 v[204:207], a[48:51], a[8:11], v[204:207]
 s_waitcnt vmcnt(21) lgkmcnt(6)
 v_mfma_f32_16x16x32_bf16 v[208:211], a[24:27], a[16:19], v[208:211]
 ds_read_b128 a[8:11], v12 offset:6144
 s_and_b32 s77, s80, 15
 v_mfma_f32_16x16x32_bf16 v[208:211], a[28:31], a[20:23], v[208:211]
 ds_read_b128 a[12:15], v13 offset:6144
 s_xor_b32 s77, s77, 15
 v_mfma_f32_16x16x32_bf16 v[212:215], a[36:39], a[20:23], v[212:215]
 ds_read_b128 a[80:83], v10 offset:38912
 s_lshl_b32 s77, s77, 7
 v_mfma_f32_16x16x32_bf16 v[212:215], a[32:35], a[16:19], v[212:215]
 ds_read_b128 a[84:87], v11 offset:38912
 s_add_u32 m0, s76, 32768
 v_mfma_f32_16x16x32_bf16 v[216:219], a[40:43], a[16:19], v[216:219]
 s_add_u32 s79, s77, 0
 buffer_load_dwordx4 v2, s[24:27], s79 offen offset:0 lds
 v_mfma_f32_16x16x32_bf16 v[216:219], a[44:47], a[20:23], v[216:219]
 v_mfma_f32_16x16x32_bf16 v[220:223], a[52:55], a[20:23], v[220:223]
 v_mfma_f32_16x16x32_bf16 v[220:223], a[48:51], a[16:19], v[220:223]
 s_waitcnt vmcnt(16) lgkmcnt(2)
 s_barrier
 v_mfma_f32_16x16x32_bf16 v[224:227], a[24:27], a[0:3], v[224:227]
 ds_read_b64_tr_b16 a[16:17], v14 offset:16896
 buffer_load_dwordx4 v3, s[24:27], s79 offen offset:1024 lds
 v_mfma_f32_16x16x32_bf16 v[224:227], a[28:31], a[4:7], v[224:227]
 ds_read_b64_tr_b16 a[18:19], v14 offset:17152
 s_add_u32 m0, s76, 34816
 v_mfma_f32_16x16x32_bf16 v[228:231], a[36:39], a[4:7], v[228:231]
 ds_read_b64_tr_b16 a[20:21], v14 offset:25344
 s_add_u32 s79, s77, 4096
 v_mfma_f32_16x16x32_bf16 v[228:231], a[32:35], a[0:3], v[228:231]
L_pad4:
 s_cbranch_execz L_pad8
 ds_read_b64_tr_b16 a[22:23], v14 offset:25600
 v_mfma_f32_16x16x32_bf16 v[232:235], a[40:43], a[0:3], v[232:235]
 v_mfma_f32_16x16x32_bf16 v[232:235], a[44:47], a[4:7], v[232:235]
 buffer_load_dwordx4 v2, s[24:27], s79 offen offset:0 lds
 v_mfma_f32_16x16x32_bf16 v[236:239], a[52:55], a[4:7], v[236:239]
 v_mfma_f32_16x16x32_bf16 v[236:239], a[48:51], a[0:3], v[236:239]
 s_waitcnt lgkmcnt(6)
 v_mfma_f32_16x16x32_bf16 v[240:243], a[24:27], a[8:11], v[240:243]
 ds_read_b64_tr_b16 a[0:1], v14 offset:16928
 v_mfma_f32_16x16x32_bf16 v[240:243], a[28:31], a[12:15], v[240:243]
 ds_read_b64_tr_b16 a[2:3], v14 offset:17184
 buffer_load_dwordx4 v3, s[24:27], s79 offen offset:1024 lds
 v_mfma_f32_16x16x32_bf16 v[244:247], a[36:39], a[12:15], v[244:247]
 ds_read_b64_tr_b16 a[4:5], v14 offset:25376
 s_add_u32 m0, s76, 36864
 v_mfma_f32_16x16x32_bf16 v[244:247], a[32:35], a[8:11], v[244:247]
 ds_read_b64_tr_b16 a[6:7], v14 offset:25632
 s_add_u32 s79, s77, 8192
 v_mfma_f32_16x16x32_bf16 v[248:251], a[40:43], a[8:11], v[248:251]
 v_mfma_f32_16x16x32_bf16 v[248:251], a[44:47], a[12:15], v[248:251]
 v_mfma_f32_16x16x32_bf16 v[252:255], a[52:55], a[12:15], v[252:255]
 buffer_load_dwordx4 v2, s[24:27], s79 offen offset:0 lds
 v_mfma_f32_16x16x32_bf16 v[252:255], a[48:51], a[8:11], v[252:255]
 s_waitcnt lgkmcnt(4)
 v_mfma_f32_16x16x32_bf16 v[80:83], a[16:19], a[56:59], v[80:83]
 ds_read_b64_tr_b16 a[8:9], v14 offset:16960
 v_mfma_f32_16x16x32_bf16 v[80:83], a[20:23], a[60:63], v[80:83]
 ds_read_b64_tr_b16 a[10:11], v14 offset:17216
 v_mfma_f32_16x16x32_bf16 v[84:87], a[20:23], a[68:71], v[84:87]
 ds_read_b64_tr_b16 a[12:13], v14 offset:25408
 buffer_load_dwordx4 v3, s[24:27], s79 offen offset:1024 lds
 v_mfma_f32_16x16x32_bf16 v[84:87], a[16:19], a[64:67], v[84:87]
 ds_read_b64_tr_b16 a[14:15], v14 offset:25664
 s_add_u32 m0, s76, 38912
 v_mfma_f32_16x16x32_bf16 v[88:91], a[16:19], a[72:75], v[88:91]
 s_add_u32 s79, s77, 12288
 v_mfma_f32_16x16x32_bf16 v[88:91], a[20:23], a[76:79], v[88:91]
 v_mfma_f32_16x16x32_bf16 v[92:95], a[20:23], a[84:87], v[92:95]
 v_mfma_f32_16x16x32_bf16 v[92:95], a[16:19], a[80:83], v[92:95]
 buffer_load_dwordx4 v2, s[24:27], s79 offen offset:0 lds
 s_waitcnt lgkmcnt(4)
 v_mfma_f32_16x16x32_bf16 v[128:131], a[0:3], a[56:59], v[128:131]
 ds_read_b64_tr_b16 a[16:17], v14 offset:16992
 v_mfma_f32_16x16x32_bf16 v[128:131], a[4:7], a[60:63], v[128:131]
 ds_read_b64_tr_b16 a[18:19], v14 offset:17248
 v_mfma_f32_16x16x32_bf16 v[132:135], a[4:7], a[68:71], v[132:135]
 ds_read_b64_tr_b16 a[20:21], v14 offset:25440
 v_mfma_f32_16x16x32_bf16 v[132:135], a[0:3], a[64:67], v[132:135]
 ds_read_b64_tr_b16 a[22:23], v14 offset:25696
 buffer_load_dwordx4 v3, s[24:27], s79 offen offset:1024 lds
 v_mfma_f32_16x16x32_bf16 v[136:139], a[0:3], a[72:75], v[136:139]
 s_add_u32 m0, s74, 0
 s_mul_i32 s78, s77, 3584
 v_mfma_f32_16x16x32_bf16 v[136:139], a[4:7], a[76:79], v[136:139]
 v_mfma_f32_16x16x32_bf16 v[140:143], a[4:7], a[84:87], v[140:143]
 v_mfma_f32_16x16x32_bf16 v[140:143], a[0:3], a[80:83], v[140:143]
 s_waitcnt lgkmcnt(4)
 v_mfma_f32_16x16x32_bf16 v[96:99], a[8:11], a[56:59], v[96:99]
 ds_read_b64_tr_b16 a[0:1], v14 offset:17024
 buffer_load_dwordx4 v6, s[32:35], s78 offen offset:0 lds
 v_mfma_f32_16x16x32_bf16 v[96:99], a[12:15], a[60:63], v[96:99]
 ds_read_b64_tr_b16 a[2:3], v14 offset:17280
 v_mfma_f32_16x16x32_bf16 v[100:103], a[12:15], a[68:71], v[100:103]
 ds_read_b64_tr_b16 a[4:5], v14 offset:25472
 v_mfma_f32_16x16x32_bf16 v[100:103], a[8:11], a[64:67], v[100:103]
 ds_read_b64_tr_b16 a[6:7], v14 offset:25728
 v_mfma_f32_16x16x32_bf16 v[104:107], a[8:11], a[72:75], v[104:107]
 buffer_load_dwordx4 v7, s[32:35], s78 offen offset:1056 lds
 v_mfma_f32_16x16x32_bf16 v[104:107], a[12:15], a[76:79], v[104:107]
 v_mfma_f32_16x16x32_bf16 v[108:111], a[12:15], a[84:87], v[108:111]
 v_mfma_f32_16x16x32_bf16 v[108:111], a[8:11], a[80:83], v[108:111]
 s_waitcnt lgkmcnt(4)
 v_mfma_f32_16x16x32_bf16 v[144:147], a[16:19], a[56:59], v[144:147]
 ds_read_b64_tr_b16 a[8:9], v14 offset:17056
 v_mfma_f32_16x16x32_bf16 v[144:147], a[20:23], a[60:63], v[144:147]
 ds_read_b64_tr_b16 a[10:11], v14 offset:17312
 buffer_load_dwordx4 v8, s[32:35], s78 offen offset:2112 lds
 v_mfma_f32_16x16x32_bf16 v[148:151], a[20:23], a[68:71], v[148:151]
 ds_read_b64_tr_b16 a[12:13], v14 offset:25504
 v_mfma_f32_16x16x32_bf16 v[148:151], a[16:19], a[64:67], v[148:151]
 ds_read_b64_tr_b16 a[14:15], v14 offset:25760
 v_mfma_f32_16x16x32_bf16 v[152:155], a[16:19], a[72:75], v[152:155]
 v_mfma_f32_16x16x32_bf16 v[152:155], a[20:23], a[76:79], v[152:155]
 buffer_load_dwordx4 v9, s[32:35], s78 offen offset:3168 lds
 s_add_u32 m0, s75, 0
 v_mfma_f32_16x16x32_bf16 v[156:159], a[20:23], a[84:87], v[156:159]
 s_nop 0
 v_mfma_f32_16x16x32_bf16 v[156:159], a[16:19], a[80:83], v[156:159]
 s_waitcnt lgkmcnt(4)
 v_mfma_f32_16x16x32_bf16 v[112:115], a[0:3], a[56:59], v[112:115]
 ds_read_b64_tr_b16 a[16:17], v14 offset:17088
 v_mfma_f32_16x16x32_bf16 v[112:115], a[4:7], a[60:63], v[112:115]
 ds_read_b64_tr_b16 a[18:19], v14 offset:17344
 v_mfma_f32_16x16x32_bf16 v[116:119], a[4:7], a[68:71], v[116:119]
 ds_read_b64_tr_b16 a[20:21], v14 offset:25536
 buffer_load_dwordx4 v4, s[28:31], s77 offen offset:0 lds
 v_mfma_f32_16x16x32_bf16 v[116:119], a[0:3], a[64:67], v[116:119]
 ds_read_b64_tr_b16 a[22:23], v14 offset:25792
 v_mfma_f32_16x16x32_bf16 v[120:123], a[0:3], a[72:75], v[120:123]
 v_mfma_f32_16x16x32_bf16 v[120:123], a[4:7], a[76:79], v[120:123]
 v_mfma_f32_16x16x32_bf16 v[124:127], a[4:7], a[84:87], v[124:127]
 buffer_load_dwordx4 v5, s[28:31], s77 offen offset:1024 lds
 s_lshl_b32 s78, s64, 11
 v_mfma_f32_16x16x32_bf16 v[124:127], a[0:3], a[80:83], v[124:127]
 s_add_u32 s78, s78, 41943040
 s_waitcnt vmcnt(27) lgkmcnt(4)
 s_waitcnt vmcnt(23)
 v_cmp_gt_u32 vcc, 0x100, v78
 s_cbranch_vccnz L_slow_1
L_back_3:
 v_mfma_f32_16x16x32_bf16 v[160:163], a[8:11], a[56:59], v[160:163]
 ds_read_b128 a[0:3], v12 offset:8192
 s_add_u32 s28, s48, s78
 s_addc_u32 s29, s49, 0
 v_mfma_f32_16x16x32_bf16 v[160:163], a[12:15], a[60:63], v[160:163]
 ds_read_b128 a[4:7], v13 offset:8192
 s_mov_b32 s30, 2048
 v_mfma_f32_16x16x32_bf16 v[164:167], a[12:15], a[68:71], v[164:167]
 ds_read_b128 a[24:27], v10 offset:0
 s_lshl_b32 s32, s63, 2
 v_mfma_f32_16x16x32_bf16 v[164:167], a[8:11], a[64:67], v[164:167]
 ds_read_b128 a[28:31], v11 offset:0
 s_add_u32 s32, s32, s101
 v_mfma_f32_16x16x32_bf16 v[168:171], a[8:11], a[72:75], v[168:171]
 s_sub_u32 s33, 8, s62
 s_lshl_b32 s33, s33, 8
 s_xor_b32 s34, s60, 3
 v_mfma_f32_16x16x32_bf16 v[168:171], a[12:15], a[76:79], v[168:171]
 s_lshl_b32 s34, s34, 12
 s_add_u32 s34, s34, s33
 s_sub_u32 s34, s34, 256
 v_mfma_f32_16x16x32_bf16 v[172:175], a[12:15], a[84:87], v[172:175]
 s_mul_i32 s35, s60, 4608
 s_min_u32 s78, s60, 1
 s_mul_i32 s78, s78, 6144
 v_mfma_f32_16x16x32_bf16 v[172:175], a[8:11], a[80:83], v[172:175]
 s_add_u32 s35, s35, s78
 s_add_u32 s35, s35, 135168
 s_waitcnt vmcnt(25) lgkmcnt(4)
 v_mfma_f32_16x16x32_bf16 v[176:179], a[16:19], a[56:59], v[176:179]
 ds_read_b128 a[8:11], v12 offset:10240
 s_lshr_b32 s75, s63, 1
 v_mfma_f32_16x16x32_bf16 v[176:179], a[20:23], a[60:63], v[176:179]
 ds_read_b128 a[12:15], v13 offset:10240
 s_mul_i32 s75, s75, 28672
 v_mfma_f32_16x16x32_bf16 v[180:183], a[20:23], a[68:71], v[180:183]
 ds_read_b128 a[32:35], v10 offset:2048
 s_and_b32 s78, s63, 1
 v_mfma_f32_16x16x32_bf16 v[180:183], a[16:19], a[64:67], v[180:183]
 ds_read_b128 a[36:39], v11 offset:2048
 s_lshl_b32 s78, s78, 9
 v_mfma_f32_16x16x32_bf16 v[184:187], a[16:19], a[72:75], v[184:187]
 s_add_u32 s75, s75, s78
 s_add_u32 s75, s75, 12288
 s_add_u32 s76, s17, 4096
 v_mfma_f32_16x16x32_bf16 v[184:187], a[20:23], a[76:79], v[184:187]
 s_add_u32 s79, s17, 8192
 s_lshl_b32 s78, s60, 9
 s_add_u32 m0, s78, 159744
 v_mfma_f32_16x16x32_bf16 v[188:191], a[20:23], a[84:87], v[188:191]
 s_lshl_b32 s78, s62, 2
 s_add_u32 s78, s78, s60
 s_lshl_b32 s78, s78, 8
 v_mfma_f32_16x16x32_bf16 v[188:191], a[16:19], a[80:83], v[188:191]
 s_add_u32 s78, s78, 42008576
 s_waitcnt vmcnt(22) lgkmcnt(6)
 v_mfma_f32_16x16x32_bf16 v[192:195], a[56:59], a[0:3], v[192:195]
 ds_read_b128 a[16:19], v12 offset:12288
 buffer_load_dword v72, s[48:51], s78 offen sc1 lds
 v_mfma_f32_16x16x32_bf16 v[192:195], a[60:63], a[4:7], v[192:195]
 ds_read_b128 a[20:23], v13 offset:12288
 s_add_u32 s78, s78, 7936
 v_mfma_f32_16x16x32_bf16 v[196:199], a[68:71], a[4:7], v[196:199]
 ds_read_b128 a[40:43], v10 offset:4096
 buffer_load_dword v72, s[48:51], s78 offen offset:256 sc1 lds
 v_mfma_f32_16x16x32_bf16 v[196:199], a[64:67], a[0:3], v[196:199]
 ds_read_b128 a[44:47], v11 offset:4096
 v_mfma_f32_16x16x32_bf16 v[200:203], a[72:75], a[0:3], v[200:203]
 v_mfma_f32_16x16x32_bf16 v[200:203], a[76:79], a[4:7], v[200:203]
 v_mfma_f32_16x16x32_bf16 v[204:207], a[84:87], a[4:7], v[204:207]
 v_mfma_f32_16x16x32_bf16 v[204:207], a[80:83], a[0:3], v[204:207]
 s_waitcnt vmcnt(22) lgkmcnt(6)
 v_mfma_f32_16x16x32_bf16 v[208:211], a[56:59], a[8:11], v[208:211]
 ds_read_b128 a[0:3], v12 offset:14336
 v_mfma_f32_16x16x32_bf16 v[208:211], a[60:63], a[12:15], v[208:211]
 ds_read_b128 a[4:7], v13 offset:14336
 v_mfma_f32_16x16x32_bf16 v[212:215], a[68:71], a[12:15], v[212:215]
 ds_read_b128 a[48:51], v10 offset:6144
 v_mfma_f32_16x16x32_bf16 v[212:215], a[64:67], a[8:11], v[212:215]
 ds_read_b128 a[52:55], v11 offset:6144
 v_mfma_f32_16x16x32_bf16 v[216:219], a[72:75], a[8:11], v[216:219]
 v_mfma_f32_16x16x32_bf16 v[216:219], a[76:79], a[12:15], v[216:219]
 v_mfma_f32_16x16x32_bf16 v[220:223], a[84:87], a[12:15], v[220:223]
 v_mfma_f32_16x16x32_bf16 v[220:223], a[80:83], a[8:11], v[220:223]
 s_waitcnt vmcnt(16) lgkmcnt(0)
 s_barrier
 v_mfma_f32_16x16x32_bf16 v[224:227], a[56:59], a[16:19], v[224:227]
 ds_read_b64_tr_b16 a[8:9], v14 offset:33792
 s_add_u32 s78, s17, 0
 v_mfma_f32_16x16x32_bf16 v[224:227], a[60:63], a[20:23], v[224:227]
 ds_read_b64_tr_b16 a[10:11], v14 offset:34048
 s_add_u32 m0, s66, 16896
 v_mfma_f32_16x16x32_bf16 v[228:231], a[68:71], a[20:23], v[228:231]
 ds_read_b64_tr_b16 a[12:13], v14 offset:42240
 s_lshl_b32 s78, s78, 4
 v_mfma_f32_16x16x32_bf16 v[228:231], a[64:67], a[16:19], v[228:231]
 ds_read_b64_tr_b16 a[14:15], v14 offset:42496
 buffer_load_dwordx4 v16, s[36:39], s78 offen offset:0 lds
 v_mfma_f32_16x16x32_bf16 v[232:235], a[72:75], a[16:19], v[232:235]
 v_mfma_f32_16x16x32_bf16 v[232:235], a[76:79], a[20:23], v[232:235]
 v_mfma_f32_16x16x32_bf16 v[236:239], a[84:87], a[20:23], v[236:239]
 v_mfma_f32_16x16x32_bf16 v[236:239], a[80:83], a[16:19], v[236:239]
 buffer_load_dwordx4 v17, s[36:39], s78 offen offset:1056 lds
 s_waitcnt lgkmcnt(6)
 v_mfma_f32_16x16x32_bf16 v[240:243], a[56:59], a[0:3], v[240:243]
 ds_read_b64_tr_b16 a[16:17], v14 offset:33824
 s_add_u32 s78, s17, 4096
 v_mfma_f32_16x16x32_bf16 v[240:243], a[60:63], a[4:7], v[240:243]
 ds_read_b64_tr_b16 a[18:19], v14 offset:34080
 s_add_u32 m0, s66, 25344
 v_mfma_f32_16x16x32_bf16 v[244:247], a[68:71], a[4:7], v[244:247]
 ds_read_b64_tr_b16 a[20:21], v14 offset:42272
 s_lshl_b32 s78, s78, 4
 v_mfma_f32_16x16x32_bf16 v[244:247], a[64:67], a[0:3], v[244:247]
 ds_read_b64_tr_b16 a[22:23], v14 offset:42528
 buffer_load_dwordx4 v16, s[36:39], s78 offen offset:0 lds
 v_mfma_f32_16x16x32_bf16 v[248:251], a[72:75], a[0:3], v[248:251]
 v_mfma_f32_16x16x32_bf16 v[248:251], a[76:79], a[4:7], v[248:251]
 v_mfma_f32_16x16x32_bf16 v[252:255], a[84:87], a[4:7], v[252:255]
 v_mfma_f32_16x16x32_bf16 v[252:255], a[80:83], a[0:3], v[252:255]
 s_waitcnt lgkmcnt(4)
 v_mfma_f32_16x16x32_bf16 v[80:83], a[8:11], a[24:27], v[80:83]
 ds_read_b64_tr_b16 a[0:1], v14 offset:33856
 buffer_load_dwordx4 v17, s[36:39], s78 offen offset:1056 lds
 v_mfma_f32_16x16x32_bf16 v[80:83], a[12:15], a[28:31], v[80:83]
 ds_read_b64_tr_b16 a[2:3], v14 offset:34112
 s_add_u32 s78, s17, 8192
 v_mfma_f32_16x16x32_bf16 v[84:87], a[12:15], a[36:39], v[84:87]
 ds_read_b64_tr_b16 a[4:5], v14 offset:42304
 s_add_u32 m0, s66, 84480
 v_mfma_f32_16x16x32_bf16 v[84:87], a[8:11], a[32:35], v[84:87]
 ds_read_b64_tr_b16 a[6:7], v14 offset:42560
 s_lshl_b32 s78, s78, 4
 v_mfma_f32_16x16x32_bf16 v[88:91], a[8:11], a[40:43], v[88:91]
 buffer_load_dwordx4 v16, s[36:39], s78 offen offset:0 lds
 v_mfma_f32_16x16x32_bf16 v[88:91], a[12:15], a[44:47], v[88:91]
 v_mfma_f32_16x16x32_bf16 v[92:95], a[12:15], a[52:55], v[92:95]
 v_mfma_f32_16x16x32_bf16 v[92:95], a[8:11], a[48:51], v[92:95]
 s_waitcnt lgkmcnt(4)
 v_mfma_f32_16x16x32_bf16 v[128:131], a[16:19], a[24:27], v[128:131]
 ds_read_b64_tr_b16 a[8:9], v14 offset:33888
 buffer_load_dwordx4 v17, s[36:39], s78 offen offset:1056 lds
 v_mfma_f32_16x16x32_bf16 v[128:131], a[20:23], a[28:31], v[128:131]
 ds_read_b64_tr_b16 a[10:11], v14 offset:34144
 s_add_u32 s78, s4, 0
 v_mfma_f32_16x16x32_bf16 v[132:135], a[20:23], a[36:39], v[132:135]
 ds_read_b64_tr_b16 a[12:13], v14 offset:42336
 s_add_u32 m0, s66, 92928
 v_mfma_f32_16x16x32_bf16 v[132:135], a[16:19], a[32:35], v[132:135]
 ds_read_b64_tr_b16 a[14:15], v14 offset:42592
 s_lshl_b32 s78, s78, 4
 v_mfma_f32_16x16x32_bf16 v[136:139], a[16:19], a[40:43], v[136:139]
 v_mfma_f32_16x16x32_bf16 v[136:139], a[20:23], a[44:47], v[136:139]
 buffer_load_dwordx4 v16, s[36:39], s78 offen offset:0 lds
 v_mfma_f32_16x16x32_bf16 v[140:143], a[20:23], a[52:55], v[140:143]
 v_mfma_f32_16x16x32_bf16 v[140:143], a[16:19], a[48:51], v[140:143]
 s_waitcnt lgkmcnt(4)
 v_mfma_f32_16x16x32_bf16 v[96:99], a[0:3], a[24:27], v[96:99]
 ds_read_b64_tr_b16 a[16:17], v14 offset:33920
 v_mfma_f32_16x16x32_bf16 v[96:99], a[4:7], a[28:31], v[96:99]
 ds_read_b64_tr_b16 a[18:19], v14 offset:34176
 buffer_load_dwordx4 v17, s[36:39], s78 offen offset:1056 lds
 v_mfma_f32_16x16x32_bf16 v[100:103], a[4:7], a[36:39], v[100:103]
 ds_read_b64_tr_b16 a[20:21], v14 offset:42368
 v_mfma_f32_16x16x32_bf16 v[100:103], a[0:3], a[32:35], v[100:103]
 ds_read_b64_tr_b16 a[22:23], v14 offset:42624
 v_mfma_f32_16x16x32_bf16 v[104:107], a[0:3], a[40:43], v[104:107]
 v_mfma_f32_16x16x32_bf16 v[104:107], a[4:7], a[44:47], v[104:107]
 v_mfma_f32_16x16x32_bf16 v[108:111], a[4:7], a[52:55], v[108:111]
 v_mfma_f32_16x16x32_bf16 v[108:111], a[0:3], a[48:51], v[108:111]
 s_waitcnt lgkmcnt(4)
 v_mfma_f32_16x16x32_bf16 v[144:147], a[8:11], a[24:27], v[144:147]
 ds_read_b64_tr_b16 a[0:1], v14 offset:33952
 v_mfma_f32_16x16x32_bf16 v[144:147], a[12:15], a[28:31], v[144:147]
 ds_read_b64_tr_b16 a[2:3], v14 offset:34208
 v_mfma_f32_16x16x32_bf16 v[148:151], a[12:15], a[36:39], v[148:151]
 ds_read_b64_tr_b16 a[4:5], v14 offset:42400
 v_mfma_f32_16x16x32_bf16 v[148:151], a[8:11], a[32:35], v[148:151]
 ds_read_b64_tr_b16 a[6:7], v14 offset:42656
 v_mfma_f32_16x16x32_bf16 v[152:155], a[8:11], a[40:43], v[152:155]
 v_mfma_f32_16x16x32_bf16 v[152:155], a[12:15], a[44:47], v[152:155]
 v_mfma_f32_16x16x32_bf16 v[156:159], a[12:15], a[52:55], v[156:159]
 v_mfma_f32_16x16x32_bf16 v[156:159], a[8:11], a[48:51], v[156:159]
 s_waitcnt lgkmcnt(4)
 v_mfma_f32_16x16x32_bf16 v[112:115], a[16:19], a[24:27], v[112:115]
 ds_read_b64_tr_b16 a[8:9], v14 offset:33984
 v_mfma_f32_16x16x32_bf16 v[112:115], a[20:23], a[28:31], v[112:115]
 ds_read_b64_tr_b16 a[10:11], v14 offset:34240
 v_mfma_f32_16x16x32_bf16 v[116:119], a[20:23], a[36:39], v[116:119]
 ds_read_b64_tr_b16 a[12:13], v14 offset:42432
 v_mfma_f32_16x16x32_bf16 v[116:119], a[16:19], a[32:35], v[116:119]
 ds_read_b64_tr_b16 a[14:15], v14 offset:42688
 v_mfma_f32_16x16x32_bf16 v[120:123], a[16:19], a[40:43], v[120:123]
 v_mfma_f32_16x16x32_bf16 v[120:123], a[20:23], a[44:47], v[120:123]
 v_mfma_f32_16x16x32_bf16 v[124:127], a[20:23], a[52:55], v[124:127]
 v_mfma_f32_16x16x32_bf16 v[124:127], a[16:19], a[48:51], v[124:127]
 s_waitcnt vmcnt(22) lgkmcnt(4)
 v_mfma_f32_16x16x32_bf16 v[160:163], a[0:3], a[24:27], v[160:163]
 ds_read_b128 a[16:19], v12 offset:16384
 v_mfma_f32_16x16x32_bf16 v[160:163], a[4:7], a[28:31], v[160:163]
 ds_read_b128 a[20:23], v13 offset:16384
 v_mfma_f32_16x16x32_bf16 v[164:167], a[4:7], a[36:39], v[164:167]
 ds_read_b128 a[56:59], v10 offset:32768
 v_mfma_f32_16x16x32_bf16 v[164:167], a[0:3], a[32:35], v[164:167]
 ds_read_b128 a[60:63], v11 offset:32768
 v_mfma_f32_16x16x32_bf16 v[168:171], a[0:3], a[40:43], v[168:171]
 v_mfma_f32_16x16x32_bf16 v[168:171], a[4:7], a[44:47], v[168:171]
 v_mfma_f32_16x16x32_bf16 v[172:175], a[4:7], a[52:55], v[172:175]
 v_mfma_f32_16x16x32_bf16 v[172:175], a[0:3], a[48:51], v[172:175]
 s_waitcnt vmcnt(20) lgkmcnt(4)
 v_mfma_f32_16x16x32_bf16 v[176:179], a[8:11], a[24:27], v[176:179]
 ds_read_b128 a[0:3], v12 offset:18432
 v_mfma_f32_16x16x32_bf16 v[176:179], a[12:15], a[28:31], v[176:179]
 ds_read_b128 a[4:7], v13 offset:18432
 v_mfma_f32_16x16x32_bf16 v[180:183], a[12:15], a[36:39], v[180:183]
 ds_read_b128 a[64:67], v10 offset:34816
 v_mfma_f32_16x16x32_bf16 v[180:183], a[8:11], a[32:35], v[180:183]
 ds_read_b128 a[68:71], v11 offset:34816
 v_mfma_f32_16x16x32_bf16 v[184:187], a[8:11], a[40:43], v[184:187]
 v_mfma_f32_16x16x32_bf16 v[184:187], a[12:15], a[44:47], v[184:187]
 v_mfma_f32_16x16x32_bf16 v[188:191], a[12:15], a[52:55], v[188:191]
 v_mfma_f32_16x16x32_bf16 v[188:191], a[8:11], a[48:51], v[188:191]
 s_waitcnt vmcnt(18) lgkmcnt(6)
 v_mfma_f32_16x16x32_bf16 v[192:195], a[24:27], a[16:19], v[192:195]
 ds_read_b128 a[8:11], v12 offset:20480
 v_mfma_f32_16x16x32_bf16 v[192:195], a[28:31], a[20:23], v[192:195]
 ds_read_b128 a[12:15], v13 offset:20480
 v_mfma_f32_16x16x32_bf16 v[196:199], a[36:39], a[20:23], v[196:199]
 ds_read_b128 a[72:75], v10 offset:36864
 v_mfma_f32_16x16x32_bf16 v[196:199], a[32:35], a[16:19], v[196:199]
 ds_read_b128 a[76:79], v11 offset:36864
 v_mfma_f32_16x16x32_bf16 v[200:203], a[40:43], a[16:19], v[200:203]
 v_mfma_f32_16x16x32_bf16 v[200:203], a[44:47], a[20:23], v[200:203]
 v_mfma_f32_16x16x32_bf16 v[204:207], a[52:55], a[20:23], v[204:207]
 v_mfma_f32_16x16x32_bf16 v[204:207], a[48:51], a[16:19], v[204:207]
 s_waitcnt vmcnt(16) lgkmcnt(6)
 v_mfma_f32_16x16x32_bf16 v[208:211], a[24:27], a[0:3], v[208:211]
 ds_read_b128 a[16:19], v12 offset:22528
 v_mfma_f32_16x16x32_bf16 v[208:211], a[28:31], a[4:7], v[208:211]
 ds_read_b128 a[20:23], v13 offset:22528
 v_mfma_f32_16x16x32_bf16 v[212:215], a[36:39], a[4:7], v[212:215]
 ds_read_b128 a[80:83], v10 offset:38912
 v_mfma_f32_16x16x32_bf16 v[212:215], a[32:35], a[0:3], v[212:215]
 ds_read_b128 a[84:87], v11 offset:38912
 v_mfma_f32_16x16x32_bf16 v[216:219], a[40:43], a[0:3], v[216:219]
 v_mfma_f32_16x16x32_bf16 v[216:219], a[44:47], a[4:7], v[216:219]
 v_mfma_f32_16x16x32_bf16 v[220:223], a[52:55], a[4:7], v[220:223]
 v_mfma_f32_16x16x32_bf16 v[220:223], a[48:51], a[0:3], v[220:223]
 s_waitcnt vmcnt(10) lgkmcnt(0)
 s_barrier
 v_mfma_f32_16x16x32_bf16 v[224:227], a[24:27], a[8:11], v[224:227]
 ds_read_b128 a[0:3], v12 offset:0
 s_add_u32 s78, s5, 0
 v_mfma_f32_16x16x32_bf16 v[224:227], a[28:31], a[12:15], v[224:227]
 ds_read_b128 a[4:7], v13 offset:0
 s_add_u32 m0, s66, 33792
 v_mfma_f32_16x16x32_bf16 v[228:231], a[36:39], a[12:15], v[228:231]
 s_lshl_b32 s78, s78, 4
 buffer_load_dwordx4 v16, s[36:39], s78 offen offset:0 lds
 v_mfma_f32_16x16x32_bf16 v[228:231], a[32:35], a[8:11], v[228:231]
 v_mov_b32 v10, 0xc0135761
 v_lshlrev_b32 v11, 26, v0
 v_mfma_f32_16x16x32_bf16 v[232:235], a[40:43], a[8:11], v[232:235]
 v_min_u32 v11, 2146435072, v11
 v_mov_b32 v76, 0
 v_mfma_f32_16x16x32_bf16 v[232:235], a[44:47], a[12:15], v[232:235]
 v_mov_b32 v77, 0
 v_mov_b32 v78, 0
 v_mfma_f32_16x16x32_bf16 v[236:239], a[52:55], a[12:15], v[236:239]
 buffer_load_dwordx4 v17, s[36:39], s78 offen offset:1056 lds
 s_add_u32 s78, s6, 0
 v_mfma_f32_16x16x32_bf16 v[236:239], a[48:51], a[8:11], v[236:239]
 s_add_u32 m0, s66, 42240
 s_lshl_b32 s78, s78, 4
 s_waitcnt lgkmcnt(4)
 v_mfma_f32_16x16x32_bf16 v[240:243], a[24:27], a[16:19], v[240:243]
 ds_read_b128 a[8:11], v12 offset:2048
 v_mov_b32 v79, 0
 v_mfma_f32_16x16x32_bf16 v[240:243], a[28:31], a[20:23], v[240:243]
 ds_read_b128 a[12:15], v13 offset:2048
 v_mfma_f32_16x16x32_bf16 v[244:247], a[36:39], a[20:23], v[244:247]
 buffer_load_dwordx4 v16, s[36:39], s78 offen offset:0 lds
 v_mfma_f32_16x16x32_bf16 v[244:247], a[32:35], a[16:19], v[244:247]
 v_mfma_f32_16x16x32_bf16 v[248:251], a[40:43], a[16:19], v[248:251]
 v_mfma_f32_16x16x32_bf16 v[248:251], a[44:47], a[20:23], v[248:251]
 v_mfma_f32_16x16x32_bf16 v[252:255], a[52:55], a[20:23], v[252:255]
 v_mfma_f32_16x16x32_bf16 v[252:255], a[48:51], a[16:19], v[252:255]
 buffer_load_dwordx4 v17, s[36:39], s78 offen offset:1056 lds
 s_waitcnt lgkmcnt(2)
 v_mfma_f32_16x16x32_bf16 v[192:195], a[56:59], a[0:3], v[192:195]
 ds_read_b128 a[16:19], v12 offset:4096
 s_add_u32 s78, s7, 0
 v_mfma_f32_16x16x32_bf16 v[192:195], a[60:63], a[4:7], v[192:195]
 ds_read_b128 a[20:23], v13 offset:4096
 s_add_u32 m0, s66, 101376
 v_mfma_f32_16x16x32_bf16 v[196:199], a[68:71], a[4:7], v[196:199]
 s_lshl_b32 s78, s78, 4
 s_lshl_b32 s72, s60, 9
 s_add_u32 s72, s72, 159744
 v_mfma_f32_16x16x32_bf16 v[196:199], a[64:67], a[0:3], v[196:199]
 buffer_load_dwordx4 v16, s[36:39], s78 offen offset:0 lds
 v_and_b32 v68, 12, v0
 v_mfma_f32_16x16x32_bf16 v[200:203], a[72:75], a[0:3], v[200:203]
 v_and_b32 v69, 3, v0
 v_lshl_add_u32 v68, v68, 2, v69
 v_mfma_f32_16x16x32_bf16 v[200:203], a[76:79], a[4:7], v[200:203]
 v_lshl_add_u32 v68, v68, 2, s72
 s_waitcnt vmcnt(13)
 v_mfma_f32_16x16x32_bf16 v[204:207], a[84:87], a[4:7], v[204:207]
 ds_read_b32 v60, v68 offset:256
 v_mfma_f32_16x16x32_bf16 v[204:207], a[80:83], a[0:3], v[204:207]
 ds_read_b32 v61, v68 offset:272
 s_waitcnt lgkmcnt(4)
 v_mfma_f32_16x16x32_bf16 v[208:211], a[56:59], a[8:11], v[208:211]
 ds_read_b128 a[0:3], v12 offset:6144
 buffer_load_dwordx4 v17, s[36:39], s78 offen offset:1056 lds
 v_mfma_f32_16x16x32_bf16 v[208:211], a[60:63], a[12:15], v[208:211]
 ds_read_b128 a[4:7], v13 offset:6144
 s_add_u32 s78, s8, 0
 v_mfma_f32_16x16x32_bf16 v[212:215], a[68:71], a[12:15], v[212:215]
 ds_read_b32 v62, v68 offset:288
 s_add_u32 m0, s66, 109824
 v_mfma_f32_16x16x32_bf16 v[212:215], a[64:67], a[8:11], v[212:215]
 ds_read_b32 v63, v68 offset:304
 s_lshl_b32 s78, s78, 4
 v_mfma_f32_16x16x32_bf16 v[216:219], a[72:75], a[8:11], v[216:219]
 buffer_load_dwordx4 v16, s[36:39], s78 offen offset:0 lds
 v_mfma_f32_16x16x32_bf16 v[216:219], a[76:79], a[12:15], v[216:219]
 v_mfma_f32_16x16x32_bf16 v[220:223], a[84:87], a[12:15], v[220:223]
 v_mfma_f32_16x16x32_bf16 v[220:223], a[80:83], a[8:11], v[220:223]
 s_waitcnt lgkmcnt(6)
 v_mfma_f32_16x16x32_bf16 v[224:227], a[56:59], a[16:19], v[224:227]
 ds_read_b64_tr_b16 a[8:9], v14 offset:0
 buffer_load_dwordx4 v17, s[36:39], s78 offen offset:1056 lds
 v_mfma_f32_16x16x32_bf16 v[224:227], a[60:63], a[20:23], v[224:227]
 ds_read_b64_tr_b16 a[10:11], v14 offset:256
 s_add_u32 s78, s9, 0
 v_mfma_f32_16x16x32_bf16 v[228:231], a[68:71], a[20:23], v[228:231]
 ds_read_b64_tr_b16 a[12:13], v14 offset:8448
 s_add_u32 m0, s66, 118272
 v_mfma_f32_16x16x32_bf16 v[228:231], a[64:67], a[16:19], v[228:231]
 ds_read_b64_tr_b16 a[14:15], v14 offset:8704
 s_lshl_b32 s78, s78, 4
 v_mfma_f32_16x16x32_bf16 v[232:235], a[72:75], a[16:19], v[232:235]
 v_mfma_f32_16x16x32_bf16 v[232:235], a[76:79], a[20:23], v[232:235]
 buffer_load_dwordx4 v16, s[36:39], s78 offen offset:0 lds
 v_mfma_f32_16x16x32_bf16 v[236:239], a[84:87], a[20:23], v[236:239]
 v_mfma_f32_16x16x32_bf16 v[236:239], a[80:83], a[16:19], v[236:239]
 s_waitcnt lgkmcnt(6)
 v_mfma_f32_16x16x32_bf16 v[240:243], a[56:59], a[0:3], v[240:243]
 ds_read_b64_tr_b16 a[16:17], v14 offset:32
 v_and_b32 v12, 48, v0
 v_mfma_f32_16x16x32_bf16 v[240:243], a[60:63], a[4:7], v[240:243]
 ds_read_b64_tr_b16 a[18:19], v14 offset:288
 buffer_load_dwordx4 v17, s[36:39], s78 offen offset:1056 lds
 v_mfma_f32_16x16x32_bf16 v[244:247], a[68:71], a[4:7], v[244:247]
 ds_read_b64_tr_b16 a[20:21], v14 offset:8480
 s_add_u32 s78, s10, 0
 v_mfma_f32_16x16x32_bf16 v[244:247], a[64:67], a[0:3], v[244:247]
 ds_read_b64_tr_b16 a[22:23], v14 offset:8736
 s_add_u32 m0, s66, 126720
 v_mfma_f32_16x16x32_bf16 v[248:251], a[72:75], a[0:3], v[248:251]
 s_lshl_b32 s78, s78, 4
 v_lshl_add_u32 v12, v12, 2, s72
 v_mfma_f32_16x16x32_bf16 v[248:251], a[76:79], a[4:7], v[248:251]
 buffer_load_dwordx4 v16, s[36:39], s78 offen offset:0 lds
 v_mfma_f32_16x16x32_bf16 v[252:255], a[84:87], a[4:7], v[252:255]
 v_mfma_f32_16x16x32_bf16 v[252:255], a[80:83], a[0:3], v[252:255]
 s_waitcnt lgkmcnt(4)
 v_mfma_f32_16x16x32_bf16 v[80:83], a[8:11], a[56:59], v[80:83]
 ds_read_b64_tr_b16 a[0:1], v14 offset:64
 v_mfma_f32_16x16x32_bf16 v[80:83], a[12:15], a[60:63], v[80:83]
 ds_read_b64_tr_b16 a[2:3], v14 offset:320
 v_mfma_f32_16x16x32_bf16 v[84:87], a[12:15], a[68:71], v[84:87]
 ds_read_b64_tr_b16 a[4:5], v14 offset:8512
 buffer_load_dwordx4 v17, s[36:39], s78 offen offset:1056 lds
 v_mfma_f32_16x16x32_bf16 v[84:87], a[8:11], a[64:67], v[84:87]
 ds_read_b64_tr_b16 a[6:7], v14 offset:8768
 v_mfma_f32_16x16x32_bf16 v[88:91], a[8:11], a[72:75], v[88:91]
 v_mfma_f32_16x16x32_bf16 v[88:91], a[12:15], a[76:79], v[88:91]
 v_mfma_f32_16x16x32_bf16 v[92:95], a[12:15], a[84:87], v[92:95]
 v_mfma_f32_16x16x32_bf16 v[92:95], a[8:11], a[80:83], v[92:95]
 s_waitcnt lgkmcnt(4)
 v_mfma_f32_16x16x32_bf16 v[128:131], a[16:19], a[56:59], v[128:131]
 ds_read_b64_tr_b16 a[8:9], v14 offset:96
 v_mfma_f32_16x16x32_bf16 v[128:131], a[20:23], a[60:63], v[128:131]
 ds_read_b64_tr_b16 a[10:11], v14 offset:352
 v_mfma_f32_16x16x32_bf16 v[132:135], a[20:23], a[68:71], v[132:135]
 ds_read_b64_tr_b16 a[12:13], v14 offset:8544
 v_mfma_f32_16x16x32_bf16 v[132:135], a[16:19], a[64:67], v[132:135]
 ds_read_b64_tr_b16 a[14:15], v14 offset:8800
 v_mfma_f32_16x16x32_bf16 v[136:139], a[16:19], a[72:75], v[136:139]
 v_mfma_f32_16x16x32_bf16 v[136:139], a[20:23], a[76:79], v[136:139]
 v_mfma_f32_16x16x32_bf16 v[140:143], a[20:23], a[84:87], v[140:143]
 v_mfma_f32_16x16x32_bf16 v[140:143], a[16:19], a[80:83], v[140:143]
L_trans:
 s_waitcnt lgkmcnt(15)
 s_nop 0
 v_pk_mul_f32 v[2:3], v[80:81], v[80:81]
 v_pk_mul_f32 v[4:5], v[82:83], v[82:83]
 v_pk_mul_f32 v[6:7], v[128:129], v[128:129]
 v_pk_mul_f32 v[8:9], v[130:131], v[130:131]
 v_pk_fma_f32 v[2:3], v[2:3], s[22:23], v[10:11] op_sel:[0,0,0] op_sel_hi:[1,0,0]
 v_pk_fma_f32 v[4:5], v[4:5], s[22:23], v[10:11] op_sel:[0,0,0] op_sel_hi:[1,0,0]
 v_pk_fma_f32 v[6:7], v[6:7], s[22:23], v[10:11] op_sel:[0,0,0] op_sel_hi:[1,0,0]
 v_pk_fma_f32 v[8:9], v[8:9], s[22:23], v[10:11] op_sel:[0,0,0] op_sel_hi:[1,0,0]
 v_pk_mul_f32 v[2:3], v[2:3], v[80:81]
 v_pk_mul_f32 v[4:5], v[4:5], v[82:83]
 v_pk_mul_f32 v[6:7], v[6:7], v[128:129]
 v_pk_mul_f32 v[8:9], v[8:9], v[130:131]
 v_exp_f32 v2, v2
 s_waitcnt lgkmcnt(4)
 v_mfma_f32_16x16x32_bf16 v[96:99], a[0:3], a[56:59], v[96:99]
 ds_read_b64_tr_b16 a[16:17], v14 offset:128
 v_exp_f32 v3, v3
 v_mfma_f32_16x16x32_bf16 v[96:99], a[4:7], a[60:63], v[96:99]
 ds_read_b64_tr_b16 a[18:19], v14 offset:384
 v_exp_f32 v4, v4
 v_mfma_f32_16x16x32_bf16 v[100:103], a[4:7], a[68:71], v[100:103]
 ds_read_b64_tr_b16 a[20:21], v14 offset:8576
 v_exp_f32 v5, v5
 v_mfma_f32_16x16x32_bf16 v[100:103], a[0:3], a[64:67], v[100:103]
 ds_read_b64_tr_b16 a[22:23], v14 offset:8832
 v_exp_f32 v6, v6
 v_mfma_f32_16x16x32_bf16 v[104:107], a[0:3], a[72:75], v[104:107]
 v_exp_f32 v7, v7
 v_exp_f32 v8, v8
 v_exp_f32 v9, v9
 v_pk_fma_f32 v[2:3], v[2:3], v[60:61], v[60:61] op_sel:[0,0,0] op_sel_hi:[1,0,0]
 v_pk_fma_f32 v[4:5], v[4:5], v[60:61], v[60:61] op_sel:[0,0,0] op_sel_hi:[1,0,0]
 v_pk_fma_f32 v[6:7], v[6:7], v[60:61], v[60:61] op_sel:[0,0,0] op_sel_hi:[1,0,0]
 v_pk_fma_f32 v[8:9], v[8:9], v[60:61], v[60:61] op_sel:[0,0,0] op_sel_hi:[1,0,0]
 v_rcp_f32 v2, v2
 v_mfma_f32_16x16x32_bf16 v[104:107], a[4:7], a[76:79], v[104:107]
 v_rcp_f32 v3, v3
 v_mfma_f32_16x16x32_bf16 v[108:111], a[4:7], a[84:87], v[108:111]
 v_rcp_f32 v4, v4
 v_mfma_f32_16x16x32_bf16 v[108:111], a[0:3], a[80:83], v[108:111]
 v_rcp_f32 v5, v5
 s_waitcnt lgkmcnt(4)
 v_mfma_f32_16x16x32_bf16 v[144:147], a[8:11], a[56:59], v[144:147]
 ds_read_b64_tr_b16 a[0:1], v14 offset:160
 v_rcp_f32 v6, v6
 v_mfma_f32_16x16x32_bf16 v[144:147], a[12:15], a[60:63], v[144:147]
 ds_read_b64_tr_b16 a[2:3], v14 offset:416
 v_rcp_f32 v7, v7
 v_rcp_f32 v8, v8
 v_rcp_f32 v9, v9
 v_pk_mul_f32 v[2:3], v[2:3], v[80:81]
 v_pk_mul_f32 v[4:5], v[4:5], v[82:83]
 v_pk_mul_f32 v[6:7], v[6:7], v[128:129]
 v_pk_mul_f32 v[8:9], v[8:9], v[130:131]
 v_cvt_pk_bf16_f32 v80, v2, v3
 v_cvt_pk_bf16_f32 v81, v4, v5
 v_cvt_pk_bf16_f32 v82, v6, v7
 v_cvt_pk_bf16_f32 v83, v8, v9
L_pad5:
 s_cbranch_execz L_pad9
 v_pk_mul_f32 v[2:3], v[84:85], v[84:85]
 v_pk_mul_f32 v[4:5], v[86:87], v[86:87]
 v_pk_mul_f32 v[6:7], v[132:133], v[132:133]
 v_pk_mul_f32 v[8:9], v[134:135], v[134:135]
 v_pk_fma_f32 v[2:3], v[2:3], s[22:23], v[10:11] op_sel:[0,0,0] op_sel_hi:[1,0,0]
 v_pk_fma_f32 v[4:5], v[4:5], s[22:23], v[10:11] op_sel:[0,0,0] op_sel_hi:[1,0,0]
 v_pk_fma_f32 v[6:7], v[6:7], s[22:23], v[10:11] op_sel:[0,0,0] op_sel_hi:[1,0,0]
 v_pk_fma_f32 v[8:9], v[8:9], s[22:23], v[10:11] op_sel:[0,0,0] op_sel_hi:[1,0,0]
 v_pk_mul_f32 v[2:3], v[2:3], v[84:85]
 v_pk_mul_f32 v[4:5], v[4:5], v[86:87]
 v_pk_mul_f32 v[6:7], v[6:7], v[132:133]
 v_pk_mul_f32 v[8:9], v[8:9], v[134:135]
 v_exp_f32 v2, v2
 v_mfma_f32_16x16x32_bf16 v[148:151], a[12:15], a[68:71], v[148:151]
 ds_read_b64_tr_b16 a[4:5], v14 offset:8608
 buffer_store_dwordx4 v[80:83], v15, s[48:51], s17 offen offset:0 sc1
 v_exp_f32 v3, v3
 v_mfma_f32_16x16x32_bf16 v[148:151], a[8:11], a[64:67], v[148:151]
 ds_read_b64_tr_b16 a[6:7], v14 offset:8864
 v_exp_f32 v4, v4
 v_mfma_f32_16x16x32_bf16 v[152:155], a[8:11], a[72:75], v[152:155]
 v_exp_f32 v5, v5
 v_mfma_f32_16x16x32_bf16 v[152:155], a[12:15], a[76:79], v[152:155]
 v_exp_f32 v6, v6
 v_mfma_f32_16x16x32_bf16 v[156:159], a[12:15], a[84:87], v[156:159]
 v_exp_f32 v7, v7
 v_exp_f32 v8, v8
 v_exp_f32 v9, v9
 v_pk_fma_f32 v[2:3], v[2:3], v[60:61], v[60:61] op_sel:[0,1,1] op_sel_hi:[1,1,1]
 v_pk_fma_f32 v[4:5], v[4:5], v[60:61], v[60:61] op_sel:[0,1,1] op_sel_hi:[1,1,1]
 v_pk_fma_f32 v[6:7], v[6:7], v[60:61], v[60:61] op_sel:[0,1,1] op_sel_hi:[1,1,1]
 v_pk_fma_f32 v[8:9], v[8:9], v[60:61], v[60:61] op_sel:[0,1,1] op_sel_hi:[1,1,1]
 v_rcp_f32 v2, v2
 v_mfma_f32_16x16x32_bf16 v[156:159], a[8:11], a[80:83], v[156:159]
 v_rcp_f32 v3, v3
 s_waitcnt lgkmcnt(4)
 v_mfma_f32_16x16x32_bf16 v[112:115], a[16:19], a[56:59], v[112:115]
 ds_read_b64_tr_b16 a[8:9], v14 offset:192
 v_rcp_f32 v4, v4
 v_mfma_f32_16x16x32_bf16 v[112:115], a[20:23], a[60:63], v[112:115]
 ds_read_b64_tr_b16 a[10:11], v14 offset:448
 v_rcp_f32 v5, v5
 v_mfma_f32_16x16x32_bf16 v[116:119], a[20:23], a[68:71], v[116:119]
 ds_read_b64_tr_b16 a[12:13], v14 offset:8640
 v_rcp_f32 v6, v6
 v_mfma_f32_16x16x32_bf16 v[116:119], a[16:19], a[64:67], v[116:119]
 ds_read_b64_tr_b16 a[14:15], v14 offset:8896
 v_rcp_f32 v7, v7
 v_rcp_f32 v8, v8
 v_rcp_f32 v9, v9
 v_pk_mul_f32 v[2:3], v[2:3], v[84:85]
 v_pk_mul_f32 v[4:5], v[4:5], v[86:87]
 v_pk_mul_f32 v[6:7], v[6:7], v[132:133]
 v_pk_mul_f32 v[8:9], v[8:9], v[134:135]
 v_cvt_pk_bf16_f32 v84, v2, v3
 v_cvt_pk_bf16_f32 v85, v4, v5
 v_cvt_pk_bf16_f32 v86, v6, v7
 v_cvt_pk_bf16_f32 v87, v8, v9
 v_pk_mul_f32 v[2:3], v[88:89], v[88:89]
 v_pk_mul_f32 v[4:5], v[90:91], v[90:91]
 v_pk_mul_f32 v[6:7], v[136:137], v[136:137]
 v_pk_mul_f32 v[8:9], v[138:139], v[138:139]
 v_pk_fma_f32 v[2:3], v[2:3], s[22:23], v[10:11] op_sel:[0,0,0] op_sel_hi:[1,0,0]
 v_pk_fma_f32 v[4:5], v[4:5], s[22:23], v[10:11] op_sel:[0,0,0] op_sel_hi:[1,0,0]
 v_pk_fma_f32 v[6:7], v[6:7], s[22:23], v[10:11] op_sel:[0,0,0] op_sel_hi:[1,0,0]
 v_pk_fma_f32 v[8:9], v[8:9], s[22:23], v[10:11] op_sel:[0,0,0] op_sel_hi:[1,0,0]
 v_pk_mul_f32 v[2:3], v[2:3], v[88:89]
 v_pk_mul_f32 v[4:5], v[4:5], v[90:91]
 v_pk_mul_f32 v[6:7], v[6:7], v[136:137]
 v_pk_mul_f32 v[8:9], v[8:9], v[138:139]
 v_exp_f32 v2, v2
 v_mfma_f32_16x16x32_bf16 v[120:123], a[16:19], a[72:75], v[120:123]
 buffer_store_dwordx4 v[84:87], v15, s[48:51], s17 offen offset:1024 sc1
 v_exp_f32 v3, v3
 v_mfma_f32_16x16x32_bf16 v[120:123], a[20:23], a[76:79], v[120:123]
 v_exp_f32 v4, v4
 v_mfma_f32_16x16x32_bf16 v[124:127], a[20:23], a[84:87], v[124:127]
 v_exp_f32 v5, v5
 v_mfma_f32_16x16x32_bf16 v[124:127], a[16:19], a[80:83], v[124:127]
 v_exp_f32 v6, v6
 s_waitcnt vmcnt(16) lgkmcnt(0)
 s_barrier
 v_mfma_f32_16x16x32_bf16 v[160:163], a[0:3], a[56:59], v[160:163]
 s_add_u32 s78, s4, 4096
 s_add_u32 m0, s66, 67584
 v_exp_f32 v7, v7
 v_exp_f32 v8, v8
 v_exp_f32 v9, v9
 v_pk_fma_f32 v[2:3], v[2:3], v[62:63], v[62:63] op_sel:[0,0,0] op_sel_hi:[1,0,0]
 v_pk_fma_f32 v[4:5], v[4:5], v[62:63], v[62:63] op_sel:[0,0,0] op_sel_hi:[1,0,0]
 v_pk_fma_f32 v[6:7], v[6:7], v[62:63], v[62:63] op_sel:[0,0,0] op_sel_hi:[1,0,0]
 v_pk_fma_f32 v[8:9], v[8:9], v[62:63], v[62:63] op_sel:[0,0,0] op_sel_hi:[1,0,0]
 v_rcp_f32 v2, v2
 v_mfma_f32_16x16x32_bf16 v[160:163], a[4:7], a[60:63], v[160:163]
 s_lshl_b32 s78, s78, 4
 buffer_load_dwordx4 v16, s[36:39], s78 offen offset:0 lds
 v_rcp_f32 v3, v3
 v_mfma_f32_16x16x32_bf16 v[164:167], a[4:7], a[68:71], v[164:167]
 buffer_load_dwordx4 v17, s[36:39], s78 offen offset:1056 lds
 s_add_u32 s78, s5, 4096
 v_rcp_f32 v4, v4
 v_mfma_f32_16x16x32_bf16 v[164:167], a[0:3], a[64:67], v[164:167]
 s_add_u32 m0, s66, 76032
 s_lshl_b32 s78, s78, 4
 v_rcp_f32 v5, v5
 v_mfma_f32_16x16x32_bf16 v[168:171], a[0:3], a[72:75], v[168:171]
 buffer_load_dwordx4 v16, s[36:39], s78 offen offset:0 lds
 v_rcp_f32 v6, v6
 v_mfma_f32_16x16x32_bf16 v[168:171], a[4:7], a[76:79], v[168:171]
 buffer_load_dwordx4 v17, s[36:39], s78 offen offset:1056 lds
 s_add_u32 s78, s6, 4096
 v_rcp_f32 v7, v7
 v_rcp_f32 v8, v8
 v_rcp_f32 v9, v9
 v_pk_mul_f32 v[2:3], v[2:3], v[88:89]
 v_pk_mul_f32 v[4:5], v[4:5], v[90:91]
 v_pk_mul_f32 v[6:7], v[6:7], v[136:137]
 v_pk_mul_f32 v[8:9], v[8:9], v[138:139]
 v_cvt_pk_bf16_f32 v88, v2, v3
 v_cvt_pk_bf16_f32 v89, v4, v5
 v_cvt_pk_bf16_f32 v90, v6, v7
 v_cvt_pk_bf16_f32 v91, v8, v9
 v_pk_mul_f32 v[2:3], v[92:93], v[92:93]
 v_pk_mul_f32 v[4:5], v[94:95], v[94:95]
 v_pk_mul_f32 v[6:7], v[140:141], v[140:141]
 v_pk_mul_f32 v[8:9], v[142:143], v[142:143]
 v_pk_fma_f32 v[2:3], v[2:3], s[22:23], v[10:11] op_sel:[0,0,0] op_sel_hi:[1,0,0]
 v_pk_fma_f32 v[4:5], v[4:5], s[22:23], v[10:11] op_sel:[0,0,0] op_sel_hi:[1,0,0]
 v_pk_fma_f32 v[6:7], v[6:7], s[22:23], v[10:11] op_sel:[0,0,0] op_sel_hi:[1,0,0]
 v_pk_fma_f32 v[8:9], v[8:9], s[22:23], v[10:11] op_sel:[0,0,0] op_sel_hi:[1,0,0]
 v_pk_mul_f32 v[2:3], v[2:3], v[92:93]
 v_pk_mul_f32 v[4:5], v[4:5], v[94:95]
 v_pk_mul_f32 v[6:7], v[6:7], v[140:141]
 v_pk_mul_f32 v[8:9], v[8:9], v[142:143]
 v_exp_f32 v2, v2
 v_mfma_f32_16x16x32_bf16 v[172:175], a[4:7], a[84:87], v[172:175]
 buffer_store_dwordx4 v[88:91], v15, s[48:51], s17 offen offset:2048 sc1
 s_add_u32 m0, s66, 0
 v_exp_f32 v3, v3
 v_mfma_f32_16x16x32_bf16 v[172:175], a[0:3], a[80:83], v[172:175]
 s_lshl_b32 s78, s78, 4
 buffer_load_dwordx4 v16, s[36:39], s78 offen offset:0 lds
 v_exp_f32 v4, v4
 s_waitcnt lgkmcnt(0)
 v_mfma_f32_16x16x32_bf16 v[176:179], a[8:11], a[56:59], v[176:179]
 v_exp_f32 v5, v5
 v_mfma_f32_16x16x32_bf16 v[176:179], a[12:15], a[60:63], v[176:179]
 buffer_load_dwordx4 v17, s[36:39], s78 offen offset:1056 lds
 s_add_u32 s78, s7, 4096
 v_exp_f32 v6, v6
 v_mfma_f32_16x16x32_bf16 v[180:183], a[12:15], a[68:71], v[180:183]
 s_add_u32 m0, s66, 8448
 s_lshl_b32 s78, s78, 4
 v_exp_f32 v7, v7
 v_exp_f32 v8, v8
 v_exp_f32 v9, v9
 v_pk_fma_f32 v[2:3], v[2:3], v[62:63], v[62:63] op_sel:[0,1,1] op_sel_hi:[1,1,1]
 v_pk_fma_f32 v[4:5], v[4:5], v[62:63], v[62:63] op_sel:[0,1,1] op_sel_hi:[1,1,1]
 v_pk_fma_f32 v[6:7], v[6:7], v[62:63], v[62:63] op_sel:[0,1,1] op_sel_hi:[1,1,1]
 v_pk_fma_f32 v[8:9], v[8:9], v[62:63], v[62:63] op_sel:[0,1,1] op_sel_hi:[1,1,1]
 v_rcp_f32 v2, v2
 v_mfma_f32_16x16x32_bf16 v[180:183], a[8:11], a[64:67], v[180:183]
 buffer_load_dwordx4 v16, s[36:39], s78 offen offset:0 lds
 v_rcp_f32 v3, v3
 v_mfma_f32_16x16x32_bf16 v[184:187], a[8:11], a[72:75], v[184:187]
 v_rcp_f32 v4, v4
 v_mfma_f32_16x16x32_bf16 v[184:187], a[12:15], a[76:79], v[184:187]
 buffer_load_dwordx4 v17, s[36:39], s78 offen offset:1056 lds
 s_add_u32 s78, s8, 4096
 v_rcp_f32 v5, v5
 v_mfma_f32_16x16x32_bf16 v[188:191], a[12:15], a[84:87], v[188:191]
 s_add_u32 m0, s66, 50688
 s_lshl_b32 s78, s78, 4
 v_rcp_f32 v6, v6
 v_mfma_f32_16x16x32_bf16 v[188:191], a[8:11], a[80:83], v[188:191]
 v_rcp_f32 v7, v7
 v_rcp_f32 v8, v8
 v_rcp_f32 v9, v9
 v_pk_mul_f32 v[2:3], v[2:3], v[92:93]
 v_pk_mul_f32 v[4:5], v[4:5], v[94:95]
 v_pk_mul_f32 v[6:7], v[6:7], v[140:141]
 v_pk_mul_f32 v[8:9], v[8:9], v[142:143]
 v_cvt_pk_bf16_f32 v92, v2, v3
 v_cvt_pk_bf16_f32 v93, v4, v5
 v_cvt_pk_bf16_f32 v94, v6, v7
 v_cvt_pk_bf16_f32 v95, v8, v9
 buffer_store_dwordx4 v[92:95], v15, s[48:51], s17 offen offset:3072 sc1
 ds_read_b64_tr_b16 a[80:81], v14 offset:16896
 ds_read_b64_tr_b16 a[82:83], v14 offset:17152
 ds_read_b64_tr_b16 a[96:97], v14 offset:16928
 ds_read_b64_tr_b16 a[98:99], v14 offset:17184
 v_pk_mul_f32 v[2:3], v[36:37], v[208:209] op_sel:[1,0] op_sel_hi:[1,1]
 v_pk_mul_f32 v[4:5], v[38:39], v[240:241] op_sel:[1,0] op_sel_hi:[1,1]
 v_pk_mul_f32 v[208:209], v[36:37], v[208:209] op_sel:[0,0] op_sel_hi:[0,1]
 v_pk_mul_f32 v[240:241], v[38:39], v[240:241] op_sel:[0,0] op_sel_hi:[0,1]
 v_pk_fma_f32 v[208:209], v[36:37], v[192:193], v[208:209] op_sel:[1,0,0] op_sel_hi:[1,1,1]
 v_pk_fma_f32 v[240:241], v[38:39], v[224:225], v[240:241] op_sel:[1,0,0] op_sel_hi:[1,1,1]
 v_pk_fma_f32 v[192:193], v[36:37], v[192:193], v[2:3] op_sel:[0,0,0] op_sel_hi:[0,1,1] neg_lo:[0,0,1] neg_hi:[0,0,1]
 v_pk_fma_f32 v[224:225], v[38:39], v[224:225], v[4:5] op_sel:[0,0,0] op_sel_hi:[0,1,1] neg_lo:[0,0,1] neg_hi:[0,0,1]
 v_pk_mul_f32 v[2:3], v[36:37], v[210:211] op_sel:[1,0] op_sel_hi:[1,1]
 v_pk_mul_f32 v[4:5], v[38:39], v[242:243] op_sel:[1,0] op_sel_hi:[1,1]
 v_pk_mul_f32 v[210:211], v[36:37], v[210:211] op_sel:[0,0] op_sel_hi:[0,1]
 v_pk_mul_f32 v[242:243], v[38:39], v[242:243] op_sel:[0,0] op_sel_hi:[0,1]
 v_pk_fma_f32 v[210:211], v[36:37], v[194:195], v[210:211] op_sel:[1,0,0] op_sel_hi:[1,1,1]
 v_pk_fma_f32 v[242:243], v[38:39], v[226:227], v[242:243] op_sel:[1,0,0] op_sel_hi:[1,1,1]
 v_pk_fma_f32 v[194:195], v[36:37], v[194:195], v[2:3] op_sel:[0,0,0] op_sel_hi:[0,1,1] neg_lo:[0,0,1] neg_hi:[0,0,1]
 v_pk_fma_f32 v[226:227], v[38:39], v[226:227], v[4:5] op_sel:[0,0,0] op_sel_hi:[0,1,1] neg_lo:[0,0,1] neg_hi:[0,0,1]
 v_pk_mul_f32 v[2:3], v[36:37], v[212:213] op_sel:[1,0] op_sel_hi:[1,1]
 v_pk_mul_f32 v[4:5], v[38:39], v[244:245] op_sel:[1,0] op_sel_hi:[1,1]
 v_pk_mul_f32 v[212:213], v[36:37], v[212:213] op_sel:[0,0] op_sel_hi:[0,1]
 v_pk_mul_f32 v[244:245], v[38:39], v[244:245] op_sel:[0,0] op_sel_hi:[0,1]
 v_pk_fma_f32 v[212:213], v[36:37], v[196:197], v[212:213] op_sel:[1,0,0] op_sel_hi:[1,1,1]
 v_pk_fma_f32 v[244:245], v[38:39], v[228:229], v[244:245] op_sel:[1,0,0] op_sel_hi:[1,1,1]
 v_pk_fma_f32 v[196:197], v[36:37], v[196:197], v[2:3] op_sel:[0,0,0] op_sel_hi:[0,1,1] neg_lo:[0,0,1] neg_hi:[0,0,1]
 v_pk_fma_f32 v[228:229], v[38:39], v[228:229], v[4:5] op_sel:[0,0,0] op_sel_hi:[0,1,1] neg_lo:[0,0,1] neg_hi:[0,0,1]
 v_pk_mul_f32 v[2:3], v[36:37], v[214:215] op_sel:[1,0] op_sel_hi:[1,1]
 v_pk_mul_f32 v[4:5], v[38:39], v[246:247] op_sel:[1,0] op_sel_hi:[1,1]
 v_pk_mul_f32 v[214:215], v[36:37], v[214:215] op_sel:[0,0] op_sel_hi:[0,1]
 v_pk_mul_f32 v[246:247], v[38:39], v[246:247] op_sel:[0,0] op_sel_hi:[0,1]
 v_pk_fma_f32 v[214:215], v[36:37], v[198:199], v[214:215] op_sel:[1,0,0] op_sel_hi:[1,1,1]
 v_pk_fma_f32 v[246:247], v[38:39], v[230:231], v[246:247] op_sel:[1,0,0] op_sel_hi:[1,1,1]
 v_pk_fma_f32 v[198:199], v[36:37], v[198:199], v[2:3] op_sel:[0,0,0] op_sel_hi:[0,1,1] neg_lo:[0,0,1] neg_hi:[0,0,1]
 v_pk_fma_f32 v[230:231], v[38:39], v[230:231], v[4:5] op_sel:[0,0,0] op_sel_hi:[0,1,1] neg_lo:[0,0,1] neg_hi:[0,0,1]
 v_pk_mul_f32 v[2:3], v[36:37], v[216:217] op_sel:[1,0] op_sel_hi:[1,1]
 v_pk_mul_f32 v[4:5], v[38:39], v[248:249] op_sel:[1,0] op_sel_hi:[1,1]
 v_pk_mul_f32 v[216:217], v[36:37], v[216:217] op_sel:[0,0] op_sel_hi:[0,1]
 v_pk_mul_f32 v[248:249], v[38:39], v[248:249] op_sel:[0,0] op_sel_hi:[0,1]
 v_pk_fma_f32 v[216:217], v[36:37], v[200:201], v[216:217] op_sel:[1,0,0] op_sel_hi:[1,1,1]
 v_pk_fma_f32 v[248:249], v[38:39], v[232:233], v[248:249] op_sel:[1,0,0] op_sel_hi:[1,1,1]
 v_pk_fma_f32 v[200:201], v[36:37], v[200:201], v[2:3] op_sel:[0,0,0] op_sel_hi:[0,1,1] neg_lo:[0,0,1] neg_hi:[0,0,1]
 v_pk_fma_f32 v[232:233], v[38:39], v[232:233], v[4:5] op_sel:[0,0,0] op_sel_hi:[0,1,1] neg_lo:[0,0,1] neg_hi:[0,0,1]
 v_pk_mul_f32 v[2:3], v[36:37], v[218:219] op_sel:[1,0] op_sel_hi:[1,1]
 v_pk_mul_f32 v[4:5], v[38:39], v[250:251] op_sel:[1,0] op_sel_hi:[1,1]
 v_pk_mul_f32 v[218:219], v[36:37], v[218:219] op_sel:[0,0] op_sel_hi:[0,1]
 v_pk_mul_f32 v[250:251], v[38:39], v[250:251] op_sel:[0,0] op_sel_hi:[0,1]
 v_pk_fma_f32 v[218:219], v[36:37], v[202:203], v[218:219] op_sel:[1,0,0] op_sel_hi:[1,1,1]
 v_pk_fma_f32 v[250:251], v[38:39], v[234:235], v[250:251] op_sel:[1,0,0] op_sel_hi:[1,1,1]
 v_pk_fma_f32 v[202:203], v[36:37], v[202:203], v[2:3] op_sel:[0,0,0] op_sel_hi:[0,1,1] neg_lo:[0,0,1] neg_hi:[0,0,1]
 v_pk_fma_f32 v[234:235], v[38:39], v[234:235], v[4:5] op_sel:[0,0,0] op_sel_hi:[0,1,1] neg_lo:[0,0,1] neg_hi:[0,0,1]
 v_pk_mul_f32 v[2:3], v[36:37], v[220:221] op_sel:[1,0] op_sel_hi:[1,1]
 v_pk_mul_f32 v[4:5], v[38:39], v[252:253] op_sel:[1,0] op_sel_hi:[1,1]
 v_pk_mul_f32 v[220:221], v[36:37], v[220:221] op_sel:[0,0] op_sel_hi:[0,1]
 v_pk_mul_f32 v[252:253], v[38:39], v[252:253] op_sel:[0,0] op_sel_hi:[0,1]
 v_pk_fma_f32 v[220:221], v[36:37], v[204:205], v[220:221] op_sel:[1,0,0] op_sel_hi:[1,1,1]
 v_pk_fma_f32 v[252:253], v[38:39], v[236:237], v[252:253] op_sel:[1,0,0] op_sel_hi:[1,1,1]
 v_pk_fma_f32 v[204:205], v[36:37], v[204:205], v[2:3] op_sel:[0,0,0] op_sel_hi:[0,1,1] neg_lo:[0,0,1] neg_hi:[0,0,1]
 v_pk_fma_f32 v[236:237], v[38:39], v[236:237], v[4:5] op_sel:[0,0,0] op_sel_hi:[0,1,1] neg_lo:[0,0,1] neg_hi:[0,0,1]
 v_pk_mul_f32 v[2:3], v[36:37], v[222:223] op_sel:[1,0] op_sel_hi:[1,1]
 v_pk_mul_f32 v[4:5], v[38:39], v[254:255] op_sel:[1,0] op_sel_hi:[1,1]
 v_pk_mul_f32 v[222:223], v[36:37], v[222:223] op_sel:[0,0] op_sel_hi:[0,1]
 v_pk_mul_f32 v[254:255], v[38:39], v[254:255] op_sel:[0,0] op_sel_hi:[0,1]
 v_pk_fma_f32 v[222:223], v[36:37], v[206:207], v[222:223] op_sel:[1,0,0] op_sel_hi:[1,1,1]
 v_pk_fma_f32 v[254:255], v[38:39], v[238:239], v[254:255] op_sel:[1,0,0] op_sel_hi:[1,1,1]
 v_pk_fma_f32 v[206:207], v[36:37], v[206:207], v[2:3] op_sel:[0,0,0] op_sel_hi:[0,1,1] neg_lo:[0,0,1] neg_hi:[0,0,1]
 v_pk_fma_f32 v[238:239], v[38:39], v[238:239], v[4:5] op_sel:[0,0,0] op_sel_hi:[0,1,1] neg_lo:[0,0,1] neg_hi:[0,0,1]
 v_pk_fma_f32 v[68:69], v[32:33], v[192:193], v[194:195] op_sel:[0,0,0] op_sel_hi:[0,1,1]
 v_pk_fma_f32 v[70:71], v[32:33], v[208:209], v[210:211] op_sel:[0,0,0] op_sel_hi:[0,1,1]
 v_pk_fma_f32 v[72:73], v[34:35], v[224:225], v[226:227] op_sel:[0,0,0] op_sel_hi:[0,1,1]
 v_pk_fma_f32 v[74:75], v[34:35], v[240:241], v[242:243] op_sel:[0,0,0] op_sel_hi:[0,1,1]
 v_pk_fma_f32 v[68:69], v[32:33], v[208:209], v[68:69] op_sel:[1,0,0] op_sel_hi:[1,1,1] neg_lo:[1,0,0] neg_hi:[1,0,0]
 v_pk_fma_f32 v[70:71], v[32:33], v[192:193], v[70:71] op_sel:[1,0,0] op_sel_hi:[1,1,1]
 v_pk_fma_f32 v[72:73], v[34:35], v[240:241], v[72:73] op_sel:[1,0,0] op_sel_hi:[1,1,1] neg_lo:[1,0,0] neg_hi:[1,0,0]
 v_pk_fma_f32 v[74:75], v[34:35], v[224:225], v[74:75] op_sel:[1,0,0] op_sel_hi:[1,1,1]
 v_pk_fma_f32 v[2:3], v[32:33], v[68:69], v[196:197] op_sel:[0,0,0] op_sel_hi:[0,1,1]
 v_pk_fma_f32 v[4:5], v[32:33], v[70:71], v[212:213] op_sel:[0,0,0] op_sel_hi:[0,1,1]
 v_pk_fma_f32 v[6:7], v[34:35], v[72:73], v[228:229] op_sel:[0,0,0] op_sel_hi:[0,1,1]
 v_pk_fma_f32 v[8:9], v[34:35], v[74:75], v[244:245] op_sel:[0,0,0] op_sel_hi:[0,1,1]
 v_pk_fma_f32 v[2:3], v[32:33], v[70:71], v[2:3] op_sel:[1,0,0] op_sel_hi:[1,1,1] neg_lo:[1,0,0] neg_hi:[1,0,0]
 v_pk_fma_f32 v[4:5], v[32:33], v[68:69], v[4:5] op_sel:[1,0,0] op_sel_hi:[1,1,1]
 v_pk_fma_f32 v[6:7], v[34:35], v[74:75], v[6:7] op_sel:[1,0,0] op_sel_hi:[1,1,1] neg_lo:[1,0,0] neg_hi:[1,0,0]
 v_pk_fma_f32 v[8:9], v[34:35], v[72:73], v[8:9] op_sel:[1,0,0] op_sel_hi:[1,1,1]
 v_pk_fma_f32 v[68:69], v[32:33], v[2:3], v[198:199] op_sel:[0,0,0] op_sel_hi:[0,1,1]
 v_pk_fma_f32 v[70:71], v[32:33], v[4:5], v[214:215] op_sel:[0,0,0] op_sel_hi:[0,1,1]
 v_pk_fma_f32 v[72:73], v[34:35], v[6:7], v[230:231] op_sel:[0,0,0] op_sel_hi:[0,1,1]
 v_pk_fma_f32 v[74:75], v[34:35], v[8:9], v[246:247] op_sel:[0,0,0] op_sel_hi:[0,1,1]
 v_pk_fma_f32 v[68:69], v[32:33], v[4:5], v[68:69] op_sel:[1,0,0] op_sel_hi:[1,1,1] neg_lo:[1,0,0] neg_hi:[1,0,0]
 v_pk_fma_f32 v[70:71], v[32:33], v[2:3], v[70:71] op_sel:[1,0,0] op_sel_hi:[1,1,1]
 v_pk_fma_f32 v[72:73], v[34:35], v[8:9], v[72:73] op_sel:[1,0,0] op_sel_hi:[1,1,1] neg_lo:[1,0,0] neg_hi:[1,0,0]
 v_pk_fma_f32 v[74:75], v[34:35], v[6:7], v[74:75] op_sel:[1,0,0] op_sel_hi:[1,1,1]
 v_pk_fma_f32 v[2:3], v[32:33], v[68:69], v[200:201] op_sel:[0,0,0] op_sel_hi:[0,1,1]
 v_pk_fma_f32 v[4:5], v[32:33], v[70:71], v[216:217] op_sel:[0,0,0] op_sel_hi:[0,1,1]
 v_pk_fma_f32 v[6:7], v[34:35], v[72:73], v[232:233] op_sel:[0,0,0] op_sel_hi:[0,1,1]
 v_pk_fma_f32 v[8:9], v[34:35], v[74:75], v[248:249] op_sel:[0,0,0] op_sel_hi:[0,1,1]
 v_pk_fma_f32 v[2:3], v[32:33], v[70:71], v[2:3] op_sel:[1,0,0] op_sel_hi:[1,1,1] neg_lo:[1,0,0] neg_hi:[1,0,0]
 v_pk_fma_f32 v[4:5], v[32:33], v[68:69], v[4:5] op_sel:[1,0,0] op_sel_hi:[1,1,1]
 v_pk_fma_f32 v[6:7], v[34:35], v[74:75], v[6:7] op_sel:[1,0,0] op_sel_hi:[1,1,1] neg_lo:[1,0,0] neg_hi:[1,0,0]
 v_pk_fma_f32 v[8:9], v[34:35], v[72:73], v[8:9] op_sel:[1,0,0] op_sel_hi:[1,1,1]
 v_pk_fma_f32 v[68:69], v[32:33], v[2:3], v[202:203] op_sel:[0,0,0] op_sel_hi:[0,1,1]
 v_pk_fma_f32 v[70:71], v[32:33], v[4:5], v[218:219] op_sel:[0,0,0] op_sel_hi:[0,1,1]
 v_pk_fma_f32 v[72:73], v[34:35], v[6:7], v[234:235] op_sel:[0,0,0] op_sel_hi:[0,1,1]
 v_pk_fma_f32 v[74:75], v[34:35], v[8:9], v[250:251] op_sel:[0,0,0] op_sel_hi:[0,1,1]
 v_pk_fma_f32 v[68:69], v[32:33], v[4:5], v[68:69] op_sel:[1,0,0] op_sel_hi:[1,1,1] neg_lo:[1,0,0] neg_hi:[1,0,0]
 v_pk_fma_f32 v[70:71], v[32:33], v[2:3], v[70:71] op_sel:[1,0,0] op_sel_hi:[1,1,1]
 v_pk_fma_f32 v[72:73], v[34:35], v[8:9], v[72:73] op_sel:[1,0,0] op_sel_hi:[1,1,1] neg_lo:[1,0,0] neg_hi:[1,0,0]
 v_pk_fma_f32 v[74:75], v[34:35], v[6:7], v[74:75] op_sel:[1,0,0] op_sel_hi:[1,1,1]
 v_pk_fma_f32 v[2:3], v[32:33], v[68:69], v[204:205] op_sel:[0,0,0] op_sel_hi:[0,1,1]
 v_pk_fma_f32 v[4:5], v[32:33], v[70:71], v[220:221] op_sel:[0,0,0] op_sel_hi:[0,1,1]
 v_pk_fma_f32 v[6:7], v[34:35], v[72:73], v[236:237] op_sel:[0,0,0] op_sel_hi:[0,1,1]
 v_pk_fma_f32 v[8:9], v[34:35], v[74:75], v[252:253] op_sel:[0,0,0] op_sel_hi:[0,1,1]
 v_pk_fma_f32 v[2:3], v[32:33], v[70:71], v[2:3] op_sel:[1,0,0] op_sel_hi:[1,1,1] neg_lo:[1,0,0] neg_hi:[1,0,0]
 v_pk_fma_f32 v[4:5], v[32:33], v[68:69], v[4:5] op_sel:[1,0,0] op_sel_hi:[1,1,1]
 v_pk_fma_f32 v[6:7], v[34:35], v[74:75], v[6:7] op_sel:[1,0,0] op_sel_hi:[1,1,1] neg_lo:[1,0,0] neg_hi:[1,0,0]
 v_pk_fma_f32 v[8:9], v[34:35], v[72:73], v[8:9] op_sel:[1,0,0] op_sel_hi:[1,1,1]
 v_pk_fma_f32 v[68:69], v[32:33], v[2:3], v[206:207] op_sel:[0,0,0] op_sel_hi:[0,1,1]
 v_pk_fma_f32 v[70:71], v[32:33], v[4:5], v[222:223] op_sel:[0,0,0] op_sel_hi:[0,1,1]
 v_pk_fma_f32 v[72:73], v[34:35], v[6:7], v[238:239] op_sel:[0,0,0] op_sel_hi:[0,1,1]
 v_pk_fma_f32 v[74:75], v[34:35], v[8:9], v[254:255] op_sel:[0,0,0] op_sel_hi:[0,1,1]
 v_pk_fma_f32 v[68:69], v[32:33], v[4:5], v[68:69] op_sel:[1,0,0] op_sel_hi:[1,1,1] neg_lo:[1,0,0] neg_hi:[1,0,0]
 v_pk_fma_f32 v[70:71], v[32:33], v[2:3], v[70:71] op_sel:[1,0,0] op_sel_hi:[1,1,1]
 v_pk_fma_f32 v[72:73], v[34:35], v[8:9], v[72:73] op_sel:[1,0,0] op_sel_hi:[1,1,1] neg_lo:[1,0,0] neg_hi:[1,0,0]
 v_pk_fma_f32 v[74:75], v[34:35], v[6:7], v[74:75] op_sel:[1,0,0] op_sel_hi:[1,1,1]
 v_fma_f32 v36, v40, v68, v69
 v_fma_f32 v37, v40, v70, v71
 v_fma_f32 v38, v42, v72, v73
 v_fma_f32 v39, v42, v74, v75
 v_fma_f32 v36, -v41, v70, v36
 v_fma_f32 v37, v41, v68, v37
 v_fma_f32 v38, -v43, v74, v38
 v_fma_f32 v39, v43, v72, v39
 ds_write_b128 v27, v[36:39]
 v_pk_mul_f32 v[2:3], v[96:97], v[96:97]
 v_pk_mul_f32 v[4:5], v[98:99], v[98:99]
 v_pk_mul_f32 v[6:7], v[144:145], v[144:145]
 v_pk_mul_f32 v[8:9], v[146:147], v[146:147]
 v_pk_fma_f32 v[2:3], v[2:3], s[22:23], v[10:11] op_sel:[0,0,0] op_sel_hi:[1,0,0]
 v_pk_fma_f32 v[4:5], v[4:5], s[22:23], v[10:11] op_sel:[0,0,0] op_sel_hi:[1,0,0]
 v_pk_fma_f32 v[6:7], v[6:7], s[22:23], v[10:11] op_sel:[0,0,0] op_sel_hi:[1,0,0]
 v_pk_fma_f32 v[8:9], v[8:9], s[22:23], v[10:11] op_sel:[0,0,0] op_sel_hi:[1,0,0]
 v_pk_mul_f32 v[2:3], v[2:3], v[96:97]
 v_pk_mul_f32 v[4:5], v[4:5], v[98:99]
 v_pk_mul_f32 v[6:7], v[6:7], v[144:145]
 v_pk_mul_f32 v[8:9], v[8:9], v[146:147]
 v_exp_f32 v2, v2
 s_waitcnt lgkmcnt(3)
 v_mfma_f32_16x16x32_bf16 a[128:131], a[80:83], v[80:83], 0
 ds_read_b64_tr_b16 a[112:113], v14 offset:16960
 buffer_load_dwordx4 v16, s[36:39], s78 offen offset:0 lds
 v_exp_f32 v3, v3
 v_mfma_f32_16x16x32_bf16 a[132:135], a[80:83], v[84:87], 0
 ds_read_b64_tr_b16 a[114:115], v14 offset:17216
 buffer_load_dwordx4 v17, s[36:39], s78 offen offset:1056 lds
 v_exp_f32 v4, v4
 v_mfma_f32_16x16x32_bf16 a[136:139], a[80:83], v[88:91], 0
 ds_read_b128 v[128:131], v28 offset:0
 s_add_u32 s78, s9, 4096
 v_exp_f32 v5, v5
 v_mfma_f32_16x16x32_bf16 a[140:143], a[80:83], v[92:95], 0
 ds_read_b128 v[132:135], v28 offset:256
 s_add_u32 m0, s66, 59136
 v_exp_f32 v6, v6
 v_exp_f32 v7, v7
 v_exp_f32 v8, v8
 v_exp_f32 v9, v9
 v_pk_fma_f32 v[2:3], v[2:3], v[60:61], v[60:61] op_sel:[0,0,0] op_sel_hi:[1,0,0]
 v_pk_fma_f32 v[4:5], v[4:5], v[60:61], v[60:61] op_sel:[0,0,0] op_sel_hi:[1,0,0]
 v_pk_fma_f32 v[6:7], v[6:7], v[60:61], v[60:61] op_sel:[0,0,0] op_sel_hi:[1,0,0]
 v_pk_fma_f32 v[8:9], v[8:9], v[60:61], v[60:61] op_sel:[0,0,0] op_sel_hi:[1,0,0]
 v_rcp_f32 v2, v2
 s_waitcnt lgkmcnt(5)
 v_mfma_f32_16x16x32_bf16 a[144:147], a[96:99], v[80:83], 0
 ds_read_b64_tr_b16 a[80:81], v14 offset:16992
 s_lshl_b32 s78, s78, 4
 v_rcp_f32 v3, v3
 v_mfma_f32_16x16x32_bf16 a[148:151], a[96:99], v[84:87], 0
 ds_read_b64_tr_b16 a[82:83], v14 offset:17248
 buffer_load_dwordx4 v16, s[36:39], s78 offen offset:0 lds
 v_rcp_f32 v4, v4
 v_mfma_f32_16x16x32_bf16 a[152:155], a[96:99], v[88:91], 0
 ds_read_b128 v[136:139], v28 offset:512
 buffer_load_dwordx4 v17, s[36:39], s78 offen offset:1056 lds
 v_rcp_f32 v5, v5
 v_mfma_f32_16x16x32_bf16 a[156:159], a[96:99], v[92:95], 0
 v_rcp_f32 v6, v6
 v_rcp_f32 v7, v7
 v_rcp_f32 v8, v8
 v_rcp_f32 v9, v9
 v_pk_mul_f32 v[2:3], v[2:3], v[96:97]
 v_pk_mul_f32 v[4:5], v[4:5], v[98:99]
 v_pk_mul_f32 v[6:7], v[6:7], v[144:145]
 v_pk_mul_f32 v[8:9], v[8:9], v[146:147]
 v_cvt_pk_bf16_f32 v96, v2, v3
 v_cvt_pk_bf16_f32 v97, v4, v5
 v_cvt_pk_bf16_f32 v98, v6, v7
 v_cvt_pk_bf16_f32 v99, v8, v9
 s_waitcnt lgkmcnt(0)
 s_lshl_b64 exec, -1, 16
 v_pk_fma_f32 v[2:3], v[44:45], v[76:77], v[128:129] op_sel:[0,0,0] op_sel_hi:[0,1,1]
 v_pk_fma_f32 v[4:5], v[46:47], v[78:79], v[130:131] op_sel:[0,0,0] op_sel_hi:[0,1,1]
 v_pk_fma_f32 v[76:77], v[44:45], v[76:77], v[2:3] op_sel:[1,1,0] op_sel_hi:[1,0,1] neg_lo:[1,0,0] neg_hi:[0,0,0]
 v_pk_fma_f32 v[78:79], v[46:47], v[78:79], v[4:5] op_sel:[1,1,0] op_sel_hi:[1,0,1] neg_lo:[1,0,0] neg_hi:[0,0,0]
 s_lshl_b64 exec, -1, 32
 v_pk_fma_f32 v[2:3], v[44:45], v[76:77], v[132:133] op_sel:[0,0,0] op_sel_hi:[0,1,1]
 v_pk_fma_f32 v[4:5], v[46:47], v[78:79], v[134:135] op_sel:[0,0,0] op_sel_hi:[0,1,1]
 v_pk_fma_f32 v[76:77], v[44:45], v[76:77], v[2:3] op_sel:[1,1,0] op_sel_hi:[1,0,1] neg_lo:[1,0,0] neg_hi:[0,0,0]
 v_pk_fma_f32 v[78:79], v[46:47], v[78:79], v[4:5] op_sel:[1,1,0] op_sel_hi:[1,0,1] neg_lo:[1,0,0] neg_hi:[0,0,0]
 s_lshl_b64 exec, -1, 48
 v_pk_fma_f32 v[2:3], v[44:45], v[76:77], v[136:137] op_sel:[0,0,0] op_sel_hi:[0,1,1]
 v_pk_fma_f32 v[4:5], v[46:47], v[78:79], v[138:139] op_sel:[0,0,0] op_sel_hi:[0,1,1]
 v_pk_fma_f32 v[76:77], v[44:45], v[76:77], v[2:3] op_sel:[1,1,0] op_sel_hi:[1,0,1] neg_lo:[1,0,0] neg_hi:[0,0,0]
 v_pk_fma_f32 v[78:79], v[46:47], v[78:79], v[4:5] op_sel:[1,1,0] op_sel_hi:[1,0,1] neg_lo:[1,0,0] neg_hi:[0,0,0]
 v_pk_fma_f32 v[2:3], v[44:45], v[76:77], v[36:37] op_sel:[0,0,0] op_sel_hi:[0,1,1]
 v_pk_fma_f32 v[4:5], v[46:47], v[78:79], v[38:39] op_sel:[0,0,0] op_sel_hi:[0,1,1]
 v_pk_fma_f32 v[36:37], v[44:45], v[76:77], v[2:3] op_sel:[1,1,0] op_sel_hi:[1,0,1] neg_lo:[1,0,0] neg_hi:[0,0,0]
 v_pk_fma_f32 v[38:39], v[46:47], v[78:79], v[4:5] op_sel:[1,1,0] op_sel_hi:[1,0,1] neg_lo:[1,0,0] neg_hi:[0,0,0]
 ds_write_b128 v29, v[36:39]
 s_mov_b64 exec, -1
 v_pk_mul_f32 v[2:3], v[100:101], v[100:101]
 v_pk_mul_f32 v[4:5], v[102:103], v[102:103]
 v_pk_mul_f32 v[6:7], v[148:149], v[148:149]
 v_pk_mul_f32 v[8:9], v[150:151], v[150:151]
 v_pk_fma_f32 v[2:3], v[2:3], s[22:23], v[10:11] op_sel:[0,0,0] op_sel_hi:[1,0,0]
 v_pk_fma_f32 v[4:5], v[4:5], s[22:23], v[10:11] op_sel:[0,0,0] op_sel_hi:[1,0,0]
 v_pk_fma_f32 v[6:7], v[6:7], s[22:23], v[10:11] op_sel:[0,0,0] op_sel_hi:[1,0,0]
 v_pk_fma_f32 v[8:9], v[8:9], s[22:23], v[10:11] op_sel:[0,0,0] op_sel_hi:[1,0,0]
 v_pk_mul_f32 v[2:3], v[2:3], v[100:101]
 v_pk_mul_f32 v[4:5], v[4:5], v[102:103]
 v_pk_mul_f32 v[6:7], v[6:7], v[148:149]
 v_pk_mul_f32 v[8:9], v[8:9], v[150:151]
 v_exp_f32 v2, v2
 s_waitcnt lgkmcnt(6)
 v_mfma_f32_16x16x32_bf16 a[160:163], a[112:115], v[80:83], 0
 ds_read_b64_tr_b16 a[96:97], v14 offset:17024
 buffer_store_dwordx4 v[96:99], v15, s[48:51], s76 offen offset:0 sc1
 v_exp_f32 v3, v3
 v_mfma_f32_16x16x32_bf16 a[164:167], a[112:115], v[84:87], 0
 ds_read_b64_tr_b16 a[98:99], v14 offset:17280
 v_exp_f32 v4, v4
 v_mfma_f32_16x16x32_bf16 a[168:171], a[112:115], v[88:91], 0
 v_mov_b32 v1, 1
 s_waitcnt vmcnt(5)
 v_exp_f32 v5, v5
 v_mfma_f32_16x16x32_bf16 a[172:175], a[112:115], v[92:95], 0
 buffer_store_dword v1, v11, s[48:51], s32 offen sc1
 v_exp_f32 v6, v6
 v_exp_f32 v7, v7
 v_exp_f32 v8, v8
 v_exp_f32 v9, v9
 v_pk_fma_f32 v[2:3], v[2:3], v[60:61], v[60:61] op_sel:[0,1,1] op_sel_hi:[1,1,1]
 v_pk_fma_f32 v[4:5], v[4:5], v[60:61], v[60:61] op_sel:[0,1,1] op_sel_hi:[1,1,1]
 v_pk_fma_f32 v[6:7], v[6:7], v[60:61], v[60:61] op_sel:[0,1,1] op_sel_hi:[1,1,1]
 v_pk_fma_f32 v[8:9], v[8:9], v[60:61], v[60:61] op_sel:[0,1,1] op_sel_hi:[1,1,1]
 v_rcp_f32 v2, v2
 s_waitcnt lgkmcnt(4)
 v_mfma_f32_16x16x32_bf16 a[176:179], a[80:83], v[80:83], 0
 ds_read_b64_tr_b16 a[112:113], v14 offset:17056
 v_rcp_f32 v3, v3
 v_mfma_f32_16x16x32_bf16 a[180:183], a[80:83], v[84:87], 0
 ds_read_b64_tr_b16 a[114:115], v14 offset:17312
 v_rcp_f32 v4, v4
 v_mfma_f32_16x16x32_bf16 a[184:187], a[80:83], v[88:91], 0
 v_rcp_f32 v5, v5
 v_mfma_f32_16x16x32_bf16 a[188:191], a[80:83], v[92:95], 0
 v_rcp_f32 v6, v6
 v_rcp_f32 v7, v7
 v_rcp_f32 v8, v8
 v_rcp_f32 v9, v9
 v_pk_mul_f32 v[2:3], v[2:3], v[100:101]
 v_pk_mul_f32 v[4:5], v[4:5], v[102:103]
 v_pk_mul_f32 v[6:7], v[6:7], v[148:149]
 v_pk_mul_f32 v[8:9], v[8:9], v[150:151]
 v_cvt_pk_bf16_f32 v100, v2, v3
 v_cvt_pk_bf16_f32 v101, v4, v5
 v_cvt_pk_bf16_f32 v102, v6, v7
 v_cvt_pk_bf16_f32 v103, v8, v9
 s_waitcnt vmcnt(18) lgkmcnt(4)
 s_barrier
 v_pk_mul_f32 v[2:3], v[104:105], v[104:105]
 v_pk_mul_f32 v[4:5], v[106:107], v[106:107]
 v_pk_mul_f32 v[6:7], v[152:153], v[152:153]
 v_pk_mul_f32 v[8:9], v[154:155], v[154:155]
 v_pk_fma_f32 v[2:3], v[2:3], s[22:23], v[10:11] op_sel:[0,0,0] op_sel_hi:[1,0,0]
 v_pk_fma_f32 v[4:5], v[4:5], s[22:23], v[10:11] op_sel:[0,0,0] op_sel_hi:[1,0,0]
 v_pk_fma_f32 v[6:7], v[6:7], s[22:23], v[10:11] op_sel:[0,0,0] op_sel_hi:[1,0,0]
 v_pk_fma_f32 v[8:9], v[8:9], s[22:23], v[10:11] op_sel:[0,0,0] op_sel_hi:[1,0,0]
 v_pk_mul_f32 v[2:3], v[2:3], v[104:105]
 v_pk_mul_f32 v[4:5], v[4:5], v[106:107]
 v_pk_mul_f32 v[6:7], v[6:7], v[152:153]
 v_pk_mul_f32 v[8:9], v[8:9], v[154:155]
 v_exp_f32 v2, v2
 s_waitcnt lgkmcnt(2)
 v_mfma_f32_16x16x32_bf16 a[192:195], a[96:99], v[80:83], 0
 ds_read_b64_tr_b16 a[80:81], v14 offset:17088
 buffer_store_dwordx4 v[100:103], v15, s[48:51], s76 offen offset:1024 sc1
 v_exp_f32 v3, v3
 v_mfma_f32_16x16x32_bf16 a[196:199], a[96:99], v[84:87], 0
 ds_read_b64_tr_b16 a[82:83], v14 offset:17344
 v_exp_f32 v4, v4
 v_mfma_f32_16x16x32_bf16 a[200:203], a[96:99], v[88:91], 0
 ds_read_b128 v[128:131], v30 offset:0
 v_exp_f32 v5, v5
 v_mfma_f32_16x16x32_bf16 a[204:207], a[96:99], v[92:95], 0
 ds_read_b128 v[132:135], v30 offset:256
 v_exp_f32 v6, v6
 v_exp_f32 v7, v7
 v_exp_f32 v8, v8
 v_exp_f32 v9, v9
 v_pk_fma_f32 v[2:3], v[2:3], v[62:63], v[62:63] op_sel:[0,0,0] op_sel_hi:[1,0,0]
 v_pk_fma_f32 v[4:5], v[4:5], v[62:63], v[62:63] op_sel:[0,0,0] op_sel_hi:[1,0,0]
 v_pk_fma_f32 v[6:7], v[6:7], v[62:63], v[62:63] op_sel:[0,0,0] op_sel_hi:[1,0,0]
 v_pk_fma_f32 v[8:9], v[8:9], v[62:63], v[62:63] op_sel:[0,0,0] op_sel_hi:[1,0,0]
 v_rcp_f32 v2, v2
 s_waitcnt lgkmcnt(4)
 v_mfma_f32_16x16x32_bf16 a[208:211], a[112:115], v[80:83], 0
 ds_read_b64_tr_b16 a[96:97], v14 offset:17120
 v_rcp_f32 v3, v3
 v_mfma_f32_16x16x32_bf16 a[212:215], a[112:115], v[84:87], 0
 ds_read_b64_tr_b16 a[98:99], v14 offset:17376
 v_rcp_f32 v4, v4
 v_mfma_f32_16x16x32_bf16 a[216:219], a[112:115], v[88:91], 0
 ds_read_b128 v[136:139], v30 offset:512
 v_rcp_f32 v5, v5
 v_mfma_f32_16x16x32_bf16 a[220:223], a[112:115], v[92:95], 0
 ds_read_b128 v[140:143], v30 offset:768
 v_rcp_f32 v6, v6
 v_rcp_f32 v7, v7
 v_rcp_f32 v8, v8
 v_rcp_f32 v9, v9
 v_pk_mul_f32 v[2:3], v[2:3], v[104:105]
 v_pk_mul_f32 v[4:5], v[4:5], v[106:107]
 v_pk_mul_f32 v[6:7], v[6:7], v[152:153]
 v_pk_mul_f32 v[8:9], v[8:9], v[154:155]
 v_cvt_pk_bf16_f32 v104, v2, v3
 v_cvt_pk_bf16_f32 v105, v4, v5
 v_cvt_pk_bf16_f32 v106, v6, v7
 v_cvt_pk_bf16_f32 v107, v8, v9
 v_mov_b32 v36, 0
 v_mov_b32 v37, 0
 v_mov_b32 v38, 0
 v_mov_b32 v39, 0
 s_waitcnt lgkmcnt(0)
 s_cmp_gt_u32 s60, 0
 s_cselect_b64 exec, -1, 0
 v_pk_fma_f32 v[2:3], v[48:49], v[36:37], v[128:129] op_sel:[0,0,0] op_sel_hi:[0,1,1]
 v_pk_fma_f32 v[4:5], v[50:51], v[38:39], v[130:131] op_sel:[0,0,0] op_sel_hi:[0,1,1]
 v_pk_fma_f32 v[36:37], v[48:49], v[36:37], v[2:3] op_sel:[1,1,0] op_sel_hi:[1,0,1] neg_lo:[1,0,0] neg_hi:[0,0,0]
 v_pk_fma_f32 v[38:39], v[50:51], v[38:39], v[4:5] op_sel:[1,1,0] op_sel_hi:[1,0,1] neg_lo:[1,0,0] neg_hi:[0,0,0]
 s_cmp_gt_u32 s60, 1
 s_cselect_b64 exec, -1, 0
 v_pk_fma_f32 v[2:3], v[48:49], v[36:37], v[132:133] op_sel:[0,0,0] op_sel_hi:[0,1,1]
 v_pk_fma_f32 v[4:5], v[50:51], v[38:39], v[134:135] op_sel:[0,0,0] op_sel_hi:[0,1,1]
 v_pk_fma_f32 v[36:37], v[48:49], v[36:37], v[2:3] op_sel:[1,1,0] op_sel_hi:[1,0,1] neg_lo:[1,0,0] neg_hi:[0,0,0]
 v_pk_fma_f32 v[38:39], v[50:51], v[38:39], v[4:5] op_sel:[1,1,0] op_sel_hi:[1,0,1] neg_lo:[1,0,0] neg_hi:[0,0,0]
 s_cmp_gt_u32 s60, 2
 s_cselect_b64 exec, -1, 0
 v_pk_fma_f32 v[2:3], v[48:49], v[36:37], v[136:137] op_sel:[0,0,0] op_sel_hi:[0,1,1]
 v_pk_fma_f32 v[4:5], v[50:51], v[38:39], v[138:139] op_sel:[0,0,0] op_sel_hi:[0,1,1]
 v_pk_fma_f32 v[36:37], v[48:49], v[36:37], v[2:3] op_sel:[1,1,0] op_sel_hi:[1,0,1] neg_lo:[1,0,0] neg_hi:[0,0,0]
 v_pk_fma_f32 v[38:39], v[50:51], v[38:39], v[4:5] op_sel:[1,1,0] op_sel_hi:[1,0,1] neg_lo:[1,0,0] neg_hi:[0,0,0]
 s_mov_b64 exec, -1
 v_pk_fma_f32 v[2:3], v[48:49], v[36:37], v[140:141] op_sel:[0,0,0] op_sel_hi:[0,1,1]
 v_pk_fma_f32 v[4:5], v[50:51], v[38:39], v[142:143] op_sel:[0,0,0] op_sel_hi:[0,1,1]
 v_pk_fma_f32 v[140:141], v[48:49], v[36:37], v[2:3] op_sel:[1,1,0] op_sel_hi:[1,0,1] neg_lo:[1,0,0] neg_hi:[0,0,0]
 v_pk_fma_f32 v[142:143], v[50:51], v[38:39], v[4:5] op_sel:[1,1,0] op_sel_hi:[1,0,1] neg_lo:[1,0,0] neg_hi:[0,0,0]
 v_pk_fma_f32 v[2:3], v[56:57], v[36:37], v[76:77] op_sel:[0,0,0] op_sel_hi:[0,1,1]
 v_pk_fma_f32 v[4:5], v[58:59], v[38:39], v[78:79] op_sel:[0,0,0] op_sel_hi:[0,1,1]
 v_pk_fma_f32 v[76:77], v[56:57], v[36:37], v[2:3] op_sel:[1,1,0] op_sel_hi:[1,0,1] neg_lo:[1,0,0] neg_hi:[0,0,0]
 v_pk_fma_f32 v[78:79], v[58:59], v[38:39], v[4:5] op_sel:[1,1,0] op_sel_hi:[1,0,1] neg_lo:[1,0,0] neg_hi:[0,0,0]
 v_pk_mul_f32 v[2:3], v[108:109], v[108:109]
 v_pk_mul_f32 v[4:5], v[110:111], v[110:111]
 v_pk_mul_f32 v[6:7], v[156:157], v[156:157]
 v_pk_mul_f32 v[8:9], v[158:159], v[158:159]
 v_pk_fma_f32 v[2:3], v[2:3], s[22:23], v[10:11] op_sel:[0,0,0] op_sel_hi:[1,0,0]
 v_pk_fma_f32 v[4:5], v[4:5], s[22:23], v[10:11] op_sel:[0,0,0] op_sel_hi:[1,0,0]
 v_pk_fma_f32 v[6:7], v[6:7], s[22:23], v[10:11] op_sel:[0,0,0] op_sel_hi:[1,0,0]
 v_pk_fma_f32 v[8:9], v[8:9], s[22:23], v[10:11] op_sel:[0,0,0] op_sel_hi:[1,0,0]
 v_pk_mul_f32 v[2:3], v[2:3], v[108:109]
 v_pk_mul_f32 v[4:5], v[4:5], v[110:111]
 v_pk_mul_f32 v[6:7], v[6:7], v[156:157]
 v_pk_mul_f32 v[8:9], v[8:9], v[158:159]
 v_exp_f32 v2, v2
 s_waitcnt lgkmcnt(6)
 v_mfma_f32_16x16x32_bf16 a[224:227], a[80:83], v[80:83], 0
 ds_read_b64_tr_b16 a[112:113], v14 offset:25344
 buffer_store_dwordx4 v[104:107], v15, s[48:51], s76 offen offset:2048 sc1
 v_exp_f32 v3, v3
 v_mfma_f32_16x16x32_bf16 a[228:231], a[80:83], v[84:87], 0
 ds_read_b64_tr_b16 a[114:115], v14 offset:25600
 buffer_store_dwordx4 v[140:143], v26, s[28:31], s34 offen sc1
 v_exp_f32 v4, v4
 v_mfma_f32_16x16x32_bf16 a[232:235], a[80:83], v[88:91], 0
L_pad6:
 s_cbranch_execz L_pad10
 v_exp_f32 v5, v5
 v_mfma_f32_16x16x32_bf16 a[236:239], a[80:83], v[92:95], 0
 v_exp_f32 v6, v6
 v_exp_f32 v7, v7
 v_exp_f32 v8, v8
 v_exp_f32 v9, v9
 v_pk_fma_f32 v[2:3], v[2:3], v[62:63], v[62:63] op_sel:[0,1,1] op_sel_hi:[1,1,1]
 v_pk_fma_f32 v[4:5], v[4:5], v[62:63], v[62:63] op_sel:[0,1,1] op_sel_hi:[1,1,1]
 v_pk_fma_f32 v[6:7], v[6:7], v[62:63], v[62:63] op_sel:[0,1,1] op_sel_hi:[1,1,1]
 v_pk_fma_f32 v[8:9], v[8:9], v[62:63], v[62:63] op_sel:[0,1,1] op_sel_hi:[1,1,1]
 v_rcp_f32 v2, v2
 s_waitcnt lgkmcnt(4)
 v_mfma_f32_16x16x32_bf16 a[240:243], a[96:99], v[80:83], 0
 ds_read_b64_tr_b16 a[80:81], v14 offset:25376
 buffer_load_dword v13, v25, s[48:51], s101 offen sc1
 v_rcp_f32 v3, v3
 v_mfma_f32_16x16x32_bf16 a[244:247], a[96:99], v[84:87], 0
 ds_read_b64_tr_b16 a[82:83], v14 offset:25632
 v_rcp_f32 v4, v4
 v_mfma_f32_16x16x32_bf16 a[248:251], a[96:99], v[88:91], 0
 v_rcp_f32 v5, v5
 v_mfma_f32_16x16x32_bf16 a[252:255], a[96:99], v[92:95], 0
 v_rcp_f32 v6, v6
 v_rcp_f32 v7, v7
 v_rcp_f32 v8, v8
 v_rcp_f32 v9, v9
 v_pk_mul_f32 v[2:3], v[2:3], v[108:109]
 v_pk_mul_f32 v[4:5], v[4:5], v[110:111]
 v_pk_mul_f32 v[6:7], v[6:7], v[156:157]
 v_pk_mul_f32 v[8:9], v[8:9], v[158:159]
 v_cvt_pk_bf16_f32 v108, v2, v3
 v_cvt_pk_bf16_f32 v109, v4, v5
 v_cvt_pk_bf16_f32 v110, v6, v7
 v_cvt_pk_bf16_f32 v111, v8, v9
 v_pk_mul_f32 v[2:3], v[112:113], v[112:113]
 v_pk_mul_f32 v[4:5], v[114:115], v[114:115]
 v_pk_mul_f32 v[6:7], v[160:161], v[160:161]
 v_pk_mul_f32 v[8:9], v[162:163], v[162:163]
 v_pk_fma_f32 v[2:3], v[2:3], s[22:23], v[10:11] op_sel:[0,0,0] op_sel_hi:[1,0,0]
 v_pk_fma_f32 v[4:5], v[4:5], s[22:23], v[10:11] op_sel:[0,0,0] op_sel_hi:[1,0,0]
 v_pk_fma_f32 v[6:7], v[6:7], s[22:23], v[10:11] op_sel:[0,0,0] op_sel_hi:[1,0,0]
 v_pk_fma_f32 v[8:9], v[8:9], s[22:23], v[10:11] op_sel:[0,0,0] op_sel_hi:[1,0,0]
 v_pk_mul_f32 v[2:3], v[2:3], v[112:113]
 v_pk_mul_f32 v[4:5], v[4:5], v[114:115]
 v_pk_mul_f32 v[6:7], v[6:7], v[160:161]
 v_pk_mul_f32 v[8:9], v[8:9], v[162:163]
 v_exp_f32 v2, v2
 s_waitcnt lgkmcnt(2)
 v_mfma_f32_16x16x32_bf16 a[128:131], a[112:115], v[96:99], a[128:131]
 ds_read_b64_tr_b16 a[96:97], v14 offset:25408
 buffer_store_dwordx4 v[108:111], v15, s[48:51], s76 offen offset:3072 sc1
 v_exp_f32 v3, v3
 v_mfma_f32_16x16x32_bf16 a[132:135], a[112:115], v[100:103], a[132:135]
 ds_read_b64_tr_b16 a[98:99], v14 offset:25664
 v_exp_f32 v4, v4
 v_mfma_f32_16x16x32_bf16 a[136:139], a[112:115], v[104:107], a[136:139]
 v_exp_f32 v5, v5
 v_mfma_f32_16x16x32_bf16 a[140:143], a[112:115], v[108:111], a[140:143]
 v_exp_f32 v6, v6
 v_exp_f32 v7, v7
 v_exp_f32 v8, v8
 v_exp_f32 v9, v9
 v_pk_fma_f32 v[2:3], v[2:3], v[60:61], v[60:61] op_sel:[0,0,0] op_sel_hi:[1,0,0]
 v_pk_fma_f32 v[4:5], v[4:5], v[60:61], v[60:61] op_sel:[0,0,0] op_sel_hi:[1,0,0]
 v_pk_fma_f32 v[6:7], v[6:7], v[60:61], v[60:61] op_sel:[0,0,0] op_sel_hi:[1,0,0]
 v_pk_fma_f32 v[8:9], v[8:9], v[60:61], v[60:61] op_sel:[0,0,0] op_sel_hi:[1,0,0]
 v_rcp_f32 v2, v2
 s_waitcnt lgkmcnt(2)
 v_mfma_f32_16x16x32_bf16 a[144:147], a[80:83], v[96:99], a[144:147]
 ds_read_b64_tr_b16 a[112:113], v14 offset:25440
 v_rcp_f32 v3, v3
 v_mfma_f32_16x16x32_bf16 a[148:151], a[80:83], v[100:103], a[148:151]
 ds_read_b64_tr_b16 a[114:115], v14 offset:25696
 v_rcp_f32 v4, v4
 v_mfma_f32_16x16x32_bf16 a[152:155], a[80:83], v[104:107], a[152:155]
 v_rcp_f32 v5, v5
 v_mfma_f32_16x16x32_bf16 a[156:159], a[80:83], v[108:111], a[156:159]
 v_rcp_f32 v6, v6
 v_rcp_f32 v7, v7
 v_rcp_f32 v8, v8
 v_rcp_f32 v9, v9
 v_pk_mul_f32 v[2:3], v[2:3], v[112:113]
 v_pk_mul_f32 v[4:5], v[4:5], v[114:115]
 v_pk_mul_f32 v[6:7], v[6:7], v[160:161]
 v_pk_mul_f32 v[8:9], v[8:9], v[162:163]
 v_cvt_pk_bf16_f32 v112, v2, v3
 v_cvt_pk_bf16_f32 v113, v4, v5
 v_cvt_pk_bf16_f32 v114, v6, v7
 v_cvt_pk_bf16_f32 v115, v8, v9
 v_pk_mul_f32 v[2:3], v[116:117], v[116:117]
 v_pk_mul_f32 v[4:5], v[118:119], v[118:119]
 v_pk_mul_f32 v[6:7], v[164:165], v[164:165]
 v_pk_mul_f32 v[8:9], v[166:167], v[166:167]
 v_pk_fma_f32 v[2:3], v[2:3], s[22:23], v[10:11] op_sel:[0,0,0] op_sel_hi:[1,0,0]
 v_pk_fma_f32 v[4:5], v[4:5], s[22:23], v[10:11] op_sel:[0,0,0] op_sel_hi:[1,0,0]
 v_pk_fma_f32 v[6:7], v[6:7], s[22:23], v[10:11] op_sel:[0,0,0] op_sel_hi:[1,0,0]
 v_pk_fma_f32 v[8:9], v[8:9], s[22:23], v[10:11] op_sel:[0,0,0] op_sel_hi:[1,0,0]
 v_pk_mul_f32 v[2:3], v[2:3], v[116:117]
 v_pk_mul_f32 v[4:5], v[4:5], v[118:119]
 v_pk_mul_f32 v[6:7], v[6:7], v[164:165]
 v_pk_mul_f32 v[8:9], v[8:9], v[166:167]
 v_exp_f32 v2, v2
 s_waitcnt lgkmcnt(2)
 v_mfma_f32_16x16x32_bf16 a[160:163], a[96:99], v[96:99], a[160:163]
 ds_read_b64_tr_b16 a[80:81], v14 offset:25472
 v_exp_f32 v3, v3
 v_mfma_f32_16x16x32_bf16 a[164:167], a[96:99], v[100:103], a[164:167]
 ds_read_b64_tr_b16 a[82:83], v14 offset:25728
 v_exp_f32 v4, v4
 v_mfma_f32_16x16x32_bf16 a[168:171], a[96:99], v[104:107], a[168:171]
 v_exp_f32 v5, v5
 v_mfma_f32_16x16x32_bf16 a[172:175], a[96:99], v[108:111], a[172:175]
 v_exp_f32 v6, v6
 v_exp_f32 v7, v7
 v_exp_f32 v8, v8
 v_exp_f32 v9, v9
 v_pk_fma_f32 v[2:3], v[2:3], v[60:61], v[60:61] op_sel:[0,1,1] op_sel_hi:[1,1,1]
 v_pk_fma_f32 v[4:5], v[4:5], v[60:61], v[60:61] op_sel:[0,1,1] op_sel_hi:[1,1,1]
 v_pk_fma_f32 v[6:7], v[6:7], v[60:61], v[60:61] op_sel:[0,1,1] op_sel_hi:[1,1,1]
 v_pk_fma_f32 v[8:9], v[8:9], v[60:61], v[60:61] op_sel:[0,1,1] op_sel_hi:[1,1,1]
 v_rcp_f32 v2, v2
 s_waitcnt lgkmcnt(2)
 v_mfma_f32_16x16x32_bf16 a[176:179], a[112:115], v[96:99], a[176:179]
 ds_read_b64_tr_b16 a[96:97], v14 offset:25504
 v_rcp_f32 v3, v3
 v_mfma_f32_16x16x32_bf16 a[180:183], a[112:115], v[100:103], a[180:183]
 ds_read_b64_tr_b16 a[98:99], v14 offset:25760
 v_rcp_f32 v4, v4
 s_waitcnt vmcnt(1)
 v_cmp_gt_u32 vcc, 1, v13
 s_cbranch_vccnz L_slow_4
L_back_6:
 v_mfma_f32_16x16x32_bf16 a[184:187], a[112:115], v[104:107], a[184:187]
 s_add_u32 s2, s4, 0
 buffer_load_dwordx4 a[0:3], v15, s[48:51], s2 offen offset:0 sc1
 v_rcp_f32 v5, v5
 v_mfma_f32_16x16x32_bf16 a[188:191], a[112:115], v[108:111], a[188:191]
 buffer_load_dwordx4 a[4:7], v15, s[48:51], s2 offen offset:1024 sc1
 v_rcp_f32 v6, v6
 v_rcp_f32 v7, v7
 v_rcp_f32 v8, v8
 v_rcp_f32 v9, v9
 v_pk_mul_f32 v[2:3], v[2:3], v[116:117]
 v_pk_mul_f32 v[4:5], v[4:5], v[118:119]
 v_pk_mul_f32 v[6:7], v[6:7], v[164:165]
 v_pk_mul_f32 v[8:9], v[8:9], v[166:167]
 v_cvt_pk_bf16_f32 v116, v2, v3
 v_cvt_pk_bf16_f32 v117, v4, v5
 v_cvt_pk_bf16_f32 v118, v6, v7
 v_cvt_pk_bf16_f32 v119, v8, v9
 v_pk_mul_f32 v[2:3], v[120:121], v[120:121]
 v_pk_mul_f32 v[4:5], v[122:123], v[122:123]
 v_pk_mul_f32 v[6:7], v[168:169], v[168:169]
 v_pk_mul_f32 v[8:9], v[170:171], v[170:171]
 v_pk_fma_f32 v[2:3], v[2:3], s[22:23], v[10:11] op_sel:[0,0,0] op_sel_hi:[1,0,0]
 v_pk_fma_f32 v[4:5], v[4:5], s[22:23], v[10:11] op_sel:[0,0,0] op_sel_hi:[1,0,0]
 v_pk_fma_f32 v[6:7], v[6:7], s[22:23], v[10:11] op_sel:[0,0,0] op_sel_hi:[1,0,0]
 v_pk_fma_f32 v[8:9], v[8:9], s[22:23], v[10:11] op_sel:[0,0,0] op_sel_hi:[1,0,0]
 v_pk_mul_f32 v[2:3], v[2:3], v[120:121]
 v_pk_mul_f32 v[4:5], v[4:5], v[122:123]
 v_pk_mul_f32 v[6:7], v[6:7], v[168:169]
 v_pk_mul_f32 v[8:9], v[8:9], v[170:171]
 v_exp_f32 v2, v2
 s_waitcnt lgkmcnt(2)
 v_mfma_f32_16x16x32_bf16 a[192:195], a[80:83], v[96:99], a[192:195]
 ds_read_b64_tr_b16 a[112:113], v14 offset:25536
 buffer_load_dwordx4 a[8:11], v15, s[48:51], s2 offen offset:2048 sc1
 v_exp_f32 v3, v3
 v_mfma_f32_16x16x32_bf16 a[196:199], a[80:83], v[100:103], a[196:199]
 ds_read_b64_tr_b16 a[114:115], v14 offset:25792
 buffer_load_dwordx4 a[12:15], v15, s[48:51], s2 offen offset:3072 sc1
 v_exp_f32 v4, v4
 v_mfma_f32_16x16x32_bf16 a[200:203], a[80:83], v[104:107], a[200:203]
 s_add_u32 s2, s5, 0
 buffer_load_dwordx4 a[16:19], v15, s[48:51], s2 offen offset:0 sc1
 v_exp_f32 v5, v5
 v_mfma_f32_16x16x32_bf16 a[204:207], a[80:83], v[108:111], a[204:207]
 v_exp_f32 v6, v6
 v_exp_f32 v7, v7
 v_exp_f32 v8, v8
 v_exp_f32 v9, v9
 v_pk_fma_f32 v[2:3], v[2:3], v[62:63], v[62:63] op_sel:[0,0,0] op_sel_hi:[1,0,0]
 v_pk_fma_f32 v[4:5], v[4:5], v[62:63], v[62:63] op_sel:[0,0,0] op_sel_hi:[1,0,0]
 v_pk_fma_f32 v[6:7], v[6:7], v[62:63], v[62:63] op_sel:[0,0,0] op_sel_hi:[1,0,0]
 v_pk_fma_f32 v[8:9], v[8:9], v[62:63], v[62:63] op_sel:[0,0,0] op_sel_hi:[1,0,0]
 v_rcp_f32 v2, v2
 s_waitcnt lgkmcnt(2)
 v_mfma_f32_16x16x32_bf16 a[208:211], a[96:99], v[96:99], a[208:211]
 ds_read_b64_tr_b16 a[80:81], v14 offset:25568
 buffer_load_dwordx4 a[20:23], v15, s[48:51], s2 offen offset:1024 sc1
 v_rcp_f32 v3, v3
 v_mfma_f32_16x16x32_bf16 a[212:215], a[96:99], v[100:103], a[212:215]
 ds_read_b64_tr_b16 a[82:83], v14 offset:25824
 buffer_load_dwordx4 a[24:27], v15, s[48:51], s2 offen offset:2048 sc1
 v_rcp_f32 v4, v4
 v_mfma_f32_16x16x32_bf16 a[216:219], a[96:99], v[104:107], a[216:219]
 v_mov_b32 v1, 2
 s_waitcnt vmcnt(7)
 v_rcp_f32 v5, v5
 v_mfma_f32_16x16x32_bf16 a[220:223], a[96:99], v[108:111], a[220:223]
 v_rcp_f32 v6, v6
 v_rcp_f32 v7, v7
 v_rcp_f32 v8, v8
 v_rcp_f32 v9, v9
 v_pk_mul_f32 v[2:3], v[2:3], v[120:121]
 v_pk_mul_f32 v[4:5], v[4:5], v[122:123]
 v_pk_mul_f32 v[6:7], v[6:7], v[168:169]
 v_pk_mul_f32 v[8:9], v[8:9], v[170:171]
 v_cvt_pk_bf16_f32 v120, v2, v3
 v_cvt_pk_bf16_f32 v121, v4, v5
 v_cvt_pk_bf16_f32 v122, v6, v7
 v_cvt_pk_bf16_f32 v123, v8, v9
 v_pk_mul_f32 v[2:3], v[124:125], v[124:125]
 v_pk_mul_f32 v[4:5], v[126:127], v[126:127]
 v_pk_mul_f32 v[6:7], v[172:173], v[172:173]
 v_pk_mul_f32 v[8:9], v[174:175], v[174:175]
 v_pk_fma_f32 v[2:3], v[2:3], s[22:23], v[10:11] op_sel:[0,0,0] op_sel_hi:[1,0,0]
 v_pk_fma_f32 v[4:5], v[4:5], s[22:23], v[10:11] op_sel:[0,0,0] op_sel_hi:[1,0,0]
 v_pk_fma_f32 v[6:7], v[6:7], s[22:23], v[10:11] op_sel:[0,0,0] op_sel_hi:[1,0,0]
 v_pk_fma_f32 v[8:9], v[8:9], s[22:23], v[10:11] op_sel:[0,0,0] op_sel_hi:[1,0,0]
 v_pk_mul_f32 v[2:3], v[2:3], v[124:125]
 v_pk_mul_f32 v[4:5], v[4:5], v[126:127]
 v_pk_mul_f32 v[6:7], v[6:7], v[172:173]
 v_pk_mul_f32 v[8:9], v[8:9], v[174:175]
 v_exp_f32 v2, v2
 s_waitcnt lgkmcnt(2)
 v_mfma_f32_16x16x32_bf16 a[224:227], a[112:115], v[96:99], a[224:227]
 ds_read_b64_tr_b16 a[96:97], v22 offset:33792
 buffer_store_dword v1, v11, s[48:51], s32 offen sc1
 v_exp_f32 v3, v3
 v_mfma_f32_16x16x32_bf16 a[228:231], a[112:115], v[100:103], a[228:231]
 ds_read_b64_tr_b16 a[98:99], v22 offset:34048
 buffer_load_dwordx4 a[28:31], v15, s[48:51], s2 offen offset:3072 sc1
 v_exp_f32 v4, v4
 v_mfma_f32_16x16x32_bf16 a[232:235], a[112:115], v[104:107], a[232:235]
 s_add_u32 s2, s6, 0
 buffer_load_dwordx4 a[32:35], v15, s[48:51], s2 offen offset:0 sc1
 v_exp_f32 v5, v5
 v_mfma_f32_16x16x32_bf16 a[236:239], a[112:115], v[108:111], a[236:239]
 buffer_load_dwordx4 a[36:39], v15, s[48:51], s2 offen offset:1024 sc1
 v_exp_f32 v6, v6
 v_exp_f32 v7, v7
 v_exp_f32 v8, v8
 v_exp_f32 v9, v9
 v_pk_fma_f32 v[2:3], v[2:3], v[62:63], v[62:63] op_sel:[0,1,1] op_sel_hi:[1,1,1]
 v_pk_fma_f32 v[4:5], v[4:5], v[62:63], v[62:63] op_sel:[0,1,1] op_sel_hi:[1,1,1]
 v_pk_fma_f32 v[6:7], v[6:7], v[62:63], v[62:63] op_sel:[0,1,1] op_sel_hi:[1,1,1]
 v_pk_fma_f32 v[8:9], v[8:9], v[62:63], v[62:63] op_sel:[0,1,1] op_sel_hi:[1,1,1]
 v_rcp_f32 v2, v2
 s_waitcnt lgkmcnt(2)
 v_mfma_f32_16x16x32_bf16 a[240:243], a[80:83], v[96:99], a[240:243]
 ds_read_b64_tr_b16 a[112:113], v22 offset:33824
 buffer_load_dwordx4 a[40:43], v15, s[48:51], s2 offen offset:2048 sc1
 v_rcp_f32 v3, v3
 v_mfma_f32_16x16x32_bf16 a[244:247], a[80:83], v[100:103], a[244:247]
 ds_read_b64_tr_b16 a[114:115], v22 offset:34080
 v_rcp_f32 v4, v4
 v_mfma_f32_16x16x32_bf16 a[248:251], a[80:83], v[104:107], a[248:251]
 buffer_load_dwordx4 a[44:47], v15, s[48:51], s2 offen offset:3072 sc1
 s_add_u32 s2, s7, 0
 v_rcp_f32 v5, v5
 v_mfma_f32_16x16x32_bf16 a[252:255], a[80:83], v[108:111], a[252:255]
 v_rcp_f32 v6, v6
 v_rcp_f32 v7, v7
 v_rcp_f32 v8, v8
 v_rcp_f32 v9, v9
 v_pk_mul_f32 v[2:3], v[2:3], v[124:125]
 v_pk_mul_f32 v[4:5], v[4:5], v[126:127]
 v_pk_mul_f32 v[6:7], v[6:7], v[172:173]
 v_pk_mul_f32 v[8:9], v[8:9], v[174:175]
 v_cvt_pk_bf16_f32 v124, v2, v3
 v_cvt_pk_bf16_f32 v125, v4, v5
 v_cvt_pk_bf16_f32 v126, v6, v7
 v_cvt_pk_bf16_f32 v127, v8, v9
 v_pk_mul_f32 v[2:3], v[176:177], v[176:177]
 v_pk_mul_f32 v[4:5], v[178:179], v[178:179]
 v_pk_mul_f32 v[6:7], v[180:181], v[180:181]
 v_pk_mul_f32 v[8:9], v[182:183], v[182:183]
 v_pk_fma_f32 v[2:3], v[2:3], s[22:23], v[10:11] op_sel:[0,0,0] op_sel_hi:[1,0,0]
 v_pk_fma_f32 v[4:5], v[4:5], s[22:23], v[10:11] op_sel:[0,0,0] op_sel_hi:[1,0,0]
 v_pk_fma_f32 v[6:7], v[6:7], s[22:23], v[10:11] op_sel:[0,0,0] op_sel_hi:[1,0,0]
 v_pk_fma_f32 v[8:9], v[8:9], s[22:23], v[10:11] op_sel:[0,0,0] op_sel_hi:[1,0,0]
 v_pk_mul_f32 v[2:3], v[2:3], v[176:177]
 v_pk_mul_f32 v[4:5], v[4:5], v[178:179]
 v_pk_mul_f32 v[6:7], v[6:7], v[180:181]
 v_pk_mul_f32 v[8:9], v[8:9], v[182:183]
 v_exp_f32 v2, v2
 s_waitcnt lgkmcnt(2)
 v_mfma_f32_16x16x32_bf16 a[128:131], a[96:99], v[112:115], a[128:131]
 ds_read_b64_tr_b16 a[80:81], v22 offset:33856
 buffer_load_dwordx4 a[48:51], v15, s[48:51], s2 offen offset:0 sc1
 v_exp_f32 v3, v3
 v_mfma_f32_16x16x32_bf16 a[132:135], a[96:99], v[116:119], a[132:135]
 ds_read_b64_tr_b16 a[82:83], v22 offset:34112
 buffer_load_dwordx4 a[52:55], v15, s[48:51], s2 offen offset:1024 sc1
 v_exp_f32 v4, v4
 v_mfma_f32_16x16x32_bf16 a[136:139], a[96:99], v[120:123], a[136:139]
 buffer_load_dwordx4 a[56:59], v15, s[48:51], s2 offen offset:2048 sc1
 s_mov_b32 m0, s35
 v_exp_f32 v5, v5
 v_mfma_f32_16x16x32_bf16 a[140:143], a[96:99], v[124:127], a[140:143]
 s_nop 0
 v_exp_f32 v6, v6
 s_waitcnt lgkmcnt(2)
 v_mfma_f32_16x16x32_bf16 a[144:147], a[112:115], v[112:115], a[144:147]
 ds_read_b64_tr_b16 a[96:97], v22 offset:33888
 v_exp_f32 v7, v7
 v_exp_f32 v8, v8
 v_exp_f32 v9, v9
 v_pk_fma_f32 v[2:3], v[2:3], v[60:61], v[60:61] op_sel:[0,0,0] op_sel_hi:[1,0,0]
 v_pk_fma_f32 v[4:5], v[4:5], v[60:61], v[60:61] op_sel:[0,0,0] op_sel_hi:[1,0,0]
 v_pk_fma_f32 v[6:7], v[6:7], v[60:61], v[60:61] op_sel:[0,1,1] op_sel_hi:[1,1,1]
 v_pk_fma_f32 v[8:9], v[8:9], v[60:61], v[60:61] op_sel:[0,1,1] op_sel_hi:[1,1,1]
 v_rcp_f32 v2, v2
 v_mfma_f32_16x16x32_bf16 a[148:151], a[112:115], v[116:119], a[148:151]
 ds_read_b64_tr_b16 a[98:99], v22 offset:34144
 buffer_load_dwordx4 v64, s[28:31], s33 offen offset:0 sc1 lds
 v_rcp_f32 v3, v3
 v_mfma_f32_16x16x32_bf16 a[152:155], a[112:115], v[120:123], a[152:155]
 buffer_load_dwordx4 v64, s[28:31], s33 offen offset:1024 sc1 lds
 v_rcp_f32 v4, v4
 v_mfma_f32_16x16x32_bf16 a[156:159], a[112:115], v[124:127], a[156:159]
 v_rcp_f32 v5, v5
 s_waitcnt lgkmcnt(2)
 v_mfma_f32_16x16x32_bf16 a[160:163], a[80:83], v[112:115], a[160:163]
 ds_read_b64_tr_b16 a[112:113], v22 offset:33920
 v_rcp_f32 v6, v6
 v_mfma_f32_16x16x32_bf16 a[164:167], a[80:83], v[116:119], a[164:167]
 ds_read_b64_tr_b16 a[114:115], v22 offset:34176
 buffer_load_dwordx4 a[60:63], v15, s[48:51], s2 offen offset:3072 sc1
 v_rcp_f32 v7, v7
 v_rcp_f32 v8, v8
 v_rcp_f32 v9, v9
 v_pk_mul_f32 v[2:3], v[2:3], v[176:177]
 v_pk_mul_f32 v[4:5], v[4:5], v[178:179]
 v_pk_mul_f32 v[6:7], v[6:7], v[180:181]
 v_pk_mul_f32 v[8:9], v[8:9], v[182:183]
 v_cvt_pk_bf16_f32 v176, v2, v3
 v_cvt_pk_bf16_f32 v177, v4, v5
 v_cvt_pk_bf16_f32 v178, v6, v7
 v_cvt_pk_bf16_f32 v179, v8, v9
 s_nop 1
 v_permlane16_swap_b32 v176, v178
 v_permlane16_swap_b32 v177, v179
 v_pk_mul_f32 v[2:3], v[184:185], v[184:185]
 v_pk_mul_f32 v[4:5], v[186:187], v[186:187]
 v_pk_mul_f32 v[6:7], v[188:189], v[188:189]
 v_pk_mul_f32 v[8:9], v[190:191], v[190:191]
 v_pk_fma_f32 v[2:3], v[2:3], s[22:23], v[10:11] op_sel:[0,0,0] op_sel_hi:[1,0,0]
 v_pk_fma_f32 v[4:5], v[4:5], s[22:23], v[10:11] op_sel:[0,0,0] op_sel_hi:[1,0,0]
 v_pk_fma_f32 v[6:7], v[6:7], s[22:23], v[10:11] op_sel:[0,0,0] op_sel_hi:[1,0,0]
 v_pk_fma_f32 v[8:9], v[8:9], s[22:23], v[10:11] op_sel:[0,0,0] op_sel_hi:[1,0,0]
 v_pk_mul_f32 v[2:3], v[2:3], v[184:185]
 v_pk_mul_f32 v[4:5], v[4:5], v[186:187]
 v_pk_mul_f32 v[6:7], v[6:7], v[188:189]
 v_pk_mul_f32 v[8:9], v[8:9], v[190:191]
 v_exp_f32 v2, v2
 v_mfma_f32_16x16x32_bf16 a[168:171], a[80:83], v[120:123], a[168:171]
 s_add_u32 s2, s8, 0
 buffer_load_dwordx4 a[64:67], v15, s[48:51], s2 offen offset:0 sc1
 v_exp_f32 v3, v3
 v_mfma_f32_16x16x32_bf16 a[172:175], a[80:83], v[124:127], a[172:175]
 buffer_load_dwordx4 a[68:71], v15, s[48:51], s2 offen offset:1024 sc1
 v_exp_f32 v4, v4
 s_waitcnt lgkmcnt(2)
 v_mfma_f32_16x16x32_bf16 a[176:179], a[96:99], v[112:115], a[176:179]
 ds_read_b64_tr_b16 a[80:81], v22 offset:33952
 v_exp_f32 v5, v5
 v_mfma_f32_16x16x32_bf16 a[180:183], a[96:99], v[116:119], a[180:183]
 ds_read_b64_tr_b16 a[82:83], v22 offset:34208
 buffer_store_dwordx4 v[112:115], v15, s[48:51], s79 offen offset:0 sc1
 v_exp_f32 v6, v6
 v_mfma_f32_16x16x32_bf16 a[184:187], a[96:99], v[120:123], a[184:187]
 v_exp_f32 v7, v7
 v_exp_f32 v8, v8
 v_exp_f32 v9, v9
 v_pk_fma_f32 v[2:3], v[2:3], v[62:63], v[62:63] op_sel:[0,0,0] op_sel_hi:[1,0,0]
 v_pk_fma_f32 v[4:5], v[4:5], v[62:63], v[62:63] op_sel:[0,0,0] op_sel_hi:[1,0,0]
 v_pk_fma_f32 v[6:7], v[6:7], v[62:63], v[62:63] op_sel:[0,1,1] op_sel_hi:[1,1,1]
 v_pk_fma_f32 v[8:9], v[8:9], v[62:63], v[62:63] op_sel:[0,1,1] op_sel_hi:[1,1,1]
 v_rcp_f32 v2, v2
 v_mfma_f32_16x16x32_bf16 a[188:191], a[96:99], v[124:127], a[188:191]
 buffer_load_dwordx4 a[72:75], v15, s[48:51], s2 offen offset:2048 sc1
 v_rcp_f32 v3, v3
 s_waitcnt lgkmcnt(2)
 v_mfma_f32_16x16x32_bf16 a[192:195], a[112:115], v[112:115], a[192:195]
 ds_read_b64_tr_b16 a[96:97], v22 offset:33984
 v_rcp_f32 v4, v4
 v_mfma_f32_16x16x32_bf16 a[196:199], a[112:115], v[116:119], a[196:199]
 ds_read_b64_tr_b16 a[98:99], v22 offset:34240
 buffer_load_dwordx4 a[76:79], v15, s[48:51], s2 offen offset:3072 sc1
 v_rcp_f32 v5, v5
 v_mfma_f32_16x16x32_bf16 a[200:203], a[112:115], v[120:123], a[200:203]
 s_add_u32 s2, s9, 0
 v_rcp_f32 v6, v6
 v_mfma_f32_16x16x32_bf16 a[204:207], a[112:115], v[124:127], a[204:207]
 v_rcp_f32 v7, v7
 v_rcp_f32 v8, v8
 v_rcp_f32 v9, v9
 v_pk_mul_f32 v[2:3], v[2:3], v[184:185]
 v_pk_mul_f32 v[4:5], v[4:5], v[186:187]
 v_pk_mul_f32 v[6:7], v[6:7], v[188:189]
 v_pk_mul_f32 v[8:9], v[8:9], v[190:191]
 v_cvt_pk_bf16_f32 v180, v2, v3
 v_cvt_pk_bf16_f32 v181, v4, v5
 v_cvt_pk_bf16_f32 v182, v6, v7
 v_cvt_pk_bf16_f32 v183, v8, v9
 s_nop 1
 v_permlane16_swap_b32 v180, v182
 v_permlane16_swap_b32 v181, v183
 s_waitcnt lgkmcnt(2)
 v_mfma_f32_16x16x32_bf16 a[208:211], a[80:83], v[112:115], a[208:211]
 ds_read_b64_tr_b16 a[112:113], v22 offset:34016
 buffer_load_dwordx4 v[80:83], v15, s[48:51], s2 offen offset:0 sc1
 v_mfma_f32_16x16x32_bf16 a[212:215], a[80:83], v[116:119], a[212:215]
 ds_read_b64_tr_b16 a[114:115], v22 offset:34272
 v_lshrrev_b32 v3, 3, v0
 v_mfma_f32_16x16x32_bf16 a[216:219], a[80:83], v[120:123], a[216:219]
 v_lshrrev_b32 v4, 4, v0
 v_and_b32 v5, 7, v0
 v_mfma_f32_16x16x32_bf16 a[220:223], a[80:83], v[124:127], a[220:223]
 s_waitcnt vmcnt(58) lgkmcnt(2)
 s_barrier
 v_mfma_f32_16x16x32_bf16 a[224:227], a[96:99], v[112:115], a[224:227]
 ds_read_b64_tr_b16 a[80:81], v22 offset:42240
 buffer_load_dwordx4 v[84:87], v15, s[48:51], s2 offen offset:1024 sc1
 v_mfma_f32_16x16x32_bf16 a[228:231], a[96:99], v[116:119], a[228:231]
 ds_read_b64_tr_b16 a[82:83], v22 offset:42496
 s_add_u32 s78, s10, 4096
 v_mfma_f32_16x16x32_bf16 a[232:235], a[96:99], v[120:123], a[232:235]
 ds_read_b64_tr_b16 a[84:85], v14 offset:33792
 s_add_u32 m0, s66, 16896
 v_mfma_f32_16x16x32_bf16 a[236:239], a[96:99], v[124:127], a[236:239]
 ds_read_b64_tr_b16 a[86:87], v14 offset:34048
 s_waitcnt lgkmcnt(4)
 v_mfma_f32_16x16x32_bf16 a[240:243], a[112:115], v[112:115], a[240:243]
 ds_read_b64_tr_b16 a[96:97], v22 offset:42272
 s_lshl_b32 s78, s78, 4
 v_mfma_f32_16x16x32_bf16 a[244:247], a[112:115], v[116:119], a[244:247]
 ds_read_b64_tr_b16 a[98:99], v22 offset:42528
 buffer_load_dwordx4 v[88:91], v15, s[48:51], s2 offen offset:2048 sc1
 v_mfma_f32_16x16x32_bf16 a[248:251], a[112:115], v[120:123], a[248:251]
 ds_read_b64_tr_b16 a[100:101], v14 offset:33824
 v_xor_b32 v5, v4, v5
 v_mfma_f32_16x16x32_bf16 a[252:255], a[112:115], v[124:127], a[252:255]
 ds_read_b64_tr_b16 a[102:103], v14 offset:34080
 s_waitcnt vmcnt(18) lgkmcnt(4)
 v_mfma_f32_16x16x32_bf16 a[128:131], a[80:83], a[0:3], a[128:131]
 ds_read_b64_tr_b16 a[112:113], v22 offset:42304
 v_lshlrev_b32 v5, 4, v5
 v_mfma_f32_16x16x32_bf16 a[128:131], a[84:87], a[16:19], a[128:131]
 ds_read_b64_tr_b16 a[114:115], v22 offset:42560
 s_and_b32 s83, s61, 1
 v_mfma_f32_16x16x32_bf16 a[132:135], a[84:87], a[20:23], a[132:135]
 ds_read_b64_tr_b16 a[116:117], v14 offset:33856
 buffer_store_dwordx4 v[116:119], v15, s[48:51], s79 offen offset:1024 sc1
 v_mfma_f32_16x16x32_bf16 a[132:135], a[80:83], a[4:7], a[132:135]
 ds_read_b64_tr_b16 a[118:119], v14 offset:34112
 s_lshl_b32 s82, s63, 1
 v_mfma_f32_16x16x32_bf16 a[136:139], a[80:83], a[8:11], a[136:139]
 s_add_u32 s82, s82, s83
 s_lshl_b32 s82, s82, 2
 s_add_u32 s82, s82, s60
 v_mfma_f32_16x16x32_bf16 a[136:139], a[84:87], a[24:27], a[136:139]
 s_lshl_b32 s82, s82, 4
 v_add_u32 v3, s82, v3
 v_lshl_add_u32 v3, v3, 11, v5
 v_mfma_f32_16x16x32_bf16 a[140:143], a[84:87], a[28:31], a[140:143]
 s_lshl_b32 s82, s61, 9
 v_add_u32 v60, s82, v3
 v_xor_b32 v62, 131072, v60
 v_mfma_f32_16x16x32_bf16 a[140:143], a[80:83], a[12:15], a[140:143]
 buffer_load_dwordx4 v[92:95], v15, s[48:51], s2 offen offset:3072 sc1
 s_waitcnt lgkmcnt(4)
 v_mfma_f32_16x16x32_bf16 a[144:147], a[96:99], a[0:3], a[144:147]
 ds_read_b64_tr_b16 a[80:81], v22 offset:42336
 s_add_u32 s2, s10, 0
 v_mfma_f32_16x16x32_bf16 a[144:147], a[100:103], a[16:19], a[144:147]
 ds_read_b64_tr_b16 a[82:83], v22 offset:42592
 v_xor_b32 v61, 64, v60
 v_mfma_f32_16x16x32_bf16 a[148:151], a[100:103], a[20:23], a[148:151]
 ds_read_b64_tr_b16 a[84:85], v14 offset:33888
 v_add_u32 v61, 15360, v61
 v_mfma_f32_16x16x32_bf16 a[148:151], a[96:99], a[4:7], a[148:151]
 ds_read_b64_tr_b16 a[86:87], v14 offset:34144
 buffer_load_dwordx4 v[96:99], v15, s[48:51], s2 offen offset:0 sc1
 v_mfma_f32_16x16x32_bf16 a[152:155], a[96:99], a[8:11], a[152:155]
 v_xor_b32 v63, 64, v62
 v_add_u32 v63, 15360, v63
 v_mfma_f32_16x16x32_bf16 a[152:155], a[100:103], a[24:27], a[152:155]
 s_waitcnt vmcnt(12)
 v_mfma_f32_16x16x32_bf16 a[156:159], a[100:103], a[28:31], a[156:159]
 ds_read_b128 v[152:155], v65 offset:1536
 v_mfma_f32_16x16x32_bf16 a[156:159], a[96:99], a[12:15], a[156:159]
 ds_read_b128 v[148:151], v65 offset:1280
 s_waitcnt lgkmcnt(6)
 v_mfma_f32_16x16x32_bf16 a[160:163], a[112:115], a[0:3], a[160:163]
 ds_read_b64_tr_b16 a[96:97], v22 offset:42368
 buffer_load_dword v13, v25, s[48:51], s101 offen sc1
 v_mfma_f32_16x16x32_bf16 a[160:163], a[116:119], a[16:19], a[160:163]
 ds_read_b64_tr_b16 a[98:99], v22 offset:42624
 v_mfma_f32_16x16x32_bf16 a[164:167], a[116:119], a[20:23], a[164:167]
 ds_read_b64_tr_b16 a[100:101], v14 offset:33920
 buffer_load_dwordx4 v[100:103], v15, s[48:51], s2 offen offset:1024 sc1
 v_mfma_f32_16x16x32_bf16 a[164:167], a[112:115], a[4:7], a[164:167]
 ds_read_b64_tr_b16 a[102:103], v14 offset:34176
 v_mfma_f32_16x16x32_bf16 a[168:171], a[112:115], a[8:11], a[168:171]
 ds_read_b128 v[144:147], v65 offset:1024
 v_mfma_f32_16x16x32_bf16 a[168:171], a[116:119], a[24:27], a[168:171]
 ds_read_b128 v[140:143], v65 offset:768
 v_mfma_f32_16x16x32_bf16 a[172:175], a[116:119], a[28:31], a[172:175]
 ds_read_b128 v[136:139], v65 offset:512
 v_mfma_f32_16x16x32_bf16 a[172:175], a[112:115], a[12:15], a[172:175]
 ds_read_b128 v[132:135], v65 offset:256
 s_waitcnt lgkmcnt(10)
 v_mfma_f32_16x16x32_bf16 a[176:179], a[80:83], a[0:3], a[176:179]
 ds_read_b64_tr_b16 a[112:113], v22 offset:42400
 buffer_store_dwordx4 v[120:123], v15, s[48:51], s79 offen offset:2048 sc1
 v_mfma_f32_16x16x32_bf16 a[176:179], a[84:87], a[16:19], a[176:179]
 ds_read_b64_tr_b16 a[114:115], v22 offset:42656
 v_mfma_f32_16x16x32_bf16 a[180:183], a[84:87], a[20:23], a[180:183]
 ds_read_b64_tr_b16 a[116:117], v14 offset:33952
 v_mfma_f32_16x16x32_bf16 a[180:183], a[80:83], a[4:7], a[180:183]
 ds_read_b64_tr_b16 a[118:119], v14 offset:34208
 v_mfma_f32_16x16x32_bf16 a[184:187], a[80:83], a[8:11], a[184:187]
 ds_read_b128 v[128:131], v65 offset:0
 buffer_load_dwordx4 v[104:107], v15, s[48:51], s2 offen offset:2048 sc1
 v_mfma_f32_16x16x32_bf16 a[184:187], a[84:87], a[24:27], a[184:187]
 ds_read_b128 v[160:163], v12 offset:0
 v_mfma_f32_16x16x32_bf16 a[188:191], a[84:87], a[28:31], a[188:191]
 ds_read_b128 v[164:167], v12 offset:16
 v_mfma_f32_16x16x32_bf16 a[188:191], a[80:83], a[12:15], a[188:191]
 ds_read_b128 v[168:171], v12 offset:32
 s_waitcnt lgkmcnt(12)
 v_mfma_f32_16x16x32_bf16 a[192:195], a[96:99], a[0:3], a[192:195]
 ds_read_b64_tr_b16 a[80:81], v22 offset:42432
 v_mfma_f32_16x16x32_bf16 a[192:195], a[100:103], a[16:19], a[192:195]
 ds_read_b64_tr_b16 a[82:83], v22 offset:42688
 buffer_load_dwordx4 v[108:111], v15, s[48:51], s2 offen offset:3072 sc1
 v_mfma_f32_16x16x32_bf16 a[196:199], a[100:103], a[20:23], a[196:199]
 ds_read_b64_tr_b16 a[84:85], v14 offset:33984
 v_mfma_f32_16x16x32_bf16 a[196:199], a[96:99], a[4:7], a[196:199]
 ds_read_b64_tr_b16 a[86:87], v14 offset:34240
 v_mfma_f32_16x16x32_bf16 a[200:203], a[96:99], a[8:11], a[200:203]
 ds_read_b128 v[172:175], v12 offset:48
 s_waitcnt lgkmcnt(8)
 v_mfma_f32_16x16x32_bf16 a[200:203], a[100:103], a[24:27], a[200:203]
 v_max3_u32 v2, v128, v129, v130
 v_max3_u32 v2, v2, v131, v132
 v_mfma_f32_16x16x32_bf16 a[204:207], a[100:103], a[28:31], a[204:207]
 buffer_load_dwordx4 v16, s[36:39], s78 offen offset:0 lds
 v_max3_u32 v2, v2, v133, v134
 v_mfma_f32_16x16x32_bf16 a[204:207], a[96:99], a[12:15], a[204:207]
 v_max3_u32 v2, v2, v135, v136
 s_waitcnt lgkmcnt(9)
 v_mfma_f32_16x16x32_bf16 a[208:211], a[112:115], a[0:3], a[208:211]
 ds_read_b64_tr_b16 a[96:97], v22 offset:42464
 v_max3_u32 v2, v2, v137, v138
 v_mfma_f32_16x16x32_bf16 a[208:211], a[116:119], a[16:19], a[208:211]
 ds_read_b64_tr_b16 a[98:99], v22 offset:42720
 v_max3_u32 v2, v2, v139, v140
 v_mfma_f32_16x16x32_bf16 a[212:215], a[116:119], a[20:23], a[212:215]
 ds_read_b64_tr_b16 a[100:101], v14 offset:34016
 v_max3_u32 v2, v2, v141, v142
 v_mfma_f32_16x16x32_bf16 a[212:215], a[112:115], a[4:7], a[212:215]
 ds_read_b64_tr_b16 a[102:103], v14 offset:34272
 buffer_store_dwordx4 v[124:127], v15, s[48:51], s79 offen offset:3072 sc1
 v_mfma_f32_16x16x32_bf16 a[216:219], a[112:115], a[8:11], a[216:219]
 v_max3_u32 v2, v2, v143, v144
 v_max3_u32 v2, v2, v145, v146
 v_mfma_f32_16x16x32_bf16 a[216:219], a[116:119], a[24:27], a[216:219]
 v_max3_u32 v2, v2, v147, v148
 v_max3_u32 v2, v2, v149, v150
 v_mfma_f32_16x16x32_bf16 a[220:223], a[116:119], a[28:31], a[220:223]
 v_max3_u32 v2, v2, v151, v152
 v_max3_u32 v2, v2, v153, v154
 v_mfma_f32_16x16x32_bf16 a[220:223], a[112:115], a[12:15], a[220:223]
 s_waitcnt vmcnt(63) lgkmcnt(5)
 s_barrier
 v_mfma_f32_16x16x32_bf16 a[224:227], a[80:83], a[0:3], a[224:227]
 ds_read_b64_tr_b16 a[112:113], v14 offset:42240
 buffer_load_dwordx4 v17, s[36:39], s78 offen offset:1056 lds
 v_mfma_f32_16x16x32_bf16 a[224:227], a[84:87], a[16:19], a[224:227]
 ds_read_b64_tr_b16 a[114:115], v14 offset:42496
 s_add_u32 s78, s4, 8192
 v_mfma_f32_16x16x32_bf16 a[228:231], a[84:87], a[20:23], a[228:231]
 ds_read_b64_tr_b16 a[116:117], v23 offset:0
 s_add_u32 m0, s66, 25344
 v_mfma_f32_16x16x32_bf16 a[228:231], a[80:83], a[4:7], a[228:231]
 ds_read_b64_tr_b16 a[118:119], v23 offset:256
 s_lshl_b32 s78, s78, 4
 v_mfma_f32_16x16x32_bf16 a[232:235], a[80:83], a[8:11], a[232:235]
 buffer_load_dwordx4 v16, s[36:39], s78 offen offset:0 lds
 v_max_u32 v2, v2, v155
 v_mfma_f32_16x16x32_bf16 a[232:235], a[84:87], a[24:27], a[232:235]
 v_cmp_eq_u32 vcc, -1, v2
 s_cbranch_vccnz L_slow_7
L_back_9:
 v_fmac_f32 v148, v52, v152
 v_mfma_f32_16x16x32_bf16 a[236:239], a[84:87], a[28:31], a[236:239]
L_pad7:
 s_cbranch_execz L_pad11
 v_fmac_f32 v149, v52, v153
 v_fma_f32 v148, -v53, v153, v148
 v_mfma_f32_16x16x32_bf16 a[236:239], a[80:83], a[12:15], a[236:239]
 v_fmac_f32 v149, v53, v152
 s_waitcnt lgkmcnt(4)
 v_mfma_f32_16x16x32_bf16 a[240:243], a[96:99], a[0:3], a[240:243]
 ds_read_b64_tr_b16 a[80:81], v14 offset:42272
 v_fmac_f32 v150, v54, v154
 v_mfma_f32_16x16x32_bf16 a[240:243], a[100:103], a[16:19], a[240:243]
 ds_read_b64_tr_b16 a[82:83], v14 offset:42528
 buffer_load_dwordx4 v17, s[36:39], s78 offen offset:1056 lds
 v_mfma_f32_16x16x32_bf16 a[244:247], a[100:103], a[20:23], a[244:247]
 ds_read_b64_tr_b16 a[84:85], v23 offset:32
 s_add_u32 s78, s5, 8192
 v_mfma_f32_16x16x32_bf16 a[244:247], a[96:99], a[4:7], a[244:247]
 ds_read_b64_tr_b16 a[86:87], v23 offset:288
 s_add_u32 m0, s66, 84480
 v_mfma_f32_16x16x32_bf16 a[248:251], a[96:99], a[8:11], a[248:251]
 s_lshl_b32 s78, s78, 4
 v_fmac_f32 v151, v54, v155
 v_fma_f32 v150, -v55, v155, v150
 v_mfma_f32_16x16x32_bf16 a[248:251], a[100:103], a[24:27], a[248:251]
 v_fmac_f32 v151, v55, v154
 v_fmac_f32 v144, v52, v148
 v_mfma_f32_16x16x32_bf16 a[252:255], a[100:103], a[28:31], a[252:255]
 buffer_store_dwordx4 v[176:179], v31, s[48:51], s75 offen offset:0 sc1
 v_fmac_f32 v145, v52, v149
 v_mfma_f32_16x16x32_bf16 a[252:255], a[96:99], a[12:15], a[252:255]
 s_waitcnt vmcnt(22) lgkmcnt(4)
 s_waitcnt vmcnt(10)
 v_cmp_gt_u32 vcc, 2, v13
 s_cbranch_vccnz L_slow_10
L_back_12:
 v_mfma_f32_16x16x32_bf16 a[128:131], a[112:115], a[32:35], a[128:131]
 ds_read_b64_tr_b16 a[96:97], v14 offset:42304
 s_add_u32 s2, s4, 4096
 v_mfma_f32_16x16x32_bf16 a[128:131], a[116:119], a[48:51], a[128:131]
 ds_read_b64_tr_b16 a[98:99], v14 offset:42560
 v_fma_f32 v144, -v53, v149, v144
 v_mfma_f32_16x16x32_bf16 a[132:135], a[116:119], a[52:55], a[132:135]
 ds_read_b64_tr_b16 a[100:101], v23 offset:64
 v_fmac_f32 v145, v53, v148
 v_mfma_f32_16x16x32_bf16 a[132:135], a[112:115], a[36:39], a[132:135]
 ds_read_b64_tr_b16 a[102:103], v23 offset:320
 buffer_load_dwordx4 v[112:115], v15, s[48:51], s2 offen offset:0 sc1
 v_mfma_f32_16x16x32_bf16 a[136:139], a[112:115], a[40:43], a[136:139]
 v_fmac_f32 v146, v54, v150
 v_fmac_f32 v147, v54, v151
 v_mfma_f32_16x16x32_bf16 a[136:139], a[116:119], a[56:59], a[136:139]
 v_fma_f32 v146, -v55, v151, v146
 v_fmac_f32 v147, v55, v150
 v_mfma_f32_16x16x32_bf16 a[140:143], a[116:119], a[60:63], a[140:143]
 v_fmac_f32 v140, v52, v144
 v_fmac_f32 v141, v52, v145
 v_mfma_f32_16x16x32_bf16 a[140:143], a[112:115], a[44:47], a[140:143]
 buffer_load_dwordx4 v[116:119], v15, s[48:51], s2 offen offset:1024 sc1
 s_waitcnt lgkmcnt(4)
 v_mfma_f32_16x16x32_bf16 a[144:147], a[80:83], a[32:35], a[144:147]
 ds_read_b64_tr_b16 a[112:113], v14 offset:42336
 v_fma_f32 v140, -v53, v145, v140
 v_mfma_f32_16x16x32_bf16 a[144:147], a[84:87], a[48:51], a[144:147]
 ds_read_b64_tr_b16 a[114:115], v14 offset:42592
 v_fmac_f32 v141, v53, v144
 v_mfma_f32_16x16x32_bf16 a[148:151], a[84:87], a[52:55], a[148:151]
 ds_read_b64_tr_b16 a[116:117], v23 offset:96
 v_fmac_f32 v142, v54, v146
 v_mfma_f32_16x16x32_bf16 a[148:151], a[80:83], a[36:39], a[148:151]
 ds_read_b64_tr_b16 a[118:119], v23 offset:352
 v_fmac_f32 v143, v54, v147
 v_mfma_f32_16x16x32_bf16 a[152:155], a[80:83], a[40:43], a[152:155]
 buffer_load_dwordx4 v[120:123], v15, s[48:51], s2 offen offset:2048 sc1
 v_fma_f32 v142, -v55, v147, v142
 v_mfma_f32_16x16x32_bf16 a[152:155], a[84:87], a[56:59], a[152:155]
 v_fmac_f32 v143, v55, v146
 v_fmac_f32 v136, v52, v140
 v_mfma_f32_16x16x32_bf16 a[156:159], a[84:87], a[60:63], a[156:159]
 v_fmac_f32 v137, v52, v141
 v_fma_f32 v136, -v53, v141, v136
 v_mfma_f32_16x16x32_bf16 a[156:159], a[80:83], a[44:47], a[156:159]
 v_fmac_f32 v137, v53, v140
 s_waitcnt lgkmcnt(4)
 v_mfma_f32_16x16x32_bf16 a[160:163], a[96:99], a[32:35], a[160:163]
 ds_read_b64_tr_b16 a[80:81], v14 offset:42368
 v_fmac_f32 v138, v54, v142
 v_mfma_f32_16x16x32_bf16 a[160:163], a[100:103], a[48:51], a[160:163]
 ds_read_b64_tr_b16 a[82:83], v14 offset:42624
 buffer_store_dwordx4 v[180:183], v31, s[48:51], s75 offen offset:2048 sc1
 v_mfma_f32_16x16x32_bf16 a[164:167], a[100:103], a[52:55], a[164:167]
 ds_read_b64_tr_b16 a[84:85], v23 offset:128
 v_fmac_f32 v139, v54, v143
 v_mfma_f32_16x16x32_bf16 a[164:167], a[96:99], a[36:39], a[164:167]
 ds_read_b64_tr_b16 a[86:87], v23 offset:384
 v_fma_f32 v138, -v55, v143, v138
 v_mfma_f32_16x16x32_bf16 a[168:171], a[96:99], a[40:43], a[168:171]
 v_fmac_f32 v139, v55, v142
 v_fmac_f32 v132, v52, v136
 v_mfma_f32_16x16x32_bf16 a[168:171], a[100:103], a[56:59], a[168:171]
 v_fmac_f32 v133, v52, v137
 v_fma_f32 v132, -v53, v137, v132
 v_mfma_f32_16x16x32_bf16 a[172:175], a[100:103], a[60:63], a[172:175]
 buffer_load_dwordx4 v[124:127], v15, s[48:51], s2 offen offset:3072 sc1
 s_add_u32 s2, s5, 4096
 v_mfma_f32_16x16x32_bf16 a[172:175], a[96:99], a[44:47], a[172:175]
 v_fmac_f32 v133, v53, v136
 s_waitcnt lgkmcnt(4)
 v_mfma_f32_16x16x32_bf16 a[176:179], a[112:115], a[32:35], a[176:179]
 ds_read_b64_tr_b16 a[96:97], v14 offset:42400
 v_fmac_f32 v134, v54, v138
 v_mfma_f32_16x16x32_bf16 a[176:179], a[116:119], a[48:51], a[176:179]
 ds_read_b64_tr_b16 a[98:99], v14 offset:42656
 v_fmac_f32 v135, v54, v139
 v_mfma_f32_16x16x32_bf16 a[180:183], a[116:119], a[52:55], a[180:183]
 ds_read_b64_tr_b16 a[100:101], v23 offset:160
 buffer_load_dwordx4 a[0:3], v15, s[48:51], s2 offen offset:0 sc1
 v_mfma_f32_16x16x32_bf16 a[180:183], a[112:115], a[36:39], a[180:183]
 ds_read_b64_tr_b16 a[102:103], v23 offset:416
 v_fma_f32 v134, -v55, v139, v134
 v_mfma_f32_16x16x32_bf16 a[184:187], a[112:115], a[40:43], a[184:187]
 v_fmac_f32 v135, v55, v138
 v_fmac_f32 v128, v52, v132
 v_mfma_f32_16x16x32_bf16 a[184:187], a[116:119], a[56:59], a[184:187]
 v_fmac_f32 v129, v52, v133
 v_fma_f32 v128, -v53, v133, v128
 v_mfma_f32_16x16x32_bf16 a[188:191], a[116:119], a[60:63], a[188:191]
 v_fmac_f32 v129, v53, v132
 v_fmac_f32 v130, v54, v134
 v_mfma_f32_16x16x32_bf16 a[188:191], a[112:115], a[44:47], a[188:191]
 buffer_load_dwordx4 a[4:7], v15, s[48:51], s2 offen offset:1024 sc1
 s_waitcnt lgkmcnt(4)
 v_mfma_f32_16x16x32_bf16 a[192:195], a[80:83], a[32:35], a[192:195]
 ds_read_b64_tr_b16 a[112:113], v14 offset:42432
 v_fmac_f32 v131, v54, v135
 v_mfma_f32_16x16x32_bf16 a[192:195], a[84:87], a[48:51], a[192:195]
 ds_read_b64_tr_b16 a[114:115], v14 offset:42688
 v_fma_f32 v130, -v55, v135, v130
 v_mfma_f32_16x16x32_bf16 a[196:199], a[84:87], a[52:55], a[196:199]
 ds_read_b64_tr_b16 a[116:117], v23 offset:192
 v_fmac_f32 v131, v55, v134
 v_mfma_f32_16x16x32_bf16 a[196:199], a[80:83], a[36:39], a[196:199]
 ds_read_b64_tr_b16 a[118:119], v23 offset:448
 v_fmac_f32 v76, v18, v128
 v_mfma_f32_16x16x32_bf16 a[200:203], a[80:83], a[40:43], a[200:203]
 buffer_load_dwordx4 a[8:11], v15, s[48:51], s2 offen offset:2048 sc1
 v_fmac_f32 v77, v18, v129
 v_mfma_f32_16x16x32_bf16 a[200:203], a[84:87], a[56:59], a[200:203]
 v_fma_f32 v76, -v19, v129, v76
 v_fmac_f32 v77, v19, v128
 v_mfma_f32_16x16x32_bf16 a[204:207], a[84:87], a[60:63], a[204:207]
 v_fmac_f32 v78, v20, v130
 v_fmac_f32 v79, v20, v131
 v_mfma_f32_16x16x32_bf16 a[204:207], a[80:83], a[44:47], a[204:207]
 v_fma_f32 v78, -v21, v131, v78
 s_waitcnt lgkmcnt(4)
 v_mfma_f32_16x16x32_bf16 a[208:211], a[96:99], a[32:35], a[208:211]
 ds_read_b64_tr_b16 a[80:81], v14 offset:42464
 v_fmac_f32 v79, v21, v130
 v_mfma_f32_16x16x32_bf16 a[208:211], a[100:103], a[48:51], a[208:211]
 ds_read_b64_tr_b16 a[82:83], v14 offset:42720
 buffer_load_dwordx4 a[12:15], v15, s[48:51], s2 offen offset:3072 sc1
 v_mfma_f32_16x16x32_bf16 a[212:215], a[100:103], a[52:55], a[212:215]
 ds_read_b64_tr_b16 a[84:85], v23 offset:224
 s_add_u32 s2, s6, 4096
 v_mfma_f32_16x16x32_bf16 a[212:215], a[96:99], a[36:39], a[212:215]
 ds_read_b64_tr_b16 a[86:87], v23 offset:480
 v_fmac_f32 v68, v40, v76
 v_mfma_f32_16x16x32_bf16 a[216:219], a[96:99], a[40:43], a[216:219]
 v_fmac_f32 v70, v40, v77
 v_fma_f32 v68, -v41, v77, v68
 v_mfma_f32_16x16x32_bf16 a[216:219], a[100:103], a[56:59], a[216:219]
 buffer_load_dwordx4 a[16:19], v15, s[48:51], s2 offen offset:0 sc1
 v_fmac_f32 v70, v41, v76
 v_mfma_f32_16x16x32_bf16 a[220:223], a[100:103], a[60:63], a[220:223]
 v_fmac_f32 v72, v42, v78
 v_fmac_f32 v74, v42, v79
 v_mfma_f32_16x16x32_bf16 a[220:223], a[96:99], a[44:47], a[220:223]
 s_waitcnt vmcnt(63) lgkmcnt(4)
 s_barrier
 v_mfma_f32_16x16x32_bf16 a[224:227], a[112:115], a[32:35], a[224:227]
 ds_read_b64_tr_b16 a[96:97], v23 offset:8448
 v_fma_f32 v72, -v43, v79, v72
 v_mfma_f32_16x16x32_bf16 a[224:227], a[116:119], a[48:51], a[224:227]
 ds_read_b64_tr_b16 a[98:99], v23 offset:8704
 v_fmac_f32 v74, v43, v78
 v_mfma_f32_16x16x32_bf16 a[228:231], a[116:119], a[52:55], a[228:231]
 ds_read_b64_tr_b16 a[100:101], v23 offset:16896
 buffer_load_dwordx4 a[20:23], v15, s[48:51], s2 offen offset:1024 sc1
 v_mfma_f32_16x16x32_bf16 a[228:231], a[112:115], a[36:39], a[228:231]
 ds_read_b64_tr_b16 a[102:103], v23 offset:17152
 v_fmac_f32 v192, v32, v76
 v_mfma_f32_16x16x32_bf16 a[232:235], a[112:115], a[40:43], a[232:235]
 v_fmac_f32 v208, v32, v77
 v_fma_f32 v192, -v33, v77, v192
 v_mfma_f32_16x16x32_bf16 a[232:235], a[116:119], a[56:59], a[232:235]
 v_fmac_f32 v208, v33, v76
 v_fmac_f32 v193, v32, v68
 v_mfma_f32_16x16x32_bf16 a[236:239], a[116:119], a[60:63], a[236:239]
 v_fmac_f32 v209, v32, v70
 v_fma_f32 v193, -v33, v70, v193
 v_mfma_f32_16x16x32_bf16 a[236:239], a[112:115], a[44:47], a[236:239]
 buffer_load_dwordx4 a[24:27], v15, s[48:51], s2 offen offset:2048 sc1
 s_waitcnt lgkmcnt(4)
 v_mfma_f32_16x16x32_bf16 a[240:243], a[80:83], a[32:35], a[240:243]
 ds_read_b64_tr_b16 a[112:113], v23 offset:8480
 v_fmac_f32 v209, v33, v68
 v_mfma_f32_16x16x32_bf16 a[240:243], a[84:87], a[48:51], a[240:243]
 ds_read_b64_tr_b16 a[114:115], v23 offset:8736
 v_fmac_f32 v224, v34, v78
 v_mfma_f32_16x16x32_bf16 a[244:247], a[84:87], a[52:55], a[244:247]
 ds_read_b64_tr_b16 a[116:117], v23 offset:16928
 v_fmac_f32 v240, v34, v79
 v_mfma_f32_16x16x32_bf16 a[244:247], a[80:83], a[36:39], a[244:247]
 ds_read_b64_tr_b16 a[118:119], v23 offset:17184
 v_fma_f32 v224, -v35, v79, v224
 v_mfma_f32_16x16x32_bf16 a[248:251], a[80:83], a[40:43], a[248:251]
 buffer_load_dwordx4 a[28:31], v15, s[48:51], s2 offen offset:3072 sc1
 s_add_u32 s2, s7, 4096
 v_mfma_f32_16x16x32_bf16 a[248:251], a[84:87], a[56:59], a[248:251]
 v_fmac_f32 v240, v35, v78
 v_fmac_f32 v225, v34, v72
 v_mfma_f32_16x16x32_bf16 a[252:255], a[84:87], a[60:63], a[252:255]
 v_fmac_f32 v241, v34, v74
 v_fma_f32 v225, -v35, v74, v225
 v_mfma_f32_16x16x32_bf16 a[252:255], a[80:83], a[44:47], a[252:255]
 v_fmac_f32 v241, v35, v72
 s_waitcnt vmcnt(25) lgkmcnt(4)
 v_mfma_f32_16x16x32_bf16 a[128:131], a[96:99], a[64:67], a[128:131]
 ds_read_b64_tr_b16 a[80:81], v23 offset:8512
 buffer_load_dwordx4 v[176:179], v15, s[48:51], s2 offen offset:0 sc1
 v_mfma_f32_16x16x32_bf16 a[128:131], a[100:103], v[80:83], a[128:131]
 ds_read_b64_tr_b16 a[82:83], v23 offset:8768
 v_fmac_f32 v194, v32, v192
 v_mfma_f32_16x16x32_bf16 a[132:135], a[100:103], v[84:87], a[132:135]
 ds_read_b64_tr_b16 a[84:85], v23 offset:16960
 v_fmac_f32 v210, v32, v208
 v_mfma_f32_16x16x32_bf16 a[132:135], a[96:99], a[68:71], a[132:135]
 ds_read_b64_tr_b16 a[86:87], v23 offset:17216
 v_fma_f32 v194, -v33, v208, v194
 v_mfma_f32_16x16x32_bf16 a[136:139], a[96:99], a[72:75], a[136:139]
 v_fmac_f32 v210, v33, v192
 v_fmac_f32 v195, v32, v193
 v_mfma_f32_16x16x32_bf16 a[136:139], a[100:103], v[88:91], a[136:139]
 buffer_load_dwordx4 v[180:183], v15, s[48:51], s2 offen offset:1024 sc1
 v_fmac_f32 v211, v32, v209
 v_mfma_f32_16x16x32_bf16 a[140:143], a[100:103], v[92:95], a[140:143]
 v_fma_f32 v195, -v33, v209, v195
 v_fmac_f32 v211, v33, v193
 v_mfma_f32_16x16x32_bf16 a[140:143], a[96:99], a[76:79], a[140:143]
 v_fmac_f32 v226, v34, v224
 s_waitcnt lgkmcnt(4)
 v_mfma_f32_16x16x32_bf16 a[144:147], a[112:115], a[64:67], a[144:147]
 ds_read_b64_tr_b16 a[96:97], v23 offset:8544
 v_fmac_f32 v242, v34, v240
 v_mfma_f32_16x16x32_bf16 a[144:147], a[116:119], v[80:83], a[144:147]
 ds_read_b64_tr_b16 a[98:99], v23 offset:8800
 v_fma_f32 v226, -v35, v240, v226
 v_mfma_f32_16x16x32_bf16 a[148:151], a[116:119], v[84:87], a[148:151]
 ds_read_b64_tr_b16 a[100:101], v23 offset:16992
 buffer_load_dwordx4 v[184:187], v15, s[48:51], s2 offen offset:2048 sc1
 v_mfma_f32_16x16x32_bf16 a[148:151], a[112:115], a[68:71], a[148:151]
 ds_read_b64_tr_b16 a[102:103], v23 offset:17248
 v_fmac_f32 v242, v35, v224
 v_mfma_f32_16x16x32_bf16 a[152:155], a[112:115], a[72:75], a[152:155]
 v_fmac_f32 v227, v34, v225
 v_fmac_f32 v243, v34, v241
 v_mfma_f32_16x16x32_bf16 a[152:155], a[116:119], v[88:91], a[152:155]
 v_fma_f32 v227, -v35, v241, v227
 v_fmac_f32 v243, v35, v225
 v_mfma_f32_16x16x32_bf16 a[156:159], a[116:119], v[92:95], a[156:159]
 v_fmac_f32 v196, v32, v194
 v_fmac_f32 v212, v32, v210
 v_mfma_f32_16x16x32_bf16 a[156:159], a[112:115], a[76:79], a[156:159]
 buffer_load_dwordx4 v[188:191], v15, s[48:51], s2 offen offset:3072 sc1
 s_waitcnt lgkmcnt(4)
 v_mfma_f32_16x16x32_bf16 a[160:163], a[80:83], a[64:67], a[160:163]
 ds_read_b64_tr_b16 a[112:113], v23 offset:8576
 s_add_u32 s2, s8, 4096
 v_mfma_f32_16x16x32_bf16 a[160:163], a[84:87], v[80:83], a[160:163]
 ds_read_b64_tr_b16 a[114:115], v23 offset:8832
 v_fma_f32 v196, -v33, v210, v196
 v_mfma_f32_16x16x32_bf16 a[164:167], a[84:87], v[84:87], a[164:167]
 ds_read_b64_tr_b16 a[116:117], v23 offset:17024
 v_fmac_f32 v212, v33, v194
 v_mfma_f32_16x16x32_bf16 a[164:167], a[80:83], a[68:71], a[164:167]
 ds_read_b64_tr_b16 a[118:119], v23 offset:17280
 buffer_load_dwordx4 a[32:35], v15, s[48:51], s2 offen offset:0 sc1
 v_mfma_f32_16x16x32_bf16 a[168:171], a[80:83], a[72:75], a[168:171]
 v_fmac_f32 v197, v32, v195
 v_fmac_f32 v213, v32, v211
 v_mfma_f32_16x16x32_bf16 a[168:171], a[84:87], v[88:91], a[168:171]
 v_fma_f32 v197, -v33, v211, v197
 v_fmac_f32 v213, v33, v195
 v_mfma_f32_16x16x32_bf16 a[172:175], a[84:87], v[92:95], a[172:175]
 v_fmac_f32 v228, v34, v226
 v_fmac_f32 v244, v34, v242
 v_mfma_f32_16x16x32_bf16 a[172:175], a[80:83], a[76:79], a[172:175]
 v_fma_f32 v228, -v35, v242, v228
 s_waitcnt lgkmcnt(4)
 v_mfma_f32_16x16x32_bf16 a[176:179], a[96:99], a[64:67], a[176:179]
 ds_read_b64_tr_b16 a[80:81], v23 offset:8608
 buffer_load_dwordx4 a[36:39], v15, s[48:51], s2 offen offset:1024 sc1
 v_mfma_f32_16x16x32_bf16 a[176:179], a[100:103], v[80:83], a[176:179]
 ds_read_b64_tr_b16 a[82:83], v23 offset:8864
 v_fmac_f32 v244, v35, v226
 v_mfma_f32_16x16x32_bf16 a[180:183], a[100:103], v[84:87], a[180:183]
 ds_read_b64_tr_b16 a[84:85], v23 offset:17056
 v_fmac_f32 v229, v34, v227
 v_mfma_f32_16x16x32_bf16 a[180:183], a[96:99], a[68:71], a[180:183]
 ds_read_b64_tr_b16 a[86:87], v23 offset:17312
 v_fmac_f32 v245, v34, v243
 v_mfma_f32_16x16x32_bf16 a[184:187], a[96:99], a[72:75], a[184:187]
 v_fma_f32 v229, -v35, v243, v229
 v_fmac_f32 v245, v35, v227
 v_mfma_f32_16x16x32_bf16 a[184:187], a[100:103], v[88:91], a[184:187]
 buffer_load_dwordx4 a[40:43], v15, s[48:51], s2 offen offset:2048 sc1
 v_fmac_f32 v198, v32, v196
 v_mfma_f32_16x16x32_bf16 a[188:191], a[100:103], v[92:95], a[188:191]
 v_fmac_f32 v214, v32, v212
 v_fma_f32 v198, -v33, v212, v198
 v_mfma_f32_16x16x32_bf16 a[188:191], a[96:99], a[76:79], a[188:191]
 v_fmac_f32 v214, v33, v196
 s_waitcnt lgkmcnt(4)
 v_mfma_f32_16x16x32_bf16 a[192:195], a[112:115], a[64:67], a[192:195]
 ds_read_b64_tr_b16 a[96:97], v23 offset:8640
 v_fmac_f32 v199, v32, v197
 v_mfma_f32_16x16x32_bf16 a[192:195], a[116:119], v[80:83], a[192:195]
 ds_read_b64_tr_b16 a[98:99], v23 offset:8896
 v_fmac_f32 v215, v32, v213
 v_mfma_f32_16x16x32_bf16 a[196:199], a[116:119], v[84:87], a[196:199]
 ds_read_b64_tr_b16 a[100:101], v23 offset:17088
 buffer_load_dwordx4 a[44:47], v15, s[48:51], s2 offen offset:3072 sc1
 v_mfma_f32_16x16x32_bf16 a[196:199], a[112:115], a[68:71], a[196:199]
 ds_read_b64_tr_b16 a[102:103], v23 offset:17344
 s_add_u32 s2, s9, 4096
 v_mfma_f32_16x16x32_bf16 a[200:203], a[112:115], a[72:75], a[200:203]
 v_fma_f32 v199, -v33, v213, v199
 v_fmac_f32 v215, v33, v197
 v_mfma_f32_16x16x32_bf16 a[200:203], a[116:119], v[88:91], a[200:203]
 v_fmac_f32 v230, v34, v228
 v_fmac_f32 v246, v34, v244
 v_mfma_f32_16x16x32_bf16 a[204:207], a[116:119], v[92:95], a[204:207]
 buffer_load_dwordx4 a[48:51], v15, s[48:51], s2 offen offset:0 sc1
 v_fma_f32 v230, -v35, v244, v230
 v_mfma_f32_16x16x32_bf16 a[204:207], a[112:115], a[76:79], a[204:207]
 v_fmac_f32 v246, v35, v228
 s_waitcnt lgkmcnt(4)
 v_mfma_f32_16x16x32_bf16 a[208:211], a[80:83], a[64:67], a[208:211]
 ds_read_b64_tr_b16 a[112:113], v23 offset:8672
 v_fmac_f32 v231, v34, v229
 v_mfma_f32_16x16x32_bf16 a[208:211], a[84:87], v[80:83], a[208:211]
 ds_read_b64_tr_b16 a[114:115], v23 offset:8928
 v_fmac_f32 v247, v34, v245
 v_mfma_f32_16x16x32_bf16 a[212:215], a[84:87], v[84:87], a[212:215]
 ds_read_b64_tr_b16 a[116:117], v23 offset:17120
 v_mov_b32 v1, 3
 v_mfma_f32_16x16x32_bf16 a[212:215], a[80:83], a[68:71], a[212:215]
 ds_read_b64_tr_b16 a[118:119], v23 offset:17376
 buffer_load_dwordx4 a[52:55], v15, s[48:51], s2 offen offset:1024 sc1
 v_mfma_f32_16x16x32_bf16 a[216:219], a[80:83], a[72:75], a[216:219]
 s_waitcnt vmcnt(19)
 v_fma_f32 v231, -v35, v245, v231
 v_fmac_f32 v247, v35, v229
 v_mfma_f32_16x16x32_bf16 a[216:219], a[84:87], v[88:91], a[216:219]
 v_fmac_f32 v200, v32, v198
 v_fmac_f32 v216, v32, v214
 v_mfma_f32_16x16x32_bf16 a[220:223], a[84:87], v[92:95], a[220:223]
 v_fma_f32 v200, -v33, v214, v200
 v_fmac_f32 v216, v33, v198
 v_mfma_f32_16x16x32_bf16 a[220:223], a[80:83], a[76:79], a[220:223]
 s_waitcnt vmcnt(63) lgkmcnt(4)
 s_barrier
 v_mfma_f32_16x16x32_bf16 a[224:227], a[96:99], a[64:67], a[224:227]
 ds_read_b64_tr_b16 a[80:81], v23 offset:25344
 buffer_store_dword v1, v11, s[48:51], s32 offen sc1
 v_mfma_f32_16x16x32_bf16 a[224:227], a[100:103], v[80:83], a[224:227]
 ds_read_b64_tr_b16 a[82:83], v23 offset:25600
 v_fmac_f32 v201, v32, v199
 v_mfma_f32_16x16x32_bf16 a[228:231], a[100:103], v[84:87], a[228:231]
 ds_read_b64_tr_b16 a[84:85], v22 offset:16896
 buffer_load_dwordx4 a[56:59], v15, s[48:51], s2 offen offset:2048 sc1
 v_mfma_f32_16x16x32_bf16 a[228:231], a[96:99], a[68:71], a[228:231]
 ds_read_b64_tr_b16 a[86:87], v22 offset:17152
 v_fmac_f32 v217, v32, v215
 v_mfma_f32_16x16x32_bf16 a[232:235], a[96:99], a[72:75], a[232:235]
 v_fma_f32 v201, -v33, v215, v201
 v_fmac_f32 v217, v33, v199
 v_mfma_f32_16x16x32_bf16 a[232:235], a[100:103], v[88:91], a[232:235]
 v_fmac_f32 v232, v34, v230
 v_fmac_f32 v248, v34, v246
 v_mfma_f32_16x16x32_bf16 a[236:239], a[100:103], v[92:95], a[236:239]
 v_fma_f32 v232, -v35, v246, v232
 v_fmac_f32 v248, v35, v230
 v_mfma_f32_16x16x32_bf16 a[236:239], a[96:99], a[76:79], a[236:239]
 buffer_load_dwordx4 a[60:63], v15, s[48:51], s2 offen offset:3072 sc1
 s_waitcnt lgkmcnt(4)
 v_mfma_f32_16x16x32_bf16 a[240:243], a[112:115], a[64:67], a[240:243]
 ds_read_b64_tr_b16 a[96:97], v23 offset:25376
 v_fmac_f32 v233, v34, v231
 v_mfma_f32_16x16x32_bf16 a[240:243], a[116:119], v[80:83], a[240:243]
 ds_read_b64_tr_b16 a[98:99], v23 offset:25632
 v_fmac_f32 v249, v34, v247
 v_mfma_f32_16x16x32_bf16 a[244:247], a[116:119], v[84:87], a[244:247]
 ds_read_b64_tr_b16 a[100:101], v22 offset:16928
 v_fma_f32 v233, -v35, v247, v233
 v_mfma_f32_16x16x32_bf16 a[244:247], a[112:115], a[68:71], a[244:247]
 ds_read_b64_tr_b16 a[102:103], v22 offset:17184
 buffer_load_dwordx4 v16, s[36:39], s78 offen offset:0 lds
 v_mfma_f32_16x16x32_bf16 a[248:251], a[112:115], a[72:75], a[248:251]
 v_fmac_f32 v249, v35, v231
 v_fmac_f32 v202, v32, v200
 v_mfma_f32_16x16x32_bf16 a[248:251], a[116:119], v[88:91], a[248:251]
 v_fmac_f32 v218, v32, v216
 v_fma_f32 v202, -v33, v216, v202
 v_mfma_f32_16x16x32_bf16 a[252:255], a[116:119], v[92:95], a[252:255]
 v_fmac_f32 v218, v33, v200
 v_fmac_f32 v203, v32, v201
 v_mfma_f32_16x16x32_bf16 a[252:255], a[112:115], a[76:79], a[252:255]
 v_fmac_f32 v219, v32, v217
 s_waitcnt vmcnt(22) lgkmcnt(4)
 v_mfma_f32_16x16x32_bf16 a[128:131], a[80:83], v[96:99], a[128:131]
 ds_read_b64_tr_b16 a[112:113], v23 offset:25408
 buffer_load_dwordx4 v17, s[36:39], s78 offen offset:1056 lds
 v_mfma_f32_16x16x32_bf16 a[128:131], a[84:87], v[112:115], a[128:131]
 ds_read_b64_tr_b16 a[114:115], v23 offset:25664
 s_add_u32 s78, s6, 8192
 v_mfma_f32_16x16x32_bf16 a[132:135], a[84:87], v[116:119], a[132:135]
 ds_read_b64_tr_b16 a[116:117], v22 offset:16960
 s_add_u32 m0, s66, 92928
 v_mfma_f32_16x16x32_bf16 a[132:135], a[80:83], v[100:103], a[132:135]
 ds_read_b64_tr_b16 a[118:119], v22 offset:17216
 s_lshl_b32 s78, s78, 4
 v_mfma_f32_16x16x32_bf16 a[136:139], a[80:83], v[104:107], a[136:139]
 s_add_u32 s2, s10, 4096
 v_fma_f32 v203, -v33, v217, v203
 v_fmac_f32 v219, v33, v201
 v_mfma_f32_16x16x32_bf16 a[136:139], a[84:87], v[120:123], a[136:139]
 buffer_load_dwordx4 a[64:67], v15, s[48:51], s2 offen offset:0 sc1
 v_fmac_f32 v234, v34, v232
 v_mfma_f32_16x16x32_bf16 a[140:143], a[84:87], v[124:127], a[140:143]
 v_fmac_f32 v250, v34, v248
 v_fma_f32 v234, -v35, v248, v234
 v_mfma_f32_16x16x32_bf16 a[140:143], a[80:83], v[108:111], a[140:143]
 v_fmac_f32 v250, v35, v232
 s_waitcnt lgkmcnt(4)
 v_mfma_f32_16x16x32_bf16 a[144:147], a[96:99], v[96:99], a[144:147]
 ds_read_b64_tr_b16 a[80:81], v23 offset:25440
 v_fmac_f32 v235, v34, v233
 v_mfma_f32_16x16x32_bf16 a[144:147], a[100:103], v[112:115], a[144:147]
 ds_read_b64_tr_b16 a[82:83], v23 offset:25696
 v_fmac_f32 v251, v34, v249
 v_mfma_f32_16x16x32_bf16 a[148:151], a[100:103], v[116:119], a[148:151]
 ds_read_b64_tr_b16 a[84:85], v22 offset:16992
 buffer_load_dwordx4 a[68:71], v15, s[48:51], s2 offen offset:1024 sc1
 v_mfma_f32_16x16x32_bf16 a[148:151], a[96:99], v[100:103], a[148:151]
 ds_read_b64_tr_b16 a[86:87], v22 offset:17248
 v_fma_f32 v235, -v35, v249, v235
 v_mfma_f32_16x16x32_bf16 a[152:155], a[96:99], v[104:107], a[152:155]
 v_fmac_f32 v251, v35, v233
 v_fmac_f32 v204, v32, v202
 v_mfma_f32_16x16x32_bf16 a[152:155], a[100:103], v[120:123], a[152:155]
 v_fmac_f32 v220, v32, v218
 v_fma_f32 v204, -v33, v218, v204
 v_mfma_f32_16x16x32_bf16 a[156:159], a[100:103], v[124:127], a[156:159]
 buffer_load_dwordx4 a[72:75], v15, s[48:51], s2 offen offset:2048 sc1
 v_fmac_f32 v220, v33, v202
 v_mfma_f32_16x16x32_bf16 a[156:159], a[96:99], v[108:111], a[156:159]
 v_fmac_f32 v205, v32, v203
 s_waitcnt lgkmcnt(4)
 v_mfma_f32_16x16x32_bf16 a[160:163], a[112:115], v[96:99], a[160:163]
 ds_read_b64_tr_b16 a[96:97], v23 offset:25472
 v_fmac_f32 v221, v32, v219
 v_mfma_f32_16x16x32_bf16 a[160:163], a[116:119], v[112:115], a[160:163]
 ds_read_b64_tr_b16 a[98:99], v23 offset:25728
 v_fma_f32 v205, -v33, v219, v205
 v_mfma_f32_16x16x32_bf16 a[164:167], a[116:119], v[116:119], a[164:167]
 ds_read_b64_tr_b16 a[100:101], v22 offset:17024
 v_fmac_f32 v221, v33, v203
 v_mfma_f32_16x16x32_bf16 a[164:167], a[112:115], v[100:103], a[164:167]
 ds_read_b64_tr_b16 a[102:103], v22 offset:17280
 buffer_load_dwordx4 a[76:79], v15, s[48:51], s2 offen offset:3072 sc1
 v_mfma_f32_16x16x32_bf16 a[168:171], a[112:115], v[104:107], a[168:171]
 v_fmac_f32 v236, v34, v234
 v_fmac_f32 v252, v34, v250
 v_mfma_f32_16x16x32_bf16 a[168:171], a[116:119], v[120:123], a[168:171]
 v_fma_f32 v236, -v35, v250, v236
 v_fmac_f32 v252, v35, v234
 v_mfma_f32_16x16x32_bf16 a[172:175], a[116:119], v[124:127], a[172:175]
 v_fmac_f32 v237, v34, v235
 v_fmac_f32 v253, v34, v251
 v_mfma_f32_16x16x32_bf16 a[172:175], a[112:115], v[108:111], a[172:175]
 v_fma_f32 v237, -v35, v251, v237
 s_waitcnt lgkmcnt(4)
 v_mfma_f32_16x16x32_bf16 a[176:179], a[80:83], v[96:99], a[176:179]
 ds_read_b64_tr_b16 a[112:113], v23 offset:25504
 buffer_load_dwordx4 v16, s[36:39], s78 offen offset:0 lds
 v_mfma_f32_16x16x32_bf16 a[176:179], a[84:87], v[112:115], a[176:179]
 ds_read_b64_tr_b16 a[114:115], v23 offset:25760
 v_fmac_f32 v253, v35, v235
 v_mfma_f32_16x16x32_bf16 a[180:183], a[84:87], v[116:119], a[180:183]
 ds_read_b64_tr_b16 a[116:117], v22 offset:17056
 v_fmac_f32 v206, v32, v204
 v_mfma_f32_16x16x32_bf16 a[180:183], a[80:83], v[100:103], a[180:183]
 ds_read_b64_tr_b16 a[118:119], v22 offset:17312
 v_fmac_f32 v222, v32, v220
 v_mfma_f32_16x16x32_bf16 a[184:187], a[80:83], v[104:107], a[184:187]
 v_fma_f32 v206, -v33, v220, v206
 v_fmac_f32 v222, v33, v204
 v_mfma_f32_16x16x32_bf16 a[184:187], a[84:87], v[120:123], a[184:187]
 buffer_load_dwordx4 v17, s[36:39], s78 offen offset:1056 lds
 s_add_u32 s78, s7, 8192
 v_mfma_f32_16x16x32_bf16 a[188:191], a[84:87], v[124:127], a[188:191]
 s_add_u32 m0, s66, 33792
 s_lshl_b32 s78, s78, 4
 v_fmac_f32 v207, v32, v205
 v_mfma_f32_16x16x32_bf16 a[188:191], a[80:83], v[108:111], a[188:191]
 v_fmac_f32 v223, v32, v221
 s_waitcnt lgkmcnt(4)
 v_mfma_f32_16x16x32_bf16 a[192:195], a[96:99], v[96:99], a[192:195]
 ds_read_b64_tr_b16 a[80:81], v23 offset:25536
 v_fma_f32 v207, -v33, v221, v207
 v_mfma_f32_16x16x32_bf16 a[192:195], a[100:103], v[112:115], a[192:195]
 ds_read_b64_tr_b16 a[82:83], v23 offset:25792
 buffer_load_dword v13, v25, s[48:51], s101 offen sc1
 v_mfma_f32_16x16x32_bf16 a[196:199], a[100:103], v[116:119], a[196:199]
 ds_read_b64_tr_b16 a[84:85], v22 offset:17088
 v_fmac_f32 v223, v33, v205
 v_mfma_f32_16x16x32_bf16 a[196:199], a[96:99], v[100:103], a[196:199]
 ds_read_b64_tr_b16 a[86:87], v22 offset:17344
 buffer_load_dwordx4 v16, s[36:39], s78 offen offset:0 lds
 v_mfma_f32_16x16x32_bf16 a[200:203], a[96:99], v[104:107], a[200:203]
 v_fmac_f32 v238, v34, v236
 v_fmac_f32 v254, v34, v252
 v_mfma_f32_16x16x32_bf16 a[200:203], a[100:103], v[120:123], a[200:203]
 v_fma_f32 v238, -v35, v252, v238
 v_fmac_f32 v254, v35, v236
 v_mfma_f32_16x16x32_bf16 a[204:207], a[100:103], v[124:127], a[204:207]
 v_fmac_f32 v239, v34, v237
 v_fmac_f32 v255, v34, v253
 v_mfma_f32_16x16x32_bf16 a[204:207], a[96:99], v[108:111], a[204:207]
 v_fma_f32 v239, -v35, v253, v239
 s_waitcnt lgkmcnt(4)
 v_mfma_f32_16x16x32_bf16 a[208:211], a[112:115], v[96:99], a[208:211]
 ds_read_b64_tr_b16 a[96:97], v23 offset:25568
 buffer_load_dwordx4 v17, s[36:39], s78 offen offset:1056 lds
 v_mfma_f32_16x16x32_bf16 a[208:211], a[116:119], v[112:115], a[208:211]
 ds_read_b64_tr_b16 a[98:99], v23 offset:25824
 s_add_u32 s78, s8, 8192
 v_mfma_f32_16x16x32_bf16 a[212:215], a[116:119], v[116:119], a[212:215]
 ds_read_b64_tr_b16 a[100:101], v22 offset:17120
 s_add_u32 m0, s66, 42240
 v_mfma_f32_16x16x32_bf16 a[212:215], a[112:115], v[100:103], a[212:215]
 ds_read_b64_tr_b16 a[102:103], v22 offset:17376
 s_lshl_b32 s78, s78, 4
 v_mfma_f32_16x16x32_bf16 a[216:219], a[112:115], v[104:107], a[216:219]
 v_fmac_f32 v255, v35, v237
 s_waitcnt lgkmcnt(15)
 v_mfma_f32_16x16x32_bf16 a[216:219], a[116:119], v[120:123], a[216:219]
 buffer_load_dwordx4 v16, s[36:39], s78 offen offset:0 lds
 v_mul_f32 v192, v192, v160
 v_mfma_f32_16x16x32_bf16 a[220:223], a[116:119], v[124:127], a[220:223]
 v_mul_f32 v193, v193, v161
 v_mul_f32 v194, v194, v162
 v_mfma_f32_16x16x32_bf16 a[220:223], a[112:115], v[108:111], a[220:223]
 s_waitcnt vmcnt(63) lgkmcnt(4)
 s_barrier
 v_mfma_f32_16x16x32_bf16 a[224:227], a[80:83], v[96:99], a[224:227]
 ds_read_b64_tr_b16 a[112:113], v22 offset:25344
 v_mul_f32 v195, v195, v163
 v_mfma_f32_16x16x32_bf16 a[224:227], a[84:87], v[112:115], a[224:227]
 ds_read_b64_tr_b16 a[114:115], v22 offset:25600
 v_cvt_pk_bf16_f32 v192, v192, v193
 v_mfma_f32_16x16x32_bf16 a[228:231], a[84:87], v[116:119], a[228:231]
 ds_read_b64_tr_b16 a[116:117], v14 offset:0
 buffer_load_dwordx4 v17, s[36:39], s78 offen offset:1056 lds
 v_mfma_f32_16x16x32_bf16 a[228:231], a[80:83], v[100:103], a[228:231]
 ds_read_b64_tr_b16 a[118:119], v14 offset:256
 s_add_u32 s78, s9, 8192
 v_mfma_f32_16x16x32_bf16 a[232:235], a[80:83], v[104:107], a[232:235]
 s_add_u32 m0, s66, 101376
 s_lshl_b32 s78, s78, 4
 v_cvt_pk_bf16_f32 v193, v194, v195
 v_mfma_f32_16x16x32_bf16 a[232:235], a[84:87], v[120:123], a[232:235]
 ds_write_b64 v66, v[192:193] offset:0
 v_mfma_f32_16x16x32_bf16 a[236:239], a[84:87], v[124:127], a[236:239]
 buffer_load_dwordx4 v16, s[36:39], s78 offen offset:0 lds
 v_mul_f32 v196, v196, v164
 v_mfma_f32_16x16x32_bf16 a[236:239], a[80:83], v[108:111], a[236:239]
 v_mul_f32 v197, v197, v165
 s_waitcnt lgkmcnt(5)
 v_mfma_f32_16x16x32_bf16 a[240:243], a[96:99], v[96:99], a[240:243]
 ds_read_b64_tr_b16 a[80:81], v22 offset:25376
 v_mul_f32 v198, v198, v166
 v_mfma_f32_16x16x32_bf16 a[240:243], a[100:103], v[112:115], a[240:243]
 ds_read_b64_tr_b16 a[82:83], v22 offset:25632
 v_mul_f32 v199, v199, v167
 v_mfma_f32_16x16x32_bf16 a[244:247], a[100:103], v[116:119], a[244:247]
 ds_read_b64_tr_b16 a[84:85], v14 offset:32
 v_cvt_pk_bf16_f32 v196, v196, v197
 v_mfma_f32_16x16x32_bf16 a[244:247], a[96:99], v[100:103], a[244:247]
 ds_read_b64_tr_b16 a[86:87], v14 offset:288
 buffer_load_dwordx4 v17, s[36:39], s78 offen offset:1056 lds
 v_mfma_f32_16x16x32_bf16 a[248:251], a[96:99], v[104:107], a[248:251]
 s_add_u32 s78, s10, 8192
 s_add_u32 m0, s66, 109824
 s_lshl_b32 s78, s78, 4
 v_mfma_f32_16x16x32_bf16 a[248:251], a[100:103], v[120:123], a[248:251]
 v_cvt_pk_bf16_f32 v197, v198, v199
 v_mfma_f32_16x16x32_bf16 a[252:255], a[100:103], v[124:127], a[252:255]
 ds_write_b64 v66, v[196:197] offset:1152
 v_mfma_f32_16x16x32_bf16 a[252:255], a[96:99], v[108:111], a[252:255]
L_pad8:
 s_cbranch_execz L_pad12
 v_mul_f32 v200, v200, v168
 s_waitcnt vmcnt(28) lgkmcnt(6)
 v_mfma_f32_16x16x32_bf16 a[128:131], a[112:115], a[0:3], a[128:131]
 ds_read_b64_tr_b16 a[96:97], v22 offset:25408
 buffer_load_dwordx4 v16, s[36:39], s78 offen offset:0 lds
 v_mfma_f32_16x16x32_bf16 a[128:131], a[116:119], a[16:19], a[128:131]
 ds_read_b64_tr_b16 a[98:99], v22 offset:25664
 v_mul_f32 v201, v201, v169
 v_mfma_f32_16x16x32_bf16 a[132:135], a[116:119], a[20:23], a[132:135]
 ds_read_b64_tr_b16 a[100:101], v14 offset:64
 v_mul_f32 v202, v202, v170
 v_mfma_f32_16x16x32_bf16 a[132:135], a[112:115], a[4:7], a[132:135]
 ds_read_b64_tr_b16 a[102:103], v14 offset:320
 v_mul_f32 v203, v203, v171
 v_mfma_f32_16x16x32_bf16 a[136:139], a[112:115], a[8:11], a[136:139]
 v_cvt_pk_bf16_f32 v200, v200, v201
 v_cvt_pk_bf16_f32 v201, v202, v203
 v_mfma_f32_16x16x32_bf16 a[136:139], a[116:119], a[24:27], a[136:139]
 ds_write_b64 v66, v[200:201] offset:2304
 v_mfma_f32_16x16x32_bf16 a[140:143], a[116:119], a[28:31], a[140:143]
 buffer_load_dwordx4 v17, s[36:39], s78 offen offset:1056 lds
 s_add_u32 s78, s11, 0
 v_mfma_f32_16x16x32_bf16 a[140:143], a[112:115], a[12:15], a[140:143]
 s_add_u32 m0, s66, 118272
 s_lshl_b32 s78, s78, 4
 s_waitcnt lgkmcnt(6)
 v_mfma_f32_16x16x32_bf16 a[144:147], a[80:83], a[0:3], a[144:147]
 ds_read_b64_tr_b16 a[112:113], v22 offset:25440
 v_mul_f32 v204, v204, v172
 v_mfma_f32_16x16x32_bf16 a[144:147], a[84:87], a[16:19], a[144:147]
 ds_read_b64_tr_b16 a[114:115], v22 offset:25696
 v_mul_f32 v205, v205, v173
 v_mfma_f32_16x16x32_bf16 a[148:151], a[84:87], a[20:23], a[148:151]
 ds_read_b64_tr_b16 a[116:117], v14 offset:96
 buffer_load_dwordx4 v24, s[36:39], s78 offen offset:0 lds
 v_mfma_f32_16x16x32_bf16 a[148:151], a[80:83], a[4:7], a[148:151]
 ds_read_b64_tr_b16 a[118:119], v14 offset:352
 s_add_u32 s78, s78, 992
 v_mfma_f32_16x16x32_bf16 a[152:155], a[80:83], a[8:11], a[152:155]
 v_mul_f32 v206, v206, v174
 v_mul_f32 v207, v207, v175
 v_mfma_f32_16x16x32_bf16 a[152:155], a[84:87], a[24:27], a[152:155]
 v_cvt_pk_bf16_f32 v204, v204, v205
 v_cvt_pk_bf16_f32 v205, v206, v207
 v_mfma_f32_16x16x32_bf16 a[156:159], a[84:87], a[28:31], a[156:159]
 ds_write_b64 v66, v[204:205] offset:3456
 v_mfma_f32_16x16x32_bf16 a[156:159], a[80:83], a[12:15], a[156:159]
 buffer_load_dwordx4 v24, s[36:39], s78 offen offset:1056 lds
 s_waitcnt lgkmcnt(6)
 v_mfma_f32_16x16x32_bf16 a[160:163], a[96:99], a[0:3], a[160:163]
 ds_read_b64_tr_b16 a[80:81], v22 offset:25472
 v_mul_f32 v224, v224, v160
 v_mfma_f32_16x16x32_bf16 a[160:163], a[100:103], a[16:19], a[160:163]
 ds_read_b64_tr_b16 a[82:83], v22 offset:25728
 s_waitcnt vmcnt(10)
 v_cmp_gt_u32 vcc, 3, v13
 s_cbranch_vccnz L_slow_13
L_back_15:
 v_mfma_f32_16x16x32_bf16 a[164:167], a[100:103], a[20:23], a[164:167]
 ds_read_b64_tr_b16 a[84:85], v14 offset:128
 s_add_u32 s2, s4, 8192
 v_mfma_f32_16x16x32_bf16 a[164:167], a[96:99], a[4:7], a[164:167]
 ds_read_b64_tr_b16 a[86:87], v14 offset:384
 v_mul_f32 v225, v225, v161
 v_mfma_f32_16x16x32_bf16 a[168:171], a[96:99], a[8:11], a[168:171]
 buffer_load_dwordx4 v[80:83], v15, s[48:51], s2 offen offset:0 sc1
 v_mul_f32 v226, v226, v162
 v_mfma_f32_16x16x32_bf16 a[168:171], a[100:103], a[24:27], a[168:171]
 v_mul_f32 v227, v227, v163
 v_cvt_pk_bf16_f32 v224, v224, v225
 v_mfma_f32_16x16x32_bf16 a[172:175], a[100:103], a[28:31], a[172:175]
 v_cvt_pk_bf16_f32 v225, v226, v227
 v_mfma_f32_16x16x32_bf16 a[172:175], a[96:99], a[12:15], a[172:175]
 s_waitcnt lgkmcnt(5)
 v_mfma_f32_16x16x32_bf16 a[176:179], a[112:115], a[0:3], a[176:179]
 ds_read_b64_tr_b16 a[96:97], v22 offset:25504
 v_mfma_f32_16x16x32_bf16 a[176:179], a[116:119], a[16:19], a[176:179]
 ds_read_b64_tr_b16 a[98:99], v22 offset:25760
 buffer_load_dwordx4 v[84:87], v15, s[48:51], s2 offen offset:1024 sc1
 v_mfma_f32_16x16x32_bf16 a[180:183], a[116:119], a[20:23], a[180:183]
 ds_read_b64_tr_b16 a[100:101], v14 offset:160
 v_mfma_f32_16x16x32_bf16 a[180:183], a[112:115], a[4:7], a[180:183]
 ds_read_b64_tr_b16 a[102:103], v14 offset:416
 v_mfma_f32_16x16x32_bf16 a[184:187], a[112:115], a[8:11], a[184:187]
 ds_write_b64 v66, v[224:225] offset:128
 v_mfma_f32_16x16x32_bf16 a[184:187], a[116:119], a[24:27], a[184:187]
 buffer_load_dwordx4 v[88:91], v15, s[48:51], s2 offen offset:2048 sc1
 v_mul_f32 v228, v228, v164
 v_mfma_f32_16x16x32_bf16 a[188:191], a[116:119], a[28:31], a[188:191]
 v_mul_f32 v229, v229, v165
 v_mul_f32 v230, v230, v166
 v_mfma_f32_16x16x32_bf16 a[188:191], a[112:115], a[12:15], a[188:191]
 v_mul_f32 v231, v231, v167
 s_waitcnt lgkmcnt(5)
 v_mfma_f32_16x16x32_bf16 a[192:195], a[80:83], a[0:3], a[192:195]
 ds_read_b64_tr_b16 a[112:113], v22 offset:25536
 v_cvt_pk_bf16_f32 v228, v228, v229
 v_mfma_f32_16x16x32_bf16 a[192:195], a[84:87], a[16:19], a[192:195]
 ds_read_b64_tr_b16 a[114:115], v22 offset:25792
 v_cvt_pk_bf16_f32 v229, v230, v231
 v_mfma_f32_16x16x32_bf16 a[196:199], a[84:87], a[20:23], a[196:199]
 ds_read_b64_tr_b16 a[116:117], v14 offset:192
 buffer_load_dwordx4 v[92:95], v15, s[48:51], s2 offen offset:3072 sc1
 v_mfma_f32_16x16x32_bf16 a[196:199], a[80:83], a[4:7], a[196:199]
 ds_read_b64_tr_b16 a[118:119], v14 offset:448
 s_add_u32 s2, s5, 8192
 v_mfma_f32_16x16x32_bf16 a[200:203], a[80:83], a[8:11], a[200:203]
 ds_write_b64 v66, v[228:229] offset:1280
 v_mfma_f32_16x16x32_bf16 a[200:203], a[84:87], a[24:27], a[200:203]
 v_mul_f32 v232, v232, v168
 v_mul_f32 v233, v233, v169
 v_mfma_f32_16x16x32_bf16 a[204:207], a[84:87], a[28:31], a[204:207]
 v_mul_f32 v234, v234, v170
 v_mul_f32 v235, v235, v171
 v_mfma_f32_16x16x32_bf16 a[204:207], a[80:83], a[12:15], a[204:207]
 buffer_load_dwordx4 v[96:99], v15, s[48:51], s2 offen offset:0 sc1
 s_waitcnt lgkmcnt(6)
 v_mfma_f32_16x16x32_bf16 a[208:211], a[96:99], a[0:3], a[208:211]
 ds_read_b64_tr_b16 a[80:81], v22 offset:25568
 v_cvt_pk_bf16_f32 v232, v232, v233
 v_mfma_f32_16x16x32_bf16 a[208:211], a[100:103], a[16:19], a[208:211]
 ds_read_b64_tr_b16 a[82:83], v22 offset:25824
 v_cvt_pk_bf16_f32 v233, v234, v235
 v_mfma_f32_16x16x32_bf16 a[212:215], a[100:103], a[20:23], a[212:215]
 ds_read_b64_tr_b16 a[84:85], v14 offset:224
 v_mfma_f32_16x16x32_bf16 a[212:215], a[96:99], a[4:7], a[212:215]
 ds_read_b64_tr_b16 a[86:87], v14 offset:480
 v_mfma_f32_16x16x32_bf16 a[216:219], a[96:99], a[8:11], a[216:219]
 ds_write_b64 v66, v[232:233] offset:2432
 v_mfma_f32_16x16x32_bf16 a[216:219], a[100:103], a[24:27], a[216:219]
 buffer_load_dwordx4 v[100:103], v15, s[48:51], s2 offen offset:1024 sc1
 v_mul_f32 v236, v236, v172
 v_mfma_f32_16x16x32_bf16 a[220:223], a[100:103], a[28:31], a[220:223]
 v_mul_f32 v237, v237, v173
 v_mul_f32 v238, v238, v174
 v_mfma_f32_16x16x32_bf16 a[220:223], a[96:99], a[12:15], a[220:223]
 s_waitcnt vmcnt(63) lgkmcnt(6)
 s_barrier
 v_mfma_f32_16x16x32_bf16 a[224:227], a[112:115], a[0:3], a[224:227]
 ds_read_b64_tr_b16 a[96:97], v14 offset:8448
 s_add_u32 s78, s12, 0
 v_mfma_f32_16x16x32_bf16 a[224:227], a[116:119], a[16:19], a[224:227]
 ds_read_b64_tr_b16 a[98:99], v14 offset:8704
 buffer_load_dwordx4 v[104:107], v15, s[48:51], s2 offen offset:2048 sc1
 v_mfma_f32_16x16x32_bf16 a[228:231], a[116:119], a[20:23], a[228:231]
 ds_read_b64_tr_b16 a[100:101], v22 offset:0
 s_add_u32 m0, s66, 126720
 v_mfma_f32_16x16x32_bf16 a[228:231], a[112:115], a[4:7], a[228:231]
 ds_read_b64_tr_b16 a[102:103], v22 offset:256
 s_lshl_b32 s78, s78, 4
 v_mfma_f32_16x16x32_bf16 a[232:235], a[112:115], a[8:11], a[232:235]
 v_mul_f32 v239, v239, v175
 v_cvt_pk_bf16_f32 v236, v236, v237
 v_mfma_f32_16x16x32_bf16 a[232:235], a[116:119], a[24:27], a[232:235]
 v_cvt_pk_bf16_f32 v237, v238, v239
 v_mfma_f32_16x16x32_bf16 a[236:239], a[116:119], a[28:31], a[236:239]
 ds_write_b64 v66, v[236:237] offset:3584
 v_mfma_f32_16x16x32_bf16 a[236:239], a[112:115], a[12:15], a[236:239]
 ds_read_b64_tr_b16 v[128:129], v67 offset:0
 s_waitcnt lgkmcnt(7)
 v_mfma_f32_16x16x32_bf16 a[240:243], a[80:83], a[0:3], a[240:243]
 ds_read_b64_tr_b16 a[112:113], v14 offset:8480
 buffer_load_dwordx4 v[108:111], v15, s[48:51], s2 offen offset:3072 sc1
 v_mfma_f32_16x16x32_bf16 a[240:243], a[84:87], a[16:19], a[240:243]
 ds_read_b64_tr_b16 a[114:115], v14 offset:8736
 s_add_u32 s2, s6, 8192
 v_mfma_f32_16x16x32_bf16 a[244:247], a[84:87], a[20:23], a[244:247]
 ds_read_b64_tr_b16 a[116:117], v22 offset:32
 v_mfma_f32_16x16x32_bf16 a[244:247], a[80:83], a[4:7], a[244:247]
 ds_read_b64_tr_b16 a[118:119], v22 offset:288
 v_mfma_f32_16x16x32_bf16 a[248:251], a[80:83], a[8:11], a[248:251]
 ds_read_b64_tr_b16 v[130:131], v67 offset:32
 buffer_load_dwordx4 v[112:115], v15, s[48:51], s2 offen offset:0 sc1
 v_mfma_f32_16x16x32_bf16 a[248:251], a[84:87], a[24:27], a[248:251]
 ds_read_b64_tr_b16 v[132:133], v67 offset:1152
 v_mfma_f32_16x16x32_bf16 a[252:255], a[84:87], a[28:31], a[252:255]
 ds_read_b64_tr_b16 v[134:135], v67 offset:1184
 v_mfma_f32_16x16x32_bf16 a[252:255], a[80:83], a[12:15], a[252:255]
 ds_read_b64_tr_b16 v[136:137], v67 offset:2304
 s_waitcnt vmcnt(33) lgkmcnt(10)
 v_mfma_f32_16x16x32_bf16 a[128:131], a[96:99], v[176:179], a[128:131]
 ds_read_b64_tr_b16 a[80:81], v14 offset:8512
 v_mfma_f32_16x16x32_bf16 a[128:131], a[100:103], a[32:35], a[128:131]
 ds_read_b64_tr_b16 a[82:83], v14 offset:8768
 buffer_load_dwordx4 v[116:119], v15, s[48:51], s2 offen offset:1024 sc1
 v_mfma_f32_16x16x32_bf16 a[132:135], a[100:103], a[36:39], a[132:135]
 ds_read_b64_tr_b16 a[84:85], v22 offset:64
 v_mfma_f32_16x16x32_bf16 a[132:135], a[96:99], v[180:183], a[132:135]
 ds_read_b64_tr_b16 a[86:87], v22 offset:320
 v_mfma_f32_16x16x32_bf16 a[136:139], a[96:99], v[184:187], a[136:139]
 ds_read_b64_tr_b16 v[138:139], v67 offset:2336
 v_mfma_f32_16x16x32_bf16 a[136:139], a[100:103], a[40:43], a[136:139]
 ds_read_b64_tr_b16 v[140:141], v67 offset:3456
 v_mfma_f32_16x16x32_bf16 a[140:143], a[100:103], a[44:47], a[140:143]
 ds_read_b64_tr_b16 v[142:143], v67 offset:3488
 buffer_load_dwordx4 v[120:123], v15, s[48:51], s2 offen offset:2048 sc1
 v_mfma_f32_16x16x32_bf16 a[140:143], a[96:99], v[188:191], a[140:143]
 v_mul_f32 v208, v208, v160
 s_waitcnt lgkmcnt(11)
 v_mfma_f32_16x16x32_bf16 a[144:147], a[112:115], v[176:179], a[144:147]
 ds_read_b64_tr_b16 a[96:97], v14 offset:8544
 v_mul_f32 v209, v209, v161
 v_mfma_f32_16x16x32_bf16 a[144:147], a[116:119], a[32:35], a[144:147]
 ds_read_b64_tr_b16 a[98:99], v14 offset:8800
 v_mul_f32 v210, v210, v162
 v_mfma_f32_16x16x32_bf16 a[148:151], a[116:119], a[36:39], a[148:151]
 ds_read_b64_tr_b16 a[100:101], v22 offset:96
 v_mul_f32 v211, v211, v163
 v_mfma_f32_16x16x32_bf16 a[148:151], a[112:115], v[180:183], a[148:151]
 ds_read_b64_tr_b16 a[102:103], v22 offset:352
 buffer_load_dwordx4 v[124:127], v15, s[48:51], s2 offen offset:3072 sc1
 v_mfma_f32_16x16x32_bf16 a[152:155], a[112:115], v[184:187], a[152:155]
 s_add_u32 s2, s7, 8192
 v_cvt_pk_bf16_f32 v208, -v208, -v209
 v_mfma_f32_16x16x32_bf16 a[152:155], a[116:119], a[40:43], a[152:155]
 v_cvt_pk_bf16_f32 v209, -v210, -v211
 v_mfma_f32_16x16x32_bf16 a[156:159], a[116:119], a[44:47], a[156:159]
 ds_write_b64 v66, v[208:209] offset:0
 v_mfma_f32_16x16x32_bf16 a[156:159], a[112:115], v[188:191], a[156:159]
 buffer_load_dwordx4 a[0:3], v15, s[48:51], s2 offen offset:0 sc1
 s_waitcnt lgkmcnt(8)
 v_mfma_f32_16x16x32_bf16 a[160:163], a[80:83], v[176:179], a[160:163]
 ds_read_b64_tr_b16 a[112:113], v14 offset:8576
 s_lshl_b32 s68, s63, 12
 v_mfma_f32_16x16x32_bf16 a[160:163], a[84:87], a[32:35], a[160:163]
 ds_read_b64_tr_b16 a[114:115], v14 offset:8832
 s_add_u32 s68, s68, 114688
 v_mfma_f32_16x16x32_bf16 a[164:167], a[84:87], a[36:39], a[164:167]
 ds_read_b64_tr_b16 a[116:117], v22 offset:128
 s_waitcnt lgkmcnt(8)
 v_mfma_f32_16x16x32_bf16 a[164:167], a[80:83], v[180:183], a[164:167]
 ds_read_b64_tr_b16 a[118:119], v22 offset:384
 v_mul_f32 v212, v212, v164
 v_mfma_f32_16x16x32_bf16 a[168:171], a[80:83], v[184:187], a[168:171]
 buffer_store_dwordx4 v[128:131], v15, s[48:51], s68 offen offset:0 sc1
 v_mul_f32 v213, v213, v165
 v_mfma_f32_16x16x32_bf16 a[168:171], a[84:87], a[40:43], a[168:171]
 v_mul_f32 v214, v214, v166
 v_mul_f32 v215, v215, v167
 v_mfma_f32_16x16x32_bf16 a[172:175], a[84:87], a[44:47], a[172:175]
 v_cvt_pk_bf16_f32 v212, -v212, -v213
 v_cvt_pk_bf16_f32 v213, -v214, -v215
 v_mfma_f32_16x16x32_bf16 a[172:175], a[80:83], v[188:191], a[172:175]
 s_waitcnt lgkmcnt(5)
 v_mfma_f32_16x16x32_bf16 a[176:179], a[96:99], v[176:179], a[176:179]
 ds_read_b64_tr_b16 a[80:81], v14 offset:8608
 v_mfma_f32_16x16x32_bf16 a[176:179], a[100:103], a[32:35], a[176:179]
 ds_read_b64_tr_b16 a[82:83], v14 offset:8864
 buffer_load_dwordx4 a[4:7], v15, s[48:51], s2 offen offset:1024 sc1
 v_mfma_f32_16x16x32_bf16 a[180:183], a[100:103], a[36:39], a[180:183]
 ds_read_b64_tr_b16 a[84:85], v22 offset:160
 v_mfma_f32_16x16x32_bf16 a[180:183], a[96:99], v[180:183], a[180:183]
 ds_read_b64_tr_b16 a[86:87], v22 offset:416
 v_mfma_f32_16x16x32_bf16 a[184:187], a[96:99], v[184:187], a[184:187]
 ds_write_b64 v66, v[212:213] offset:1152
 v_mfma_f32_16x16x32_bf16 a[184:187], a[100:103], a[40:43], a[184:187]
 v_mul_f32 v216, v216, v168
 v_mul_f32 v217, v217, v169
 v_mfma_f32_16x16x32_bf16 a[188:191], a[100:103], a[44:47], a[188:191]
 buffer_load_dwordx4 a[8:11], v15, s[48:51], s2 offen offset:2048 sc1
 v_mul_f32 v218, v218, v170
 v_mfma_f32_16x16x32_bf16 a[188:191], a[96:99], v[188:191], a[188:191]
 v_mul_f32 v219, v219, v171
 s_waitcnt lgkmcnt(5)
 v_mfma_f32_16x16x32_bf16 a[192:195], a[112:115], v[176:179], a[192:195]
 ds_read_b64_tr_b16 a[96:97], v14 offset:8640
 v_cvt_pk_bf16_f32 v216, -v216, -v217
 v_mfma_f32_16x16x32_bf16 a[192:195], a[116:119], a[32:35], a[192:195]
 ds_read_b64_tr_b16 a[98:99], v14 offset:8896
 v_cvt_pk_bf16_f32 v217, -v218, -v219
 v_mfma_f32_16x16x32_bf16 a[196:199], a[116:119], a[36:39], a[196:199]
 ds_read_b64_tr_b16 a[100:101], v22 offset:192
 buffer_store_dwordx4 v[132:135], v15, s[48:51], s68 offen offset:1024 sc1
 v_mfma_f32_16x16x32_bf16 a[196:199], a[112:115], v[180:183], a[196:199]
 ds_read_b64_tr_b16 a[102:103], v22 offset:448
 v_mfma_f32_16x16x32_bf16 a[200:203], a[112:115], v[184:187], a[200:203]
 ds_write_b64 v66, v[216:217] offset:2304
 v_mfma_f32_16x16x32_bf16 a[200:203], a[116:119], a[40:43], a[200:203]
 v_mul_f32 v220, v220, v172
 v_mul_f32 v221, v221, v173
 v_mfma_f32_16x16x32_bf16 a[204:207], a[116:119], a[44:47], a[204:207]
 v_mul_f32 v222, v222, v174
 v_mul_f32 v223, v223, v175
 v_mfma_f32_16x16x32_bf16 a[204:207], a[112:115], v[188:191], a[204:207]
 buffer_load_dwordx4 a[12:15], v15, s[48:51], s2 offen offset:3072 sc1
 s_waitcnt lgkmcnt(6)
 v_mfma_f32_16x16x32_bf16 a[208:211], a[80:83], v[176:179], a[208:211]
 ds_read_b64_tr_b16 a[112:113], v14 offset:8672
 s_add_u32 s2, s8, 8192
 v_mfma_f32_16x16x32_bf16 a[208:211], a[84:87], a[32:35], a[208:211]
 ds_read_b64_tr_b16 a[114:115], v14 offset:8928
 v_cvt_pk_bf16_f32 v220, -v220, -v221
 v_mfma_f32_16x16x32_bf16 a[212:215], a[84:87], a[36:39], a[212:215]
 ds_read_b64_tr_b16 a[116:117], v22 offset:224
 v_cvt_pk_bf16_f32 v221, -v222, -v223
 v_mfma_f32_16x16x32_bf16 a[212:215], a[80:83], v[180:183], a[212:215]
 ds_read_b64_tr_b16 a[118:119], v22 offset:480
 v_mfma_f32_16x16x32_bf16 a[216:219], a[80:83], v[184:187], a[216:219]
 ds_write_b64 v66, v[220:221] offset:3456
 v_mfma_f32_16x16x32_bf16 a[216:219], a[84:87], a[40:43], a[216:219]
 buffer_load_dwordx4 a[16:19], v15, s[48:51], s2 offen offset:0 sc1
 v_mul_f32 v240, v240, v160
 v_mfma_f32_16x16x32_bf16 a[220:223], a[84:87], a[44:47], a[220:223]
 v_mul_f32 v241, v241, v161
 v_mul_f32 v242, v242, v162
 v_mfma_f32_16x16x32_bf16 a[220:223], a[80:83], v[188:191], a[220:223]
 s_waitcnt vmcnt(63) lgkmcnt(6)
 s_barrier
 v_mfma_f32_16x16x32_bf16 a[224:227], a[96:99], v[176:179], a[224:227]
 ds_read_b64_tr_b16 a[80:81], v22 offset:8448
 v_mul_f32 v243, v243, v163
 v_mfma_f32_16x16x32_bf16 a[224:227], a[100:103], a[32:35], a[224:227]
 ds_read_b64_tr_b16 a[82:83], v22 offset:8704
 buffer_load_dwordx4 a[20:23], v15, s[48:51], s2 offen offset:1024 sc1
 v_mfma_f32_16x16x32_bf16 a[228:231], a[100:103], a[36:39], a[228:231]
 ds_read_b64_tr_b16 a[84:85], v14 offset:16896
 v_cvt_pk_bf16_f32 v240, -v240, -v241
 v_mfma_f32_16x16x32_bf16 a[228:231], a[96:99], v[180:183], a[228:231]
 ds_read_b64_tr_b16 a[86:87], v14 offset:17152
 v_cvt_pk_bf16_f32 v241, -v242, -v243
 v_mfma_f32_16x16x32_bf16 a[232:235], a[96:99], v[184:187], a[232:235]
 ds_write_b64 v66, v[240:241] offset:128
 v_mfma_f32_16x16x32_bf16 a[232:235], a[100:103], a[40:43], a[232:235]
 v_mul_f32 v244, v244, v164
 v_mul_f32 v245, v245, v165
 v_mfma_f32_16x16x32_bf16 a[236:239], a[100:103], a[44:47], a[236:239]
 buffer_store_dwordx4 v[136:139], v15, s[48:51], s68 offen offset:2048 sc1
 v_mul_f32 v246, v246, v166
 v_mfma_f32_16x16x32_bf16 a[236:239], a[96:99], v[188:191], a[236:239]
 v_mul_f32 v247, v247, v167
 s_waitcnt lgkmcnt(6)
 v_mfma_f32_16x16x32_bf16 a[240:243], a[112:115], v[176:179], a[240:243]
 ds_read_b64_tr_b16 a[96:97], v22 offset:8480
 v_cvt_pk_bf16_f32 v244, -v244, -v245
 v_mfma_f32_16x16x32_bf16 a[240:243], a[116:119], a[32:35], a[240:243]
 ds_read_b64_tr_b16 a[98:99], v22 offset:8736
 v_cvt_pk_bf16_f32 v245, -v246, -v247
 v_mfma_f32_16x16x32_bf16 a[244:247], a[116:119], a[36:39], a[244:247]
 ds_read_b64_tr_b16 a[100:101], v14 offset:16928
 v_mfma_f32_16x16x32_bf16 a[244:247], a[112:115], v[180:183], a[244:247]
 ds_read_b64_tr_b16 a[102:103], v14 offset:17184
 buffer_load_dwordx4 a[24:27], v15, s[48:51], s2 offen offset:2048 sc1
 v_mfma_f32_16x16x32_bf16 a[248:251], a[112:115], v[184:187], a[248:251]
 ds_write_b64 v66, v[244:245] offset:1280
 v_mfma_f32_16x16x32_bf16 a[248:251], a[116:119], a[40:43], a[248:251]
 v_mul_f32 v248, v248, v168
 v_mul_f32 v249, v249, v169
 v_mfma_f32_16x16x32_bf16 a[252:255], a[116:119], a[44:47], a[252:255]
 v_mul_f32 v250, v250, v170
 v_mul_f32 v251, v251, v171
 v_mfma_f32_16x16x32_bf16 a[252:255], a[112:115], v[188:191], a[252:255]
 v_cvt_pk_bf16_f32 v248, -v248, -v249
 s_waitcnt vmcnt(35) lgkmcnt(6)
 v_mfma_f32_16x16x32_bf16 a[128:131], a[80:83], a[48:51], a[128:131]
 ds_read_b64_tr_b16 a[112:113], v22 offset:8512
 buffer_load_dwordx4 a[28:31], v15, s[48:51], s2 offen offset:3072 sc1
 v_mfma_f32_16x16x32_bf16 a[128:131], a[84:87], a[64:67], a[128:131]
 ds_read_b64_tr_b16 a[114:115], v22 offset:8768
 s_add_u32 s2, s9, 8192
 v_mfma_f32_16x16x32_bf16 a[132:135], a[84:87], a[68:71], a[132:135]
 ds_read_b64_tr_b16 a[116:117], v14 offset:16960
 v_cvt_pk_bf16_f32 v249, -v250, -v251
 v_mfma_f32_16x16x32_bf16 a[132:135], a[80:83], a[52:55], a[132:135]
 ds_read_b64_tr_b16 a[118:119], v14 offset:17216
 v_mfma_f32_16x16x32_bf16 a[136:139], a[80:83], a[56:59], a[136:139]
 ds_write_b64 v66, v[248:249] offset:2432
 v_mfma_f32_16x16x32_bf16 a[136:139], a[84:87], a[72:75], a[136:139]
 buffer_load_dwordx4 a[32:35], v15, s[48:51], s2 offen offset:0 sc1
 v_mul_f32 v252, v252, v172
 v_mfma_f32_16x16x32_bf16 a[140:143], a[84:87], a[76:79], a[140:143]
 v_mul_f32 v253, v253, v173
 v_mul_f32 v254, v254, v174
 v_mfma_f32_16x16x32_bf16 a[140:143], a[80:83], a[60:63], a[140:143]
 v_mul_f32 v255, v255, v175
 s_waitcnt lgkmcnt(6)
 v_mfma_f32_16x16x32_bf16 a[144:147], a[96:99], a[48:51], a[144:147]
 ds_read_b64_tr_b16 a[80:81], v22 offset:8544
 v_cvt_pk_bf16_f32 v252, -v252, -v253
 v_mfma_f32_16x16x32_bf16 a[144:147], a[100:103], a[64:67], a[144:147]
 ds_read_b64_tr_b16 a[82:83], v22 offset:8800
 buffer_load_dwordx4 a[36:39], v15, s[48:51], s2 offen offset:1024 sc1
 v_mfma_f32_16x16x32_bf16 a[148:151], a[100:103], a[68:71], a[148:151]
 ds_read_b64_tr_b16 a[84:85], v14 offset:16992
 v_cvt_pk_bf16_f32 v253, -v254, -v255
 v_mfma_f32_16x16x32_bf16 a[148:151], a[96:99], a[52:55], a[148:151]
 ds_read_b64_tr_b16 a[86:87], v14 offset:17248
 v_mfma_f32_16x16x32_bf16 a[152:155], a[96:99], a[56:59], a[152:155]
 ds_write_b64 v66, v[252:253] offset:3584
 v_mfma_f32_16x16x32_bf16 a[152:155], a[100:103], a[72:75], a[152:155]
 ds_read_b64_tr_b16 v[144:145], v67 offset:0
 v_mfma_f32_16x16x32_bf16 a[156:159], a[100:103], a[76:79], a[156:159]
 ds_read_b64_tr_b16 v[146:147], v67 offset:32
 buffer_store_dwordx4 v[140:143], v15, s[48:51], s68 offen offset:3072 sc1
 v_mfma_f32_16x16x32_bf16 a[156:159], a[96:99], a[60:63], a[156:159]
 ds_read_b64_tr_b16 v[148:149], v67 offset:1152
 s_waitcnt lgkmcnt(9)
 v_mfma_f32_16x16x32_bf16 a[160:163], a[112:115], a[48:51], a[160:163]
 ds_read_b64_tr_b16 a[96:97], v22 offset:8576
 v_mfma_f32_16x16x32_bf16 a[160:163], a[116:119], a[64:67], a[160:163]
 ds_read_b64_tr_b16 a[98:99], v22 offset:8832
 v_mfma_f32_16x16x32_bf16 a[164:167], a[116:119], a[68:71], a[164:167]
 ds_read_b64_tr_b16 a[100:101], v14 offset:17024
 v_mfma_f32_16x16x32_bf16 a[164:167], a[112:115], a[52:55], a[164:167]
 ds_read_b64_tr_b16 a[102:103], v14 offset:17280
 buffer_load_dwordx4 a[40:43], v15, s[48:51], s2 offen offset:2048 sc1
 v_mfma_f32_16x16x32_bf16 a[168:171], a[112:115], a[56:59], a[168:171]
 ds_read_b64_tr_b16 v[150:151], v67 offset:1184
 v_mfma_f32_16x16x32_bf16 a[168:171], a[116:119], a[72:75], a[168:171]
 ds_read_b64_tr_b16 v[152:153], v67 offset:2304
 v_mfma_f32_16x16x32_bf16 a[172:175], a[116:119], a[76:79], a[172:175]
 ds_read_b64_tr_b16 v[154:155], v67 offset:2336
 v_mfma_f32_16x16x32_bf16 a[172:175], a[112:115], a[60:63], a[172:175]
 ds_read_b64_tr_b16 v[156:157], v67 offset:3456
 s_waitcnt lgkmcnt(12)
 v_mfma_f32_16x16x32_bf16 a[176:179], a[80:83], a[48:51], a[176:179]
 ds_read_b64_tr_b16 a[112:113], v22 offset:8608
 buffer_load_dwordx4 a[44:47], v15, s[48:51], s2 offen offset:3072 sc1
 v_mfma_f32_16x16x32_bf16 a[176:179], a[84:87], a[64:67], a[176:179]
 ds_read_b64_tr_b16 a[114:115], v22 offset:8864
 s_add_u32 s2, s10, 8192
 v_mfma_f32_16x16x32_bf16 a[180:183], a[84:87], a[68:71], a[180:183]
 ds_read_b64_tr_b16 a[116:117], v14 offset:17056
 v_mfma_f32_16x16x32_bf16 a[180:183], a[80:83], a[52:55], a[180:183]
 ds_read_b64_tr_b16 a[118:119], v14 offset:17312
 v_mfma_f32_16x16x32_bf16 a[184:187], a[80:83], a[56:59], a[184:187]
 ds_read_b64_tr_b16 v[158:159], v67 offset:3488
 buffer_load_dwordx4 v[176:179], v15, s[48:51], s2 offen offset:0 sc1
 v_mfma_f32_16x16x32_bf16 a[184:187], a[84:87], a[72:75], a[184:187]
 s_and_b32 s82, s61, 2
 s_lshl_b32 s82, s82, 10
 s_xor_b32 s83, s82, 2048
 v_mfma_f32_16x16x32_bf16 a[188:191], a[84:87], a[76:79], a[188:191]
 v_add_u32 v18, s82, v15
 v_add_u32 v19, s83, v15
 v_mfma_f32_16x16x32_bf16 a[188:191], a[80:83], a[60:63], a[188:191]
 v_lshrrev_b32 v2, 4, v0
 s_waitcnt lgkmcnt(9)
 v_mfma_f32_16x16x32_bf16 a[192:195], a[96:99], a[48:51], a[192:195]
 ds_read_b64_tr_b16 a[80:81], v22 offset:8640
 v_bfe_u32 v3, v0, 1, 3
 v_mfma_f32_16x16x32_bf16 a[192:195], a[100:103], a[64:67], a[192:195]
 ds_read_b64_tr_b16 a[82:83], v22 offset:8896
 buffer_load_dwordx4 v[180:183], v15, s[48:51], s2 offen offset:1024 sc1
 v_mfma_f32_16x16x32_bf16 a[196:199], a[100:103], a[68:71], a[196:199]
 ds_read_b64_tr_b16 a[84:85], v14 offset:17088
 s_add_u32 s68, s68, 32768
 v_mfma_f32_16x16x32_bf16 a[196:199], a[96:99], a[52:55], a[196:199]
 ds_read_b64_tr_b16 a[86:87], v14 offset:17344
 s_waitcnt lgkmcnt(4)
 v_mfma_f32_16x16x32_bf16 a[200:203], a[96:99], a[56:59], a[200:203]
 v_xor_b32 v2, v2, v3
 v_lshlrev_b32 v2, 4, v2
 v_mfma_f32_16x16x32_bf16 a[200:203], a[100:103], a[72:75], a[200:203]
 v_lshl_add_u32 v26, v26, 3, v2
 v_xor_b32 v29, 64, v26
 v_mfma_f32_16x16x32_bf16 a[204:207], a[100:103], a[76:79], a[204:207]
 buffer_store_dwordx4 v[144:147], v15, s[48:51], s68 offen offset:0 sc1
 v_add_u32 v27, 50688, v26
 v_mfma_f32_16x16x32_bf16 a[204:207], a[96:99], a[60:63], a[204:207]
 v_add_u32 v30, 50688, v29
 s_waitcnt lgkmcnt(5)
 v_mfma_f32_16x16x32_bf16 a[208:211], a[112:115], a[48:51], a[208:211]
 ds_read_b64_tr_b16 a[96:97], v22 offset:8672
 v_add_u32 v28, 101376, v26
 v_mfma_f32_16x16x32_bf16 a[208:211], a[116:119], a[64:67], a[208:211]
 ds_read_b64_tr_b16 a[98:99], v22 offset:8928
 v_add_u32 v31, 101376, v29
 v_mfma_f32_16x16x32_bf16 a[212:215], a[116:119], a[68:71], a[212:215]
 ds_read_b64_tr_b16 a[100:101], v14 offset:17120
 v_mov_b32 v68, 0
 v_mfma_f32_16x16x32_bf16 a[212:215], a[112:115], a[52:55], a[212:215]
 ds_read_b64_tr_b16 a[102:103], v14 offset:17376
 buffer_load_dwordx4 v[184:187], v15, s[48:51], s2 offen offset:2048 sc1
 v_mfma_f32_16x16x32_bf16 a[216:219], a[112:115], a[56:59], a[216:219]
 v_mov_b32 v69, 0
 v_mov_b32 v72, 0
 v_mfma_f32_16x16x32_bf16 a[216:219], a[116:119], a[72:75], a[216:219]
 v_mov_b32 v73, 0
 v_lshrrev_b32 v2, 4, v0
 v_mfma_f32_16x16x32_bf16 a[220:223], a[116:119], a[76:79], a[220:223]
 v_bfe_u32 v3, v0, 2, 2
 v_xor_b32 v3, v2, v3
 v_mfma_f32_16x16x32_bf16 a[220:223], a[112:115], a[60:63], a[220:223]
 s_waitcnt vmcnt(49) lgkmcnt(4)
 s_barrier
 v_mfma_f32_16x16x32_bf16 a[224:227], a[80:83], a[48:51], a[224:227]
 ds_read_b64_tr_b16 a[112:113], v14 offset:25344
 buffer_load_dwordx4 v[188:191], v15, s[48:51], s2 offen offset:3072 sc1
 v_mfma_f32_16x16x32_bf16 a[224:227], a[84:87], a[64:67], a[224:227]
 ds_read_b64_tr_b16 a[114:115], v14 offset:25600
 s_add_u32 s2, s11, 0
 v_mfma_f32_16x16x32_bf16 a[228:231], a[84:87], a[68:71], a[228:231]
 ds_read_b64_tr_b16 a[116:117], v22 offset:33792
 v_and_b32 v4, 1, v0
 v_mfma_f32_16x16x32_bf16 a[228:231], a[80:83], a[52:55], a[228:231]
 ds_read_b64_tr_b16 a[118:119], v22 offset:34048
 v_lshlrev_b32 v4, 4, v4
 v_mfma_f32_16x16x32_bf16 a[232:235], a[80:83], a[56:59], a[232:235]
 buffer_store_dwordx4 v[148:151], v15, s[48:51], s68 offen offset:1024 sc1
 v_mov_b32 v5, 0x3f80
 v_mfma_f32_16x16x32_bf16 a[232:235], a[84:87], a[72:75], a[232:235]
 v_lshlrev_b32 v4, v4, v5
 v_min_u32 v3, 1, v3
 v_mfma_f32_16x16x32_bf16 a[236:239], a[84:87], a[76:79], a[236:239]
 v_add_u32 v3, -1, v3
 v_and_b32 v4, v3, v4
 v_mfma_f32_16x16x32_bf16 a[236:239], a[80:83], a[60:63], a[236:239]
 v_bfe_i32 v3, v0, 1, 1
 s_waitcnt lgkmcnt(4)
 v_mfma_f32_16x16x32_bf16 a[240:243], a[96:99], a[48:51], a[240:243]
 ds_read_b64_tr_b16 a[80:81], v14 offset:25376
 v_and_b32 v71, v3, v4
 v_mfma_f32_16x16x32_bf16 a[240:243], a[100:103], a[64:67], a[240:243]
 ds_read_b64_tr_b16 a[82:83], v14 offset:25632
 buffer_load_dwordx4 v[192:195], v15, s[48:51], s2 offen offset:0 sc1
 v_mfma_f32_16x16x32_bf16 a[244:247], a[100:103], a[68:71], a[244:247]
 ds_read_b64_tr_b16 a[84:85], v22 offset:33824
 v_xor_b32 v70, v71, v4
 v_mfma_f32_16x16x32_bf16 a[244:247], a[96:99], a[52:55], a[244:247]
 ds_read_b64_tr_b16 a[86:87], v22 offset:34080
 v_and_b32 v3, 1, v2
 v_mfma_f32_16x16x32_bf16 a[248:251], a[96:99], a[56:59], a[248:251]
 v_lshrrev_b32 v4, 5, v0
 v_lshl_add_u32 v3, v3, 3, v4
 v_mfma_f32_16x16x32_bf16 a[248:251], a[100:103], a[72:75], a[248:251]
 s_lshl_b32 s82, s62, 2
 s_add_u32 s82, s82, s60
 s_lshl_b32 s82, s82, 5
 v_mfma_f32_16x16x32_bf16 a[252:255], a[100:103], a[76:79], a[252:255]
 buffer_load_dwordx4 v[196:199], v15, s[48:51], s2 offen offset:1024 sc1
 s_and_b32 s83, s61, 2
 v_mfma_f32_16x16x32_bf16 a[252:255], a[96:99], a[60:63], a[252:255]
 s_add_u32 s82, s82, s83
 s_lshl_b32 s82, s82, 1
 s_waitcnt vmcnt(28) lgkmcnt(4)
 v_mfma_f32_16x16x32_bf16 a[128:131], a[112:115], v[80:83], a[128:131]
 ds_read_b64_tr_b16 a[96:97], v14 offset:25408
 v_add_u32 v3, s82, v3
 v_mfma_f32_16x16x32_bf16 a[128:131], a[116:119], v[96:99], a[128:131]
 ds_read_b64_tr_b16 a[98:99], v14 offset:25664
 s_lshl_b32 s82, s63, 1
 v_mfma_f32_16x16x32_bf16 a[132:135], a[116:119], v[100:103], a[132:135]
 ds_read_b64_tr_b16 a[100:101], v22 offset:33856
 s_and_b32 s83, s61, 1
 v_mfma_f32_16x16x32_bf16 a[132:135], a[112:115], v[84:87], a[132:135]
 ds_read_b64_tr_b16 a[102:103], v22 offset:34112
 buffer_store_dwordx4 v[152:155], v15, s[48:51], s68 offen offset:2048 sc1
 v_mfma_f32_16x16x32_bf16 a[136:139], a[112:115], v[88:91], a[136:139]
 s_add_u32 s82, s82, s83
 s_lshl_b32 s82, s82, 7
 v_and_b32 v4, 15, v0
 v_mfma_f32_16x16x32_bf16 a[136:139], a[116:119], v[104:107], a[136:139]
 v_lshl_add_u32 v20, v4, 3, s82
 v_lshl_add_u32 v75, v3, 11, v20
 v_mfma_f32_16x16x32_bf16 a[140:143], a[116:119], v[108:111], a[140:143]
 v_lshlrev_b32 v74, 1, v75
 s_and_b32 s83, s61, 2
 v_mfma_f32_16x16x32_bf16 a[140:143], a[112:115], v[92:95], a[140:143]
 buffer_load_dwordx4 v[200:203], v15, s[48:51], s2 offen offset:2048 sc1
 s_waitcnt lgkmcnt(4)
 v_mfma_f32_16x16x32_bf16 a[144:147], a[80:83], v[80:83], a[144:147]
 ds_read_b64_tr_b16 a[112:113], v14 offset:25440
 s_lshl_b32 s83, s83, 4
 v_mfma_f32_16x16x32_bf16 a[144:147], a[84:87], v[96:99], a[144:147]
 ds_read_b64_tr_b16 a[114:115], v14 offset:25696
 s_lshl_b32 s82, s60, 9
 v_mfma_f32_16x16x32_bf16 a[148:151], a[84:87], v[100:103], a[148:151]
 ds_read_b64_tr_b16 a[116:117], v22 offset:33888
 s_add_u32 s82, s82, s83
 v_mfma_f32_16x16x32_bf16 a[148:151], a[80:83], v[84:87], a[148:151]
 ds_read_b64_tr_b16 a[118:119], v22 offset:34144
 s_add_u32 s82, s82, 159744
 v_mfma_f32_16x16x32_bf16 a[152:155], a[80:83], v[88:91], a[152:155]
 buffer_load_dwordx4 v[204:207], v15, s[48:51], s2 offen offset:3072 sc1
 s_add_u32 s2, s12, 0
 v_mfma_f32_16x16x32_bf16 a[152:155], a[84:87], v[104:107], a[152:155]
 v_lshl_add_u32 v79, v2, 2, s82
 s_mul_i32 s82, s60, 4352
 v_mfma_f32_16x16x32_bf16 a[156:159], a[84:87], v[108:111], a[156:159]
L_pad9:
 s_cbranch_execz L_pad13
 s_add_u32 s82, s82, 135168
 v_mul_u32_u24 v77, 272, v4
 v_mfma_f32_16x16x32_bf16 a[156:159], a[80:83], v[92:95], a[156:159]
 v_lshl_add_u32 v77, v2, 4, v77
 s_waitcnt lgkmcnt(4)
 v_mfma_f32_16x16x32_bf16 a[160:163], a[96:99], v[80:83], a[160:163]
 ds_read_b64_tr_b16 a[80:81], v14 offset:25472
 v_add_u32 v77, s82, v77
 v_mfma_f32_16x16x32_bf16 a[160:163], a[100:103], v[96:99], a[160:163]
 ds_read_b64_tr_b16 a[82:83], v14 offset:25728
 buffer_load_dwordx4 v24, s[36:39], s78 offen offset:0 lds
 v_mfma_f32_16x16x32_bf16 a[164:167], a[100:103], v[100:103], a[164:167]
 ds_read_b64_tr_b16 a[84:85], v22 offset:33920
 s_add_u32 s78, s78, 992
 v_mfma_f32_16x16x32_bf16 a[164:167], a[96:99], v[84:87], a[164:167]
 ds_read_b64_tr_b16 a[86:87], v22 offset:34176
 v_mul_u32_u24 v78, 272, v2
 v_mfma_f32_16x16x32_bf16 a[168:171], a[96:99], v[88:91], a[168:171]
 v_lshl_add_u32 v78, v4, 4, v78
 v_add_u32 v78, s82, v78
 v_mfma_f32_16x16x32_bf16 a[168:171], a[100:103], v[104:107], a[168:171]
 v_mfma_f32_16x16x32_bf16 a[172:175], a[100:103], v[108:111], a[172:175]
 buffer_store_dwordx4 v[156:159], v15, s[48:51], s68 offen offset:3072 sc1
 v_mfma_f32_16x16x32_bf16 a[172:175], a[96:99], v[92:95], a[172:175]
 s_waitcnt lgkmcnt(4)
 v_mfma_f32_16x16x32_bf16 a[176:179], a[112:115], v[80:83], a[176:179]
 ds_read_b64_tr_b16 a[96:97], v14 offset:25504
 v_mfma_f32_16x16x32_bf16 a[176:179], a[116:119], v[96:99], a[176:179]
 ds_read_b64_tr_b16 a[98:99], v14 offset:25760
 v_mfma_f32_16x16x32_bf16 a[180:183], a[116:119], v[100:103], a[180:183]
 ds_read_b64_tr_b16 a[100:101], v22 offset:33952
 buffer_load_dwordx4 v24, s[36:39], s78 offen offset:1056 lds
 v_mfma_f32_16x16x32_bf16 a[180:183], a[112:115], v[84:87], a[180:183]
 ds_read_b64_tr_b16 a[102:103], v22 offset:34208
 s_add_u32 s78, s13, 0
 v_mfma_f32_16x16x32_bf16 a[184:187], a[112:115], v[88:91], a[184:187]
 s_add_u32 m0, s66, 67584
 s_lshl_b32 s78, s78, 4
 v_mfma_f32_16x16x32_bf16 a[184:187], a[116:119], v[104:107], a[184:187]
 v_mfma_f32_16x16x32_bf16 a[188:191], a[116:119], v[108:111], a[188:191]
 v_mfma_f32_16x16x32_bf16 a[188:191], a[112:115], v[92:95], a[188:191]
 buffer_load_dwordx4 v24, s[36:39], s78 offen offset:0 lds
 s_waitcnt lgkmcnt(4)
 v_mfma_f32_16x16x32_bf16 a[192:195], a[80:83], v[80:83], a[192:195]
 ds_read_b64_tr_b16 a[112:113], v14 offset:25536
 s_add_u32 s78, s78, 992
 v_mfma_f32_16x16x32_bf16 a[192:195], a[84:87], v[96:99], a[192:195]
 ds_read_b64_tr_b16 a[114:115], v14 offset:25792
 v_mfma_f32_16x16x32_bf16 a[196:199], a[84:87], v[100:103], a[196:199]
 ds_read_b64_tr_b16 a[116:117], v22 offset:33984
 v_mfma_f32_16x16x32_bf16 a[196:199], a[80:83], v[84:87], a[196:199]
 ds_read_b64_tr_b16 a[118:119], v22 offset:34240
 v_mfma_f32_16x16x32_bf16 a[200:203], a[80:83], v[88:91], a[200:203]
 buffer_load_dwordx4 v24, s[36:39], s78 offen offset:1056 lds
 s_add_u32 s78, s16, 0
 v_mfma_f32_16x16x32_bf16 a[200:203], a[84:87], v[104:107], a[200:203]
 s_add_u32 m0, s66, 76032
 s_lshl_b32 s78, s78, 4
 v_mfma_f32_16x16x32_bf16 a[204:207], a[84:87], v[108:111], a[204:207]
 v_mfma_f32_16x16x32_bf16 a[204:207], a[80:83], v[92:95], a[204:207]
 s_waitcnt lgkmcnt(4)
 v_mfma_f32_16x16x32_bf16 a[208:211], a[96:99], v[80:83], a[208:211]
 ds_read_b64_tr_b16 a[80:81], v14 offset:25568
 v_mfma_f32_16x16x32_bf16 a[208:211], a[100:103], v[96:99], a[208:211]
 ds_read_b64_tr_b16 a[82:83], v14 offset:25824
 buffer_load_dwordx4 v24, s[36:39], s78 offen offset:0 lds
 v_mfma_f32_16x16x32_bf16 a[212:215], a[100:103], v[100:103], a[212:215]
 ds_read_b64_tr_b16 a[84:85], v22 offset:34016
 s_add_u32 s78, s78, 992
 v_mfma_f32_16x16x32_bf16 a[212:215], a[96:99], v[84:87], a[212:215]
 ds_read_b64_tr_b16 a[86:87], v22 offset:34272
 v_mfma_f32_16x16x32_bf16 a[216:219], a[96:99], v[88:91], a[216:219]
 v_mfma_f32_16x16x32_bf16 a[216:219], a[100:103], v[104:107], a[216:219]
 buffer_load_dwordx4 v24, s[36:39], s78 offen offset:1056 lds
 s_xor_b32 s78, s3, 0
 v_mfma_f32_16x16x32_bf16 a[220:223], a[100:103], v[108:111], a[220:223]
 s_add_u32 m0, s67, 8192
 s_lshl_b32 s78, s78, 7
 v_mfma_f32_16x16x32_bf16 a[220:223], a[96:99], v[92:95], a[220:223]
 s_waitcnt vmcnt(54) lgkmcnt(4)
 s_barrier
 v_mfma_f32_16x16x32_bf16 a[224:227], a[112:115], v[80:83], a[224:227]
 ds_read_b64_tr_b16 a[96:97], v22 offset:42240
 v_mfma_f32_16x16x32_bf16 a[224:227], a[116:119], v[96:99], a[224:227]
 ds_read_b64_tr_b16 a[98:99], v22 offset:42496
 v_mfma_f32_16x16x32_bf16 a[228:231], a[116:119], v[100:103], a[228:231]
 ds_read_b64_tr_b16 a[100:101], v14 offset:33792
 buffer_load_dwordx4 v[208:211], v15, s[48:51], s2 offen offset:0 sc1
 v_mfma_f32_16x16x32_bf16 a[228:231], a[112:115], v[84:87], a[228:231]
 ds_read_b64_tr_b16 a[102:103], v14 offset:34048
 v_mfma_f32_16x16x32_bf16 a[232:235], a[112:115], v[88:91], a[232:235]
 v_mfma_f32_16x16x32_bf16 a[232:235], a[116:119], v[104:107], a[232:235]
 v_mfma_f32_16x16x32_bf16 a[236:239], a[116:119], v[108:111], a[236:239]
 v_mfma_f32_16x16x32_bf16 a[236:239], a[112:115], v[92:95], a[236:239]
 buffer_load_dwordx4 v[212:215], v15, s[48:51], s2 offen offset:1024 sc1
 s_waitcnt lgkmcnt(4)
 v_mfma_f32_16x16x32_bf16 a[240:243], a[80:83], v[80:83], a[240:243]
 ds_read_b64_tr_b16 a[112:113], v22 offset:42272
 v_mfma_f32_16x16x32_bf16 a[240:243], a[84:87], v[96:99], a[240:243]
 ds_read_b64_tr_b16 a[114:115], v22 offset:42528
 v_mfma_f32_16x16x32_bf16 a[244:247], a[84:87], v[100:103], a[244:247]
 ds_read_b64_tr_b16 a[116:117], v14 offset:33824
 v_mfma_f32_16x16x32_bf16 a[244:247], a[80:83], v[84:87], a[244:247]
 ds_read_b64_tr_b16 a[118:119], v14 offset:34080
 v_mfma_f32_16x16x32_bf16 a[248:251], a[80:83], v[88:91], a[248:251]
 buffer_load_dwordx4 v[216:219], v15, s[48:51], s2 offen offset:2048 sc1
 v_mfma_f32_16x16x32_bf16 a[248:251], a[84:87], v[104:107], a[248:251]
 v_mfma_f32_16x16x32_bf16 a[252:255], a[84:87], v[108:111], a[252:255]
 v_mfma_f32_16x16x32_bf16 a[252:255], a[80:83], v[92:95], a[252:255]
 s_waitcnt vmcnt(31) lgkmcnt(4)
 v_mfma_f32_16x16x32_bf16 a[128:131], a[96:99], v[112:115], a[128:131]
 ds_read_b64_tr_b16 a[80:81], v22 offset:42304
 buffer_load_dwordx4 v[220:223], v15, s[48:51], s2 offen offset:3072 sc1
 v_mfma_f32_16x16x32_bf16 a[128:131], a[100:103], a[0:3], a[128:131]
 ds_read_b64_tr_b16 a[82:83], v22 offset:42560
 s_add_u32 s2, s13, 0
 v_mfma_f32_16x16x32_bf16 a[132:135], a[100:103], a[4:7], a[132:135]
 ds_read_b64_tr_b16 a[84:85], v14 offset:33856
 v_mfma_f32_16x16x32_bf16 a[132:135], a[96:99], v[116:119], a[132:135]
 ds_read_b64_tr_b16 a[86:87], v14 offset:34112
 v_mfma_f32_16x16x32_bf16 a[136:139], a[96:99], v[120:123], a[136:139]
 v_mfma_f32_16x16x32_bf16 a[136:139], a[100:103], a[8:11], a[136:139]
 buffer_load_dwordx4 v[224:227], v15, s[48:51], s2 offen offset:0 sc1
 v_mfma_f32_16x16x32_bf16 a[140:143], a[100:103], a[12:15], a[140:143]
 v_mfma_f32_16x16x32_bf16 a[140:143], a[96:99], v[124:127], a[140:143]
 s_waitcnt lgkmcnt(4)
 v_mfma_f32_16x16x32_bf16 a[144:147], a[112:115], v[112:115], a[144:147]
 ds_read_b64_tr_b16 a[96:97], v22 offset:42336
 v_mfma_f32_16x16x32_bf16 a[144:147], a[116:119], a[0:3], a[144:147]
 ds_read_b64_tr_b16 a[98:99], v22 offset:42592
 v_mfma_f32_16x16x32_bf16 a[148:151], a[116:119], a[4:7], a[148:151]
 ds_read_b64_tr_b16 a[100:101], v14 offset:33888
 buffer_load_dwordx4 v[228:231], v15, s[48:51], s2 offen offset:1024 sc1
 v_mfma_f32_16x16x32_bf16 a[148:151], a[112:115], v[116:119], a[148:151]
 ds_read_b64_tr_b16 a[102:103], v14 offset:34144
 v_mfma_f32_16x16x32_bf16 a[152:155], a[112:115], v[120:123], a[152:155]
 v_mfma_f32_16x16x32_bf16 a[152:155], a[116:119], a[8:11], a[152:155]
 v_mfma_f32_16x16x32_bf16 a[156:159], a[116:119], a[12:15], a[156:159]
 v_mfma_f32_16x16x32_bf16 a[156:159], a[112:115], v[124:127], a[156:159]
 buffer_load_dwordx4 v[232:235], v15, s[48:51], s2 offen offset:2048 sc1
 s_waitcnt lgkmcnt(4)
 v_mfma_f32_16x16x32_bf16 a[160:163], a[80:83], v[112:115], a[160:163]
 ds_read_b64_tr_b16 a[112:113], v22 offset:42368
 v_mfma_f32_16x16x32_bf16 a[160:163], a[84:87], a[0:3], a[160:163]
 ds_read_b64_tr_b16 a[114:115], v22 offset:42624
 v_mfma_f32_16x16x32_bf16 a[164:167], a[84:87], a[4:7], a[164:167]
 ds_read_b64_tr_b16 a[116:117], v14 offset:33920
 v_mfma_f32_16x16x32_bf16 a[164:167], a[80:83], v[116:119], a[164:167]
 ds_read_b64_tr_b16 a[118:119], v14 offset:34176
 buffer_load_dwordx4 v[236:239], v15, s[48:51], s2 offen offset:3072 sc1
 v_mfma_f32_16x16x32_bf16 a[168:171], a[80:83], v[120:123], a[168:171]
 s_add_u32 s2, s16, 0
 v_mfma_f32_16x16x32_bf16 a[168:171], a[84:87], a[8:11], a[168:171]
 v_mfma_f32_16x16x32_bf16 a[172:175], a[84:87], a[12:15], a[172:175]
 v_mfma_f32_16x16x32_bf16 a[172:175], a[80:83], v[124:127], a[172:175]
 s_waitcnt lgkmcnt(4)
 v_mfma_f32_16x16x32_bf16 a[176:179], a[96:99], v[112:115], a[176:179]
 ds_read_b64_tr_b16 a[80:81], v22 offset:42400
 buffer_load_dwordx4 v[240:243], v15, s[48:51], s2 offen offset:0 sc1
 v_mfma_f32_16x16x32_bf16 a[176:179], a[100:103], a[0:3], a[176:179]
 ds_read_b64_tr_b16 a[82:83], v22 offset:42656
 v_mfma_f32_16x16x32_bf16 a[180:183], a[100:103], a[4:7], a[180:183]
 ds_read_b64_tr_b16 a[84:85], v14 offset:33952
 v_mfma_f32_16x16x32_bf16 a[180:183], a[96:99], v[116:119], a[180:183]
 ds_read_b64_tr_b16 a[86:87], v14 offset:34208
 v_mfma_f32_16x16x32_bf16 a[184:187], a[96:99], v[120:123], a[184:187]
 v_mfma_f32_16x16x32_bf16 a[184:187], a[100:103], a[8:11], a[184:187]
 buffer_load_dwordx4 v[244:247], v15, s[48:51], s2 offen offset:1024 sc1
 v_mfma_f32_16x16x32_bf16 a[188:191], a[100:103], a[12:15], a[188:191]
 v_mfma_f32_16x16x32_bf16 a[188:191], a[96:99], v[124:127], a[188:191]
 s_waitcnt lgkmcnt(4)
 v_mfma_f32_16x16x32_bf16 a[192:195], a[112:115], v[112:115], a[192:195]
 ds_read_b64_tr_b16 a[96:97], v22 offset:42432
 v_mfma_f32_16x16x32_bf16 a[192:195], a[116:119], a[0:3], a[192:195]
 ds_read_b64_tr_b16 a[98:99], v22 offset:42688
 v_mfma_f32_16x16x32_bf16 a[196:199], a[116:119], a[4:7], a[196:199]
 ds_read_b64_tr_b16 a[100:101], v14 offset:33984
 buffer_load_dwordx4 v[248:251], v15, s[48:51], s2 offen offset:2048 sc1
 v_mfma_f32_16x16x32_bf16 a[196:199], a[112:115], v[116:119], a[196:199]
 ds_read_b64_tr_b16 a[102:103], v14 offset:34240
 v_mfma_f32_16x16x32_bf16 a[200:203], a[112:115], v[120:123], a[200:203]
 v_mfma_f32_16x16x32_bf16 a[200:203], a[116:119], a[8:11], a[200:203]
 v_mfma_f32_16x16x32_bf16 a[204:207], a[116:119], a[12:15], a[204:207]
 buffer_load_dwordx4 v[252:255], v15, s[48:51], s2 offen offset:3072 sc1
 v_mfma_f32_16x16x32_bf16 a[204:207], a[112:115], v[124:127], a[204:207]
 s_waitcnt lgkmcnt(4)
 v_mfma_f32_16x16x32_bf16 a[208:211], a[80:83], v[112:115], a[208:211]
 ds_read_b64_tr_b16 a[112:113], v22 offset:42464
 v_mfma_f32_16x16x32_bf16 a[208:211], a[84:87], a[0:3], a[208:211]
 ds_read_b64_tr_b16 a[114:115], v22 offset:42720
 v_mfma_f32_16x16x32_bf16 a[212:215], a[84:87], a[4:7], a[212:215]
 ds_read_b64_tr_b16 a[116:117], v14 offset:34016
 v_mfma_f32_16x16x32_bf16 a[212:215], a[80:83], v[116:119], a[212:215]
 ds_read_b64_tr_b16 a[118:119], v14 offset:34272
 buffer_load_dwordx4 v62, s[40:43], s78 offen offset:0 lds
 v_mfma_f32_16x16x32_bf16 a[216:219], a[80:83], v[120:123], a[216:219]
 v_mov_b32 v1, 4
 s_waitcnt vmcnt(18)
 v_mfma_f32_16x16x32_bf16 a[216:219], a[84:87], a[8:11], a[216:219]
 v_mfma_f32_16x16x32_bf16 a[220:223], a[84:87], a[12:15], a[220:223]
 v_mfma_f32_16x16x32_bf16 a[220:223], a[80:83], v[124:127], a[220:223]
 s_waitcnt vmcnt(63) lgkmcnt(4)
 s_barrier
 v_mfma_f32_16x16x32_bf16 a[224:227], a[96:99], v[112:115], a[224:227]
 ds_read_b64_tr_b16 a[80:81], v14 offset:42240
 buffer_store_dword v1, v11, s[48:51], s32 offen sc1
 v_mfma_f32_16x16x32_bf16 a[224:227], a[100:103], a[0:3], a[224:227]
 ds_read_b64_tr_b16 a[82:83], v14 offset:42496
 v_mfma_f32_16x16x32_bf16 a[228:231], a[100:103], a[4:7], a[228:231]
 ds_read_b64_tr_b16 a[84:85], v23 offset:0
 buffer_load_dwordx4 v63, s[40:43], s78 offen offset:1024 lds
 v_mfma_f32_16x16x32_bf16 a[228:231], a[96:99], v[116:119], a[228:231]
 ds_read_b64_tr_b16 a[86:87], v23 offset:256
 s_xor_b32 s78, s3, 1
 v_mfma_f32_16x16x32_bf16 a[232:235], a[96:99], v[120:123], a[232:235]
 s_add_u32 m0, s67, 58880
 s_lshl_b32 s78, s78, 7
 v_mfma_f32_16x16x32_bf16 a[232:235], a[100:103], a[8:11], a[232:235]
 v_mfma_f32_16x16x32_bf16 a[236:239], a[100:103], a[12:15], a[236:239]
 v_mfma_f32_16x16x32_bf16 a[236:239], a[96:99], v[124:127], a[236:239]
 buffer_load_dwordx4 v62, s[40:43], s78 offen offset:0 lds
 s_waitcnt lgkmcnt(4)
 v_mfma_f32_16x16x32_bf16 a[240:243], a[112:115], v[112:115], a[240:243]
 ds_read_b64_tr_b16 a[96:97], v14 offset:42272
 v_mfma_f32_16x16x32_bf16 a[240:243], a[116:119], a[0:3], a[240:243]
 ds_read_b64_tr_b16 a[98:99], v14 offset:42528
 v_mfma_f32_16x16x32_bf16 a[244:247], a[116:119], a[4:7], a[244:247]
 ds_read_b64_tr_b16 a[100:101], v23 offset:32
 v_mfma_f32_16x16x32_bf16 a[244:247], a[112:115], v[116:119], a[244:247]
 ds_read_b64_tr_b16 a[102:103], v23 offset:288
 buffer_load_dwordx4 v63, s[40:43], s78 offen offset:1024 lds
 v_mfma_f32_16x16x32_bf16 a[248:251], a[112:115], v[120:123], a[248:251]
 s_xor_b32 s78, s3, 2
 s_add_u32 m0, s67, 25088
 s_lshl_b32 s78, s78, 7
 v_mfma_f32_16x16x32_bf16 a[248:251], a[116:119], a[8:11], a[248:251]
 v_mfma_f32_16x16x32_bf16 a[252:255], a[116:119], a[12:15], a[252:255]
 v_mfma_f32_16x16x32_bf16 a[252:255], a[112:115], v[124:127], a[252:255]
 s_waitcnt vmcnt(35) lgkmcnt(4)
 v_mfma_f32_16x16x32_bf16 a[128:131], a[80:83], a[16:19], a[128:131]
 ds_read_b64_tr_b16 a[112:113], v14 offset:42304
 buffer_load_dwordx4 v62, s[40:43], s78 offen offset:0 lds
 v_mfma_f32_16x16x32_bf16 a[128:131], a[84:87], a[32:35], a[128:131]
 ds_read_b64_tr_b16 a[114:115], v14 offset:42560
 v_mfma_f32_16x16x32_bf16 a[132:135], a[84:87], a[36:39], a[132:135]
 ds_read_b64_tr_b16 a[116:117], v23 offset:64
 v_mfma_f32_16x16x32_bf16 a[132:135], a[80:83], a[20:23], a[132:135]
 ds_read_b64_tr_b16 a[118:119], v23 offset:320
 v_mfma_f32_16x16x32_bf16 a[136:139], a[80:83], a[24:27], a[136:139]
 v_mfma_f32_16x16x32_bf16 a[136:139], a[84:87], a[40:43], a[136:139]
 buffer_load_dwordx4 v63, s[40:43], s78 offen offset:1024 lds
 s_xor_b32 s78, s3, 0
 v_mfma_f32_16x16x32_bf16 a[140:143], a[84:87], a[44:47], a[140:143]
 s_add_u32 m0, s67, 0
 s_lshl_b32 s78, s78, 7
 v_mfma_f32_16x16x32_bf16 a[140:143], a[80:83], a[28:31], a[140:143]
 s_waitcnt lgkmcnt(4)
 v_mfma_f32_16x16x32_bf16 a[144:147], a[96:99], a[16:19], a[144:147]
 ds_read_b64_tr_b16 a[80:81], v14 offset:42336
 s_lshl_b32 s72, s63, 2
 v_mfma_f32_16x16x32_bf16 a[144:147], a[100:103], a[32:35], a[144:147]
 ds_read_b64_tr_b16 a[82:83], v14 offset:42592
 s_add_u32 s72, s72, s65
 v_mfma_f32_16x16x32_bf16 a[148:151], a[100:103], a[36:39], a[148:151]
 ds_read_b64_tr_b16 a[84:85], v23 offset:96
 buffer_load_dwordx4 v60, s[40:43], s78 offen offset:0 lds
 v_mfma_f32_16x16x32_bf16 a[148:151], a[96:99], a[20:23], a[148:151]
 ds_read_b64_tr_b16 a[86:87], v23 offset:352
 s_lshl_b32 s72, s72, 2
 v_mfma_f32_16x16x32_bf16 a[152:155], a[96:99], a[24:27], a[152:155]
 s_add_u32 s72, s72, s60
 s_lshl_b32 s72, s72, 8
 s_add_u32 s72, s72, L_tail0-L_pc
 v_mfma_f32_16x16x32_bf16 a[152:155], a[100:103], a[40:43], a[152:155]
 v_and_b32 v56, 1, v0
 v_lshl_add_u32 v56, v56, 7, s72
 v_mfma_f32_16x16x32_bf16 a[156:159], a[100:103], a[44:47], a[156:159]
 buffer_load_dwordx4 v61, s[40:43], s78 offen offset:1024 lds
 s_xor_b32 s78, s3, 1
 v_mfma_f32_16x16x32_bf16 a[156:159], a[96:99], a[28:31], a[156:159]
 s_add_u32 m0, s67, 50688
 s_lshl_b32 s78, s78, 7
 s_waitcnt lgkmcnt(4)
 v_mfma_f32_16x16x32_bf16 a[160:163], a[112:115], a[16:19], a[160:163]
 ds_read_b64_tr_b16 a[96:97], v14 offset:42368
 v_min_u32 v56, L_end-L_pc-4, v56
 v_mfma_f32_16x16x32_bf16 a[160:163], a[116:119], a[32:35], a[160:163]
 ds_read_b64_tr_b16 a[98:99], v14 offset:42624
 v_mfma_f32_16x16x32_bf16 a[164:167], a[116:119], a[36:39], a[164:167]
 ds_read_b64_tr_b16 a[100:101], v23 offset:128
 v_mfma_f32_16x16x32_bf16 a[164:167], a[112:115], a[20:23], a[164:167]
 ds_read_b64_tr_b16 a[102:103], v23 offset:384
 global_load_dword v57, v56, s[18:19]
 v_mfma_f32_16x16x32_bf16 a[168:171], a[112:115], a[24:27], a[168:171]
 v_mfma_f32_16x16x32_bf16 a[168:171], a[116:119], a[40:43], a[168:171]
 buffer_load_dwordx4 v60, s[40:43], s78 offen offset:0 lds
 v_mfma_f32_16x16x32_bf16 a[172:175], a[116:119], a[44:47], a[172:175]
 v_mfma_f32_16x16x32_bf16 a[172:175], a[112:115], a[28:31], a[172:175]
 s_waitcnt lgkmcnt(4)
 v_mfma_f32_16x16x32_bf16 a[176:179], a[80:83], a[16:19], a[176:179]
 ds_read_b64_tr_b16 a[112:113], v14 offset:42400
 v_mfma_f32_16x16x32_bf16 a[176:179], a[84:87], a[32:35], a[176:179]
 ds_read_b64_tr_b16 a[114:115], v14 offset:42656
 v_mfma_f32_16x16x32_bf16 a[180:183], a[84:87], a[36:39], a[180:183]
 ds_read_b64_tr_b16 a[116:117], v23 offset:160
 buffer_load_dwordx4 v61, s[40:43], s78 offen offset:1024 lds
 v_mfma_f32_16x16x32_bf16 a[180:183], a[80:83], a[20:23], a[180:183]
 ds_read_b64_tr_b16 a[118:119], v23 offset:416
 s_xor_b32 s78, s3, 2
 v_mfma_f32_16x16x32_bf16 a[184:187], a[80:83], a[24:27], a[184:187]
 s_add_u32 m0, s67, 16896
 s_lshl_b32 s78, s78, 7
 v_mfma_f32_16x16x32_bf16 a[184:187], a[84:87], a[40:43], a[184:187]
 v_mfma_f32_16x16x32_bf16 a[188:191], a[84:87], a[44:47], a[188:191]
 v_mfma_f32_16x16x32_bf16 a[188:191], a[80:83], a[28:31], a[188:191]
 global_load_dwordx2 v[56:57], v20, s[14:15]
 s_waitcnt lgkmcnt(4)
 v_mfma_f32_16x16x32_bf16 a[192:195], a[96:99], a[16:19], a[192:195]
 ds_read_b64_tr_b16 a[80:81], v14 offset:42432
 v_mfma_f32_16x16x32_bf16 a[192:195], a[100:103], a[32:35], a[192:195]
 ds_read_b64_tr_b16 a[82:83], v14 offset:42688
 global_load_dwordx2 v[58:59], v20, s[20:21]
 v_mfma_f32_16x16x32_bf16 a[196:199], a[100:103], a[36:39], a[196:199]
 ds_read_b64_tr_b16 a[84:85], v23 offset:192
 s_mov_b32 s72, 0
 v_mfma_f32_16x16x32_bf16 a[196:199], a[96:99], a[20:23], a[196:199]
 ds_read_b64_tr_b16 a[86:87], v23 offset:448
 buffer_load_dwordx2 v[40:41], v75, s[24:27], s72 offen
 v_mfma_f32_16x16x32_bf16 a[200:203], a[96:99], a[24:27], a[200:203]
 s_mov_b32 s72, 32768
 v_mfma_f32_16x16x32_bf16 a[200:203], a[100:103], a[40:43], a[200:203]
 buffer_load_dwordx2 v[42:43], v75, s[24:27], s72 offen
 s_mov_b32 s72, 65536
 v_mfma_f32_16x16x32_bf16 a[204:207], a[100:103], a[44:47], a[204:207]
 v_mfma_f32_16x16x32_bf16 a[204:207], a[96:99], a[28:31], a[204:207]
 buffer_load_dwordx2 v[44:45], v75, s[24:27], s72 offen
 s_waitcnt lgkmcnt(4)
 v_mfma_f32_16x16x32_bf16 a[208:211], a[112:115], a[16:19], a[208:211]
 ds_read_b64_tr_b16 a[96:97], v14 offset:42464
 s_mov_b32 s72, 98304
 v_mfma_f32_16x16x32_bf16 a[208:211], a[116:119], a[32:35], a[208:211]
 ds_read_b64_tr_b16 a[98:99], v14 offset:42720
 buffer_load_dwordx2 v[46:47], v75, s[24:27], s72 offen
 v_mfma_f32_16x16x32_bf16 a[212:215], a[116:119], a[36:39], a[212:215]
 ds_read_b64_tr_b16 a[100:101], v23 offset:224
 s_mov_b32 s72, 4096
 v_mfma_f32_16x16x32_bf16 a[212:215], a[112:115], a[20:23], a[212:215]
 ds_read_b64_tr_b16 a[102:103], v23 offset:480
 buffer_load_dwordx2 v[48:49], v75, s[24:27], s72 offen
 v_mfma_f32_16x16x32_bf16 a[216:219], a[112:115], a[24:27], a[216:219]
 s_mov_b32 s72, 36864
 v_mfma_f32_16x16x32_bf16 a[216:219], a[116:119], a[40:43], a[216:219]
 buffer_load_dwordx2 v[50:51], v75, s[24:27], s72 offen
 s_mov_b32 s72, 69632
 v_mfma_f32_16x16x32_bf16 a[220:223], a[116:119], a[44:47], a[220:223]
 v_mfma_f32_16x16x32_bf16 a[220:223], a[112:115], a[28:31], a[220:223]
 s_waitcnt vmcnt(63) lgkmcnt(4)
 s_barrier
 v_mfma_f32_16x16x32_bf16 a[224:227], a[80:83], a[16:19], a[224:227]
 ds_read_b64_tr_b16 a[112:113], v23 offset:8448
 buffer_load_dwordx2 v[52:53], v75, s[24:27], s72 offen
 v_mfma_f32_16x16x32_bf16 a[224:227], a[84:87], a[32:35], a[224:227]
 ds_read_b64_tr_b16 a[114:115], v23 offset:8704
 s_mov_b32 s72, 102400
 v_mfma_f32_16x16x32_bf16 a[228:231], a[84:87], a[36:39], a[228:231]
 ds_read_b64_tr_b16 a[116:117], v23 offset:16896
 buffer_load_dwordx2 v[54:55], v75, s[24:27], s72 offen
 v_mfma_f32_16x16x32_bf16 a[228:231], a[80:83], a[20:23], a[228:231]
 ds_read_b64_tr_b16 a[118:119], v23 offset:17152
 v_mfma_f32_16x16x32_bf16 a[232:235], a[80:83], a[24:27], a[232:235]
 buffer_load_dword v13, v25, s[48:51], s101 offen sc1
 v_mfma_f32_16x16x32_bf16 a[232:235], a[84:87], a[40:43], a[232:235]
 v_mfma_f32_16x16x32_bf16 a[236:239], a[84:87], a[44:47], a[236:239]
 buffer_load_dwordx4 v60, s[40:43], s78 offen offset:0 lds
 v_mfma_f32_16x16x32_bf16 a[236:239], a[80:83], a[28:31], a[236:239]
 s_waitcnt lgkmcnt(4)
 v_mfma_f32_16x16x32_bf16 a[240:243], a[96:99], a[16:19], a[240:243]
 ds_read_b64_tr_b16 a[80:81], v23 offset:8480
 v_mfma_f32_16x16x32_bf16 a[240:243], a[100:103], a[32:35], a[240:243]
 ds_read_b64_tr_b16 a[82:83], v23 offset:8736
 v_mfma_f32_16x16x32_bf16 a[244:247], a[100:103], a[36:39], a[244:247]
 ds_read_b64_tr_b16 a[84:85], v23 offset:16928
 buffer_load_dwordx4 v61, s[40:43], s78 offen offset:1024 lds
 v_mfma_f32_16x16x32_bf16 a[244:247], a[96:99], a[20:23], a[244:247]
 ds_read_b64_tr_b16 a[86:87], v23 offset:17184
 s_xor_b32 s78, s3, 3
 v_mfma_f32_16x16x32_bf16 a[248:251], a[96:99], a[24:27], a[248:251]
 s_add_u32 m0, s67, 92672
 s_lshl_b32 s78, s78, 7
 v_mfma_f32_16x16x32_bf16 a[248:251], a[100:103], a[40:43], a[248:251]
 v_mfma_f32_16x16x32_bf16 a[252:255], a[100:103], a[44:47], a[252:255]
 v_mfma_f32_16x16x32_bf16 a[252:255], a[96:99], a[28:31], a[252:255]
 buffer_load_dwordx4 v62, s[40:43], s78 offen offset:0 lds
 s_waitcnt vmcnt(45) lgkmcnt(4)
 v_mfma_f32_16x16x32_bf16 a[128:131], a[112:115], v[176:179], a[128:131]
 ds_read_b64_tr_b16 a[96:97], v23 offset:8512
 v_mfma_f32_16x16x32_bf16 a[128:131], a[116:119], v[192:195], a[128:131]
 ds_read_b64_tr_b16 a[98:99], v23 offset:8768
 v_mfma_f32_16x16x32_bf16 a[132:135], a[116:119], v[196:199], a[132:135]
 ds_read_b64_tr_b16 a[100:101], v23 offset:16960
 v_mfma_f32_16x16x32_bf16 a[132:135], a[112:115], v[180:183], a[132:135]
 ds_read_b64_tr_b16 a[102:103], v23 offset:17216
 v_mfma_f32_16x16x32_bf16 a[136:139], a[112:115], v[184:187], a[136:139]
 buffer_load_dwordx4 v63, s[40:43], s78 offen offset:1024 lds
 v_mfma_f32_16x16x32_bf16 a[136:139], a[116:119], v[200:203], a[136:139]
 v_mfma_f32_16x16x32_bf16 a[140:143], a[116:119], v[204:207], a[140:143]
 v_mfma_f32_16x16x32_bf16 a[140:143], a[112:115], v[188:191], a[140:143]
 s_waitcnt lgkmcnt(4)
 v_mfma_f32_16x16x32_bf16 a[144:147], a[80:83], v[176:179], a[144:147]
 ds_read_b64_tr_b16 a[112:113], v23 offset:8544
 v_mfma_f32_16x16x32_bf16 a[144:147], a[84:87], v[192:195], a[144:147]
 ds_read_b64_tr_b16 a[114:115], v23 offset:8800
 v_mfma_f32_16x16x32_bf16 a[148:151], a[84:87], v[196:199], a[148:151]
 ds_read_b64_tr_b16 a[116:117], v23 offset:16992
 v_mfma_f32_16x16x32_bf16 a[148:151], a[80:83], v[180:183], a[148:151]
 ds_read_b64_tr_b16 a[118:119], v23 offset:17248
 v_mfma_f32_16x16x32_bf16 a[152:155], a[80:83], v[184:187], a[152:155]
 v_mfma_f32_16x16x32_bf16 a[152:155], a[84:87], v[200:203], a[152:155]
 s_waitcnt vmcnt(4)
 v_cmp_gt_u32 vcc, 4, v13
 s_cbranch_vccnz L_slow_16
L_back_18:
 v_mfma_f32_16x16x32_bf16 a[156:159], a[84:87], v[204:207], a[156:159]
 s_xor_b32 s2, s3, 0
 s_lshl_b32 s2, s2, 13
 s_add_u32 s2, s2, 114688
 v_mfma_f32_16x16x32_bf16 a[156:159], a[80:83], v[188:191], a[156:159]
 buffer_load_dwordx4 v[160:163], v19, s[48:51], s2 offen offset:0 sc1
 s_waitcnt lgkmcnt(4)
 v_mfma_f32_16x16x32_bf16 a[160:163], a[96:99], v[176:179], a[160:163]
 ds_read_b64_tr_b16 a[80:81], v23 offset:8576
 v_mfma_f32_16x16x32_bf16 a[160:163], a[100:103], v[192:195], a[160:163]
 ds_read_b64_tr_b16 a[82:83], v23 offset:8832
 v_mfma_f32_16x16x32_bf16 a[164:167], a[100:103], v[196:199], a[164:167]
 ds_read_b64_tr_b16 a[84:85], v23 offset:17024
 v_mfma_f32_16x16x32_bf16 a[164:167], a[96:99], v[180:183], a[164:167]
 ds_read_b64_tr_b16 a[86:87], v23 offset:17280
 buffer_load_dwordx4 v[164:167], v19, s[48:51], s2 offen offset:1024 sc1
 v_mfma_f32_16x16x32_bf16 a[168:171], a[96:99], v[184:187], a[168:171]
 s_add_u32 s2, s2, 4096
 v_mfma_f32_16x16x32_bf16 a[168:171], a[100:103], v[200:203], a[168:171]
 v_mfma_f32_16x16x32_bf16 a[172:175], a[100:103], v[204:207], a[172:175]
 v_mfma_f32_16x16x32_bf16 a[172:175], a[96:99], v[188:191], a[172:175]
 s_waitcnt lgkmcnt(4)
 v_mfma_f32_16x16x32_bf16 a[176:179], a[112:115], v[176:179], a[176:179]
 ds_read_b64_tr_b16 a[96:97], v23 offset:8608
 buffer_load_dwordx4 v[168:171], v19, s[48:51], s2 offen offset:0 sc1
 v_mfma_f32_16x16x32_bf16 a[176:179], a[116:119], v[192:195], a[176:179]
 ds_read_b64_tr_b16 a[98:99], v23 offset:8864
 v_mfma_f32_16x16x32_bf16 a[180:183], a[116:119], v[196:199], a[180:183]
 ds_read_b64_tr_b16 a[100:101], v23 offset:17056
 v_mfma_f32_16x16x32_bf16 a[180:183], a[112:115], v[180:183], a[180:183]
 ds_read_b64_tr_b16 a[102:103], v23 offset:17312
 v_mfma_f32_16x16x32_bf16 a[184:187], a[112:115], v[184:187], a[184:187]
 v_mfma_f32_16x16x32_bf16 a[184:187], a[116:119], v[200:203], a[184:187]
 buffer_load_dwordx4 v[172:175], v19, s[48:51], s2 offen offset:1024 sc1
 s_xor_b32 s2, s3, 1
 v_mfma_f32_16x16x32_bf16 a[188:191], a[116:119], v[204:207], a[188:191]
 s_lshl_b32 s2, s2, 13
 s_add_u32 s2, s2, 114688
 v_mfma_f32_16x16x32_bf16 a[188:191], a[112:115], v[188:191], a[188:191]
 s_waitcnt lgkmcnt(4)
 v_mfma_f32_16x16x32_bf16 a[192:195], a[80:83], v[176:179], a[192:195]
 ds_read_b64_tr_b16 a[112:113], v23 offset:8640
 v_mfma_f32_16x16x32_bf16 a[192:195], a[84:87], v[192:195], a[192:195]
 ds_read_b64_tr_b16 a[114:115], v23 offset:8896
 v_mfma_f32_16x16x32_bf16 a[196:199], a[84:87], v[196:199], a[196:199]
 ds_read_b64_tr_b16 a[116:117], v23 offset:17088
 buffer_load_dwordx4 a[48:51], v19, s[48:51], s2 offen offset:0 sc1
 v_mfma_f32_16x16x32_bf16 a[196:199], a[80:83], v[180:183], a[196:199]
 ds_read_b64_tr_b16 a[118:119], v23 offset:17344
 v_mfma_f32_16x16x32_bf16 a[200:203], a[80:83], v[184:187], a[200:203]
 v_mfma_f32_16x16x32_bf16 a[200:203], a[84:87], v[200:203], a[200:203]
 v_mfma_f32_16x16x32_bf16 a[204:207], a[84:87], v[204:207], a[204:207]
 buffer_load_dwordx4 a[52:55], v19, s[48:51], s2 offen offset:1024 sc1
 s_add_u32 s2, s2, 4096
 v_mfma_f32_16x16x32_bf16 a[204:207], a[80:83], v[188:191], a[204:207]
 s_waitcnt lgkmcnt(4)
 v_mfma_f32_16x16x32_bf16 a[208:211], a[96:99], v[176:179], a[208:211]
 ds_read_b64_tr_b16 a[80:81], v23 offset:8672
 v_mfma_f32_16x16x32_bf16 a[208:211], a[100:103], v[192:195], a[208:211]
 ds_read_b64_tr_b16 a[82:83], v23 offset:8928
 v_mfma_f32_16x16x32_bf16 a[212:215], a[100:103], v[196:199], a[212:215]
 ds_read_b64_tr_b16 a[84:85], v23 offset:17120
 v_mfma_f32_16x16x32_bf16 a[212:215], a[96:99], v[180:183], a[212:215]
 ds_read_b64_tr_b16 a[86:87], v23 offset:17376
 buffer_load_dwordx4 a[56:59], v19, s[48:51], s2 offen offset:0 sc1
 v_mfma_f32_16x16x32_bf16 a[216:219], a[96:99], v[184:187], a[216:219]
 v_mfma_f32_16x16x32_bf16 a[216:219], a[100:103], v[200:203], a[216:219]
 v_mfma_f32_16x16x32_bf16 a[220:223], a[100:103], v[204:207], a[220:223]
 v_mfma_f32_16x16x32_bf16 a[220:223], a[96:99], v[188:191], a[220:223]
 s_waitcnt vmcnt(46) lgkmcnt(4)
 s_barrier
 v_mfma_f32_16x16x32_bf16 a[224:227], a[112:115], v[176:179], a[224:227]
 ds_read_b64_tr_b16 a[96:97], v23 offset:25344
 buffer_load_dwordx4 a[60:63], v19, s[48:51], s2 offen offset:1024 sc1
 v_mfma_f32_16x16x32_bf16 a[224:227], a[116:119], v[192:195], a[224:227]
 ds_read_b64_tr_b16 a[98:99], v23 offset:25600
 s_xor_b32 s78, s3, 0
 v_mfma_f32_16x16x32_bf16 a[228:231], a[116:119], v[196:199], a[228:231]
 ds_read_b64_tr_b16 a[100:101], v22 offset:16896
 s_add_u32 m0, s67, 41984
 v_mfma_f32_16x16x32_bf16 a[228:231], a[112:115], v[180:183], a[228:231]
 ds_read_b64_tr_b16 a[102:103], v22 offset:17152
 s_lshl_b32 s78, s78, 7
 v_mfma_f32_16x16x32_bf16 a[232:235], a[112:115], v[184:187], a[232:235]
 ds_read_b64_tr_b16 a[104:105], v22 offset:25344
 s_xor_b32 s2, s3, 2
 v_mfma_f32_16x16x32_bf16 a[232:235], a[116:119], v[200:203], a[232:235]
 ds_read_b64_tr_b16 a[106:107], v22 offset:25600
 buffer_load_dwordx4 v62, s[44:47], s78 offen offset:0 lds
 v_mfma_f32_16x16x32_bf16 a[236:239], a[116:119], v[204:207], a[236:239]
 s_lshl_b32 s2, s2, 13
 s_add_u32 s2, s2, 114688
 v_mfma_f32_16x16x32_bf16 a[236:239], a[112:115], v[188:191], a[236:239]
 s_waitcnt lgkmcnt(6)
 v_mfma_f32_16x16x32_bf16 a[240:243], a[80:83], v[176:179], a[240:243]
 ds_read_b64_tr_b16 a[112:113], v23 offset:25376
 v_mfma_f32_16x16x32_bf16 a[240:243], a[84:87], v[192:195], a[240:243]
 ds_read_b64_tr_b16 a[114:115], v23 offset:25632
 buffer_load_dwordx4 a[64:67], v19, s[48:51], s2 offen offset:0 sc1
 v_mfma_f32_16x16x32_bf16 a[244:247], a[84:87], v[196:199], a[244:247]
 ds_read_b64_tr_b16 a[116:117], v22 offset:16928
 v_mfma_f32_16x16x32_bf16 a[244:247], a[80:83], v[180:183], a[244:247]
 ds_read_b64_tr_b16 a[118:119], v22 offset:17184
 v_mfma_f32_16x16x32_bf16 a[248:251], a[80:83], v[184:187], a[248:251]
 ds_read_b64_tr_b16 a[120:121], v22 offset:25376
 v_mfma_f32_16x16x32_bf16 a[248:251], a[84:87], v[200:203], a[248:251]
 ds_read_b64_tr_b16 a[122:123], v22 offset:25632
 v_mfma_f32_16x16x32_bf16 a[252:255], a[84:87], v[204:207], a[252:255]
 buffer_load_dwordx4 a[68:71], v19, s[48:51], s2 offen offset:1024 sc1
 s_add_u32 s2, s2, 4096
 v_mfma_f32_16x16x32_bf16 a[252:255], a[80:83], v[188:191], a[252:255]
 s_waitcnt vmcnt(38) lgkmcnt(6)
 v_mfma_f32_16x16x32_bf16 a[128:131], a[96:99], v[208:211], a[128:131]
 ds_read_b64_tr_b16 a[80:81], v23 offset:25408
 v_mfma_f32_16x16x32_bf16 a[128:131], a[100:103], v[224:227], a[128:131]
 ds_read_b64_tr_b16 a[82:83], v23 offset:25664
 v_mfma_f32_16x16x32_bf16 a[128:131], a[104:107], v[240:243], a[128:131]
 ds_read_b64_tr_b16 a[84:85], v22 offset:16960
 v_mfma_f32_16x16x32_bf16 a[132:135], a[104:107], v[244:247], a[132:135]
 ds_read_b64_tr_b16 a[86:87], v22 offset:17216
 buffer_load_dwordx4 a[72:75], v19, s[48:51], s2 offen offset:0 sc1
 v_mfma_f32_16x16x32_bf16 a[132:135], a[100:103], v[228:231], a[132:135]
 ds_read_b64_tr_b16 a[88:89], v22 offset:25408
 v_mfma_f32_16x16x32_bf16 a[132:135], a[96:99], v[212:215], a[132:135]
 ds_read_b64_tr_b16 a[90:91], v22 offset:25664
 v_mfma_f32_16x16x32_bf16 a[136:139], a[96:99], v[216:219], a[136:139]
 v_mfma_f32_16x16x32_bf16 a[136:139], a[100:103], v[232:235], a[136:139]
 v_mfma_f32_16x16x32_bf16 a[136:139], a[104:107], v[248:251], a[136:139]
 buffer_load_dwordx4 a[76:79], v19, s[48:51], s2 offen offset:1024 sc1
 s_xor_b32 s2, s3, 3
 v_mfma_f32_16x16x32_bf16 a[140:143], a[104:107], v[252:255], a[140:143]
L_pad10:
 s_cbranch_execz L_pad14
 s_lshl_b32 s2, s2, 13
 s_add_u32 s2, s2, 114688
 v_mfma_f32_16x16x32_bf16 a[140:143], a[100:103], v[236:239], a[140:143]
 v_mfma_f32_16x16x32_bf16 a[140:143], a[96:99], v[220:223], a[140:143]
 s_waitcnt lgkmcnt(6)
 v_mfma_f32_16x16x32_bf16 a[144:147], a[112:115], v[208:211], a[144:147]
 ds_read_b64_tr_b16 a[96:97], v23 offset:25440
 buffer_load_dwordx4 v[128:131], v19, s[48:51], s2 offen offset:0 sc1
 v_mfma_f32_16x16x32_bf16 a[144:147], a[116:119], v[224:227], a[144:147]
 ds_read_b64_tr_b16 a[98:99], v23 offset:25696
 v_mfma_f32_16x16x32_bf16 a[144:147], a[120:123], v[240:243], a[144:147]
 ds_read_b64_tr_b16 a[100:101], v22 offset:16992
 v_mfma_f32_16x16x32_bf16 a[148:151], a[120:123], v[244:247], a[148:151]
 ds_read_b64_tr_b16 a[102:103], v22 offset:17248
 v_mfma_f32_16x16x32_bf16 a[148:151], a[116:119], v[228:231], a[148:151]
 ds_read_b64_tr_b16 a[104:105], v22 offset:25440
 v_mfma_f32_16x16x32_bf16 a[148:151], a[112:115], v[212:215], a[148:151]
 ds_read_b64_tr_b16 a[106:107], v22 offset:25696
 buffer_load_dwordx4 v[132:135], v19, s[48:51], s2 offen offset:1024 sc1
 v_mfma_f32_16x16x32_bf16 a[152:155], a[112:115], v[216:219], a[152:155]
 s_add_u32 s2, s2, 4096
 v_mfma_f32_16x16x32_bf16 a[152:155], a[116:119], v[232:235], a[152:155]
 v_mfma_f32_16x16x32_bf16 a[152:155], a[120:123], v[248:251], a[152:155]
 v_mfma_f32_16x16x32_bf16 a[156:159], a[120:123], v[252:255], a[156:159]
 v_mfma_f32_16x16x32_bf16 a[156:159], a[116:119], v[236:239], a[156:159]
 buffer_load_dwordx4 v[136:139], v19, s[48:51], s2 offen offset:0 sc1
 v_mfma_f32_16x16x32_bf16 a[156:159], a[112:115], v[220:223], a[156:159]
 s_waitcnt lgkmcnt(6)
 v_mfma_f32_16x16x32_bf16 a[160:163], a[80:83], v[208:211], a[160:163]
 ds_read_b64_tr_b16 a[112:113], v23 offset:25472
 v_mfma_f32_16x16x32_bf16 a[160:163], a[84:87], v[224:227], a[160:163]
 ds_read_b64_tr_b16 a[114:115], v23 offset:25728
 v_mfma_f32_16x16x32_bf16 a[160:163], a[88:91], v[240:243], a[160:163]
 ds_read_b64_tr_b16 a[116:117], v22 offset:17024
 v_mfma_f32_16x16x32_bf16 a[164:167], a[88:91], v[244:247], a[164:167]
 ds_read_b64_tr_b16 a[118:119], v22 offset:17280
 buffer_load_dwordx4 v[140:143], v19, s[48:51], s2 offen offset:1024 sc1
 v_mfma_f32_16x16x32_bf16 a[164:167], a[84:87], v[228:231], a[164:167]
 ds_read_b64_tr_b16 a[120:121], v22 offset:25472
 s_xor_b32 s2, s3, 0
 v_mfma_f32_16x16x32_bf16 a[164:167], a[80:83], v[212:215], a[164:167]
 ds_read_b64_tr_b16 a[122:123], v22 offset:25728
 s_lshl_b32 s2, s2, 13
 v_mfma_f32_16x16x32_bf16 a[168:171], a[80:83], v[216:219], a[168:171]
 s_add_u32 s2, s2, 147456
 v_mfma_f32_16x16x32_bf16 a[168:171], a[84:87], v[232:235], a[168:171]
 buffer_load_dwordx4 v63, s[44:47], s78 offen offset:1024 lds
 v_mfma_f32_16x16x32_bf16 a[168:171], a[88:91], v[248:251], a[168:171]
 v_mfma_f32_16x16x32_bf16 a[172:175], a[88:91], v[252:255], a[172:175]
 v_mfma_f32_16x16x32_bf16 a[172:175], a[84:87], v[236:239], a[172:175]
 v_mfma_f32_16x16x32_bf16 a[172:175], a[80:83], v[220:223], a[172:175]
 s_waitcnt lgkmcnt(6)
 v_mfma_f32_16x16x32_bf16 a[176:179], a[96:99], v[208:211], a[176:179]
 ds_read_b64_tr_b16 a[80:81], v23 offset:25504
 buffer_load_dwordx4 v[80:83], v19, s[48:51], s2 offen offset:0 sc1
 v_mfma_f32_16x16x32_bf16 a[176:179], a[100:103], v[224:227], a[176:179]
 ds_read_b64_tr_b16 a[82:83], v23 offset:25760
 v_mfma_f32_16x16x32_bf16 a[176:179], a[104:107], v[240:243], a[176:179]
 ds_read_b64_tr_b16 a[84:85], v22 offset:17056
 v_mfma_f32_16x16x32_bf16 a[180:183], a[104:107], v[244:247], a[180:183]
 ds_read_b64_tr_b16 a[86:87], v22 offset:17312
 v_mfma_f32_16x16x32_bf16 a[180:183], a[100:103], v[228:231], a[180:183]
 ds_read_b64_tr_b16 a[88:89], v22 offset:25504
 v_mfma_f32_16x16x32_bf16 a[180:183], a[96:99], v[212:215], a[180:183]
 ds_read_b64_tr_b16 a[90:91], v22 offset:25760
 buffer_load_dwordx4 v[84:87], v19, s[48:51], s2 offen offset:1024 sc1
 v_mfma_f32_16x16x32_bf16 a[184:187], a[96:99], v[216:219], a[184:187]
 s_add_u32 s2, s2, 4096
 v_mfma_f32_16x16x32_bf16 a[184:187], a[100:103], v[232:235], a[184:187]
 v_mfma_f32_16x16x32_bf16 a[184:187], a[104:107], v[248:251], a[184:187]
 v_mfma_f32_16x16x32_bf16 a[188:191], a[104:107], v[252:255], a[188:191]
 v_mfma_f32_16x16x32_bf16 a[188:191], a[100:103], v[236:239], a[188:191]
 buffer_load_dwordx4 v[88:91], v19, s[48:51], s2 offen offset:0 sc1
 v_mfma_f32_16x16x32_bf16 a[188:191], a[96:99], v[220:223], a[188:191]
 s_waitcnt lgkmcnt(6)
 v_mfma_f32_16x16x32_bf16 a[192:195], a[112:115], v[208:211], a[192:195]
 ds_read_b64_tr_b16 a[96:97], v23 offset:25536
 v_mfma_f32_16x16x32_bf16 a[192:195], a[116:119], v[224:227], a[192:195]
 ds_read_b64_tr_b16 a[98:99], v23 offset:25792
 v_mfma_f32_16x16x32_bf16 a[192:195], a[120:123], v[240:243], a[192:195]
 ds_read_b64_tr_b16 a[100:101], v22 offset:17088
 buffer_load_dwordx4 v[92:95], v19, s[48:51], s2 offen offset:1024 sc1
 v_mfma_f32_16x16x32_bf16 a[196:199], a[120:123], v[244:247], a[196:199]
 ds_read_b64_tr_b16 a[102:103], v22 offset:17344
 s_xor_b32 s2, s3, 1
 v_mfma_f32_16x16x32_bf16 a[196:199], a[116:119], v[228:231], a[196:199]
 ds_read_b64_tr_b16 a[104:105], v22 offset:25536
 s_lshl_b32 s2, s2, 13
 v_mfma_f32_16x16x32_bf16 a[196:199], a[112:115], v[212:215], a[196:199]
 ds_read_b64_tr_b16 a[106:107], v22 offset:25792
 s_add_u32 s2, s2, 147456
 v_mfma_f32_16x16x32_bf16 a[200:203], a[112:115], v[216:219], a[200:203]
 v_mfma_f32_16x16x32_bf16 a[200:203], a[116:119], v[232:235], a[200:203]
 buffer_load_dwordx4 v[96:99], v19, s[48:51], s2 offen offset:0 sc1
 v_mfma_f32_16x16x32_bf16 a[200:203], a[120:123], v[248:251], a[200:203]
 v_mfma_f32_16x16x32_bf16 a[204:207], a[120:123], v[252:255], a[204:207]
 v_mfma_f32_16x16x32_bf16 a[204:207], a[116:119], v[236:239], a[204:207]
 v_mfma_f32_16x16x32_bf16 a[204:207], a[112:115], v[220:223], a[204:207]
 s_waitcnt lgkmcnt(6)
 v_mfma_f32_16x16x32_bf16 a[208:211], a[80:83], v[208:211], a[208:211]
 ds_read_b64_tr_b16 a[112:113], v23 offset:25568
 buffer_load_dwordx4 v[100:103], v19, s[48:51], s2 offen offset:1024 sc1
 v_mfma_f32_16x16x32_bf16 a[208:211], a[84:87], v[224:227], a[208:211]
 ds_read_b64_tr_b16 a[114:115], v23 offset:25824
 s_add_u32 s2, s2, 4096
 v_mfma_f32_16x16x32_bf16 a[208:211], a[88:91], v[240:243], a[208:211]
 ds_read_b64_tr_b16 a[116:117], v22 offset:17120
 v_mfma_f32_16x16x32_bf16 a[212:215], a[88:91], v[244:247], a[212:215]
 ds_read_b64_tr_b16 a[118:119], v22 offset:17376
 v_mfma_f32_16x16x32_bf16 a[212:215], a[84:87], v[228:231], a[212:215]
 ds_read_b64_tr_b16 a[120:121], v22 offset:25568
 v_mfma_f32_16x16x32_bf16 a[212:215], a[80:83], v[212:215], a[212:215]
 ds_read_b64_tr_b16 a[122:123], v22 offset:25824
 buffer_load_dwordx4 v[104:107], v19, s[48:51], s2 offen offset:0 sc1
 v_mfma_f32_16x16x32_bf16 a[216:219], a[80:83], v[216:219], a[216:219]
 v_mfma_f32_16x16x32_bf16 a[216:219], a[84:87], v[232:235], a[216:219]
 v_mfma_f32_16x16x32_bf16 a[216:219], a[88:91], v[248:251], a[216:219]
 v_mfma_f32_16x16x32_bf16 a[220:223], a[88:91], v[252:255], a[220:223]
 buffer_load_dwordx4 v[108:111], v19, s[48:51], s2 offen offset:1024 sc1
 s_xor_b32 s2, s3, 2
 v_mfma_f32_16x16x32_bf16 a[220:223], a[84:87], v[236:239], a[220:223]
 s_lshl_b32 s2, s2, 13
 s_add_u32 s2, s2, 147456
 v_mfma_f32_16x16x32_bf16 a[220:223], a[80:83], v[220:223], a[220:223]
 s_waitcnt vmcnt(48) lgkmcnt(0)
 s_barrier
 v_mfma_f32_16x16x32_bf16 a[224:227], a[96:99], v[208:211], a[224:227]
 ds_read_b128 a[80:83], v26 offset:8192
 s_xor_b32 s78, s3, 1
 v_mfma_f32_16x16x32_bf16 a[224:227], a[100:103], v[224:227], a[224:227]
 ds_read_b128 a[84:87], v29 offset:8192
 s_add_u32 m0, s67, 109568
 v_mfma_f32_16x16x32_bf16 a[224:227], a[104:107], v[240:243], a[224:227]
 ds_read_b128 a[88:91], v27 offset:8192
 buffer_load_dwordx4 v[144:147], v19, s[48:51], s2 offen offset:0 sc1
 v_mfma_f32_16x16x32_bf16 a[228:231], a[104:107], v[244:247], a[228:231]
 ds_read_b128 a[92:95], v30 offset:8192
 s_lshl_b32 s78, s78, 7
 v_mfma_f32_16x16x32_bf16 a[228:231], a[100:103], v[228:231], a[228:231]
 v_mfma_f32_16x16x32_bf16 a[228:231], a[96:99], v[212:215], a[228:231]
 v_mfma_f32_16x16x32_bf16 a[232:235], a[96:99], v[216:219], a[232:235]
 v_mfma_f32_16x16x32_bf16 a[232:235], a[100:103], v[232:235], a[232:235]
 buffer_load_dwordx4 v62, s[44:47], s78 offen offset:0 lds
 v_mfma_f32_16x16x32_bf16 a[232:235], a[104:107], v[248:251], a[232:235]
 v_mfma_f32_16x16x32_bf16 a[236:239], a[104:107], v[252:255], a[236:239]
 v_mfma_f32_16x16x32_bf16 a[236:239], a[100:103], v[236:239], a[236:239]
 v_mfma_f32_16x16x32_bf16 a[236:239], a[96:99], v[220:223], a[236:239]
 s_waitcnt lgkmcnt(4)
 v_mfma_f32_16x16x32_bf16 a[240:243], a[112:115], v[208:211], a[240:243]
 ds_read_b128 a[96:99], v26 offset:10240
 buffer_load_dwordx4 v63, s[44:47], s78 offen offset:1024 lds
 v_mfma_f32_16x16x32_bf16 a[240:243], a[116:119], v[224:227], a[240:243]
 ds_read_b128 a[100:103], v29 offset:10240
 s_xor_b32 s78, s3, 2
 v_mfma_f32_16x16x32_bf16 a[240:243], a[120:123], v[240:243], a[240:243]
 ds_read_b128 a[104:107], v27 offset:10240
 s_add_u32 m0, s67, 126464
 v_mfma_f32_16x16x32_bf16 a[244:247], a[120:123], v[244:247], a[244:247]
 ds_read_b128 a[108:111], v30 offset:10240
 s_lshl_b32 s78, s78, 7
 v_mfma_f32_16x16x32_bf16 a[244:247], a[116:119], v[228:231], a[244:247]
 buffer_load_dwordx4 v62, s[44:47], s78 offen offset:0 lds
 v_mfma_f32_16x16x32_bf16 a[244:247], a[112:115], v[212:215], a[244:247]
 v_mfma_f32_16x16x32_bf16 a[248:251], a[112:115], v[216:219], a[248:251]
 v_mfma_f32_16x16x32_bf16 a[248:251], a[116:119], v[232:235], a[248:251]
 v_mfma_f32_16x16x32_bf16 a[248:251], a[120:123], v[248:251], a[248:251]
 v_mfma_f32_16x16x32_bf16 a[252:255], a[120:123], v[252:255], a[252:255]
 buffer_load_dwordx4 v63, s[44:47], s78 offen offset:1024 lds
 s_xor_b32 s78, s3, 3
 v_mfma_f32_16x16x32_bf16 a[252:255], a[116:119], v[236:239], a[252:255]
 s_add_u32 m0, s67, 75776
 s_lshl_b32 s78, s78, 7
 v_mfma_f32_16x16x32_bf16 a[252:255], a[112:115], v[220:223], a[252:255]
 s_bitcmp1_b32 s61, 1
 s_cbranch_scc1 L_tail1
L_tail0:
 s_waitcnt vmcnt(23) lgkmcnt(4)
 v_mfma_f32_16x16x32_bf16 a[200:203], a[80:83], v[160:163], a[200:203]
 ds_read_b128 a[112:115], v26 offset:12288
 s_lshl_b32 s68, s100, 14
 v_mfma_f32_16x16x32_bf16 a[200:203], a[84:87], v[168:171], a[200:203]
 ds_read_b128 a[116:119], v29 offset:12288
 v_mov_b32 v1, 1
 v_mfma_f32_16x16x32_bf16 a[200:203], a[88:91], a[48:51], a[200:203]
 ds_read_b128 a[120:123], v27 offset:12288
 buffer_load_dwordx4 v62, s[44:47], s78 offen offset:0 lds
 v_mfma_f32_16x16x32_bf16 a[200:203], a[92:95], a[56:59], a[200:203]
 ds_read_b128 a[124:127], v30 offset:12288
 s_add_u32 s69, s68, 25169920
 v_mfma_f32_16x16x32_bf16 a[204:207], a[92:95], a[60:63], a[204:207]
 s_add_u32 s70, s68, 25174016
 s_add_u32 s71, s68, 25178112
 s_lshl_b32 s68, s100, 7
 v_mfma_f32_16x16x32_bf16 a[204:207], a[88:91], a[52:55], a[204:207]
 s_add_u32 s68, s68, 42041344
 v_mfma_f32_16x16x32_bf16 a[204:207], a[84:87], v[172:175], a[204:207]
 v_mfma_f32_16x16x32_bf16 a[204:207], a[80:83], v[164:167], a[204:207]
 buffer_load_dwordx4 v63, s[44:47], s78 offen offset:1024 lds
 s_waitcnt lgkmcnt(4)
 v_mfma_f32_16x16x32_bf16 a[216:219], a[96:99], v[160:163], a[216:219]
 ds_read_b128 a[80:83], v26 offset:14336
 s_xor_b32 s78, s3, 3
 v_mfma_f32_16x16x32_bf16 a[216:219], a[100:103], v[168:171], a[216:219]
 ds_read_b128 a[84:87], v29 offset:14336
 s_add_u32 m0, s67, 84480
 v_mfma_f32_16x16x32_bf16 a[216:219], a[104:107], a[48:51], a[216:219]
 ds_read_b128 a[88:91], v27 offset:14336
 s_lshl_b32 s78, s78, 7
 v_mfma_f32_16x16x32_bf16 a[216:219], a[108:111], a[56:59], a[216:219]
 ds_read_b128 a[92:95], v30 offset:14336
 buffer_load_dwordx4 v[148:151], v19, s[48:51], s2 offen offset:1024 sc1
 v_mfma_f32_16x16x32_bf16 a[220:223], a[108:111], a[60:63], a[220:223]
 s_add_u32 s2, s2, 4096
 v_mfma_f32_16x16x32_bf16 a[220:223], a[104:107], a[52:55], a[220:223]
 v_mfma_f32_16x16x32_bf16 a[220:223], a[100:103], v[172:175], a[220:223]
 v_mfma_f32_16x16x32_bf16 a[220:223], a[96:99], v[164:167], a[220:223]
 s_waitcnt vmcnt(34) lgkmcnt(4)
 s_barrier
 v_mfma_f32_16x16x32_bf16 a[232:235], a[112:115], v[160:163], a[232:235]
 ds_read_b128 a[96:99], v26 offset:25088
 buffer_load_dwordx4 v[152:155], v19, s[48:51], s2 offen offset:0 sc1
 v_mfma_f32_16x16x32_bf16 a[232:235], a[116:119], v[168:171], a[232:235]
 ds_read_b128 a[100:103], v29 offset:25088
 v_mfma_f32_16x16x32_bf16 a[232:235], a[120:123], a[48:51], a[232:235]
 ds_read_b128 a[104:107], v27 offset:41984
 v_mfma_f32_16x16x32_bf16 a[232:235], a[124:127], a[56:59], a[232:235]
 ds_read_b128 a[108:111], v30 offset:41984
 v_mfma_f32_16x16x32_bf16 a[236:239], a[124:127], a[60:63], a[236:239]
 v_mfma_f32_16x16x32_bf16 a[236:239], a[120:123], a[52:55], a[236:239]
 buffer_load_dwordx4 v[156:159], v19, s[48:51], s2 offen offset:1024 sc1
 s_xor_b32 s2, s3, 3
 v_mfma_f32_16x16x32_bf16 a[236:239], a[116:119], v[172:175], a[236:239]
 s_lshl_b32 s2, s2, 13
 s_add_u32 s2, s2, 147456
 v_mfma_f32_16x16x32_bf16 a[236:239], a[112:115], v[164:167], a[236:239]
 s_waitcnt lgkmcnt(4)
 v_mfma_f32_16x16x32_bf16 a[248:251], a[80:83], v[160:163], a[248:251]
 ds_read_b128 a[112:115], v26 offset:27136
 v_mfma_f32_16x16x32_bf16 a[248:251], a[84:87], v[168:171], a[248:251]
 ds_read_b128 a[116:119], v29 offset:27136
 v_mfma_f32_16x16x32_bf16 a[248:251], a[88:91], a[48:51], a[248:251]
 ds_read_b128 a[120:123], v27 offset:44032
 buffer_load_dwordx4 a[0:3], v19, s[48:51], s2 offen offset:0 sc1
 v_mfma_f32_16x16x32_bf16 a[248:251], a[92:95], a[56:59], a[248:251]
 ds_read_b128 a[124:127], v30 offset:44032
 v_mfma_f32_16x16x32_bf16 a[252:255], a[92:95], a[60:63], a[252:255]
 v_mfma_f32_16x16x32_bf16 a[252:255], a[88:91], a[52:55], a[252:255]
 v_mfma_f32_16x16x32_bf16 a[252:255], a[84:87], v[172:175], a[252:255]
 buffer_load_dwordx4 a[4:7], v19, s[48:51], s2 offen offset:1024 sc1
 s_add_u32 s2, s2, 4096
 v_mfma_f32_16x16x32_bf16 a[252:255], a[80:83], v[164:167], a[252:255]
 s_waitcnt vmcnt(21) lgkmcnt(4)
 v_mfma_f32_16x16x32_bf16 a[200:203], a[96:99], a[64:67], a[200:203]
 ds_read_b128 a[80:83], v26 offset:29184
 v_mfma_f32_16x16x32_bf16 a[200:203], a[100:103], a[72:75], a[200:203]
 ds_read_b128 a[84:87], v29 offset:29184
 v_mfma_f32_16x16x32_bf16 a[200:203], a[104:107], v[128:131], a[200:203]
 ds_read_b128 a[88:91], v27 offset:46080
 v_mfma_f32_16x16x32_bf16 a[200:203], a[108:111], v[136:139], a[200:203]
 ds_read_b128 a[92:95], v30 offset:46080
 buffer_load_dwordx4 a[8:11], v19, s[48:51], s2 offen offset:0 sc1
 v_mfma_f32_16x16x32_bf16 a[204:207], a[108:111], v[140:143], a[204:207]
 v_mfma_f32_16x16x32_bf16 a[204:207], a[104:107], v[132:135], a[204:207]
 v_mfma_f32_16x16x32_bf16 a[204:207], a[100:103], a[76:79], a[204:207]
 v_mfma_f32_16x16x32_bf16 a[204:207], a[96:99], a[68:71], a[204:207]
 s_waitcnt lgkmcnt(4)
 v_mfma_f32_16x16x32_bf16 a[216:219], a[112:115], a[64:67], a[216:219]
 ds_read_b128 a[96:99], v26 offset:31232
 buffer_load_dwordx4 a[12:15], v19, s[48:51], s2 offen offset:1024 sc1
 v_mfma_f32_16x16x32_bf16 a[216:219], a[116:119], a[72:75], a[216:219]
 ds_read_b128 a[100:103], v29 offset:31232
 s_xor_b32 s2, s3, 0
 v_mfma_f32_16x16x32_bf16 a[216:219], a[120:123], v[128:131], a[216:219]
 ds_read_b128 a[104:107], v27 offset:48128
 s_lshl_b32 s2, s2, 13
 v_mfma_f32_16x16x32_bf16 a[216:219], a[124:127], v[136:139], a[216:219]
 ds_read_b128 a[108:111], v30 offset:48128
 s_add_u32 s2, s2, 114688
 v_mfma_f32_16x16x32_bf16 a[220:223], a[124:127], v[140:143], a[220:223]
 v_mfma_f32_16x16x32_bf16 a[220:223], a[120:123], v[132:135], a[220:223]
 buffer_load_dwordx4 v60, s[40:43], s78 offen offset:0 lds
 v_mfma_f32_16x16x32_bf16 a[220:223], a[116:119], a[76:79], a[220:223]
 v_mfma_f32_16x16x32_bf16 a[220:223], a[112:115], a[68:71], a[220:223]
 s_waitcnt vmcnt(12) lgkmcnt(4)
 s_barrier
 v_mfma_f32_16x16x32_bf16 a[232:235], a[80:83], a[64:67], a[232:235]
 ds_read_b128 a[112:115], v26 offset:41984
 v_mfma_f32_16x16x32_bf16 a[232:235], a[84:87], a[72:75], a[232:235]
 ds_read_b128 a[116:119], v29 offset:41984
 buffer_load_dwordx4 v61, s[40:43], s78 offen offset:1024 lds
 v_mfma_f32_16x16x32_bf16 a[232:235], a[88:91], v[128:131], a[232:235]
 ds_read_b128 a[120:123], v28 offset:8192
 s_xor_b32 s78, s3, 0
 v_mfma_f32_16x16x32_bf16 a[232:235], a[92:95], v[136:139], a[232:235]
 ds_read_b128 a[124:127], v31 offset:8192
 s_add_u32 m0, s67, 33792
 v_mfma_f32_16x16x32_bf16 a[236:239], a[92:95], v[140:143], a[236:239]
 s_lshl_b32 s78, s78, 7
 v_mfma_f32_16x16x32_bf16 a[236:239], a[88:91], v[132:135], a[236:239]
 v_mfma_f32_16x16x32_bf16 a[236:239], a[84:87], a[76:79], a[236:239]
 buffer_load_dwordx4 v60, s[44:47], s78 offen offset:0 lds
 v_mfma_f32_16x16x32_bf16 a[236:239], a[80:83], a[68:71], a[236:239]
 s_waitcnt lgkmcnt(4)
 v_mfma_f32_16x16x32_bf16 a[248:251], a[96:99], a[64:67], a[248:251]
 ds_read_b128 a[80:83], v26 offset:44032
 v_mfma_f32_16x16x32_bf16 a[248:251], a[100:103], a[72:75], a[248:251]
 ds_read_b128 a[84:87], v29 offset:44032
 v_mfma_f32_16x16x32_bf16 a[248:251], a[104:107], v[128:131], a[248:251]
 ds_read_b128 a[88:91], v28 offset:10240
 v_mfma_f32_16x16x32_bf16 a[248:251], a[108:111], v[136:139], a[248:251]
 ds_read_b128 a[92:95], v31 offset:10240
 buffer_load_dwordx4 v61, s[44:47], s78 offen offset:1024 lds
 v_mfma_f32_16x16x32_bf16 a[252:255], a[108:111], v[140:143], a[252:255]
 s_xor_b32 s78, s3, 1
 s_add_u32 m0, s67, 101376
 s_lshl_b32 s78, s78, 7
 v_mfma_f32_16x16x32_bf16 a[252:255], a[104:107], v[132:135], a[252:255]
 v_mfma_f32_16x16x32_bf16 a[252:255], a[100:103], a[76:79], a[252:255]
 v_mfma_f32_16x16x32_bf16 a[252:255], a[96:99], a[68:71], a[252:255]
 s_waitcnt vmcnt(18) lgkmcnt(4)
 v_mfma_f32_16x16x32_bf16 a[200:203], a[112:115], v[80:83], a[200:203]
 ds_read_b128 a[96:99], v26 offset:46080
 buffer_load_dwordx4 v60, s[44:47], s78 offen offset:0 lds
 v_mfma_f32_16x16x32_bf16 a[200:203], a[116:119], v[88:91], a[200:203]
 ds_read_b128 a[100:103], v29 offset:46080
 v_mfma_f32_16x16x32_bf16 a[200:203], a[120:123], v[96:99], a[200:203]
 ds_read_b128 a[104:107], v28 offset:12288
 v_mfma_f32_16x16x32_bf16 a[200:203], a[124:127], v[104:107], a[200:203]
 ds_read_b128 a[108:111], v31 offset:12288
 v_mfma_f32_16x16x32_bf16 a[204:207], a[124:127], v[108:111], a[204:207]
 buffer_load_dwordx4 v61, s[44:47], s78 offen offset:1024 lds
 s_xor_b32 s78, s3, 2
 v_mfma_f32_16x16x32_bf16 a[204:207], a[120:123], v[100:103], a[204:207]
 s_add_u32 m0, s67, 118272
 s_lshl_b32 s78, s78, 7
 v_mfma_f32_16x16x32_bf16 a[204:207], a[116:119], v[92:95], a[204:207]
 v_mfma_f32_16x16x32_bf16 a[204:207], a[112:115], v[84:87], a[204:207]
 s_waitcnt lgkmcnt(4)
 v_mfma_f32_16x16x32_bf16 a[216:219], a[80:83], v[80:83], a[216:219]
 ds_read_b128 a[112:115], v26 offset:48128
 v_mfma_f32_16x16x32_bf16 a[216:219], a[84:87], v[88:91], a[216:219]
 ds_read_b128 a[116:119], v29 offset:48128
 buffer_load_dwordx4 v60, s[44:47], s78 offen offset:0 lds
 v_mfma_f32_16x16x32_bf16 a[216:219], a[88:91], v[96:99], a[216:219]
 ds_read_b128 a[120:123], v28 offset:14336
 v_mfma_f32_16x16x32_bf16 a[216:219], a[92:95], v[104:107], a[216:219]
 ds_read_b128 a[124:127], v31 offset:14336
 v_mfma_f32_16x16x32_bf16 a[220:223], a[92:95], v[108:111], a[220:223]
 v_mfma_f32_16x16x32_bf16 a[220:223], a[88:91], v[100:103], a[220:223]
 v_mfma_f32_16x16x32_bf16 a[220:223], a[84:87], v[92:95], a[220:223]
 buffer_load_dwordx4 v61, s[44:47], s78 offen offset:1024 lds
 s_xor_b32 s78, s3, 3
 v_mfma_f32_16x16x32_bf16 a[220:223], a[80:83], v[84:87], a[220:223]
 s_add_u32 m0, s67, 67584
 s_waitcnt vmcnt(15) lgkmcnt(4)
 s_barrier
 v_mfma_f32_16x16x32_bf16 a[232:235], a[96:99], v[80:83], a[232:235]
 ds_read_b128 a[80:83], v28 offset:25088
 s_lshl_b32 s78, s78, 7
 v_mfma_f32_16x16x32_bf16 a[232:235], a[100:103], v[88:91], a[232:235]
 ds_read_b128 a[84:87], v31 offset:25088
 v_mfma_f32_16x16x32_bf16 a[232:235], a[104:107], v[96:99], a[232:235]
 ds_read_b128 a[88:91], v27 offset:25088
 v_mfma_f32_16x16x32_bf16 a[232:235], a[108:111], v[104:107], a[232:235]
 ds_read_b128 a[92:95], v30 offset:25088
 buffer_load_dwordx4 v60, s[44:47], s78 offen offset:0 lds
 v_mfma_f32_16x16x32_bf16 a[236:239], a[108:111], v[108:111], a[236:239]
 v_mfma_f32_16x16x32_bf16 a[236:239], a[104:107], v[100:103], a[236:239]
 v_mfma_f32_16x16x32_bf16 a[236:239], a[100:103], v[92:95], a[236:239]
 v_mfma_f32_16x16x32_bf16 a[236:239], a[96:99], v[84:87], a[236:239]
 buffer_load_dwordx4 v61, s[44:47], s78 offen offset:1024 lds
 s_waitcnt lgkmcnt(4)
 v_mfma_f32_16x16x32_bf16 a[248:251], a[112:115], v[80:83], a[248:251]
 ds_read_b128 a[96:99], v28 offset:27136
 v_mfma_f32_16x16x32_bf16 a[248:251], a[116:119], v[88:91], a[248:251]
 ds_read_b128 a[100:103], v31 offset:27136
 v_mfma_f32_16x16x32_bf16 a[248:251], a[120:123], v[96:99], a[248:251]
 ds_read_b128 a[104:107], v27 offset:27136
 v_mfma_f32_16x16x32_bf16 a[248:251], a[124:127], v[104:107], a[248:251]
 ds_read_b128 a[108:111], v30 offset:27136
 v_mfma_f32_16x16x32_bf16 a[252:255], a[124:127], v[108:111], a[252:255]
 buffer_load_dwordx4 v[112:115], v18, s[48:51], s2 offen offset:0 sc1
 v_mfma_f32_16x16x32_bf16 a[252:255], a[120:123], v[100:103], a[252:255]
 v_mfma_f32_16x16x32_bf16 a[252:255], a[116:119], v[92:95], a[252:255]
 v_mfma_f32_16x16x32_bf16 a[252:255], a[112:115], v[84:87], a[252:255]
 s_waitcnt vmcnt(11) lgkmcnt(4)
 v_mfma_f32_16x16x32_bf16 a[200:203], a[80:83], v[144:147], a[200:203]
 ds_read_b128 a[112:115], v28 offset:29184
 v_mfma_f32_16x16x32_bf16 a[200:203], a[84:87], v[152:155], a[200:203]
 ds_read_b128 a[116:119], v31 offset:29184
 buffer_load_dwordx4 v[116:119], v18, s[48:51], s2 offen offset:1024 sc1
 v_mfma_f32_16x16x32_bf16 a[200:203], a[88:91], a[0:3], a[200:203]
 ds_read_b128 a[120:123], v27 offset:29184
 s_add_u32 s2, s2, 4096
 v_mfma_f32_16x16x32_bf16 a[200:203], a[92:95], a[8:11], a[200:203]
 ds_read_b128 a[124:127], v30 offset:29184
 v_mfma_f32_16x16x32_bf16 a[204:207], a[92:95], a[12:15], a[204:207]
 v_mfma_f32_16x16x32_bf16 a[204:207], a[88:91], a[4:7], a[204:207]
 v_mfma_f32_16x16x32_bf16 a[204:207], a[84:87], v[156:159], a[204:207]
 buffer_load_dwordx4 v[120:123], v18, s[48:51], s2 offen offset:0 sc1
 v_mfma_f32_16x16x32_bf16 a[204:207], a[80:83], v[148:151], a[204:207]
 s_waitcnt lgkmcnt(4)
 v_mfma_f32_16x16x32_bf16 a[216:219], a[96:99], v[144:147], a[216:219]
 ds_read_b128 a[80:83], v28 offset:31232
 v_mfma_f32_16x16x32_bf16 a[216:219], a[100:103], v[152:155], a[216:219]
 ds_read_b128 a[84:87], v31 offset:31232
 v_mfma_f32_16x16x32_bf16 a[216:219], a[104:107], a[0:3], a[216:219]
 ds_read_b128 a[88:91], v27 offset:31232
 buffer_load_dwordx4 v[124:127], v18, s[48:51], s2 offen offset:1024 sc1
 v_mfma_f32_16x16x32_bf16 a[216:219], a[108:111], a[8:11], a[216:219]
 ds_read_b128 a[92:95], v30 offset:31232
 s_xor_b32 s2, s3, 1
 v_mfma_f32_16x16x32_bf16 a[220:223], a[108:111], a[12:15], a[220:223]
 s_lshl_b32 s2, s2, 13
 s_add_u32 s2, s2, 114688
 v_mfma_f32_16x16x32_bf16 a[220:223], a[104:107], a[4:7], a[220:223]
 v_mfma_f32_16x16x32_bf16 a[220:223], a[100:103], v[156:159], a[220:223]
 v_mfma_f32_16x16x32_bf16 a[220:223], a[96:99], v[148:151], a[220:223]
 s_waitcnt vmcnt(63) lgkmcnt(4)
 s_barrier
 v_mfma_f32_16x16x32_bf16 a[232:235], a[112:115], v[144:147], a[232:235]
 ds_read_b128 a[96:99], v26 offset:0
 buffer_load_dwordx4 a[16:19], v18, s[48:51], s2 offen offset:0 sc1
 v_mfma_f32_16x16x32_bf16 a[232:235], a[116:119], v[152:155], a[232:235]
 ds_read_b128 a[100:103], v29 offset:0
 v_mfma_f32_16x16x32_bf16 a[232:235], a[120:123], a[0:3], a[232:235]
 ds_read_b128 a[104:107], v27 offset:0
 v_mfma_f32_16x16x32_bf16 a[232:235], a[124:127], a[8:11], a[232:235]
 ds_read_b128 a[108:111], v30 offset:0
 v_mfma_f32_16x16x32_bf16 a[236:239], a[124:127], a[12:15], a[236:239]
 buffer_load_dwordx4 a[20:23], v18, s[48:51], s2 offen offset:1024 sc1
 s_add_u32 s2, s2, 4096
 v_mfma_f32_16x16x32_bf16 a[236:239], a[120:123], a[4:7], a[236:239]
 v_mfma_f32_16x16x32_bf16 a[236:239], a[116:119], v[156:159], a[236:239]
 v_mfma_f32_16x16x32_bf16 a[236:239], a[112:115], v[148:151], a[236:239]
 s_waitcnt lgkmcnt(4)
 v_mfma_f32_16x16x32_bf16 a[248:251], a[80:83], v[144:147], a[248:251]
 ds_read_b128 a[112:115], v26 offset:2048
 v_mfma_f32_16x16x32_bf16 a[248:251], a[84:87], v[152:155], a[248:251]
 ds_read_b128 a[116:119], v29 offset:2048
 buffer_load_dwordx4 a[24:27], v18, s[48:51], s2 offen offset:0 sc1
 v_mfma_f32_16x16x32_bf16 a[248:251], a[88:91], a[0:3], a[248:251]
 ds_read_b128 a[120:123], v27 offset:2048
 v_mfma_f32_16x16x32_bf16 a[248:251], a[92:95], a[8:11], a[248:251]
 ds_read_b128 a[124:127], v30 offset:2048
 v_mfma_f32_16x16x32_bf16 a[252:255], a[92:95], a[12:15], a[252:255]
 v_mfma_f32_16x16x32_bf16 a[252:255], a[88:91], a[4:7], a[252:255]
 v_mfma_f32_16x16x32_bf16 a[252:255], a[84:87], v[156:159], a[252:255]
 buffer_load_dwordx4 a[28:31], v18, s[48:51], s2 offen offset:1024 sc1
 s_xor_b32 s2, s3, 2
 v_mfma_f32_16x16x32_bf16 a[252:255], a[80:83], v[148:151], a[252:255]
 s_lshl_b32 s2, s2, 13
 s_add_u32 s2, s2, 114688
 s_waitcnt lgkmcnt(4)
 v_mfma_f32_16x16x32_bf16 a[136:139], a[96:99], v[160:163], a[136:139]
 ds_read_b128 a[80:83], v26 offset:4096
 v_mfma_f32_16x16x32_bf16 a[136:139], a[100:103], v[168:171], a[136:139]
 ds_read_b128 a[84:87], v29 offset:4096
 v_mfma_f32_16x16x32_bf16 a[136:139], a[104:107], a[48:51], a[136:139]
 ds_read_b128 a[88:91], v27 offset:4096
 v_mfma_f32_16x16x32_bf16 a[136:139], a[108:111], a[56:59], a[136:139]
 ds_read_b128 a[92:95], v30 offset:4096
 buffer_load_dwordx4 a[32:35], v18, s[48:51], s2 offen offset:0 sc1
 v_mfma_f32_16x16x32_bf16 a[140:143], a[108:111], a[60:63], a[140:143]
 v_mfma_f32_16x16x32_bf16 a[140:143], a[104:107], a[52:55], a[140:143]
 v_mfma_f32_16x16x32_bf16 a[140:143], a[100:103], v[172:175], a[140:143]
 v_mfma_f32_16x16x32_bf16 a[140:143], a[96:99], v[164:167], a[140:143]
 buffer_load_dwordx4 a[36:39], v18, s[48:51], s2 offen offset:1024 sc1
 s_waitcnt lgkmcnt(4)
 v_mfma_f32_16x16x32_bf16 a[152:155], a[112:115], v[160:163], a[152:155]
 ds_read_b128 a[96:99], v26 offset:6144
 s_add_u32 s2, s2, 4096
 v_mfma_f32_16x16x32_bf16 a[152:155], a[116:119], v[168:171], a[152:155]
 ds_read_b128 a[100:103], v29 offset:6144
 s_xor_b32 s82, s100, 3
 v_mfma_f32_16x16x32_bf16 a[152:155], a[120:123], a[48:51], a[152:155]
 ds_read_b128 a[104:107], v27 offset:6144
 s_lshl_b32 s82, s82, 14
 v_mfma_f32_16x16x32_bf16 a[152:155], a[124:127], a[56:59], a[152:155]
 ds_read_b128 a[108:111], v30 offset:6144
 s_add_u32 s82, s82, 25178112
 v_mfma_f32_16x16x32_bf16 a[156:159], a[124:127], a[60:63], a[156:159]
 buffer_load_dwordx4 a[40:43], v18, s[48:51], s2 offen offset:0 sc1
 v_accvgpr_read_b32 v2, a200
 v_mfma_f32_16x16x32_bf16 a[156:159], a[120:123], a[52:55], a[156:159]
 v_accvgpr_read_b32 v3, a201
 v_accvgpr_read_b32 v4, a202
 v_mfma_f32_16x16x32_bf16 a[156:159], a[116:119], v[172:175], a[156:159]
 v_accvgpr_read_b32 v5, a203
 v_accvgpr_read_b32 v6, a216
 v_mfma_f32_16x16x32_bf16 a[156:159], a[112:115], v[164:167], a[156:159]
 s_waitcnt vmcnt(19) lgkmcnt(4)
 s_barrier
 v_mfma_f32_16x16x32_bf16 a[168:171], a[80:83], v[160:163], a[168:171]
 ds_read_b128 a[112:115], v26 offset:16896
 v_accvgpr_read_b32 v7, a217
 v_mfma_f32_16x16x32_bf16 a[168:171], a[84:87], v[168:171], a[168:171]
 ds_read_b128 a[116:119], v29 offset:16896
 buffer_load_dwordx4 a[44:47], v18, s[48:51], s2 offen offset:1024 sc1
 v_mfma_f32_16x16x32_bf16 a[168:171], a[88:91], a[48:51], a[168:171]
 ds_read_b128 a[120:123], v27 offset:33792
 s_xor_b32 s2, s3, 3
 v_mfma_f32_16x16x32_bf16 a[168:171], a[92:95], a[56:59], a[168:171]
 ds_read_b128 a[124:127], v30 offset:33792
 s_lshl_b32 s2, s2, 13
 v_mfma_f32_16x16x32_bf16 a[172:175], a[92:95], a[60:63], a[172:175]
 s_add_u32 s2, s2, 114688
 v_accvgpr_read_b32 v8, a218
 v_mfma_f32_16x16x32_bf16 a[172:175], a[88:91], a[52:55], a[172:175]
 v_accvgpr_read_b32 v9, a219
 v_cvt_pk_bf16_f32 v32, v2, v3
 v_mfma_f32_16x16x32_bf16 a[172:175], a[84:87], v[172:175], a[172:175]
 buffer_load_dwordx4 v[176:179], v18, s[48:51], s2 offen offset:0 sc1
 v_cvt_pk_bf16_f32 v33, v4, v5
 v_mfma_f32_16x16x32_bf16 a[172:175], a[80:83], v[164:167], a[172:175]
 v_cvt_pk_bf16_f32 v34, v6, v7
 s_waitcnt lgkmcnt(4)
 v_mfma_f32_16x16x32_bf16 a[184:187], a[96:99], v[160:163], a[184:187]
 ds_read_b128 a[80:83], v26 offset:18944
 v_cvt_pk_bf16_f32 v35, v8, v9
 v_mfma_f32_16x16x32_bf16 a[184:187], a[100:103], v[168:171], a[184:187]
 ds_read_b128 a[84:87], v29 offset:18944
 v_mfma_f32_16x16x32_bf16 a[184:187], a[104:107], a[48:51], a[184:187]
 ds_read_b128 a[88:91], v27 offset:35840
 buffer_store_dwordx4 v[32:35], v64, s[48:51], s82 offen offset:0 sc1
 v_mfma_f32_16x16x32_bf16 a[184:187], a[108:111], a[56:59], a[184:187]
 ds_read_b128 a[92:95], v30 offset:35840
 v_accvgpr_read_b32 v2, a232
 v_mfma_f32_16x16x32_bf16 a[188:191], a[108:111], a[60:63], a[188:191]
 v_accvgpr_read_b32 v3, a233
 v_accvgpr_read_b32 v4, a234
 v_mfma_f32_16x16x32_bf16 a[188:191], a[104:107], a[52:55], a[188:191]
 v_accvgpr_read_b32 v5, a235
 v_accvgpr_read_b32 v6, a248
 v_mfma_f32_16x16x32_bf16 a[188:191], a[100:103], v[172:175], a[188:191]
 v_accvgpr_read_b32 v7, a249
 v_accvgpr_read_b32 v8, a250
 v_mfma_f32_16x16x32_bf16 a[188:191], a[96:99], v[164:167], a[188:191]
 buffer_load_dwordx4 v[180:183], v18, s[48:51], s2 offen offset:1024 sc1
 s_waitcnt lgkmcnt(4)
 v_mfma_f32_16x16x32_bf16 a[136:139], a[112:115], a[64:67], a[136:139]
 ds_read_b128 a[96:99], v26 offset:20992
 s_add_u32 s2, s2, 4096
 v_mfma_f32_16x16x32_bf16 a[136:139], a[116:119], a[72:75], a[136:139]
 ds_read_b128 a[100:103], v29 offset:20992
 v_accvgpr_read_b32 v9, a251
 v_mfma_f32_16x16x32_bf16 a[136:139], a[120:123], v[128:131], a[136:139]
 ds_read_b128 a[104:107], v27 offset:37888
 v_cvt_pk_bf16_f32 v36, v2, v3
 v_mfma_f32_16x16x32_bf16 a[136:139], a[124:127], v[136:139], a[136:139]
 ds_read_b128 a[108:111], v30 offset:37888
 v_cvt_pk_bf16_f32 v37, v4, v5
 v_mfma_f32_16x16x32_bf16 a[140:143], a[124:127], v[140:143], a[140:143]
L_pad11:
 s_cbranch_execz L_pad15
 buffer_load_dwordx4 v[184:187], v18, s[48:51], s2 offen offset:0 sc1
 v_cvt_pk_bf16_f32 v38, v6, v7
 v_mfma_f32_16x16x32_bf16 a[140:143], a[120:123], v[132:135], a[140:143]
 v_cvt_pk_bf16_f32 v39, v8, v9
 v_mfma_f32_16x16x32_bf16 a[140:143], a[116:119], a[76:79], a[140:143]
 v_mfma_f32_16x16x32_bf16 a[140:143], a[112:115], a[68:71], a[140:143]
 s_waitcnt lgkmcnt(4)
 v_mfma_f32_16x16x32_bf16 a[152:155], a[80:83], a[64:67], a[152:155]
 ds_read_b128 a[112:115], v26 offset:23040
 v_mfma_f32_16x16x32_bf16 a[152:155], a[84:87], a[72:75], a[152:155]
 ds_read_b128 a[116:119], v29 offset:23040
 buffer_store_dwordx4 v[36:39], v64, s[48:51], s82 offen offset:1024 sc1
 v_mfma_f32_16x16x32_bf16 a[152:155], a[88:91], v[128:131], a[152:155]
 ds_read_b128 a[120:123], v27 offset:39936
 v_accvgpr_read_b32 v2, a204
 v_mfma_f32_16x16x32_bf16 a[152:155], a[92:95], v[136:139], a[152:155]
 ds_read_b128 a[124:127], v30 offset:39936
 v_accvgpr_read_b32 v3, a205
 v_mfma_f32_16x16x32_bf16 a[156:159], a[92:95], v[140:143], a[156:159]
 v_accvgpr_read_b32 v4, a206
 v_accvgpr_read_b32 v5, a207
 v_mfma_f32_16x16x32_bf16 a[156:159], a[88:91], v[132:135], a[156:159]
 buffer_load_dwordx4 v[188:191], v18, s[48:51], s2 offen offset:1024 sc1
 s_xor_b32 s2, s3, 0
 v_mfma_f32_16x16x32_bf16 a[156:159], a[84:87], a[76:79], a[156:159]
 s_lshl_b32 s2, s2, 13
 s_add_u32 s2, s2, 147456
 v_accvgpr_read_b32 v6, a220
 v_mfma_f32_16x16x32_bf16 a[156:159], a[80:83], a[68:71], a[156:159]
 s_waitcnt vmcnt(22) lgkmcnt(4)
 s_barrier
 v_mfma_f32_16x16x32_bf16 a[168:171], a[96:99], a[64:67], a[168:171]
 ds_read_b128 a[80:83], v26 offset:33792
 v_accvgpr_read_b32 v7, a221
 v_mfma_f32_16x16x32_bf16 a[168:171], a[100:103], a[72:75], a[168:171]
 ds_read_b128 a[84:87], v29 offset:33792
 v_accvgpr_read_b32 v8, a222
 v_mfma_f32_16x16x32_bf16 a[168:171], a[104:107], v[128:131], a[168:171]
 ds_read_b128 a[88:91], v28 offset:0
 buffer_load_dwordx4 v[192:195], v18, s[48:51], s2 offen offset:0 sc1
 v_mfma_f32_16x16x32_bf16 a[168:171], a[108:111], v[136:139], a[168:171]
 ds_read_b128 a[92:95], v31 offset:0
 v_accvgpr_read_b32 v9, a223
 v_mfma_f32_16x16x32_bf16 a[172:175], a[108:111], v[140:143], a[172:175]
 v_cvt_pk_bf16_f32 v32, v2, v3
 v_cvt_pk_bf16_f32 v33, v4, v5
 v_mfma_f32_16x16x32_bf16 a[172:175], a[104:107], v[132:135], a[172:175]
 v_cvt_pk_bf16_f32 v34, v6, v7
 v_cvt_pk_bf16_f32 v35, v8, v9
 v_mfma_f32_16x16x32_bf16 a[172:175], a[100:103], a[76:79], a[172:175]
 v_mfma_f32_16x16x32_bf16 a[172:175], a[96:99], a[68:71], a[172:175]
 buffer_store_dwordx4 v[32:35], v64, s[48:51], s82 offen offset:2048 sc1
 s_waitcnt lgkmcnt(4)
 v_mfma_f32_16x16x32_bf16 a[184:187], a[112:115], a[64:67], a[184:187]
 ds_read_b128 a[96:99], v26 offset:35840
 v_accvgpr_read_b32 v2, a236
 v_mfma_f32_16x16x32_bf16 a[184:187], a[116:119], a[72:75], a[184:187]
 ds_read_b128 a[100:103], v29 offset:35840
 v_accvgpr_read_b32 v3, a237
 v_mfma_f32_16x16x32_bf16 a[184:187], a[120:123], v[128:131], a[184:187]
 ds_read_b128 a[104:107], v28 offset:2048
 v_accvgpr_read_b32 v4, a238
 v_mfma_f32_16x16x32_bf16 a[184:187], a[124:127], v[136:139], a[184:187]
 ds_read_b128 a[108:111], v31 offset:2048
 v_accvgpr_read_b32 v5, a239
 v_mfma_f32_16x16x32_bf16 a[188:191], a[124:127], v[140:143], a[188:191]
 buffer_load_dwordx4 v[196:199], v18, s[48:51], s2 offen offset:1024 sc1
 s_add_u32 s2, s2, 4096
 v_mfma_f32_16x16x32_bf16 a[188:191], a[120:123], v[132:135], a[188:191]
 v_accvgpr_read_b32 v6, a252
 v_accvgpr_read_b32 v7, a253
 v_mfma_f32_16x16x32_bf16 a[188:191], a[116:119], a[76:79], a[188:191]
 v_accvgpr_read_b32 v8, a254
 v_accvgpr_read_b32 v9, a255
 v_mfma_f32_16x16x32_bf16 a[188:191], a[112:115], a[68:71], a[188:191]
 v_cvt_pk_bf16_f32 v36, v2, v3
 s_waitcnt lgkmcnt(4)
 v_mfma_f32_16x16x32_bf16 a[136:139], a[80:83], v[80:83], a[136:139]
 ds_read_b128 a[112:115], v26 offset:37888
 buffer_load_dwordx4 v[200:203], v18, s[48:51], s2 offen offset:0 sc1
 v_mfma_f32_16x16x32_bf16 a[136:139], a[84:87], v[88:91], a[136:139]
 ds_read_b128 a[116:119], v29 offset:37888
 v_cvt_pk_bf16_f32 v37, v4, v5
 v_mfma_f32_16x16x32_bf16 a[136:139], a[88:91], v[96:99], a[136:139]
 ds_read_b128 a[120:123], v28 offset:4096
 v_cvt_pk_bf16_f32 v38, v6, v7
 v_mfma_f32_16x16x32_bf16 a[136:139], a[92:95], v[104:107], a[136:139]
 ds_read_b128 a[124:127], v31 offset:4096
 v_cvt_pk_bf16_f32 v39, v8, v9
 v_mfma_f32_16x16x32_bf16 a[140:143], a[92:95], v[108:111], a[140:143]
 v_mfma_f32_16x16x32_bf16 a[140:143], a[88:91], v[100:103], a[140:143]
 buffer_store_dwordx4 v[36:39], v64, s[48:51], s82 offen offset:3072 sc1
 v_mfma_f32_16x16x32_bf16 a[140:143], a[84:87], v[92:95], a[140:143]
 v_mfma_f32_16x16x32_bf16 a[140:143], a[80:83], v[84:87], a[140:143]
 s_waitcnt lgkmcnt(4)
 v_mfma_f32_16x16x32_bf16 a[152:155], a[96:99], v[80:83], a[152:155]
 ds_read_b128 a[80:83], v26 offset:39936
 v_mfma_f32_16x16x32_bf16 a[152:155], a[100:103], v[88:91], a[152:155]
 ds_read_b128 a[84:87], v29 offset:39936
 v_mfma_f32_16x16x32_bf16 a[152:155], a[104:107], v[96:99], a[152:155]
 ds_read_b128 a[88:91], v28 offset:6144
 buffer_load_dwordx4 v[204:207], v18, s[48:51], s2 offen offset:1024 sc1
 v_mfma_f32_16x16x32_bf16 a[152:155], a[108:111], v[104:107], a[152:155]
 ds_read_b128 a[92:95], v31 offset:6144
 s_xor_b32 s2, s3, 1
 v_mfma_f32_16x16x32_bf16 a[156:159], a[108:111], v[108:111], a[156:159]
 s_lshl_b32 s2, s2, 13
 s_add_u32 s2, s2, 147456
 v_mfma_f32_16x16x32_bf16 a[156:159], a[104:107], v[100:103], a[156:159]
 v_mfma_f32_16x16x32_bf16 a[156:159], a[100:103], v[92:95], a[156:159]
 v_mfma_f32_16x16x32_bf16 a[156:159], a[96:99], v[84:87], a[156:159]
 s_waitcnt vmcnt(24) lgkmcnt(4)
 s_barrier
 v_mfma_f32_16x16x32_bf16 a[168:171], a[112:115], v[80:83], a[168:171]
 ds_read_b128 a[96:99], v28 offset:16896
 buffer_load_dwordx4 v[208:211], v18, s[48:51], s2 offen offset:0 sc1
 v_mfma_f32_16x16x32_bf16 a[168:171], a[116:119], v[88:91], a[168:171]
 ds_read_b128 a[100:103], v31 offset:16896
 v_mfma_f32_16x16x32_bf16 a[168:171], a[120:123], v[96:99], a[168:171]
 ds_read_b128 a[104:107], v27 offset:16896
 v_mfma_f32_16x16x32_bf16 a[168:171], a[124:127], v[104:107], a[168:171]
 ds_read_b128 a[108:111], v30 offset:16896
 v_mfma_f32_16x16x32_bf16 a[172:175], a[124:127], v[108:111], a[172:175]
 buffer_load_dwordx4 v[212:215], v18, s[48:51], s2 offen offset:1024 sc1
 s_add_u32 s2, s2, 4096
 v_mfma_f32_16x16x32_bf16 a[172:175], a[120:123], v[100:103], a[172:175]
 v_mfma_f32_16x16x32_bf16 a[172:175], a[116:119], v[92:95], a[172:175]
 v_mfma_f32_16x16x32_bf16 a[172:175], a[112:115], v[84:87], a[172:175]
 s_waitcnt lgkmcnt(4)
 v_mfma_f32_16x16x32_bf16 a[184:187], a[80:83], v[80:83], a[184:187]
 ds_read_b128 a[112:115], v28 offset:18944
 v_mfma_f32_16x16x32_bf16 a[184:187], a[84:87], v[88:91], a[184:187]
 ds_read_b128 a[116:119], v31 offset:18944
 buffer_load_dwordx4 v[216:219], v18, s[48:51], s2 offen offset:0 sc1
 v_mfma_f32_16x16x32_bf16 a[184:187], a[88:91], v[96:99], a[184:187]
 ds_read_b128 a[120:123], v27 offset:18944
 v_mfma_f32_16x16x32_bf16 a[184:187], a[92:95], v[104:107], a[184:187]
 ds_read_b128 a[124:127], v30 offset:18944
 v_mfma_f32_16x16x32_bf16 a[188:191], a[92:95], v[108:111], a[188:191]
 v_mfma_f32_16x16x32_bf16 a[188:191], a[88:91], v[100:103], a[188:191]
 v_mfma_f32_16x16x32_bf16 a[188:191], a[84:87], v[92:95], a[188:191]
 buffer_load_dwordx4 v[220:223], v18, s[48:51], s2 offen offset:1024 sc1
 s_xor_b32 s2, s3, 2
 v_mfma_f32_16x16x32_bf16 a[188:191], a[80:83], v[84:87], a[188:191]
 s_lshl_b32 s2, s2, 13
 s_add_u32 s2, s2, 147456
 s_waitcnt lgkmcnt(4)
 v_mfma_f32_16x16x32_bf16 a[136:139], a[96:99], v[144:147], a[136:139]
 ds_read_b128 a[80:83], v28 offset:20992
 v_mfma_f32_16x16x32_bf16 a[136:139], a[100:103], v[152:155], a[136:139]
 ds_read_b128 a[84:87], v31 offset:20992
 v_mfma_f32_16x16x32_bf16 a[136:139], a[104:107], a[0:3], a[136:139]
 ds_read_b128 a[88:91], v27 offset:20992
 v_mfma_f32_16x16x32_bf16 a[136:139], a[108:111], a[8:11], a[136:139]
 ds_read_b128 a[92:95], v30 offset:20992
 buffer_load_dwordx4 v[224:227], v18, s[48:51], s2 offen offset:0 sc1
 v_mfma_f32_16x16x32_bf16 a[140:143], a[108:111], a[12:15], a[140:143]
 v_mfma_f32_16x16x32_bf16 a[140:143], a[104:107], a[4:7], a[140:143]
 v_mfma_f32_16x16x32_bf16 a[140:143], a[100:103], v[156:159], a[140:143]
 v_mfma_f32_16x16x32_bf16 a[140:143], a[96:99], v[148:151], a[140:143]
 buffer_load_dwordx4 v[228:231], v18, s[48:51], s2 offen offset:1024 sc1
 s_waitcnt lgkmcnt(4)
 v_mfma_f32_16x16x32_bf16 a[152:155], a[112:115], v[144:147], a[152:155]
 ds_read_b128 a[96:99], v28 offset:23040
 s_add_u32 s2, s2, 4096
 v_mfma_f32_16x16x32_bf16 a[152:155], a[116:119], v[152:155], a[152:155]
 ds_read_b128 a[100:103], v31 offset:23040
 v_mfma_f32_16x16x32_bf16 a[152:155], a[120:123], a[0:3], a[152:155]
 ds_read_b128 a[104:107], v27 offset:23040
 v_mfma_f32_16x16x32_bf16 a[152:155], a[124:127], a[8:11], a[152:155]
 ds_read_b128 a[108:111], v30 offset:23040
 v_mfma_f32_16x16x32_bf16 a[156:159], a[124:127], a[12:15], a[156:159]
 buffer_load_dwordx4 v[232:235], v18, s[48:51], s2 offen offset:0 sc1
 v_mfma_f32_16x16x32_bf16 a[156:159], a[120:123], a[4:7], a[156:159]
 v_mfma_f32_16x16x32_bf16 a[156:159], a[116:119], v[156:159], a[156:159]
 v_mfma_f32_16x16x32_bf16 a[156:159], a[112:115], v[148:151], a[156:159]
 s_waitcnt lgkmcnt(4)
 v_mfma_f32_16x16x32_bf16 a[168:171], a[80:83], v[144:147], a[168:171]
 ds_read_b128 a[112:115], v26 offset:8192
 v_mfma_f32_16x16x32_bf16 a[168:171], a[84:87], v[152:155], a[168:171]
 ds_read_b128 a[116:119], v29 offset:8192
 buffer_load_dwordx4 v[236:239], v18, s[48:51], s2 offen offset:1024 sc1
 v_mfma_f32_16x16x32_bf16 a[168:171], a[88:91], a[0:3], a[168:171]
 ds_read_b128 a[120:123], v27 offset:8192
 s_xor_b32 s2, s3, 3
 v_mfma_f32_16x16x32_bf16 a[168:171], a[92:95], a[8:11], a[168:171]
 ds_read_b128 a[124:127], v30 offset:8192
 s_lshl_b32 s2, s2, 13
 v_mfma_f32_16x16x32_bf16 a[172:175], a[92:95], a[12:15], a[172:175]
 s_add_u32 s2, s2, 147456
 v_mfma_f32_16x16x32_bf16 a[172:175], a[88:91], a[4:7], a[172:175]
 v_mfma_f32_16x16x32_bf16 a[172:175], a[84:87], v[156:159], a[172:175]
 buffer_load_dwordx4 v[240:243], v18, s[48:51], s2 offen offset:0 sc1
 v_mfma_f32_16x16x32_bf16 a[172:175], a[80:83], v[148:151], a[172:175]
 s_waitcnt lgkmcnt(4)
 v_mfma_f32_16x16x32_bf16 a[184:187], a[96:99], v[144:147], a[184:187]
 ds_read_b128 a[80:83], v26 offset:10240
 v_mfma_f32_16x16x32_bf16 a[184:187], a[100:103], v[152:155], a[184:187]
 ds_read_b128 a[84:87], v29 offset:10240
 v_mfma_f32_16x16x32_bf16 a[184:187], a[104:107], a[0:3], a[184:187]
 ds_read_b128 a[88:91], v27 offset:10240
 buffer_load_dwordx4 v[244:247], v18, s[48:51], s2 offen offset:1024 sc1
 v_mfma_f32_16x16x32_bf16 a[184:187], a[108:111], a[8:11], a[184:187]
 ds_read_b128 a[92:95], v30 offset:10240
 s_add_u32 s2, s2, 4096
 v_mfma_f32_16x16x32_bf16 a[188:191], a[108:111], a[12:15], a[188:191]
 v_mfma_f32_16x16x32_bf16 a[188:191], a[104:107], a[4:7], a[188:191]
 v_mfma_f32_16x16x32_bf16 a[188:191], a[100:103], v[156:159], a[188:191]
 v_mfma_f32_16x16x32_bf16 a[188:191], a[96:99], v[148:151], a[188:191]
 buffer_load_dwordx4 v[248:251], v18, s[48:51], s2 offen offset:0 sc1
 s_waitcnt vmcnt(27) lgkmcnt(4)
 v_mfma_f32_16x16x32_bf16 a[192:195], a[112:115], v[112:115], a[192:195]
 ds_read_b128 a[96:99], v26 offset:12288
 v_mfma_f32_16x16x32_bf16 a[192:195], a[116:119], v[120:123], a[192:195]
 ds_read_b128 a[100:103], v29 offset:12288
 v_mfma_f32_16x16x32_bf16 a[192:195], a[120:123], a[16:19], a[192:195]
 ds_read_b128 a[104:107], v27 offset:12288
 v_mfma_f32_16x16x32_bf16 a[192:195], a[124:127], a[24:27], a[192:195]
 ds_read_b128 a[108:111], v30 offset:12288
 v_mfma_f32_16x16x32_bf16 a[196:199], a[124:127], a[28:31], a[196:199]
 buffer_load_dwordx4 v[252:255], v18, s[48:51], s2 offen offset:1024 sc1
 v_mfma_f32_16x16x32_bf16 a[196:199], a[120:123], a[20:23], a[196:199]
 v_mfma_f32_16x16x32_bf16 a[196:199], a[116:119], v[124:127], a[196:199]
 v_mfma_f32_16x16x32_bf16 a[196:199], a[112:115], v[116:119], a[196:199]
 s_waitcnt lgkmcnt(4)
 v_mfma_f32_16x16x32_bf16 a[208:211], a[80:83], v[112:115], a[208:211]
 ds_read_b128 a[112:115], v26 offset:14336
 s_xor_b32 s82, s100, 2
 v_mfma_f32_16x16x32_bf16 a[208:211], a[84:87], v[120:123], a[208:211]
 ds_read_b128 a[116:119], v29 offset:14336
 s_lshl_b32 s82, s82, 14
 v_mfma_f32_16x16x32_bf16 a[208:211], a[88:91], a[16:19], a[208:211]
 ds_read_b128 a[120:123], v27 offset:14336
 s_add_u32 s82, s82, 25174016
 v_mfma_f32_16x16x32_bf16 a[208:211], a[92:95], a[24:27], a[208:211]
 ds_read_b128 a[124:127], v30 offset:14336
 v_accvgpr_read_b32 v2, a136
 v_mfma_f32_16x16x32_bf16 a[212:215], a[92:95], a[28:31], a[212:215]
 v_accvgpr_read_b32 v3, a137
 v_accvgpr_read_b32 v4, a138
 v_mfma_f32_16x16x32_bf16 a[212:215], a[88:91], a[20:23], a[212:215]
 v_accvgpr_read_b32 v5, a139
 v_accvgpr_read_b32 v6, a152
 v_mfma_f32_16x16x32_bf16 a[212:215], a[84:87], v[124:127], a[212:215]
 v_accvgpr_read_b32 v7, a153
 v_accvgpr_read_b32 v8, a154
 v_mfma_f32_16x16x32_bf16 a[212:215], a[80:83], v[116:119], a[212:215]
 v_accvgpr_read_b32 v9, a155
 s_waitcnt lgkmcnt(4)
 v_mfma_f32_16x16x32_bf16 a[224:227], a[96:99], v[112:115], a[224:227]
 ds_read_b128 a[80:83], v26 offset:25088
 v_cvt_pk_bf16_f32 v32, v2, v3
 v_mfma_f32_16x16x32_bf16 a[224:227], a[100:103], v[120:123], a[224:227]
 ds_read_b128 a[84:87], v29 offset:25088
 v_cvt_pk_bf16_f32 v33, v4, v5
 v_mfma_f32_16x16x32_bf16 a[224:227], a[104:107], a[16:19], a[224:227]
 ds_read_b128 a[88:91], v27 offset:41984
 v_cvt_pk_bf16_f32 v34, v6, v7
 v_mfma_f32_16x16x32_bf16 a[224:227], a[108:111], a[24:27], a[224:227]
 ds_read_b128 a[92:95], v30 offset:41984
 v_cvt_pk_bf16_f32 v35, v8, v9
 v_mfma_f32_16x16x32_bf16 a[228:231], a[108:111], a[28:31], a[228:231]
 buffer_store_dwordx4 v[32:35], v64, s[48:51], s82 offen offset:0 sc1
 v_accvgpr_read_b32 v2, a168
 v_mfma_f32_16x16x32_bf16 a[228:231], a[104:107], a[20:23], a[228:231]
 v_accvgpr_read_b32 v3, a169
 v_accvgpr_read_b32 v4, a170
 v_mfma_f32_16x16x32_bf16 a[228:231], a[100:103], v[124:127], a[228:231]
 v_accvgpr_read_b32 v5, a171
 v_accvgpr_read_b32 v6, a184
 v_mfma_f32_16x16x32_bf16 a[228:231], a[96:99], v[116:119], a[228:231]
 v_accvgpr_read_b32 v7, a185
 s_waitcnt lgkmcnt(4)
 v_mfma_f32_16x16x32_bf16 a[240:243], a[112:115], v[112:115], a[240:243]
 ds_read_b128 a[96:99], v26 offset:27136
 v_accvgpr_read_b32 v8, a186
 v_mfma_f32_16x16x32_bf16 a[240:243], a[116:119], v[120:123], a[240:243]
 ds_read_b128 a[100:103], v29 offset:27136
 v_accvgpr_read_b32 v9, a187
 v_mfma_f32_16x16x32_bf16 a[240:243], a[120:123], a[16:19], a[240:243]
 ds_read_b128 a[104:107], v27 offset:44032
 v_cvt_pk_bf16_f32 v36, v2, v3
 v_mfma_f32_16x16x32_bf16 a[240:243], a[124:127], a[24:27], a[240:243]
 ds_read_b128 a[108:111], v30 offset:44032
 v_cvt_pk_bf16_f32 v37, v4, v5
 v_mfma_f32_16x16x32_bf16 a[244:247], a[124:127], a[28:31], a[244:247]
 v_cvt_pk_bf16_f32 v38, v6, v7
 v_cvt_pk_bf16_f32 v39, v8, v9
 v_mfma_f32_16x16x32_bf16 a[244:247], a[120:123], a[20:23], a[244:247]
 buffer_store_dwordx4 v[36:39], v64, s[48:51], s82 offen offset:1024 sc1
 v_accvgpr_read_b32 v2, a140
 v_mfma_f32_16x16x32_bf16 a[244:247], a[116:119], v[124:127], a[244:247]
 v_accvgpr_read_b32 v3, a141
 v_accvgpr_read_b32 v4, a142
 v_mfma_f32_16x16x32_bf16 a[244:247], a[112:115], v[116:119], a[244:247]
 v_accvgpr_read_b32 v5, a143
 s_waitcnt vmcnt(20) lgkmcnt(4)
 v_mfma_f32_16x16x32_bf16 a[192:195], a[80:83], a[32:35], a[192:195]
 ds_read_b128 a[112:115], v26 offset:29184
 s_xor_b32 s75, s100, 3
 v_mfma_f32_16x16x32_bf16 a[192:195], a[84:87], a[40:43], a[192:195]
 ds_read_b128 a[116:119], v29 offset:29184
 s_lshl_b32 s75, s75, 7
 v_mfma_f32_16x16x32_bf16 a[192:195], a[88:91], v[176:179], a[192:195]
 ds_read_b128 a[120:123], v27 offset:46080
 s_add_u32 s75, s75, 42041356
 v_mfma_f32_16x16x32_bf16 a[192:195], a[92:95], v[184:187], a[192:195]
 ds_read_b128 a[124:127], v30 offset:46080
 s_waitcnt vmcnt(15)
 v_mfma_f32_16x16x32_bf16 a[196:199], a[92:95], v[188:191], a[196:199]
 buffer_store_dword v1, v11, s[48:51], s75 offen sc1
 v_accvgpr_read_b32 v6, a156
 v_mfma_f32_16x16x32_bf16 a[196:199], a[88:91], v[180:183], a[196:199]
 v_accvgpr_read_b32 v7, a157
 v_accvgpr_read_b32 v8, a158
 v_mfma_f32_16x16x32_bf16 a[196:199], a[84:87], a[44:47], a[196:199]
 v_accvgpr_read_b32 v9, a159
 v_cvt_pk_bf16_f32 v32, v2, v3
 v_mfma_f32_16x16x32_bf16 a[196:199], a[80:83], a[36:39], a[196:199]
 v_cvt_pk_bf16_f32 v33, v4, v5
 s_waitcnt lgkmcnt(4)
 v_mfma_f32_16x16x32_bf16 a[208:211], a[96:99], a[32:35], a[208:211]
 ds_read_b128 a[80:83], v26 offset:31232
 v_cvt_pk_bf16_f32 v34, v6, v7
 v_mfma_f32_16x16x32_bf16 a[208:211], a[100:103], a[40:43], a[208:211]
 ds_read_b128 a[84:87], v29 offset:31232
 v_cvt_pk_bf16_f32 v35, v8, v9
 v_mfma_f32_16x16x32_bf16 a[208:211], a[104:107], v[176:179], a[208:211]
 ds_read_b128 a[88:91], v27 offset:48128
 buffer_store_dwordx4 v[32:35], v64, s[48:51], s82 offen offset:2048 sc1
 v_mfma_f32_16x16x32_bf16 a[208:211], a[108:111], v[184:187], a[208:211]
 ds_read_b128 a[92:95], v30 offset:48128
 v_accvgpr_read_b32 v2, a172
 v_mfma_f32_16x16x32_bf16 a[212:215], a[108:111], v[188:191], a[212:215]
 v_accvgpr_read_b32 v3, a173
 v_accvgpr_read_b32 v4, a174
 v_mfma_f32_16x16x32_bf16 a[212:215], a[104:107], v[180:183], a[212:215]
 v_accvgpr_read_b32 v5, a175
 v_accvgpr_read_b32 v6, a188
 v_mfma_f32_16x16x32_bf16 a[212:215], a[100:103], a[44:47], a[212:215]
 v_accvgpr_read_b32 v7, a189
 v_accvgpr_read_b32 v8, a190
 v_mfma_f32_16x16x32_bf16 a[212:215], a[96:99], a[36:39], a[212:215]
 v_accvgpr_read_b32 v9, a191
 s_waitcnt lgkmcnt(4)
 v_mfma_f32_16x16x32_bf16 a[224:227], a[112:115], a[32:35], a[224:227]
 ds_read_b128 a[96:99], v26 offset:41984
 v_cvt_pk_bf16_f32 v36, v2, v3
 v_mfma_f32_16x16x32_bf16 a[224:227], a[116:119], a[40:43], a[224:227]
 ds_read_b128 a[100:103], v29 offset:41984
 v_cvt_pk_bf16_f32 v37, v4, v5
 v_mfma_f32_16x16x32_bf16 a[224:227], a[120:123], v[176:179], a[224:227]
 ds_read_b128 a[104:107], v28 offset:8192
 v_cvt_pk_bf16_f32 v38, v6, v7
 v_mfma_f32_16x16x32_bf16 a[224:227], a[124:127], v[184:187], a[224:227]
 ds_read_b128 a[108:111], v31 offset:8192
 v_cvt_pk_bf16_f32 v39, v8, v9
 v_mfma_f32_16x16x32_bf16 a[228:231], a[124:127], v[188:191], a[228:231]
 buffer_store_dwordx4 v[36:39], v64, s[48:51], s82 offen offset:3072 sc1
 v_mfma_f32_16x16x32_bf16 a[228:231], a[120:123], v[180:183], a[228:231]
 ds_read_b32 v80, v79 offset:0
 v_mfma_f32_16x16x32_bf16 a[228:231], a[116:119], a[44:47], a[228:231]
 ds_read_b32 v81, v79 offset:64
 v_mfma_f32_16x16x32_bf16 a[228:231], a[112:115], a[36:39], a[228:231]
 ds_read_b32 v82, v79 offset:128
 s_waitcnt lgkmcnt(7)
 v_mfma_f32_16x16x32_bf16 a[240:243], a[80:83], a[32:35], a[240:243]
 ds_read_b128 a[112:115], v26 offset:44032
 v_mfma_f32_16x16x32_bf16 a[240:243], a[84:87], a[40:43], a[240:243]
 ds_read_b128 a[116:119], v29 offset:44032
 v_mfma_f32_16x16x32_bf16 a[240:243], a[88:91], v[176:179], a[240:243]
 ds_read_b128 a[120:123], v28 offset:10240
 v_mfma_f32_16x16x32_bf16 a[240:243], a[92:95], v[184:187], a[240:243]
 ds_read_b128 a[124:127], v31 offset:10240
 v_mfma_f32_16x16x32_bf16 a[244:247], a[92:95], v[188:191], a[244:247]
 ds_read_b32 v83, v79 offset:192
 v_mfma_f32_16x16x32_bf16 a[244:247], a[88:91], v[180:183], a[244:247]
 ds_read_b32 v84, v79 offset:16
 v_mfma_f32_16x16x32_bf16 a[244:247], a[84:87], a[44:47], a[244:247]
 ds_read_b32 v85, v79 offset:80
 v_mfma_f32_16x16x32_bf16 a[244:247], a[80:83], a[36:39], a[244:247]
 ds_read_b32 v86, v79 offset:144
 s_waitcnt vmcnt(13) lgkmcnt(11)
 v_mfma_f32_16x16x32_bf16 a[192:195], a[96:99], v[192:195], a[192:195]
 ds_read_b128 a[80:83], v26 offset:46080
 v_mfma_f32_16x16x32_bf16 a[192:195], a[100:103], v[200:203], a[192:195]
 ds_read_b128 a[84:87], v29 offset:46080
 v_mfma_f32_16x16x32_bf16 a[192:195], a[104:107], v[208:211], a[192:195]
 ds_read_b128 a[88:91], v28 offset:12288
 v_mfma_f32_16x16x32_bf16 a[192:195], a[108:111], v[216:219], a[192:195]
 ds_read_b128 a[92:95], v31 offset:12288
 v_mfma_f32_16x16x32_bf16 a[196:199], a[108:111], v[220:223], a[196:199]
 ds_read_b32 v87, v79 offset:208
 s_waitcnt vmcnt(63)
 v_mfma_f32_16x16x32_bf16 a[196:199], a[104:107], v[212:215], a[196:199]
 v_lshlrev_b32 v88, 16, v56
 v_lshlrev_b32 v92, 16, v58
 v_mfma_f32_16x16x32_bf16 a[196:199], a[100:103], v[204:207], a[196:199]
 v_and_b32 v89, 0xffff0000, v56
 v_and_b32 v93, 0xffff0000, v58
 v_mfma_f32_16x16x32_bf16 a[196:199], a[96:99], v[196:199], a[196:199]
 v_lshlrev_b32 v90, 16, v57
 s_waitcnt lgkmcnt(9)
 v_mfma_f32_16x16x32_bf16 a[208:211], a[112:115], v[192:195], a[208:211]
 ds_read_b128 a[96:99], v26 offset:48128
 v_lshlrev_b32 v94, 16, v59
 v_mfma_f32_16x16x32_bf16 a[208:211], a[116:119], v[200:203], a[208:211]
 ds_read_b128 a[100:103], v29 offset:48128
 v_and_b32 v91, 0xffff0000, v57
 v_mfma_f32_16x16x32_bf16 a[208:211], a[120:123], v[208:211], a[208:211]
 ds_read_b128 a[104:107], v28 offset:14336
 v_and_b32 v95, 0xffff0000, v59
 v_mfma_f32_16x16x32_bf16 a[208:211], a[124:127], v[216:219], a[208:211]
 ds_read_b128 a[108:111], v31 offset:14336
 s_waitcnt lgkmcnt(4)
 v_mfma_f32_16x16x32_bf16 a[212:215], a[124:127], v[220:223], a[212:215]
 v_lshlrev_b32 v160, 16, v40
 v_fma_f32 v160, v160, v88, -v92
 v_mfma_f32_16x16x32_bf16 a[212:215], a[120:123], v[212:215], a[212:215]
 buffer_load_dword v13, off, s[48:51], s68 offset:12 sc1
 v_fma_f32 v160, v160, v80, v92
 v_mfma_f32_16x16x32_bf16 a[212:215], a[116:119], v[204:207], a[212:215]
 v_and_b32 v161, 0xffff0000, v40
 v_fma_f32 v161, v161, v89, -v93
 v_mfma_f32_16x16x32_bf16 a[212:215], a[112:115], v[196:199], a[212:215]
 v_fma_f32 v161, v161, v80, v93
 s_waitcnt lgkmcnt(5)
 v_mfma_f32_16x16x32_bf16 a[224:227], a[80:83], v[192:195], a[224:227]
 ds_read_b128 a[112:115], v28 offset:25088
 v_lshlrev_b32 v162, 16, v41
 v_mfma_f32_16x16x32_bf16 a[224:227], a[84:87], v[200:203], a[224:227]
 ds_read_b128 a[116:119], v31 offset:25088
 v_fma_f32 v162, v162, v90, -v94
 v_mfma_f32_16x16x32_bf16 a[224:227], a[88:91], v[208:211], a[224:227]
 ds_read_b128 a[120:123], v27 offset:25088
 v_fma_f32 v162, v162, v80, v94
 v_mfma_f32_16x16x32_bf16 a[224:227], a[92:95], v[216:219], a[224:227]
 ds_read_b128 a[124:127], v30 offset:25088
 v_and_b32 v163, 0xffff0000, v41
 v_mfma_f32_16x16x32_bf16 a[228:231], a[92:95], v[220:223], a[228:231]
 v_fma_f32 v163, v163, v91, -v95
 v_fma_f32 v163, v163, v80, v95
 v_mfma_f32_16x16x32_bf16 a[228:231], a[88:91], v[212:215], a[228:231]
 v_lshlrev_b32 v164, 16, v42
 v_fma_f32 v164, v164, v88, -v92
 v_mfma_f32_16x16x32_bf16 a[228:231], a[84:87], v[204:207], a[228:231]
 v_fma_f32 v164, v164, v81, v92
 v_and_b32 v165, 0xffff0000, v42
 v_mfma_f32_16x16x32_bf16 a[228:231], a[80:83], v[196:199], a[228:231]
 v_fma_f32 v165, v165, v89, -v93
 s_waitcnt lgkmcnt(4)
 v_mfma_f32_16x16x32_bf16 a[240:243], a[96:99], v[192:195], a[240:243]
 ds_read_b128 a[80:83], v28 offset:27136
 v_fma_f32 v165, v165, v81, v93
 v_mfma_f32_16x16x32_bf16 a[240:243], a[100:103], v[200:203], a[240:243]
 ds_read_b128 a[84:87], v31 offset:27136
 v_lshlrev_b32 v166, 16, v43
 v_mfma_f32_16x16x32_bf16 a[240:243], a[104:107], v[208:211], a[240:243]
 ds_read_b128 a[88:91], v27 offset:27136
 v_fma_f32 v166, v166, v90, -v94
 v_mfma_f32_16x16x32_bf16 a[240:243], a[108:111], v[216:219], a[240:243]
 ds_read_b128 a[92:95], v30 offset:27136
 v_fma_f32 v166, v166, v81, v94
 v_mfma_f32_16x16x32_bf16 a[244:247], a[108:111], v[220:223], a[244:247]
 v_and_b32 v167, 0xffff0000, v43
 v_fma_f32 v167, v167, v91, -v95
 v_mfma_f32_16x16x32_bf16 a[244:247], a[104:107], v[212:215], a[244:247]
 v_fma_f32 v167, v167, v81, v95
 v_lshlrev_b32 v168, 16, v44
 v_mfma_f32_16x16x32_bf16 a[244:247], a[100:103], v[204:207], a[244:247]
 v_fma_f32 v168, v168, v88, -v92
 v_fma_f32 v168, v168, v82, v92
 v_mfma_f32_16x16x32_bf16 a[244:247], a[96:99], v[196:199], a[244:247]
 v_and_b32 v169, 0xffff0000, v44
 s_waitcnt vmcnt(6) lgkmcnt(4)
 v_mfma_f32_16x16x32_bf16 a[192:195], a[112:115], v[224:227], a[192:195]
 ds_read_b128 a[96:99], v28 offset:29184
 v_fma_f32 v169, v169, v89, -v93
 v_mfma_f32_16x16x32_bf16 a[192:195], a[116:119], v[232:235], a[192:195]
 ds_read_b128 a[100:103], v31 offset:29184
 v_fma_f32 v169, v169, v82, v93
 v_mfma_f32_16x16x32_bf16 a[192:195], a[120:123], v[240:243], a[192:195]
 ds_read_b128 a[104:107], v27 offset:29184
 v_lshlrev_b32 v170, 16, v45
 v_mfma_f32_16x16x32_bf16 a[192:195], a[124:127], v[248:251], a[192:195]
 ds_read_b128 a[108:111], v30 offset:29184
 v_fma_f32 v170, v170, v90, -v94
 v_mfma_f32_16x16x32_bf16 a[196:199], a[124:127], v[252:255], a[196:199]
 v_fma_f32 v170, v170, v82, v94
 v_and_b32 v171, 0xffff0000, v45
 v_mfma_f32_16x16x32_bf16 a[196:199], a[120:123], v[244:247], a[196:199]
 v_fma_f32 v171, v171, v91, -v95
 v_fma_f32 v171, v171, v82, v95
 v_mfma_f32_16x16x32_bf16 a[196:199], a[116:119], v[236:239], a[196:199]
 v_lshlrev_b32 v172, 16, v46
 v_fma_f32 v172, v172, v88, -v92
 v_mfma_f32_16x16x32_bf16 a[196:199], a[112:115], v[228:231], a[196:199]
 s_waitcnt lgkmcnt(4)
 v_mfma_f32_16x16x32_bf16 a[208:211], a[80:83], v[224:227], a[208:211]
 ds_read_b128 a[112:115], v28 offset:31232
 v_mfma_f32_16x16x32_bf16 a[208:211], a[84:87], v[232:235], a[208:211]
 ds_read_b128 a[116:119], v31 offset:31232
 v_mfma_f32_16x16x32_bf16 a[208:211], a[88:91], v[240:243], a[208:211]
 ds_read_b128 a[120:123], v27 offset:31232
 v_mfma_f32_16x16x32_bf16 a[208:211], a[92:95], v[248:251], a[208:211]
 ds_read_b128 a[124:127], v30 offset:31232
 v_mfma_f32_16x16x32_bf16 a[212:215], a[92:95], v[252:255], a[212:215]
 v_mfma_f32_16x16x32_bf16 a[212:215], a[88:91], v[244:247], a[212:215]
 v_mfma_f32_16x16x32_bf16 a[212:215], a[84:87], v[236:239], a[212:215]
 v_mfma_f32_16x16x32_bf16 a[212:215], a[80:83], v[228:231], a[212:215]
 s_waitcnt lgkmcnt(4)
 v_mfma_f32_16x16x32_bf16 a[224:227], a[96:99], v[224:227], a[224:227]
 ds_read_b128 a[80:83], v26 offset:0
 v_mfma_f32_16x16x32_bf16 a[224:227], a[100:103], v[232:235], a[224:227]
 ds_read_b128 a[84:87], v29 offset:0
 v_mfma_f32_16x16x32_bf16 a[224:227], a[104:107], v[240:243], a[224:227]
 ds_read_b128 a[88:91], v27 offset:0
 v_mfma_f32_16x16x32_bf16 a[224:227], a[108:111], v[248:251], a[224:227]
 ds_read_b128 a[92:95], v30 offset:0
 v_mfma_f32_16x16x32_bf16 a[228:231], a[108:111], v[252:255], a[228:231]
 v_mfma_f32_16x16x32_bf16 a[228:231], a[104:107], v[244:247], a[228:231]
 v_mfma_f32_16x16x32_bf16 a[228:231], a[100:103], v[236:239], a[228:231]
 v_mfma_f32_16x16x32_bf16 a[228:231], a[96:99], v[228:231], a[228:231]
 s_waitcnt lgkmcnt(4)
 v_mfma_f32_16x16x32_bf16 a[240:243], a[112:115], v[224:227], a[240:243]
 ds_read_b128 a[96:99], v26 offset:2048
 v_mfma_f32_16x16x32_bf16 a[240:243], a[116:119], v[232:235], a[240:243]
 ds_read_b128 a[100:103], v29 offset:2048
 s_waitcnt vmcnt(0)
 v_cmp_ne_u32 vcc, 1, v13
 s_cbranch_vccnz L_slow_19
L_back_21:
 v_mfma_f32_16x16x32_bf16 a[240:243], a[120:123], v[240:243], a[240:243]
 ds_read_b128 a[104:107], v27 offset:2048
 buffer_load_dwordx4 a[200:203], v64, s[48:51], s71 offen offset:0 sc1
 v_mfma_f32_16x16x32_bf16 a[240:243], a[124:127], v[248:251], a[240:243]
 ds_read_b128 a[108:111], v30 offset:2048
 v_mfma_f32_16x16x32_bf16 a[244:247], a[124:127], v[252:255], a[244:247]
L_pad12:
 s_cbranch_execz L_pad16
 v_mfma_f32_16x16x32_bf16 a[244:247], a[120:123], v[244:247], a[244:247]
 v_mfma_f32_16x16x32_bf16 a[244:247], a[116:119], v[236:239], a[244:247]
 v_mfma_f32_16x16x32_bf16 a[244:247], a[112:115], v[228:231], a[244:247]
 s_waitcnt lgkmcnt(4)
 v_mfma_f32_16x16x32_bf16 a[128:131], a[80:83], v[112:115], a[128:131]
 ds_read_b128 a[112:115], v26 offset:4096
 buffer_load_dwordx4 a[216:219], v64, s[48:51], s71 offen offset:1024 sc1
 v_mfma_f32_16x16x32_bf16 a[128:131], a[84:87], v[120:123], a[128:131]
 ds_read_b128 a[116:119], v29 offset:4096
 v_mfma_f32_16x16x32_bf16 a[128:131], a[88:91], a[16:19], a[128:131]
 ds_read_b128 a[120:123], v27 offset:4096
 s_xor_b32 s75, s100, 2
 v_mfma_f32_16x16x32_bf16 a[128:131], a[92:95], a[24:27], a[128:131]
 ds_read_b128 a[124:127], v30 offset:4096
 s_lshl_b32 s75, s75, 7
 v_mfma_f32_16x16x32_bf16 a[132:135], a[92:95], a[28:31], a[132:135]
 s_add_u32 s75, s75, 42041352
 s_waitcnt vmcnt(3)
 v_mfma_f32_16x16x32_bf16 a[132:135], a[88:91], a[20:23], a[132:135]
 buffer_store_dword v1, v11, s[48:51], s75 offen sc1
 v_mfma_f32_16x16x32_bf16 a[132:135], a[84:87], v[124:127], a[132:135]
 v_mfma_f32_16x16x32_bf16 a[132:135], a[80:83], v[116:119], a[132:135]
 buffer_load_dwordx4 a[232:235], v64, s[48:51], s71 offen offset:2048 sc1
 s_waitcnt lgkmcnt(4)
 v_mfma_f32_16x16x32_bf16 a[144:147], a[96:99], v[112:115], a[144:147]
 ds_read_b128 a[80:83], v26 offset:6144
 s_xor_b32 s82, s100, 1
 v_mfma_f32_16x16x32_bf16 a[144:147], a[100:103], v[120:123], a[144:147]
 ds_read_b128 a[84:87], v29 offset:6144
 s_lshl_b32 s82, s82, 14
 v_mfma_f32_16x16x32_bf16 a[144:147], a[104:107], a[16:19], a[144:147]
 ds_read_b128 a[88:91], v27 offset:6144
 s_add_u32 s82, s82, 25169920
 v_mfma_f32_16x16x32_bf16 a[144:147], a[108:111], a[24:27], a[144:147]
 ds_read_b128 a[92:95], v30 offset:6144
 v_accvgpr_read_b32 v2, a192
 v_mfma_f32_16x16x32_bf16 a[148:151], a[108:111], a[28:31], a[148:151]
 buffer_load_dwordx4 a[248:251], v64, s[48:51], s71 offen offset:3072 sc1
 v_accvgpr_read_b32 v3, a193
 v_mfma_f32_16x16x32_bf16 a[148:151], a[104:107], a[20:23], a[148:151]
 v_accvgpr_read_b32 v4, a194
 v_accvgpr_read_b32 v5, a195
 v_mfma_f32_16x16x32_bf16 a[148:151], a[100:103], v[124:127], a[148:151]
 v_accvgpr_read_b32 v6, a208
 v_accvgpr_read_b32 v7, a209
 v_mfma_f32_16x16x32_bf16 a[148:151], a[96:99], v[116:119], a[148:151]
 v_accvgpr_read_b32 v8, a210
 s_waitcnt lgkmcnt(4)
 v_mfma_f32_16x16x32_bf16 a[160:163], a[112:115], v[112:115], a[160:163]
 ds_read_b128 a[96:99], v26 offset:16896
 v_accvgpr_read_b32 v9, a211
 v_mfma_f32_16x16x32_bf16 a[160:163], a[116:119], v[120:123], a[160:163]
 ds_read_b128 a[100:103], v29 offset:16896
 v_cvt_pk_bf16_f32 v32, v2, v3
 v_mfma_f32_16x16x32_bf16 a[160:163], a[120:123], a[16:19], a[160:163]
 ds_read_b128 a[104:107], v27 offset:33792
 v_cvt_pk_bf16_f32 v33, v4, v5
 v_mfma_f32_16x16x32_bf16 a[160:163], a[124:127], a[24:27], a[160:163]
 ds_read_b128 a[108:111], v30 offset:33792
 v_cvt_pk_bf16_f32 v34, v6, v7
 v_mfma_f32_16x16x32_bf16 a[164:167], a[124:127], a[28:31], a[164:167]
 v_cvt_pk_bf16_f32 v35, v8, v9
 v_mfma_f32_16x16x32_bf16 a[164:167], a[120:123], a[20:23], a[164:167]
 buffer_store_dwordx4 v[32:35], v64, s[48:51], s82 offen offset:0 sc1
 v_accvgpr_read_b32 v2, a224
 v_mfma_f32_16x16x32_bf16 a[164:167], a[116:119], v[124:127], a[164:167]
 v_accvgpr_read_b32 v3, a225
 v_accvgpr_read_b32 v4, a226
 v_mfma_f32_16x16x32_bf16 a[164:167], a[112:115], v[116:119], a[164:167]
 v_accvgpr_read_b32 v5, a227
 s_waitcnt lgkmcnt(4)
 v_mfma_f32_16x16x32_bf16 a[176:179], a[80:83], v[112:115], a[176:179]
 ds_read_b128 a[112:115], v26 offset:18944
 v_accvgpr_read_b32 v6, a240
 v_mfma_f32_16x16x32_bf16 a[176:179], a[84:87], v[120:123], a[176:179]
 ds_read_b128 a[116:119], v29 offset:18944
 v_accvgpr_read_b32 v7, a241
 v_mfma_f32_16x16x32_bf16 a[176:179], a[88:91], a[16:19], a[176:179]
 ds_read_b128 a[120:123], v27 offset:35840
 v_accvgpr_read_b32 v8, a242
 v_mfma_f32_16x16x32_bf16 a[176:179], a[92:95], a[24:27], a[176:179]
 ds_read_b128 a[124:127], v30 offset:35840
 v_accvgpr_read_b32 v9, a243
 v_mfma_f32_16x16x32_bf16 a[180:183], a[92:95], a[28:31], a[180:183]
 v_cvt_pk_bf16_f32 v36, v2, v3
 v_cvt_pk_bf16_f32 v37, v4, v5
 v_mfma_f32_16x16x32_bf16 a[180:183], a[88:91], a[20:23], a[180:183]
 v_cvt_pk_bf16_f32 v38, v6, v7
 v_cvt_pk_bf16_f32 v39, v8, v9
 v_mfma_f32_16x16x32_bf16 a[180:183], a[84:87], v[124:127], a[180:183]
 buffer_store_dwordx4 v[36:39], v64, s[48:51], s82 offen offset:1024 sc1
 v_accvgpr_read_b32 v2, a196
 v_mfma_f32_16x16x32_bf16 a[180:183], a[80:83], v[116:119], a[180:183]
 v_accvgpr_read_b32 v3, a197
 s_waitcnt lgkmcnt(4)
 v_mfma_f32_16x16x32_bf16 a[128:131], a[96:99], a[32:35], a[128:131]
 ds_read_b128 a[80:83], v26 offset:20992
 v_accvgpr_read_b32 v4, a198
 v_mfma_f32_16x16x32_bf16 a[128:131], a[100:103], a[40:43], a[128:131]
 ds_read_b128 a[84:87], v29 offset:20992
 v_accvgpr_read_b32 v5, a199
 v_mfma_f32_16x16x32_bf16 a[128:131], a[104:107], v[176:179], a[128:131]
 ds_read_b128 a[88:91], v27 offset:37888
 v_accvgpr_read_b32 v6, a212
 v_mfma_f32_16x16x32_bf16 a[128:131], a[108:111], v[184:187], a[128:131]
 ds_read_b128 a[92:95], v30 offset:37888
 v_accvgpr_read_b32 v7, a213
 v_mfma_f32_16x16x32_bf16 a[132:135], a[108:111], v[188:191], a[132:135]
 v_accvgpr_read_b32 v8, a214
 v_accvgpr_read_b32 v9, a215
 v_mfma_f32_16x16x32_bf16 a[132:135], a[104:107], v[180:183], a[132:135]
 v_cvt_pk_bf16_f32 v32, v2, v3
 v_cvt_pk_bf16_f32 v33, v4, v5
 v_mfma_f32_16x16x32_bf16 a[132:135], a[100:103], a[44:47], a[132:135]
 v_cvt_pk_bf16_f32 v34, v6, v7
 v_cvt_pk_bf16_f32 v35, v8, v9
 v_mfma_f32_16x16x32_bf16 a[132:135], a[96:99], a[36:39], a[132:135]
 buffer_store_dwordx4 v[32:35], v64, s[48:51], s82 offen offset:2048 sc1
 s_waitcnt lgkmcnt(4)
 v_mfma_f32_16x16x32_bf16 a[144:147], a[112:115], a[32:35], a[144:147]
 ds_read_b128 a[96:99], v26 offset:23040
 v_accvgpr_read_b32 v2, a228
 v_mfma_f32_16x16x32_bf16 a[144:147], a[116:119], a[40:43], a[144:147]
 ds_read_b128 a[100:103], v29 offset:23040
 v_accvgpr_read_b32 v3, a229
 v_mfma_f32_16x16x32_bf16 a[144:147], a[120:123], v[176:179], a[144:147]
 ds_read_b128 a[104:107], v27 offset:39936
 v_accvgpr_read_b32 v4, a230
 v_mfma_f32_16x16x32_bf16 a[144:147], a[124:127], v[184:187], a[144:147]
 ds_read_b128 a[108:111], v30 offset:39936
 v_accvgpr_read_b32 v5, a231
 v_mfma_f32_16x16x32_bf16 a[148:151], a[124:127], v[188:191], a[148:151]
 v_accvgpr_read_b32 v6, a244
 v_accvgpr_read_b32 v7, a245
 v_mfma_f32_16x16x32_bf16 a[148:151], a[120:123], v[180:183], a[148:151]
 v_accvgpr_read_b32 v8, a246
 v_accvgpr_read_b32 v9, a247
 v_mfma_f32_16x16x32_bf16 a[148:151], a[116:119], a[44:47], a[148:151]
 v_cvt_pk_bf16_f32 v36, v2, v3
 v_cvt_pk_bf16_f32 v37, v4, v5
 v_mfma_f32_16x16x32_bf16 a[148:151], a[112:115], a[36:39], a[148:151]
 buffer_load_dword v13, off, s[48:51], s68 offset:8 sc1
 s_waitcnt lgkmcnt(4)
 v_mfma_f32_16x16x32_bf16 a[160:163], a[80:83], a[32:35], a[160:163]
 ds_read_b128 a[112:115], v26 offset:33792
 v_cvt_pk_bf16_f32 v38, v6, v7
 v_mfma_f32_16x16x32_bf16 a[160:163], a[84:87], a[40:43], a[160:163]
 ds_read_b128 a[116:119], v29 offset:33792
 v_cvt_pk_bf16_f32 v39, v8, v9
 v_mfma_f32_16x16x32_bf16 a[160:163], a[88:91], v[176:179], a[160:163]
 ds_read_b128 a[120:123], v28 offset:0
 buffer_store_dwordx4 v[36:39], v64, s[48:51], s82 offen offset:3072 sc1
 v_mfma_f32_16x16x32_bf16 a[160:163], a[92:95], v[184:187], a[160:163]
 ds_read_b128 a[124:127], v31 offset:0
 v_fma_f32 v172, v172, v83, v92
 v_mfma_f32_16x16x32_bf16 a[164:167], a[92:95], v[188:191], a[164:167]
 v_and_b32 v173, 0xffff0000, v46
 v_fma_f32 v173, v173, v89, -v93
 v_mfma_f32_16x16x32_bf16 a[164:167], a[88:91], v[180:183], a[164:167]
 v_fma_f32 v173, v173, v83, v93
 v_lshlrev_b32 v174, 16, v47
 v_mfma_f32_16x16x32_bf16 a[164:167], a[84:87], a[44:47], a[164:167]
 v_fma_f32 v174, v174, v90, -v94
 v_fma_f32 v174, v174, v83, v94
 v_mfma_f32_16x16x32_bf16 a[164:167], a[80:83], a[36:39], a[164:167]
 v_and_b32 v175, 0xffff0000, v47
 s_waitcnt lgkmcnt(4)
 v_mfma_f32_16x16x32_bf16 a[176:179], a[96:99], a[32:35], a[176:179]
 ds_read_b128 a[80:83], v26 offset:35840
 v_fma_f32 v175, v175, v91, -v95
 v_mfma_f32_16x16x32_bf16 a[176:179], a[100:103], a[40:43], a[176:179]
 ds_read_b128 a[84:87], v29 offset:35840
 v_fma_f32 v175, v175, v83, v95
 v_mfma_f32_16x16x32_bf16 a[176:179], a[104:107], v[176:179], a[176:179]
 ds_read_b128 a[88:91], v28 offset:2048
 v_lshlrev_b32 v128, 16, v48
 v_mfma_f32_16x16x32_bf16 a[176:179], a[108:111], v[184:187], a[176:179]
 ds_read_b128 a[92:95], v31 offset:2048
 v_fma_f32 v128, v128, v88, -v92
 v_mfma_f32_16x16x32_bf16 a[180:183], a[108:111], v[188:191], a[180:183]
 v_fma_f32 v128, v128, v84, v92
 v_and_b32 v129, 0xffff0000, v48
 v_mfma_f32_16x16x32_bf16 a[180:183], a[104:107], v[180:183], a[180:183]
 v_fma_f32 v129, v129, v89, -v93
 v_fma_f32 v129, v129, v84, v93
 v_mfma_f32_16x16x32_bf16 a[180:183], a[100:103], a[44:47], a[180:183]
 v_lshlrev_b32 v130, 16, v49
 v_fma_f32 v130, v130, v90, -v94
 v_mfma_f32_16x16x32_bf16 a[180:183], a[96:99], a[36:39], a[180:183]
 v_fma_f32 v130, v130, v84, v94
 s_waitcnt lgkmcnt(4)
 v_mfma_f32_16x16x32_bf16 a[128:131], a[112:115], v[192:195], a[128:131]
 ds_read_b128 a[96:99], v26 offset:37888
 v_and_b32 v131, 0xffff0000, v49
 v_mfma_f32_16x16x32_bf16 a[128:131], a[116:119], v[200:203], a[128:131]
 ds_read_b128 a[100:103], v29 offset:37888
 v_fma_f32 v131, v131, v91, -v95
 v_mfma_f32_16x16x32_bf16 a[128:131], a[120:123], v[208:211], a[128:131]
 ds_read_b128 a[104:107], v28 offset:4096
 v_fma_f32 v131, v131, v84, v95
 v_mfma_f32_16x16x32_bf16 a[128:131], a[124:127], v[216:219], a[128:131]
 ds_read_b128 a[108:111], v31 offset:4096
 v_lshlrev_b32 v132, 16, v50
 v_mfma_f32_16x16x32_bf16 a[132:135], a[124:127], v[220:223], a[132:135]
 v_fma_f32 v132, v132, v88, -v92
 v_fma_f32 v132, v132, v85, v92
 v_mfma_f32_16x16x32_bf16 a[132:135], a[120:123], v[212:215], a[132:135]
 v_and_b32 v133, 0xffff0000, v50
 v_fma_f32 v133, v133, v89, -v93
 v_mfma_f32_16x16x32_bf16 a[132:135], a[116:119], v[204:207], a[132:135]
 v_fma_f32 v133, v133, v85, v93
 v_lshlrev_b32 v134, 16, v51
 v_mfma_f32_16x16x32_bf16 a[132:135], a[112:115], v[196:199], a[132:135]
 v_fma_f32 v134, v134, v90, -v94
 s_waitcnt lgkmcnt(4)
 v_mfma_f32_16x16x32_bf16 a[144:147], a[80:83], v[192:195], a[144:147]
 ds_read_b128 a[112:115], v26 offset:39936
 v_fma_f32 v134, v134, v85, v94
 v_mfma_f32_16x16x32_bf16 a[144:147], a[84:87], v[200:203], a[144:147]
 ds_read_b128 a[116:119], v29 offset:39936
 v_and_b32 v135, 0xffff0000, v51
 v_mfma_f32_16x16x32_bf16 a[144:147], a[88:91], v[208:211], a[144:147]
 ds_read_b128 a[120:123], v28 offset:6144
 v_fma_f32 v135, v135, v91, -v95
 v_mfma_f32_16x16x32_bf16 a[144:147], a[92:95], v[216:219], a[144:147]
 ds_read_b128 a[124:127], v31 offset:6144
 v_fma_f32 v135, v135, v85, v95
 v_mfma_f32_16x16x32_bf16 a[148:151], a[92:95], v[220:223], a[148:151]
 v_lshlrev_b32 v136, 16, v52
 v_fma_f32 v136, v136, v88, -v92
 v_mfma_f32_16x16x32_bf16 a[148:151], a[88:91], v[212:215], a[148:151]
 v_fma_f32 v136, v136, v86, v92
 v_and_b32 v137, 0xffff0000, v52
 v_mfma_f32_16x16x32_bf16 a[148:151], a[84:87], v[204:207], a[148:151]
 v_fma_f32 v137, v137, v89, -v93
 v_fma_f32 v137, v137, v86, v93
 v_mfma_f32_16x16x32_bf16 a[148:151], a[80:83], v[196:199], a[148:151]
 v_lshlrev_b32 v138, 16, v53
 s_waitcnt lgkmcnt(4)
 v_mfma_f32_16x16x32_bf16 a[160:163], a[96:99], v[192:195], a[160:163]
 ds_read_b128 a[80:83], v28 offset:16896
 v_fma_f32 v138, v138, v90, -v94
 v_mfma_f32_16x16x32_bf16 a[160:163], a[100:103], v[200:203], a[160:163]
 ds_read_b128 a[84:87], v31 offset:16896
 v_fma_f32 v138, v138, v86, v94
 v_mfma_f32_16x16x32_bf16 a[160:163], a[104:107], v[208:211], a[160:163]
 ds_read_b128 a[88:91], v27 offset:16896
 v_and_b32 v139, 0xffff0000, v53
 v_mfma_f32_16x16x32_bf16 a[160:163], a[108:111], v[216:219], a[160:163]
 ds_read_b128 a[92:95], v30 offset:16896
 v_fma_f32 v139, v139, v91, -v95
 v_mfma_f32_16x16x32_bf16 a[164:167], a[108:111], v[220:223], a[164:167]
 v_fma_f32 v139, v139, v86, v95
 v_lshlrev_b32 v140, 16, v54
 v_mfma_f32_16x16x32_bf16 a[164:167], a[104:107], v[212:215], a[164:167]
 v_fma_f32 v140, v140, v88, -v92
 v_fma_f32 v140, v140, v87, v92
 v_mfma_f32_16x16x32_bf16 a[164:167], a[100:103], v[204:207], a[164:167]
 v_and_b32 v141, 0xffff0000, v54
 v_fma_f32 v141, v141, v89, -v93
 v_mfma_f32_16x16x32_bf16 a[164:167], a[96:99], v[196:199], a[164:167]
 v_fma_f32 v141, v141, v87, v93
 s_waitcnt lgkmcnt(4)
 v_mfma_f32_16x16x32_bf16 a[176:179], a[112:115], v[192:195], a[176:179]
 ds_read_b128 a[96:99], v28 offset:18944
 v_lshlrev_b32 v142, 16, v55
 v_mfma_f32_16x16x32_bf16 a[176:179], a[116:119], v[200:203], a[176:179]
 ds_read_b128 a[100:103], v31 offset:18944
 v_fma_f32 v142, v142, v90, -v94
 v_mfma_f32_16x16x32_bf16 a[176:179], a[120:123], v[208:211], a[176:179]
 ds_read_b128 a[104:107], v27 offset:18944
 s_xor_b32 s75, s100, 1
 v_mfma_f32_16x16x32_bf16 a[176:179], a[124:127], v[216:219], a[176:179]
 ds_read_b128 a[108:111], v30 offset:18944
 s_waitcnt vmcnt(1)
 v_cmp_ne_u32 vcc, 1, v13
 s_cbranch_vccnz L_slow_22
L_back_24:
 v_mfma_f32_16x16x32_bf16 a[180:183], a[124:127], v[220:223], a[180:183]
 buffer_load_dwordx4 a[204:207], v64, s[48:51], s70 offen offset:0 sc1
 s_lshl_b32 s75, s75, 7
 v_mfma_f32_16x16x32_bf16 a[180:183], a[120:123], v[212:215], a[180:183]
 s_add_u32 s75, s75, 42041348
 s_waitcnt vmcnt(1)
 v_fma_f32 v142, v142, v87, v94
 v_mfma_f32_16x16x32_bf16 a[180:183], a[116:119], v[204:207], a[180:183]
 v_and_b32 v143, 0xffff0000, v55
 v_fma_f32 v143, v143, v91, -v95
 v_mfma_f32_16x16x32_bf16 a[180:183], a[112:115], v[196:199], a[180:183]
 v_fma_f32 v143, v143, v87, v95
 s_waitcnt vmcnt(6)
 v_mfma_f32_16x16x32_bf16 a[128:131], v[70:73], a[200:203], a[128:131]
 buffer_store_dword v1, v11, s[48:51], s75 offen sc1
 v_mfma_f32_16x16x32_bf16 a[144:147], v[68:71], a[200:203], a[144:147]
 v_mfma_f32_16x16x32_bf16 a[160:163], v[70:73], a[216:219], a[160:163]
 buffer_load_dwordx4 a[220:223], v64, s[48:51], s70 offen offset:1024 sc1
 v_mfma_f32_16x16x32_bf16 a[176:179], v[68:71], a[216:219], a[176:179]
 v_mfma_f32_16x16x32_bf16 a[132:135], v[70:73], a[232:235], a[132:135]
 v_mfma_f32_16x16x32_bf16 a[148:151], v[68:71], a[232:235], a[148:151]
 v_mfma_f32_16x16x32_bf16 a[164:167], v[70:73], a[248:251], a[164:167]
 v_mfma_f32_16x16x32_bf16 a[180:183], v[68:71], a[248:251], a[180:183]
 s_waitcnt lgkmcnt(4)
 v_mfma_f32_16x16x32_bf16 a[128:131], a[80:83], v[224:227], a[128:131]
 ds_read_b128 a[112:115], v28 offset:20992
 buffer_load_dwordx4 a[236:239], v64, s[48:51], s70 offen offset:2048 sc1
 v_mfma_f32_16x16x32_bf16 a[128:131], a[84:87], v[232:235], a[128:131]
 ds_read_b128 a[116:119], v31 offset:20992
 v_mfma_f32_16x16x32_bf16 a[128:131], a[88:91], v[240:243], a[128:131]
 ds_read_b128 a[120:123], v27 offset:20992
 v_mfma_f32_16x16x32_bf16 a[128:131], a[92:95], v[248:251], a[128:131]
 ds_read_b128 a[124:127], v30 offset:20992
 v_mfma_f32_16x16x32_bf16 a[132:135], a[92:95], v[252:255], a[132:135]
 v_mfma_f32_16x16x32_bf16 a[132:135], a[88:91], v[244:247], a[132:135]
 v_mfma_f32_16x16x32_bf16 a[132:135], a[84:87], v[236:239], a[132:135]
 buffer_load_dwordx4 a[252:255], v64, s[48:51], s70 offen offset:3072 sc1
 v_mfma_f32_16x16x32_bf16 a[132:135], a[80:83], v[228:231], a[132:135]
 s_waitcnt lgkmcnt(4)
 v_mfma_f32_16x16x32_bf16 a[144:147], a[96:99], v[224:227], a[144:147]
 ds_read_b128 a[80:83], v28 offset:23040
 v_mfma_f32_16x16x32_bf16 a[144:147], a[100:103], v[232:235], a[144:147]
 ds_read_b128 a[84:87], v31 offset:23040
 v_mfma_f32_16x16x32_bf16 a[144:147], a[104:107], v[240:243], a[144:147]
 ds_read_b128 a[88:91], v27 offset:23040
 v_mfma_f32_16x16x32_bf16 a[144:147], a[108:111], v[248:251], a[144:147]
 ds_read_b128 a[92:95], v30 offset:23040
 v_mfma_f32_16x16x32_bf16 a[148:151], a[108:111], v[252:255], a[148:151]
 v_mfma_f32_16x16x32_bf16 a[148:151], a[104:107], v[244:247], a[148:151]
 v_mfma_f32_16x16x32_bf16 a[148:151], a[100:103], v[236:239], a[148:151]
 v_mfma_f32_16x16x32_bf16 a[148:151], a[96:99], v[228:231], a[148:151]
 s_waitcnt lgkmcnt(4)
 v_mfma_f32_16x16x32_bf16 a[160:163], a[112:115], v[224:227], a[160:163]
 v_mfma_f32_16x16x32_bf16 a[160:163], a[116:119], v[232:235], a[160:163]
 v_mfma_f32_16x16x32_bf16 a[160:163], a[120:123], v[240:243], a[160:163]
 v_mfma_f32_16x16x32_bf16 a[160:163], a[124:127], v[248:251], a[160:163]
 v_mfma_f32_16x16x32_bf16 a[164:167], a[124:127], v[252:255], a[164:167]
 buffer_load_dword v13, off, s[48:51], s68 offset:4 sc1
 v_mfma_f32_16x16x32_bf16 a[164:167], a[120:123], v[244:247], a[164:167]
 v_mfma_f32_16x16x32_bf16 a[164:167], a[116:119], v[236:239], a[164:167]
 v_mfma_f32_16x16x32_bf16 a[164:167], a[112:115], v[228:231], a[164:167]
 s_waitcnt lgkmcnt(0)
 v_mfma_f32_16x16x32_bf16 a[176:179], a[80:83], v[224:227], a[176:179]
 v_mfma_f32_16x16x32_bf16 a[176:179], a[84:87], v[232:235], a[176:179]
 v_mfma_f32_16x16x32_bf16 a[176:179], a[88:91], v[240:243], a[176:179]
 v_mfma_f32_16x16x32_bf16 a[176:179], a[92:95], v[248:251], a[176:179]
 v_mfma_f32_16x16x32_bf16 a[180:183], a[92:95], v[252:255], a[180:183]
 v_mfma_f32_16x16x32_bf16 a[180:183], a[88:91], v[244:247], a[180:183]
 v_mfma_f32_16x16x32_bf16 a[180:183], a[84:87], v[236:239], a[180:183]
 v_mfma_f32_16x16x32_bf16 a[180:183], a[80:83], v[228:231], a[180:183]
 s_waitcnt vmcnt(1)
 v_mfma_f32_16x16x32_bf16 a[128:131], v[70:73], a[204:207], a[128:131]
 v_mfma_f32_16x16x32_bf16 a[144:147], v[68:71], a[204:207], a[144:147]
 v_mfma_f32_16x16x32_bf16 a[160:163], v[70:73], a[220:223], a[160:163]
 v_mfma_f32_16x16x32_bf16 a[176:179], v[68:71], a[220:223], a[176:179]
 v_mfma_f32_16x16x32_bf16 a[132:135], v[70:73], a[236:239], a[132:135]
 v_mfma_f32_16x16x32_bf16 a[148:151], v[68:71], a[236:239], a[148:151]
 v_mfma_f32_16x16x32_bf16 a[164:167], v[70:73], a[252:255], a[164:167]
 v_mfma_f32_16x16x32_bf16 a[180:183], v[68:71], a[252:255], a[180:183]
 s_waitcnt vmcnt(0)
 v_cmp_ne_u32 vcc, 1, v13
 s_cbranch_vccnz L_slow_25
L_back_27:
 buffer_load_dwordx4 a[136:139], v64, s[48:51], s69 offen offset:0 sc1
 buffer_load_dwordx4 a[152:155], v64, s[48:51], s69 offen offset:1024 sc1
 buffer_load_dwordx4 a[168:171], v64, s[48:51], s69 offen offset:2048 sc1
 buffer_load_dwordx4 a[184:187], v64, s[48:51], s69 offen offset:3072 sc1
 s_waitcnt vmcnt(2)
 v_mfma_f32_16x16x32_bf16 a[128:131], v[70:73], a[136:139], a[128:131]
 v_mfma_f32_16x16x32_bf16 a[144:147], v[68:71], a[136:139], a[144:147]
 v_mfma_f32_16x16x32_bf16 a[160:163], v[70:73], a[152:155], a[160:163]
 v_mfma_f32_16x16x32_bf16 a[176:179], v[68:71], a[152:155], a[176:179]
 s_nop 4
 ds_write_b128 v77, a[128:131] offset:0
 ds_write_b128 v77, a[144:147] offset:64
 ds_write_b128 v77, a[160:163] offset:128
 ds_write_b128 v77, a[176:179] offset:192
 ds_read_b128 v[80:83], v78 offset:0
 ds_read_b128 v[84:87], v78 offset:1088
 ds_read_b128 v[88:91], v78 offset:2176
 ds_read_b128 v[92:95], v78 offset:3264
 s_waitcnt lgkmcnt(3)
 v_pk_add_f32 v[80:81], v[80:81], v[160:161]
 v_pk_add_f32 v[82:83], v[82:83], v[162:163]
 s_mov_b32 s72, 0
 buffer_store_dwordx4 v[80:83], v74, s[52:55], s72 offen sc1
 s_waitcnt lgkmcnt(2)
 v_pk_add_f32 v[84:85], v[84:85], v[164:165]
 v_pk_add_f32 v[86:87], v[86:87], v[166:167]
 s_mov_b32 s72, 65536
 buffer_store_dwordx4 v[84:87], v74, s[52:55], s72 offen sc1
 s_waitcnt lgkmcnt(1)
 v_pk_add_f32 v[88:89], v[88:89], v[168:169]
 v_pk_add_f32 v[90:91], v[90:91], v[170:171]
 s_mov_b32 s72, 131072
 buffer_store_dwordx4 v[88:91], v74, s[52:55], s72 offen sc1
 s_waitcnt lgkmcnt(0)
 v_pk_add_f32 v[92:93], v[92:93], v[172:173]
 v_pk_add_f32 v[94:95], v[94:95], v[174:175]
 s_mov_b32 s72, 196608
 buffer_store_dwordx4 v[92:95], v74, s[52:55], s72 offen sc1
 s_waitcnt vmcnt(4)
 v_mfma_f32_16x16x32_bf16 a[132:135], v[70:73], a[168:171], a[132:135]
 v_mfma_f32_16x16x32_bf16 a[148:151], v[68:71], a[168:171], a[148:151]
 v_mfma_f32_16x16x32_bf16 a[164:167], v[70:73], a[184:187], a[164:167]
 v_mfma_f32_16x16x32_bf16 a[180:183], v[68:71], a[184:187], a[180:183]
 s_nop 4
 ds_write_b128 v77, a[132:135] offset:0
 ds_write_b128 v77, a[148:151] offset:64
 ds_write_b128 v77, a[164:167] offset:128
 ds_write_b128 v77, a[180:183] offset:192
 ds_read_b128 v[96:99], v78 offset:0
 ds_read_b128 v[100:103], v78 offset:1088
 ds_read_b128 v[104:107], v78 offset:2176
 ds_read_b128 v[108:111], v78 offset:3264
 s_waitcnt lgkmcnt(3)
 v_pk_add_f32 v[96:97], v[96:97], v[128:129]
 v_pk_add_f32 v[98:99], v[98:99], v[130:131]
 s_mov_b32 s72, 8192
 buffer_store_dwordx4 v[96:99], v74, s[52:55], s72 offen sc1
 s_waitcnt lgkmcnt(2)
 v_pk_add_f32 v[100:101], v[100:101], v[132:133]
 v_pk_add_f32 v[102:103], v[102:103], v[134:135]
 s_mov_b32 s72, 73728
 buffer_store_dwordx4 v[100:103], v74, s[52:55], s72 offen sc1
 s_waitcnt lgkmcnt(1)
 v_pk_add_f32 v[104:105], v[104:105], v[136:137]
 v_pk_add_f32 v[106:107], v[106:107], v[138:139]
 s_mov_b32 s72, 139264
 buffer_store_dwordx4 v[104:107], v74, s[52:55], s72 offen sc1
 s_waitcnt lgkmcnt(0)
 v_pk_add_f32 v[108:109], v[108:109], v[140:141]
 v_pk_add_f32 v[110:111], v[110:111], v[142:143]
 s_mov_b32 s72, 204800
 buffer_store_dwordx4 v[108:111], v74, s[52:55], s72 offen sc1
L_exit:
 s_endpgm
L_tail1:
L_pad13:
 s_cbranch_execz L_main
 s_waitcnt vmcnt(23) lgkmcnt(4)
 v_mfma_f32_16x16x32_bf16 a[192:195], a[80:83], v[160:163], a[192:195]
 ds_read_b128 a[112:115], v26 offset:12288
 s_lshl_b32 s68, s100, 14
 v_mfma_f32_16x16x32_bf16 a[192:195], a[84:87], v[168:171], a[192:195]
 ds_read_b128 a[116:119], v29 offset:12288
 v_mov_b32 v1, 1
 v_mfma_f32_16x16x32_bf16 a[192:195], a[88:91], a[48:51], a[192:195]
 ds_read_b128 a[120:123], v27 offset:12288
 buffer_load_dwordx4 v62, s[44:47], s78 offen offset:0 lds
 v_mfma_f32_16x16x32_bf16 a[192:195], a[92:95], a[56:59], a[192:195]
 ds_read_b128 a[124:127], v30 offset:12288
 s_add_u32 s69, s68, 25169920
 v_mfma_f32_16x16x32_bf16 a[196:199], a[92:95], a[60:63], a[196:199]
 s_add_u32 s70, s68, 25174016
 s_add_u32 s71, s68, 25178112
 s_lshl_b32 s68, s100, 7
 v_mfma_f32_16x16x32_bf16 a[196:199], a[88:91], a[52:55], a[196:199]
 s_add_u32 s68, s68, 42041344
 v_mfma_f32_16x16x32_bf16 a[196:199], a[84:87], v[172:175], a[196:199]
 v_mfma_f32_16x16x32_bf16 a[196:199], a[80:83], v[164:167], a[196:199]
 buffer_load_dwordx4 v63, s[44:47], s78 offen offset:1024 lds
 s_waitcnt lgkmcnt(4)
 v_mfma_f32_16x16x32_bf16 a[208:211], a[96:99], v[160:163], a[208:211]
 ds_read_b128 a[80:83], v26 offset:14336
 s_xor_b32 s78, s3, 3
 v_mfma_f32_16x16x32_bf16 a[208:211], a[100:103], v[168:171], a[208:211]
 ds_read_b128 a[84:87], v29 offset:14336
 s_add_u32 m0, s67, 84480
 v_mfma_f32_16x16x32_bf16 a[208:211], a[104:107], a[48:51], a[208:211]
 ds_read_b128 a[88:91], v27 offset:14336
 s_lshl_b32 s78, s78, 7
 v_mfma_f32_16x16x32_bf16 a[208:211], a[108:111], a[56:59], a[208:211]
 ds_read_b128 a[92:95], v30 offset:14336
 buffer_load_dwordx4 v[148:151], v19, s[48:51], s2 offen offset:1024 sc1
 v_mfma_f32_16x16x32_bf16 a[212:215], a[108:111], a[60:63], a[212:215]
 s_add_u32 s2, s2, 4096
 v_mfma_f32_16x16x32_bf16 a[212:215], a[104:107], a[52:55], a[212:215]
 v_mfma_f32_16x16x32_bf16 a[212:215], a[100:103], v[172:175], a[212:215]
 v_mfma_f32_16x16x32_bf16 a[212:215], a[96:99], v[164:167], a[212:215]
 s_waitcnt vmcnt(34) lgkmcnt(4)
 s_barrier
 v_mfma_f32_16x16x32_bf16 a[224:227], a[112:115], v[160:163], a[224:227]
 ds_read_b128 a[96:99], v26 offset:25088
 buffer_load_dwordx4 v[152:155], v19, s[48:51], s2 offen offset:0 sc1
 v_mfma_f32_16x16x32_bf16 a[224:227], a[116:119], v[168:171], a[224:227]
 ds_read_b128 a[100:103], v29 offset:25088
 v_mfma_f32_16x16x32_bf16 a[224:227], a[120:123], a[48:51], a[224:227]
 ds_read_b128 a[104:107], v27 offset:41984
 v_mfma_f32_16x16x32_bf16 a[224:227], a[124:127], a[56:59], a[224:227]
 ds_read_b128 a[108:111], v30 offset:41984
 v_mfma_f32_16x16x32_bf16 a[228:231], a[124:127], a[60:63], a[228:231]
 v_mfma_f32_16x16x32_bf16 a[228:231], a[120:123], a[52:55], a[228:231]
 buffer_load_dwordx4 v[156:159], v19, s[48:51], s2 offen offset:1024 sc1
 s_xor_b32 s2, s3, 3
 v_mfma_f32_16x16x32_bf16 a[228:231], a[116:119], v[172:175], a[228:231]
 s_lshl_b32 s2, s2, 13
 s_add_u32 s2, s2, 147456
 v_mfma_f32_16x16x32_bf16 a[228:231], a[112:115], v[164:167], a[228:231]
 s_waitcnt lgkmcnt(4)
 v_mfma_f32_16x16x32_bf16 a[240:243], a[80:83], v[160:163], a[240:243]
 ds_read_b128 a[112:115], v26 offset:27136
 v_mfma_f32_16x16x32_bf16 a[240:243], a[84:87], v[168:171], a[240:243]
 ds_read_b128 a[116:119], v29 offset:27136
 v_mfma_f32_16x16x32_bf16 a[240:243], a[88:91], a[48:51], a[240:243]
 ds_read_b128 a[120:123], v27 offset:44032
 buffer_load_dwordx4 a[0:3], v19, s[48:51], s2 offen offset:0 sc1
 v_mfma_f32_16x16x32_bf16 a[240:243], a[92:95], a[56:59], a[240:243]
 ds_read_b128 a[124:127], v30 offset:44032
 v_mfma_f32_16x16x32_bf16 a[244:247], a[92:95], a[60:63], a[244:247]
 v_mfma_f32_16x16x32_bf16 a[244:247], a[88:91], a[52:55], a[244:247]
 v_mfma_f32_16x16x32_bf16 a[244:247], a[84:87], v[172:175], a[244:247]
 buffer_load_dwordx4 a[4:7], v19, s[48:51], s2 offen offset:1024 sc1
 s_add_u32 s2, s2, 4096
 v_mfma_f32_16x16x32_bf16 a[244:247], a[80:83], v[164:167], a[244:247]
 s_waitcnt vmcnt(21) lgkmcnt(4)
 v_mfma_f32_16x16x32_bf16 a[192:195], a[96:99], a[64:67], a[192:195]
 ds_read_b128 a[80:83], v26 offset:29184
 v_mfma_f32_16x16x32_bf16 a[192:195], a[100:103], a[72:75], a[192:195]
 ds_read_b128 a[84:87], v29 offset:29184
 v_mfma_f32_16x16x32_bf16 a[192:195], a[104:107], v[128:131], a[192:195]
 ds_read_b128 a[88:91], v27 offset:46080
 v_mfma_f32_16x16x32_bf16 a[192:195], a[108:111], v[136:139], a[192:195]
 ds_read_b128 a[92:95], v30 offset:46080
 buffer_load_dwordx4 a[8:11], v19, s[48:51], s2 offen offset:0 sc1
 v_mfma_f32_16x16x32_bf16 a[196:199], a[108:111], v[140:143], a[196:199]
 v_mfma_f32_16x16x32_bf16 a[196:199], a[104:107], v[132:135], a[196:199]
 v_mfma_f32_16x16x32_bf16 a[196:199], a[100:103], a[76:79], a[196:199]
 v_mfma_f32_16x16x32_bf16 a[196:199], a[96:99], a[68:71], a[196:199]
 s_waitcnt lgkmcnt(4)
 v_mfma_f32_16x16x32_bf16 a[208:211], a[112:115], a[64:67], a[208:211]
 ds_read_b128 a[96:99], v26 offset:31232
 buffer_load_dwordx4 a[12:15], v19, s[48:51], s2 offen offset:1024 sc1
 v_mfma_f32_16x16x32_bf16 a[208:211], a[116:119], a[72:75], a[208:211]
 ds_read_b128 a[100:103], v29 offset:31232
 s_xor_b32 s2, s3, 0
 v_mfma_f32_16x16x32_bf16 a[208:211], a[120:123], v[128:131], a[208:211]
 ds_read_b128 a[104:107], v27 offset:48128
 s_lshl_b32 s2, s2, 13
 v_mfma_f32_16x16x32_bf16 a[208:211], a[124:127], v[136:139], a[208:211]
 ds_read_b128 a[108:111], v30 offset:48128
 s_add_u32 s2, s2, 114688
 v_mfma_f32_16x16x32_bf16 a[212:215], a[124:127], v[140:143], a[212:215]
 v_mfma_f32_16x16x32_bf16 a[212:215], a[120:123], v[132:135], a[212:215]
 buffer_load_dwordx4 v60, s[40:43], s78 offen offset:0 lds
 v_mfma_f32_16x16x32_bf16 a[212:215], a[116:119], a[76:79], a[212:215]
 v_mfma_f32_16x16x32_bf16 a[212:215], a[112:115], a[68:71], a[212:215]
 s_waitcnt vmcnt(12) lgkmcnt(4)
 s_barrier
 v_mfma_f32_16x16x32_bf16 a[224:227], a[80:83], a[64:67], a[224:227]
 ds_read_b128 a[112:115], v26 offset:41984
 v_mfma_f32_16x16x32_bf16 a[224:227], a[84:87], a[72:75], a[224:227]
 ds_read_b128 a[116:119], v29 offset:41984
 buffer_load_dwordx4 v61, s[40:43], s78 offen offset:1024 lds
 v_mfma_f32_16x16x32_bf16 a[224:227], a[88:91], v[128:131], a[224:227]
 ds_read_b128 a[120:123], v28 offset:8192
 s_xor_b32 s78, s3, 0
 v_mfma_f32_16x16x32_bf16 a[224:227], a[92:95], v[136:139], a[224:227]
 ds_read_b128 a[124:127], v31 offset:8192
 s_add_u32 m0, s67, 33792
L_pad14:
 s_cbranch_execz L_main
 v_mfma_f32_16x16x32_bf16 a[228:231], a[92:95], v[140:143], a[228:231]
 s_lshl_b32 s78, s78, 7
 v_mfma_f32_16x16x32_bf16 a[228:231], a[88:91], v[132:135], a[228:231]
 v_mfma_f32_16x16x32_bf16 a[228:231], a[84:87], a[76:79], a[228:231]
 buffer_load_dwordx4 v60, s[44:47], s78 offen offset:0 lds
 v_mfma_f32_16x16x32_bf16 a[228:231], a[80:83], a[68:71], a[228:231]
 s_waitcnt lgkmcnt(4)
 v_mfma_f32_16x16x32_bf16 a[240:243], a[96:99], a[64:67], a[240:243]
 ds_read_b128 a[80:83], v26 offset:44032
 v_mfma_f32_16x16x32_bf16 a[240:243], a[100:103], a[72:75], a[240:243]
 ds_read_b128 a[84:87], v29 offset:44032
 v_mfma_f32_16x16x32_bf16 a[240:243], a[104:107], v[128:131], a[240:243]
 ds_read_b128 a[88:91], v28 offset:10240
 v_mfma_f32_16x16x32_bf16 a[240:243], a[108:111], v[136:139], a[240:243]
 ds_read_b128 a[92:95], v31 offset:10240
 buffer_load_dwordx4 v61, s[44:47], s78 offen offset:1024 lds
 v_mfma_f32_16x16x32_bf16 a[244:247], a[108:111], v[140:143], a[244:247]
 s_xor_b32 s78, s3, 1
 s_add_u32 m0, s67, 101376
 s_lshl_b32 s78, s78, 7
 v_mfma_f32_16x16x32_bf16 a[244:247], a[104:107], v[132:135], a[244:247]
 v_mfma_f32_16x16x32_bf16 a[244:247], a[100:103], a[76:79], a[244:247]
 v_mfma_f32_16x16x32_bf16 a[244:247], a[96:99], a[68:71], a[244:247]
 s_waitcnt vmcnt(18) lgkmcnt(4)
 v_mfma_f32_16x16x32_bf16 a[192:195], a[112:115], v[80:83], a[192:195]
 ds_read_b128 a[96:99], v26 offset:46080
 buffer_load_dwordx4 v60, s[44:47], s78 offen offset:0 lds
 v_mfma_f32_16x16x32_bf16 a[192:195], a[116:119], v[88:91], a[192:195]
 ds_read_b128 a[100:103], v29 offset:46080
 v_mfma_f32_16x16x32_bf16 a[192:195], a[120:123], v[96:99], a[192:195]
 ds_read_b128 a[104:107], v28 offset:12288
 v_mfma_f32_16x16x32_bf16 a[192:195], a[124:127], v[104:107], a[192:195]
 ds_read_b128 a[108:111], v31 offset:12288
 v_mfma_f32_16x16x32_bf16 a[196:199], a[124:127], v[108:111], a[196:199]
 buffer_load_dwordx4 v61, s[44:47], s78 offen offset:1024 lds
 s_xor_b32 s78, s3, 2
 v_mfma_f32_16x16x32_bf16 a[196:199], a[120:123], v[100:103], a[196:199]
 s_add_u32 m0, s67, 118272
 s_lshl_b32 s78, s78, 7
 v_mfma_f32_16x16x32_bf16 a[196:199], a[116:119], v[92:95], a[196:199]
 v_mfma_f32_16x16x32_bf16 a[196:199], a[112:115], v[84:87], a[196:199]
 s_waitcnt lgkmcnt(4)
 v_mfma_f32_16x16x32_bf16 a[208:211], a[80:83], v[80:83], a[208:211]
 ds_read_b128 a[112:115], v26 offset:48128
 v_mfma_f32_16x16x32_bf16 a[208:211], a[84:87], v[88:91], a[208:211]
 ds_read_b128 a[116:119], v29 offset:48128
 buffer_load_dwordx4 v60, s[44:47], s78 offen offset:0 lds
 v_mfma_f32_16x16x32_bf16 a[208:211], a[88:91], v[96:99], a[208:211]
 ds_read_b128 a[120:123], v28 offset:14336
 v_mfma_f32_16x16x32_bf16 a[208:211], a[92:95], v[104:107], a[208:211]
 ds_read_b128 a[124:127], v31 offset:14336
 v_mfma_f32_16x16x32_bf16 a[212:215], a[92:95], v[108:111], a[212:215]
 v_mfma_f32_16x16x32_bf16 a[212:215], a[88:91], v[100:103], a[212:215]
 v_mfma_f32_16x16x32_bf16 a[212:215], a[84:87], v[92:95], a[212:215]
 buffer_load_dwordx4 v61, s[44:47], s78 offen offset:1024 lds
 s_xor_b32 s78, s3, 3
 v_mfma_f32_16x16x32_bf16 a[212:215], a[80:83], v[84:87], a[212:215]
 s_add_u32 m0, s67, 67584
 s_waitcnt vmcnt(15) lgkmcnt(4)
 s_barrier
 v_mfma_f32_16x16x32_bf16 a[224:227], a[96:99], v[80:83], a[224:227]
 ds_read_b128 a[80:83], v28 offset:25088
 s_lshl_b32 s78, s78, 7
 v_mfma_f32_16x16x32_bf16 a[224:227], a[100:103], v[88:91], a[224:227]
 ds_read_b128 a[84:87], v31 offset:25088
 v_mfma_f32_16x16x32_bf16 a[224:227], a[104:107], v[96:99], a[224:227]
 ds_read_b128 a[88:91], v27 offset:25088
 v_mfma_f32_16x16x32_bf16 a[224:227], a[108:111], v[104:107], a[224:227]
 ds_read_b128 a[92:95], v30 offset:25088
 buffer_load_dwordx4 v60, s[44:47], s78 offen offset:0 lds
 v_mfma_f32_16x16x32_bf16 a[228:231], a[108:111], v[108:111], a[228:231]
 v_mfma_f32_16x16x32_bf16 a[228:231], a[104:107], v[100:103], a[228:231]
 v_mfma_f32_16x16x32_bf16 a[228:231], a[100:103], v[92:95], a[228:231]
 v_mfma_f32_16x16x32_bf16 a[228:231], a[96:99], v[84:87], a[228:231]
 buffer_load_dwordx4 v61, s[44:47], s78 offen offset:1024 lds
 s_waitcnt lgkmcnt(4)
 v_mfma_f32_16x16x32_bf16 a[240:243], a[112:115], v[80:83], a[240:243]
 ds_read_b128 a[96:99], v28 offset:27136
 v_mfma_f32_16x16x32_bf16 a[240:243], a[116:119], v[88:91], a[240:243]
 ds_read_b128 a[100:103], v31 offset:27136
 v_mfma_f32_16x16x32_bf16 a[240:243], a[120:123], v[96:99], a[240:243]
 ds_read_b128 a[104:107], v27 offset:27136
 v_mfma_f32_16x16x32_bf16 a[240:243], a[124:127], v[104:107], a[240:243]
 ds_read_b128 a[108:111], v30 offset:27136
 v_mfma_f32_16x16x32_bf16 a[244:247], a[124:127], v[108:111], a[244:247]
 buffer_load_dwordx4 v[112:115], v18, s[48:51], s2 offen offset:0 sc1
 v_mfma_f32_16x16x32_bf16 a[244:247], a[120:123], v[100:103], a[244:247]
 v_mfma_f32_16x16x32_bf16 a[244:247], a[116:119], v[92:95], a[244:247]
 v_mfma_f32_16x16x32_bf16 a[244:247], a[112:115], v[84:87], a[244:247]
 s_waitcnt vmcnt(11) lgkmcnt(4)
 v_mfma_f32_16x16x32_bf16 a[192:195], a[80:83], v[144:147], a[192:195]
 ds_read_b128 a[112:115], v28 offset:29184
 v_mfma_f32_16x16x32_bf16 a[192:195], a[84:87], v[152:155], a[192:195]
 ds_read_b128 a[116:119], v31 offset:29184
 buffer_load_dwordx4 v[116:119], v18, s[48:51], s2 offen offset:1024 sc1
 v_mfma_f32_16x16x32_bf16 a[192:195], a[88:91], a[0:3], a[192:195]
 ds_read_b128 a[120:123], v27 offset:29184
 s_add_u32 s2, s2, 4096
 v_mfma_f32_16x16x32_bf16 a[192:195], a[92:95], a[8:11], a[192:195]
 ds_read_b128 a[124:127], v30 offset:29184
 v_mfma_f32_16x16x32_bf16 a[196:199], a[92:95], a[12:15], a[196:199]
 v_mfma_f32_16x16x32_bf16 a[196:199], a[88:91], a[4:7], a[196:199]
 v_mfma_f32_16x16x32_bf16 a[196:199], a[84:87], v[156:159], a[196:199]
 buffer_load_dwordx4 v[120:123], v18, s[48:51], s2 offen offset:0 sc1
 v_mfma_f32_16x16x32_bf16 a[196:199], a[80:83], v[148:151], a[196:199]
 s_waitcnt lgkmcnt(4)
 v_mfma_f32_16x16x32_bf16 a[208:211], a[96:99], v[144:147], a[208:211]
 ds_read_b128 a[80:83], v28 offset:31232
 v_mfma_f32_16x16x32_bf16 a[208:211], a[100:103], v[152:155], a[208:211]
 ds_read_b128 a[84:87], v31 offset:31232
 v_mfma_f32_16x16x32_bf16 a[208:211], a[104:107], a[0:3], a[208:211]
 ds_read_b128 a[88:91], v27 offset:31232
 buffer_load_dwordx4 v[124:127], v18, s[48:51], s2 offen offset:1024 sc1
 v_mfma_f32_16x16x32_bf16 a[208:211], a[108:111], a[8:11], a[208:211]
 ds_read_b128 a[92:95], v30 offset:31232
 s_xor_b32 s2, s3, 1
 v_mfma_f32_16x16x32_bf16 a[212:215], a[108:111], a[12:15], a[212:215]
 s_lshl_b32 s2, s2, 13
 s_add_u32 s2, s2, 114688
 v_mfma_f32_16x16x32_bf16 a[212:215], a[104:107], a[4:7], a[212:215]
 v_mfma_f32_16x16x32_bf16 a[212:215], a[100:103], v[156:159], a[212:215]
 v_mfma_f32_16x16x32_bf16 a[212:215], a[96:99], v[148:151], a[212:215]
 s_waitcnt vmcnt(63) lgkmcnt(4)
 s_barrier
 v_mfma_f32_16x16x32_bf16 a[224:227], a[112:115], v[144:147], a[224:227]
 ds_read_b128 a[96:99], v26 offset:0
 buffer_load_dwordx4 a[16:19], v18, s[48:51], s2 offen offset:0 sc1
 v_mfma_f32_16x16x32_bf16 a[224:227], a[116:119], v[152:155], a[224:227]
 ds_read_b128 a[100:103], v29 offset:0
 v_mfma_f32_16x16x32_bf16 a[224:227], a[120:123], a[0:3], a[224:227]
 ds_read_b128 a[104:107], v27 offset:0
 v_mfma_f32_16x16x32_bf16 a[224:227], a[124:127], a[8:11], a[224:227]
 ds_read_b128 a[108:111], v30 offset:0
 v_mfma_f32_16x16x32_bf16 a[228:231], a[124:127], a[12:15], a[228:231]
 buffer_load_dwordx4 a[20:23], v18, s[48:51], s2 offen offset:1024 sc1
 s_add_u32 s2, s2, 4096
 v_mfma_f32_16x16x32_bf16 a[228:231], a[120:123], a[4:7], a[228:231]
 v_mfma_f32_16x16x32_bf16 a[228:231], a[116:119], v[156:159], a[228:231]
 v_mfma_f32_16x16x32_bf16 a[228:231], a[112:115], v[148:151], a[228:231]
 s_waitcnt lgkmcnt(4)
 v_mfma_f32_16x16x32_bf16 a[240:243], a[80:83], v[144:147], a[240:243]
 ds_read_b128 a[112:115], v26 offset:2048
 v_mfma_f32_16x16x32_bf16 a[240:243], a[84:87], v[152:155], a[240:243]
 ds_read_b128 a[116:119], v29 offset:2048
 buffer_load_dwordx4 a[24:27], v18, s[48:51], s2 offen offset:0 sc1
 v_mfma_f32_16x16x32_bf16 a[240:243], a[88:91], a[0:3], a[240:243]
 ds_read_b128 a[120:123], v27 offset:2048
 v_mfma_f32_16x16x32_bf16 a[240:243], a[92:95], a[8:11], a[240:243]
 ds_read_b128 a[124:127], v30 offset:2048
 v_mfma_f32_16x16x32_bf16 a[244:247], a[92:95], a[12:15], a[244:247]
 v_mfma_f32_16x16x32_bf16 a[244:247], a[88:91], a[4:7], a[244:247]
 v_mfma_f32_16x16x32_bf16 a[244:247], a[84:87], v[156:159], a[244:247]
 buffer_load_dwordx4 a[28:31], v18, s[48:51], s2 offen offset:1024 sc1
 s_xor_b32 s2, s3, 2
 v_mfma_f32_16x16x32_bf16 a[244:247], a[80:83], v[148:151], a[244:247]
 s_lshl_b32 s2, s2, 13
 s_add_u32 s2, s2, 114688
 s_waitcnt lgkmcnt(4)
 v_mfma_f32_16x16x32_bf16 a[128:131], a[96:99], v[160:163], a[128:131]
 ds_read_b128 a[80:83], v26 offset:4096
 v_mfma_f32_16x16x32_bf16 a[128:131], a[100:103], v[168:171], a[128:131]
 ds_read_b128 a[84:87], v29 offset:4096
 v_mfma_f32_16x16x32_bf16 a[128:131], a[104:107], a[48:51], a[128:131]
 ds_read_b128 a[88:91], v27 offset:4096
 v_mfma_f32_16x16x32_bf16 a[128:131], a[108:111], a[56:59], a[128:131]
 ds_read_b128 a[92:95], v30 offset:4096
 buffer_load_dwordx4 a[32:35], v18, s[48:51], s2 offen offset:0 sc1
 v_mfma_f32_16x16x32_bf16 a[132:135], a[108:111], a[60:63], a[132:135]
 v_mfma_f32_16x16x32_bf16 a[132:135], a[104:107], a[52:55], a[132:135]
 v_mfma_f32_16x16x32_bf16 a[132:135], a[100:103], v[172:175], a[132:135]
 v_mfma_f32_16x16x32_bf16 a[132:135], a[96:99], v[164:167], a[132:135]
 buffer_load_dwordx4 a[36:39], v18, s[48:51], s2 offen offset:1024 sc1
 s_waitcnt lgkmcnt(4)
 v_mfma_f32_16x16x32_bf16 a[144:147], a[112:115], v[160:163], a[144:147]
 ds_read_b128 a[96:99], v26 offset:6144
 s_add_u32 s2, s2, 4096
 v_mfma_f32_16x16x32_bf16 a[144:147], a[116:119], v[168:171], a[144:147]
 ds_read_b128 a[100:103], v29 offset:6144
 s_xor_b32 s82, s100, 3
 v_mfma_f32_16x16x32_bf16 a[144:147], a[120:123], a[48:51], a[144:147]
 ds_read_b128 a[104:107], v27 offset:6144
 s_lshl_b32 s82, s82, 14
 v_mfma_f32_16x16x32_bf16 a[144:147], a[124:127], a[56:59], a[144:147]
 ds_read_b128 a[108:111], v30 offset:6144
 s_add_u32 s82, s82, 25178112
 v_mfma_f32_16x16x32_bf16 a[148:151], a[124:127], a[60:63], a[148:151]
 buffer_load_dwordx4 a[40:43], v18, s[48:51], s2 offen offset:0 sc1
 v_accvgpr_read_b32 v2, a192
 v_mfma_f32_16x16x32_bf16 a[148:151], a[120:123], a[52:55], a[148:151]
 v_accvgpr_read_b32 v3, a193
 v_accvgpr_read_b32 v4, a194
 v_mfma_f32_16x16x32_bf16 a[148:151], a[116:119], v[172:175], a[148:151]
 v_accvgpr_read_b32 v5, a195
 v_accvgpr_read_b32 v6, a208
 v_mfma_f32_16x16x32_bf16 a[148:151], a[112:115], v[164:167], a[148:151]
 s_waitcnt vmcnt(19) lgkmcnt(4)
 s_barrier
 v_mfma_f32_16x16x32_bf16 a[160:163], a[80:83], v[160:163], a[160:163]
 ds_read_b128 a[112:115], v26 offset:16896
 v_accvgpr_read_b32 v7, a209
 v_mfma_f32_16x16x32_bf16 a[160:163], a[84:87], v[168:171], a[160:163]
 ds_read_b128 a[116:119], v29 offset:16896
 buffer_load_dwordx4 a[44:47], v18, s[48:51], s2 offen offset:1024 sc1
 v_mfma_f32_16x16x32_bf16 a[160:163], a[88:91], a[48:51], a[160:163]
 ds_read_b128 a[120:123], v27 offset:33792
 s_xor_b32 s2, s3, 3
 v_mfma_f32_16x16x32_bf16 a[160:163], a[92:95], a[56:59], a[160:163]
 ds_read_b128 a[124:127], v30 offset:33792
 s_lshl_b32 s2, s2, 13
 v_mfma_f32_16x16x32_bf16 a[164:167], a[92:95], a[60:63], a[164:167]
 s_add_u32 s2, s2, 114688
 v_accvgpr_read_b32 v8, a210
 v_mfma_f32_16x16x32_bf16 a[164:167], a[88:91], a[52:55], a[164:167]
 v_accvgpr_read_b32 v9, a211
 v_cvt_pk_bf16_f32 v32, v2, v3
 v_mfma_f32_16x16x32_bf16 a[164:167], a[84:87], v[172:175], a[164:167]
 buffer_load_dwordx4 v[176:179], v18, s[48:51], s2 offen offset:0 sc1
 v_cvt_pk_bf16_f32 v33, v4, v5
 v_mfma_f32_16x16x32_bf16 a[164:167], a[80:83], v[164:167], a[164:167]
 v_cvt_pk_bf16_f32 v34, v6, v7
 s_waitcnt lgkmcnt(4)
 v_mfma_f32_16x16x32_bf16 a[176:179], a[96:99], v[160:163], a[176:179]
 ds_read_b128 a[80:83], v26 offset:18944
 v_cvt_pk_bf16_f32 v35, v8, v9
 v_mfma_f32_16x16x32_bf16 a[176:179], a[100:103], v[168:171], a[176:179]
 ds_read_b128 a[84:87], v29 offset:18944
 v_mfma_f32_16x16x32_bf16 a[176:179], a[104:107], a[48:51], a[176:179]
 ds_read_b128 a[88:91], v27 offset:35840
 buffer_store_dwordx4 v[32:35], v64, s[48:51], s82 offen offset:0 sc1
 v_mfma_f32_16x16x32_bf16 a[176:179], a[108:111], a[56:59], a[176:179]
 ds_read_b128 a[92:95], v30 offset:35840
 v_accvgpr_read_b32 v2, a224
 v_mfma_f32_16x16x32_bf16 a[180:183], a[108:111], a[60:63], a[180:183]
 v_accvgpr_read_b32 v3, a225
 v_accvgpr_read_b32 v4, a226
 v_mfma_f32_16x16x32_bf16 a[180:183], a[104:107], a[52:55], a[180:183]
 v_accvgpr_read_b32 v5, a227
 v_accvgpr_read_b32 v6, a240
 v_mfma_f32_16x16x32_bf16 a[180:183], a[100:103], v[172:175], a[180:183]
 v_accvgpr_read_b32 v7, a241
 v_accvgpr_read_b32 v8, a242
 v_mfma_f32_16x16x32_bf16 a[180:183], a[96:99], v[164:167], a[180:183]
 buffer_load_dwordx4 v[180:183], v18, s[48:51], s2 offen offset:1024 sc1
 s_waitcnt lgkmcnt(4)
 v_mfma_f32_16x16x32_bf16 a[128:131], a[112:115], a[64:67], a[128:131]
 ds_read_b128 a[96:99], v26 offset:20992
 s_add_u32 s2, s2, 4096
 v_mfma_f32_16x16x32_bf16 a[128:131], a[116:119], a[72:75], a[128:131]
 ds_read_b128 a[100:103], v29 offset:20992
 v_accvgpr_read_b32 v9, a243
 v_mfma_f32_16x16x32_bf16 a[128:131], a[120:123], v[128:131], a[128:131]
 ds_read_b128 a[104:107], v27 offset:37888
 v_cvt_pk_bf16_f32 v36, v2, v3
 v_mfma_f32_16x16x32_bf16 a[128:131], a[124:127], v[136:139], a[128:131]
 ds_read_b128 a[108:111], v30 offset:37888
 v_cvt_pk_bf16_f32 v37, v4, v5
 v_mfma_f32_16x16x32_bf16 a[132:135], a[124:127], v[140:143], a[132:135]
 buffer_load_dwordx4 v[184:187], v18, s[48:51], s2 offen offset:0 sc1
 v_cvt_pk_bf16_f32 v38, v6, v7
 v_mfma_f32_16x16x32_bf16 a[132:135], a[120:123], v[132:135], a[132:135]
 v_cvt_pk_bf16_f32 v39, v8, v9
 v_mfma_f32_16x16x32_bf16 a[132:135], a[116:119], a[76:79], a[132:135]
 v_mfma_f32_16x16x32_bf16 a[132:135], a[112:115], a[68:71], a[132:135]
 s_waitcnt lgkmcnt(4)
 v_mfma_f32_16x16x32_bf16 a[144:147], a[80:83], a[64:67], a[144:147]
 ds_read_b128 a[112:115], v26 offset:23040
 v_mfma_f32_16x16x32_bf16 a[144:147], a[84:87], a[72:75], a[144:147]
 ds_read_b128 a[116:119], v29 offset:23040
 buffer_store_dwordx4 v[36:39], v64, s[48:51], s82 offen offset:1024 sc1
 v_mfma_f32_16x16x32_bf16 a[144:147], a[88:91], v[128:131], a[144:147]
 ds_read_b128 a[120:123], v27 offset:39936
 v_accvgpr_read_b32 v2, a196
 v_mfma_f32_16x16x32_bf16 a[144:147], a[92:95], v[136:139], a[144:147]
 ds_read_b128 a[124:127], v30 offset:39936
 v_accvgpr_read_b32 v3, a197
 v_mfma_f32_16x16x32_bf16 a[148:151], a[92:95], v[140:143], a[148:151]
 v_accvgpr_read_b32 v4, a198
 v_accvgpr_read_b32 v5, a199
 v_mfma_f32_16x16x32_bf16 a[148:151], a[88:91], v[132:135], a[148:151]
 buffer_load_dwordx4 v[188:191], v18, s[48:51], s2 offen offset:1024 sc1
 s_xor_b32 s2, s3, 0
 v_mfma_f32_16x16x32_bf16 a[148:151], a[84:87], a[76:79], a[148:151]
 s_lshl_b32 s2, s2, 13
 s_add_u32 s2, s2, 147456
 v_accvgpr_read_b32 v6, a212
 v_mfma_f32_16x16x32_bf16 a[148:151], a[80:83], a[68:71], a[148:151]
 s_waitcnt vmcnt(22) lgkmcnt(4)
 s_barrier
 v_mfma_f32_16x16x32_bf16 a[160:163], a[96:99], a[64:67], a[160:163]
 ds_read_b128 a[80:83], v26 offset:33792
 v_accvgpr_read_b32 v7, a213
 v_mfma_f32_16x16x32_bf16 a[160:163], a[100:103], a[72:75], a[160:163]
 ds_read_b128 a[84:87], v29 offset:33792
 v_accvgpr_read_b32 v8, a214
 v_mfma_f32_16x16x32_bf16 a[160:163], a[104:107], v[128:131], a[160:163]
 ds_read_b128 a[88:91], v28 offset:0
 buffer_load_dwordx4 v[192:195], v18, s[48:51], s2 offen offset:0 sc1
 v_mfma_f32_16x16x32_bf16 a[160:163], a[108:111], v[136:139], a[160:163]
 ds_read_b128 a[92:95], v31 offset:0
 v_accvgpr_read_b32 v9, a215
 v_mfma_f32_16x16x32_bf16 a[164:167], a[108:111], v[140:143], a[164:167]
 v_cvt_pk_bf16_f32 v32, v2, v3
 v_cvt_pk_bf16_f32 v33, v4, v5
 v_mfma_f32_16x16x32_bf16 a[164:167], a[104:107], v[132:135], a[164:167]
 v_cvt_pk_bf16_f32 v34, v6, v7
 v_cvt_pk_bf16_f32 v35, v8, v9
 v_mfma_f32_16x16x32_bf16 a[164:167], a[100:103], a[76:79], a[164:167]
 v_mfma_f32_16x16x32_bf16 a[164:167], a[96:99], a[68:71], a[164:167]
 buffer_store_dwordx4 v[32:35], v64, s[48:51], s82 offen offset:2048 sc1
 s_waitcnt lgkmcnt(4)
 v_mfma_f32_16x16x32_bf16 a[176:179], a[112:115], a[64:67], a[176:179]
 ds_read_b128 a[96:99], v26 offset:35840
 v_accvgpr_read_b32 v2, a228
 v_mfma_f32_16x16x32_bf16 a[176:179], a[116:119], a[72:75], a[176:179]
 ds_read_b128 a[100:103], v29 offset:35840
 v_accvgpr_read_b32 v3, a229
 v_mfma_f32_16x16x32_bf16 a[176:179], a[120:123], v[128:131], a[176:179]
 ds_read_b128 a[104:107], v28 offset:2048
 v_accvgpr_read_b32 v4, a230
 v_mfma_f32_16x16x32_bf16 a[176:179], a[124:127], v[136:139], a[176:179]
 ds_read_b128 a[108:111], v31 offset:2048
 v_accvgpr_read_b32 v5, a231
 v_mfma_f32_16x16x32_bf16 a[180:183], a[124:127], v[140:143], a[180:183]
 buffer_load_dwordx4 v[196:199], v18, s[48:51], s2 offen offset:1024 sc1
 s_add_u32 s2, s2, 4096
 v_mfma_f32_16x16x32_bf16 a[180:183], a[120:123], v[132:135], a[180:183]
 v_accvgpr_read_b32 v6, a244
 v_accvgpr_read_b32 v7, a245
 v_mfma_f32_16x16x32_bf16 a[180:183], a[116:119], a[76:79], a[180:183]
 v_accvgpr_read_b32 v8, a246
 v_accvgpr_read_b32 v9, a247
 v_mfma_f32_16x16x32_bf16 a[180:183], a[112:115], a[68:71], a[180:183]
 v_cvt_pk_bf16_f32 v36, v2, v3
 s_waitcnt lgkmcnt(4)
 v_mfma_f32_16x16x32_bf16 a[128:131], a[80:83], v[80:83], a[128:131]
 ds_read_b128 a[112:115], v26 offset:37888
 buffer_load_dwordx4 v[200:203], v18, s[48:51], s2 offen offset:0 sc1
 v_mfma_f32_16x16x32_bf16 a[128:131], a[84:87], v[88:91], a[128:131]
 ds_read_b128 a[116:119], v29 offset:37888
 v_cvt_pk_bf16_f32 v37, v4, v5
 v_mfma_f32_16x16x32_bf16 a[128:131], a[88:91], v[96:99], a[128:131]
 ds_read_b128 a[120:123], v28 offset:4096
 v_cvt_pk_bf16_f32 v38, v6, v7
 v_mfma_f32_16x16x32_bf16 a[128:131], a[92:95], v[104:107], a[128:131]
 ds_read_b128 a[124:127], v31 offset:4096
 v_cvt_pk_bf16_f32 v39, v8, v9
 v_mfma_f32_16x16x32_bf16 a[132:135], a[92:95], v[108:111], a[132:135]
 v_mfma_f32_16x16x32_bf16 a[132:135], a[88:91], v[100:103], a[132:135]
 buffer_store_dwordx4 v[36:39], v64, s[48:51], s82 offen offset:3072 sc1
 v_mfma_f32_16x16x32_bf16 a[132:135], a[84:87], v[92:95], a[132:135]
 v_mfma_f32_16x16x32_bf16 a[132:135], a[80:83], v[84:87], a[132:135]
 s_waitcnt lgkmcnt(4)
 v_mfma_f32_16x16x32_bf16 a[144:147], a[96:99], v[80:83], a[144:147]
 ds_read_b128 a[80:83], v26 offset:39936
 v_mfma_f32_16x16x32_bf16 a[144:147], a[100:103], v[88:91], a[144:147]
 ds_read_b128 a[84:87], v29 offset:39936
 v_mfma_f32_16x16x32_bf16 a[144:147], a[104:107], v[96:99], a[144:147]
 ds_read_b128 a[88:91], v28 offset:6144
 buffer_load_dwordx4 v[204:207], v18, s[48:51], s2 offen offset:1024 sc1
 v_mfma_f32_16x16x32_bf16 a[144:147], a[108:111], v[104:107], a[144:147]
 ds_read_b128 a[92:95], v31 offset:6144
 s_xor_b32 s2, s3, 1
 v_mfma_f32_16x16x32_bf16 a[148:151], a[108:111], v[108:111], a[148:151]
 s_lshl_b32 s2, s2, 13
 s_add_u32 s2, s2, 147456
 v_mfma_f32_16x16x32_bf16 a[148:151], a[104:107], v[100:103], a[148:151]
 v_mfma_f32_16x16x32_bf16 a[148:151], a[100:103], v[92:95], a[148:151]
 v_mfma_f32_16x16x32_bf16 a[148:151], a[96:99], v[84:87], a[148:151]
 s_waitcnt vmcnt(24) lgkmcnt(4)
 s_barrier
 v_mfma_f32_16x16x32_bf16 a[160:163], a[112:115], v[80:83], a[160:163]
 ds_read_b128 a[96:99], v28 offset:16896
 buffer_load_dwordx4 v[208:211], v18, s[48:51], s2 offen offset:0 sc1
 v_mfma_f32_16x16x32_bf16 a[160:163], a[116:119], v[88:91], a[160:163]
 ds_read_b128 a[100:103], v31 offset:16896
 v_mfma_f32_16x16x32_bf16 a[160:163], a[120:123], v[96:99], a[160:163]
 ds_read_b128 a[104:107], v27 offset:16896
 v_mfma_f32_16x16x32_bf16 a[160:163], a[124:127], v[104:107], a[160:163]
 ds_read_b128 a[108:111], v30 offset:16896
 v_mfma_f32_16x16x32_bf16 a[164:167], a[124:127], v[108:111], a[164:167]
 buffer_load_dwordx4 v[212:215], v18, s[48:51], s2 offen offset:1024 sc1
 s_add_u32 s2, s2, 4096
 v_mfma_f32_16x16x32_bf16 a[164:167], a[120:123], v[100:103], a[164:167]
 v_mfma_f32_16x16x32_bf16 a[164:167], a[116:119], v[92:95], a[164:167]
 v_mfma_f32_16x16x32_bf16 a[164:167], a[112:115], v[84:87], a[164:167]
 s_waitcnt lgkmcnt(4)
 v_mfma_f32_16x16x32_bf16 a[176:179], a[80:83], v[80:83], a[176:179]
 ds_read_b128 a[112:115], v28 offset:18944
 v_mfma_f32_16x16x32_bf16 a[176:179], a[84:87], v[88:91], a[176:179]
 ds_read_b128 a[116:119], v31 offset:18944
 buffer_load_dwordx4 v[216:219], v18, s[48:51], s2 offen offset:0 sc1
 v_mfma_f32_16x16x32_bf16 a[176:179], a[88:91], v[96:99], a[176:179]
 ds_read_b128 a[120:123], v27 offset:18944
 v_mfma_f32_16x16x32_bf16 a[176:179], a[92:95], v[104:107], a[176:179]
 ds_read_b128 a[124:127], v30 offset:18944
 v_mfma_f32_16x16x32_bf16 a[180:183], a[92:95], v[108:111], a[180:183]
 v_mfma_f32_16x16x32_bf16 a[180:183], a[88:91], v[100:103], a[180:183]
 v_mfma_f32_16x16x32_bf16 a[180:183], a[84:87], v[92:95], a[180:183]
 buffer_load_dwordx4 v[220:223], v18, s[48:51], s2 offen offset:1024 sc1
 s_xor_b32 s2, s3, 2
 v_mfma_f32_16x16x32_bf16 a[180:183], a[80:83], v[84:87], a[180:183]
 s_lshl_b32 s2, s2, 13
 s_add_u32 s2, s2, 147456
 s_waitcnt lgkmcnt(4)
 v_mfma_f32_16x16x32_bf16 a[128:131], a[96:99], v[144:147], a[128:131]
 ds_read_b128 a[80:83], v28 offset:20992
 v_mfma_f32_16x16x32_bf16 a[128:131], a[100:103], v[152:155], a[128:131]
 ds_read_b128 a[84:87], v31 offset:20992
 v_mfma_f32_16x16x32_bf16 a[128:131], a[104:107], a[0:3], a[128:131]
 ds_read_b128 a[88:91], v27 offset:20992
 v_mfma_f32_16x16x32_bf16 a[128:131], a[108:111], a[8:11], a[128:131]
 ds_read_b128 a[92:95], v30 offset:20992
 buffer_load_dwordx4 v[224:227], v18, s[48:51], s2 offen offset:0 sc1
 v_mfma_f32_16x16x32_bf16 a[132:135], a[108:111], a[12:15], a[132:135]
 v_mfma_f32_16x16x32_bf16 a[132:135], a[104:107], a[4:7], a[132:135]
 v_mfma_f32_16x16x32_bf16 a[132:135], a[100:103], v[156:159], a[132:135]
 v_mfma_f32_16x16x32_bf16 a[132:135], a[96:99], v[148:151], a[132:135]
 buffer_load_dwordx4 v[228:231], v18, s[48:51], s2 offen offset:1024 sc1
 s_waitcnt lgkmcnt(4)
 v_mfma_f32_16x16x32_bf16 a[144:147], a[112:115], v[144:147], a[144:147]
 ds_read_b128 a[96:99], v28 offset:23040
 s_add_u32 s2, s2, 4096
 v_mfma_f32_16x16x32_bf16 a[144:147], a[116:119], v[152:155], a[144:147]
 ds_read_b128 a[100:103], v31 offset:23040
 v_mfma_f32_16x16x32_bf16 a[144:147], a[120:123], a[0:3], a[144:147]
 ds_read_b128 a[104:107], v27 offset:23040
 v_mfma_f32_16x16x32_bf16 a[144:147], a[124:127], a[8:11], a[144:147]
 ds_read_b128 a[108:111], v30 offset:23040
 v_mfma_f32_16x16x32_bf16 a[148:151], a[124:127], a[12:15], a[148:151]
 buffer_load_dwordx4 v[232:235], v18, s[48:51], s2 offen offset:0 sc1
 v_mfma_f32_16x16x32_bf16 a[148:151], a[120:123], a[4:7], a[148:151]
 v_mfma_f32_16x16x32_bf16 a[148:151], a[116:119], v[156:159], a[148:151]
 v_mfma_f32_16x16x32_bf16 a[148:151], a[112:115], v[148:151], a[148:151]
 s_waitcnt lgkmcnt(4)
 v_mfma_f32_16x16x32_bf16 a[160:163], a[80:83], v[144:147], a[160:163]
 ds_read_b128 a[112:115], v26 offset:8192
 v_mfma_f32_16x16x32_bf16 a[160:163], a[84:87], v[152:155], a[160:163]
 ds_read_b128 a[116:119], v29 offset:8192
 buffer_load_dwordx4 v[236:239], v18, s[48:51], s2 offen offset:1024 sc1
 v_mfma_f32_16x16x32_bf16 a[160:163], a[88:91], a[0:3], a[160:163]
 ds_read_b128 a[120:123], v27 offset:8192
 s_xor_b32 s2, s3, 3
 v_mfma_f32_16x16x32_bf16 a[160:163], a[92:95], a[8:11], a[160:163]
 ds_read_b128 a[124:127], v30 offset:8192
 s_lshl_b32 s2, s2, 13
 v_mfma_f32_16x16x32_bf16 a[164:167], a[92:95], a[12:15], a[164:167]
 s_add_u32 s2, s2, 147456
 v_mfma_f32_16x16x32_bf16 a[164:167], a[88:91], a[4:7], a[164:167]
 v_mfma_f32_16x16x32_bf16 a[164:167], a[84:87], v[156:159], a[164:167]
 buffer_load_dwordx4 v[240:243], v18, s[48:51], s2 offen offset:0 sc1
 v_mfma_f32_16x16x32_bf16 a[164:167], a[80:83], v[148:151], a[164:167]
 s_waitcnt lgkmcnt(4)
 v_mfma_f32_16x16x32_bf16 a[176:179], a[96:99], v[144:147], a[176:179]
 ds_read_b128 a[80:83], v26 offset:10240
 v_mfma_f32_16x16x32_bf16 a[176:179], a[100:103], v[152:155], a[176:179]
 ds_read_b128 a[84:87], v29 offset:10240
 v_mfma_f32_16x16x32_bf16 a[176:179], a[104:107], a[0:3], a[176:179]
 ds_read_b128 a[88:91], v27 offset:10240
 buffer_load_dwordx4 v[244:247], v18, s[48:51], s2 offen offset:1024 sc1
 v_mfma_f32_16x16x32_bf16 a[176:179], a[108:111], a[8:11], a[176:179]
 ds_read_b128 a[92:95], v30 offset:10240
 s_add_u32 s2, s2, 4096
 v_mfma_f32_16x16x32_bf16 a[180:183], a[108:111], a[12:15], a[180:183]
 v_mfma_f32_16x16x32_bf16 a[180:183], a[104:107], a[4:7], a[180:183]
 v_mfma_f32_16x16x32_bf16 a[180:183], a[100:103], v[156:159], a[180:183]
 v_mfma_f32_16x16x32_bf16 a[180:183], a[96:99], v[148:151], a[180:183]
 buffer_load_dwordx4 v[248:251], v18, s[48:51], s2 offen offset:0 sc1
 s_waitcnt vmcnt(27) lgkmcnt(4)
 v_mfma_f32_16x16x32_bf16 a[200:203], a[112:115], v[112:115], a[200:203]
 ds_read_b128 a[96:99], v26 offset:12288
 v_mfma_f32_16x16x32_bf16 a[200:203], a[116:119], v[120:123], a[200:203]
 ds_read_b128 a[100:103], v29 offset:12288
 v_mfma_f32_16x16x32_bf16 a[200:203], a[120:123], a[16:19], a[200:203]
 ds_read_b128 a[104:107], v27 offset:12288
 v_mfma_f32_16x16x32_bf16 a[200:203], a[124:127], a[24:27], a[200:203]
 ds_read_b128 a[108:111], v30 offset:12288
 v_mfma_f32_16x16x32_bf16 a[204:207], a[124:127], a[28:31], a[204:207]
 buffer_load_dwordx4 v[252:255], v18, s[48:51], s2 offen offset:1024 sc1
 v_mfma_f32_16x16x32_bf16 a[204:207], a[120:123], a[20:23], a[204:207]
 v_mfma_f32_16x16x32_bf16 a[204:207], a[116:119], v[124:127], a[204:207]
 v_mfma_f32_16x16x32_bf16 a[204:207], a[112:115], v[116:119], a[204:207]
 s_waitcnt lgkmcnt(4)
 v_mfma_f32_16x16x32_bf16 a[216:219], a[80:83], v[112:115], a[216:219]
 ds_read_b128 a[112:115], v26 offset:14336
 s_xor_b32 s82, s100, 2
 v_mfma_f32_16x16x32_bf16 a[216:219], a[84:87], v[120:123], a[216:219]
 ds_read_b128 a[116:119], v29 offset:14336
 s_lshl_b32 s82, s82, 14
 v_mfma_f32_16x16x32_bf16 a[216:219], a[88:91], a[16:19], a[216:219]
 ds_read_b128 a[120:123], v27 offset:14336
 s_add_u32 s82, s82, 25174016
 v_mfma_f32_16x16x32_bf16 a[216:219], a[92:95], a[24:27], a[216:219]
 ds_read_b128 a[124:127], v30 offset:14336
 v_accvgpr_read_b32 v2, a128
 v_mfma_f32_16x16x32_bf16 a[220:223], a[92:95], a[28:31], a[220:223]
 v_accvgpr_read_b32 v3, a129
 v_accvgpr_read_b32 v4, a130
 v_mfma_f32_16x16x32_bf16 a[220:223], a[88:91], a[20:23], a[220:223]
 v_accvgpr_read_b32 v5, a131
 v_accvgpr_read_b32 v6, a144
 v_mfma_f32_16x16x32_bf16 a[220:223], a[84:87], v[124:127], a[220:223]
 v_accvgpr_read_b32 v7, a145
 v_accvgpr_read_b32 v8, a146
 v_mfma_f32_16x16x32_bf16 a[220:223], a[80:83], v[116:119], a[220:223]
 v_accvgpr_read_b32 v9, a147
 s_waitcnt lgkmcnt(4)
 v_mfma_f32_16x16x32_bf16 a[232:235], a[96:99], v[112:115], a[232:235]
 ds_read_b128 a[80:83], v26 offset:25088
 v_cvt_pk_bf16_f32 v32, v2, v3
 v_mfma_f32_16x16x32_bf16 a[232:235], a[100:103], v[120:123], a[232:235]
 ds_read_b128 a[84:87], v29 offset:25088
 v_cvt_pk_bf16_f32 v33, v4, v5
 v_mfma_f32_16x16x32_bf16 a[232:235], a[104:107], a[16:19], a[232:235]
 ds_read_b128 a[88:91], v27 offset:41984
 v_cvt_pk_bf16_f32 v34, v6, v7
 v_mfma_f32_16x16x32_bf16 a[232:235], a[108:111], a[24:27], a[232:235]
 ds_read_b128 a[92:95], v30 offset:41984
 v_cvt_pk_bf16_f32 v35, v8, v9
 v_mfma_f32_16x16x32_bf16 a[236:239], a[108:111], a[28:31], a[236:239]
 buffer_store_dwordx4 v[32:35], v64, s[48:51], s82 offen offset:0 sc1
 v_accvgpr_read_b32 v2, a160
 v_mfma_f32_16x16x32_bf16 a[236:239], a[104:107], a[20:23], a[236:239]
 v_accvgpr_read_b32 v3, a161
 v_accvgpr_read_b32 v4, a162
 v_mfma_f32_16x16x32_bf16 a[236:239], a[100:103], v[124:127], a[236:239]
 v_accvgpr_read_b32 v5, a163
 v_accvgpr_read_b32 v6, a176
 v_mfma_f32_16x16x32_bf16 a[236:239], a[96:99], v[116:119], a[236:239]
 v_accvgpr_read_b32 v7, a177
 s_waitcnt lgkmcnt(4)
 v_mfma_f32_16x16x32_bf16 a[248:251], a[112:115], v[112:115], a[248:251]
 ds_read_b128 a[96:99], v26 offset:27136
 v_accvgpr_read_b32 v8, a178
 v_mfma_f32_16x16x32_bf16 a[248:251], a[116:119], v[120:123], a[248:251]
 ds_read_b128 a[100:103], v29 offset:27136
 v_accvgpr_read_b32 v9, a179
 v_mfma_f32_16x16x32_bf16 a[248:251], a[120:123], a[16:19], a[248:251]
 ds_read_b128 a[104:107], v27 offset:44032
 v_cvt_pk_bf16_f32 v36, v2, v3
 v_mfma_f32_16x16x32_bf16 a[248:251], a[124:127], a[24:27], a[248:251]
 ds_read_b128 a[108:111], v30 offset:44032
L_pad15:
 s_cbranch_execz L_main
 v_cvt_pk_bf16_f32 v37, v4, v5
 v_mfma_f32_16x16x32_bf16 a[252:255], a[124:127], a[28:31], a[252:255]
 v_cvt_pk_bf16_f32 v38, v6, v7
 v_cvt_pk_bf16_f32 v39, v8, v9
 v_mfma_f32_16x16x32_bf16 a[252:255], a[120:123], a[20:23], a[252:255]
 buffer_store_dwordx4 v[36:39], v64, s[48:51], s82 offen offset:1024 sc1
 v_accvgpr_read_b32 v2, a132
 v_mfma_f32_16x16x32_bf16 a[252:255], a[116:119], v[124:127], a[252:255]
 v_accvgpr_read_b32 v3, a133
 v_accvgpr_read_b32 v4, a134
 v_mfma_f32_16x16x32_bf16 a[252:255], a[112:115], v[116:119], a[252:255]
 v_accvgpr_read_b32 v5, a135
 s_waitcnt vmcnt(20) lgkmcnt(4)
 v_mfma_f32_16x16x32_bf16 a[200:203], a[80:83], a[32:35], a[200:203]
 ds_read_b128 a[112:115], v26 offset:29184
 s_xor_b32 s75, s100, 3
 v_mfma_f32_16x16x32_bf16 a[200:203], a[84:87], a[40:43], a[200:203]
 ds_read_b128 a[116:119], v29 offset:29184
 s_lshl_b32 s75, s75, 7
 v_mfma_f32_16x16x32_bf16 a[200:203], a[88:91], v[176:179], a[200:203]
 ds_read_b128 a[120:123], v27 offset:46080
 s_add_u32 s75, s75, 42041356
 v_mfma_f32_16x16x32_bf16 a[200:203], a[92:95], v[184:187], a[200:203]
 ds_read_b128 a[124:127], v30 offset:46080
 s_waitcnt vmcnt(15)
 v_mfma_f32_16x16x32_bf16 a[204:207], a[92:95], v[188:191], a[204:207]
 buffer_store_dword v1, v11, s[48:51], s75 offen sc1
 v_accvgpr_read_b32 v6, a148
 v_mfma_f32_16x16x32_bf16 a[204:207], a[88:91], v[180:183], a[204:207]
 v_accvgpr_read_b32 v7, a149
 v_accvgpr_read_b32 v8, a150
 v_mfma_f32_16x16x32_bf16 a[204:207], a[84:87], a[44:47], a[204:207]
 v_accvgpr_read_b32 v9, a151
 v_cvt_pk_bf16_f32 v32, v2, v3
 v_mfma_f32_16x16x32_bf16 a[204:207], a[80:83], a[36:39], a[204:207]
 v_cvt_pk_bf16_f32 v33, v4, v5
 s_waitcnt lgkmcnt(4)
 v_mfma_f32_16x16x32_bf16 a[216:219], a[96:99], a[32:35], a[216:219]
 ds_read_b128 a[80:83], v26 offset:31232
 v_cvt_pk_bf16_f32 v34, v6, v7
 v_mfma_f32_16x16x32_bf16 a[216:219], a[100:103], a[40:43], a[216:219]
 ds_read_b128 a[84:87], v29 offset:31232
 v_cvt_pk_bf16_f32 v35, v8, v9
 v_mfma_f32_16x16x32_bf16 a[216:219], a[104:107], v[176:179], a[216:219]
 ds_read_b128 a[88:91], v27 offset:48128
 buffer_store_dwordx4 v[32:35], v64, s[48:51], s82 offen offset:2048 sc1
 v_mfma_f32_16x16x32_bf16 a[216:219], a[108:111], v[184:187], a[216:219]
 ds_read_b128 a[92:95], v30 offset:48128
 v_accvgpr_read_b32 v2, a164
 v_mfma_f32_16x16x32_bf16 a[220:223], a[108:111], v[188:191], a[220:223]
 v_accvgpr_read_b32 v3, a165
 v_accvgpr_read_b32 v4, a166
 v_mfma_f32_16x16x32_bf16 a[220:223], a[104:107], v[180:183], a[220:223]
 v_accvgpr_read_b32 v5, a167
 v_accvgpr_read_b32 v6, a180
 v_mfma_f32_16x16x32_bf16 a[220:223], a[100:103], a[44:47], a[220:223]
 v_accvgpr_read_b32 v7, a181
 v_accvgpr_read_b32 v8, a182
 v_mfma_f32_16x16x32_bf16 a[220:223], a[96:99], a[36:39], a[220:223]
 v_accvgpr_read_b32 v9, a183
 s_waitcnt lgkmcnt(4)
 v_mfma_f32_16x16x32_bf16 a[232:235], a[112:115], a[32:35], a[232:235]
 ds_read_b128 a[96:99], v26 offset:41984
 v_cvt_pk_bf16_f32 v36, v2, v3
 v_mfma_f32_16x16x32_bf16 a[232:235], a[116:119], a[40:43], a[232:235]
 ds_read_b128 a[100:103], v29 offset:41984
 v_cvt_pk_bf16_f32 v37, v4, v5
 v_mfma_f32_16x16x32_bf16 a[232:235], a[120:123], v[176:179], a[232:235]
 ds_read_b128 a[104:107], v28 offset:8192
 v_cvt_pk_bf16_f32 v38, v6, v7
 v_mfma_f32_16x16x32_bf16 a[232:235], a[124:127], v[184:187], a[232:235]
 ds_read_b128 a[108:111], v31 offset:8192
 v_cvt_pk_bf16_f32 v39, v8, v9
 v_mfma_f32_16x16x32_bf16 a[236:239], a[124:127], v[188:191], a[236:239]
 buffer_store_dwordx4 v[36:39], v64, s[48:51], s82 offen offset:3072 sc1
 v_mfma_f32_16x16x32_bf16 a[236:239], a[120:123], v[180:183], a[236:239]
 ds_read_b32 v80, v79 offset:0
 v_mfma_f32_16x16x32_bf16 a[236:239], a[116:119], a[44:47], a[236:239]
 ds_read_b32 v81, v79 offset:64
 v_mfma_f32_16x16x32_bf16 a[236:239], a[112:115], a[36:39], a[236:239]
 ds_read_b32 v82, v79 offset:128
 s_waitcnt lgkmcnt(7)
 v_mfma_f32_16x16x32_bf16 a[248:251], a[80:83], a[32:35], a[248:251]
 ds_read_b128 a[112:115], v26 offset:44032
 v_mfma_f32_16x16x32_bf16 a[248:251], a[84:87], a[40:43], a[248:251]
 ds_read_b128 a[116:119], v29 offset:44032
 v_mfma_f32_16x16x32_bf16 a[248:251], a[88:91], v[176:179], a[248:251]
 ds_read_b128 a[120:123], v28 offset:10240
 v_mfma_f32_16x16x32_bf16 a[248:251], a[92:95], v[184:187], a[248:251]
 ds_read_b128 a[124:127], v31 offset:10240
 v_mfma_f32_16x16x32_bf16 a[252:255], a[92:95], v[188:191], a[252:255]
 ds_read_b32 v83, v79 offset:192
 v_mfma_f32_16x16x32_bf16 a[252:255], a[88:91], v[180:183], a[252:255]
 ds_read_b32 v84, v79 offset:16
 v_mfma_f32_16x16x32_bf16 a[252:255], a[84:87], a[44:47], a[252:255]
 ds_read_b32 v85, v79 offset:80
 v_mfma_f32_16x16x32_bf16 a[252:255], a[80:83], a[36:39], a[252:255]
 ds_read_b32 v86, v79 offset:144
 s_waitcnt vmcnt(13) lgkmcnt(11)
 v_mfma_f32_16x16x32_bf16 a[200:203], a[96:99], v[192:195], a[200:203]
 ds_read_b128 a[80:83], v26 offset:46080
 v_mfma_f32_16x16x32_bf16 a[200:203], a[100:103], v[200:203], a[200:203]
 ds_read_b128 a[84:87], v29 offset:46080
 v_mfma_f32_16x16x32_bf16 a[200:203], a[104:107], v[208:211], a[200:203]
 ds_read_b128 a[88:91], v28 offset:12288
 v_mfma_f32_16x16x32_bf16 a[200:203], a[108:111], v[216:219], a[200:203]
 ds_read_b128 a[92:95], v31 offset:12288
 v_mfma_f32_16x16x32_bf16 a[204:207], a[108:111], v[220:223], a[204:207]
 ds_read_b32 v87, v79 offset:208
 s_waitcnt vmcnt(63)
 v_mfma_f32_16x16x32_bf16 a[204:207], a[104:107], v[212:215], a[204:207]
 v_lshlrev_b32 v88, 16, v56
 v_lshlrev_b32 v92, 16, v58
 v_mfma_f32_16x16x32_bf16 a[204:207], a[100:103], v[204:207], a[204:207]
 v_and_b32 v89, 0xffff0000, v56
 v_and_b32 v93, 0xffff0000, v58
 v_mfma_f32_16x16x32_bf16 a[204:207], a[96:99], v[196:199], a[204:207]
 v_lshlrev_b32 v90, 16, v57
 s_waitcnt lgkmcnt(9)
 v_mfma_f32_16x16x32_bf16 a[216:219], a[112:115], v[192:195], a[216:219]
 ds_read_b128 a[96:99], v26 offset:48128
 v_lshlrev_b32 v94, 16, v59
 v_mfma_f32_16x16x32_bf16 a[216:219], a[116:119], v[200:203], a[216:219]
 ds_read_b128 a[100:103], v29 offset:48128
 v_and_b32 v91, 0xffff0000, v57
 v_mfma_f32_16x16x32_bf16 a[216:219], a[120:123], v[208:211], a[216:219]
 ds_read_b128 a[104:107], v28 offset:14336
 v_and_b32 v95, 0xffff0000, v59
 v_mfma_f32_16x16x32_bf16 a[216:219], a[124:127], v[216:219], a[216:219]
 ds_read_b128 a[108:111], v31 offset:14336
 s_waitcnt lgkmcnt(4)
 v_mfma_f32_16x16x32_bf16 a[220:223], a[124:127], v[220:223], a[220:223]
 v_lshlrev_b32 v160, 16, v40
 v_fma_f32 v160, v160, v88, -v92
 v_mfma_f32_16x16x32_bf16 a[220:223], a[120:123], v[212:215], a[220:223]
 buffer_load_dword v13, off, s[48:51], s68 offset:12 sc1
 v_fma_f32 v160, v160, v80, v92
 v_mfma_f32_16x16x32_bf16 a[220:223], a[116:119], v[204:207], a[220:223]
 v_and_b32 v161, 0xffff0000, v40
 v_fma_f32 v161, v161, v89, -v93
 v_mfma_f32_16x16x32_bf16 a[220:223], a[112:115], v[196:199], a[220:223]
 v_fma_f32 v161, v161, v80, v93
 s_waitcnt lgkmcnt(5)
 v_mfma_f32_16x16x32_bf16 a[232:235], a[80:83], v[192:195], a[232:235]
 ds_read_b128 a[112:115], v28 offset:25088
 v_lshlrev_b32 v162, 16, v41
 v_mfma_f32_16x16x32_bf16 a[232:235], a[84:87], v[200:203], a[232:235]
 ds_read_b128 a[116:119], v31 offset:25088
 v_fma_f32 v162, v162, v90, -v94
 v_mfma_f32_16x16x32_bf16 a[232:235], a[88:91], v[208:211], a[232:235]
 ds_read_b128 a[120:123], v27 offset:25088
 v_fma_f32 v162, v162, v80, v94
 v_mfma_f32_16x16x32_bf16 a[232:235], a[92:95], v[216:219], a[232:235]
 ds_read_b128 a[124:127], v30 offset:25088
 v_and_b32 v163, 0xffff0000, v41
 v_mfma_f32_16x16x32_bf16 a[236:239], a[92:95], v[220:223], a[236:239]
 v_fma_f32 v163, v163, v91, -v95
 v_fma_f32 v163, v163, v80, v95
 v_mfma_f32_16x16x32_bf16 a[236:239], a[88:91], v[212:215], a[236:239]
 v_lshlrev_b32 v164, 16, v42
 v_fma_f32 v164, v164, v88, -v92
 v_mfma_f32_16x16x32_bf16 a[236:239], a[84:87], v[204:207], a[236:239]
 v_fma_f32 v164, v164, v81, v92
 v_and_b32 v165, 0xffff0000, v42
 v_mfma_f32_16x16x32_bf16 a[236:239], a[80:83], v[196:199], a[236:239]
 v_fma_f32 v165, v165, v89, -v93
 s_waitcnt lgkmcnt(4)
 v_mfma_f32_16x16x32_bf16 a[248:251], a[96:99], v[192:195], a[248:251]
 ds_read_b128 a[80:83], v28 offset:27136
 v_fma_f32 v165, v165, v81, v93
 v_mfma_f32_16x16x32_bf16 a[248:251], a[100:103], v[200:203], a[248:251]
 ds_read_b128 a[84:87], v31 offset:27136
 v_lshlrev_b32 v166, 16, v43
 v_mfma_f32_16x16x32_bf16 a[248:251], a[104:107], v[208:211], a[248:251]
 ds_read_b128 a[88:91], v27 offset:27136
 v_fma_f32 v166, v166, v90, -v94
 v_mfma_f32_16x16x32_bf16 a[248:251], a[108:111], v[216:219], a[248:251]
 ds_read_b128 a[92:95], v30 offset:27136
 v_fma_f32 v166, v166, v81, v94
 v_mfma_f32_16x16x32_bf16 a[252:255], a[108:111], v[220:223], a[252:255]
 v_and_b32 v167, 0xffff0000, v43
 v_fma_f32 v167, v167, v91, -v95
 v_mfma_f32_16x16x32_bf16 a[252:255], a[104:107], v[212:215], a[252:255]
 v_fma_f32 v167, v167, v81, v95
 v_lshlrev_b32 v168, 16, v44
 v_mfma_f32_16x16x32_bf16 a[252:255], a[100:103], v[204:207], a[252:255]
 v_fma_f32 v168, v168, v88, -v92
 v_fma_f32 v168, v168, v82, v92
 v_mfma_f32_16x16x32_bf16 a[252:255], a[96:99], v[196:199], a[252:255]
 v_and_b32 v169, 0xffff0000, v44
 s_waitcnt vmcnt(6) lgkmcnt(4)
 v_mfma_f32_16x16x32_bf16 a[200:203], a[112:115], v[224:227], a[200:203]
 ds_read_b128 a[96:99], v28 offset:29184
 v_fma_f32 v169, v169, v89, -v93
 v_mfma_f32_16x16x32_bf16 a[200:203], a[116:119], v[232:235], a[200:203]
 ds_read_b128 a[100:103], v31 offset:29184
 v_fma_f32 v169, v169, v82, v93
 v_mfma_f32_16x16x32_bf16 a[200:203], a[120:123], v[240:243], a[200:203]
 ds_read_b128 a[104:107], v27 offset:29184
 v_lshlrev_b32 v170, 16, v45
 v_mfma_f32_16x16x32_bf16 a[200:203], a[124:127], v[248:251], a[200:203]
 ds_read_b128 a[108:111], v30 offset:29184
 v_fma_f32 v170, v170, v90, -v94
 v_mfma_f32_16x16x32_bf16 a[204:207], a[124:127], v[252:255], a[204:207]
 v_fma_f32 v170, v170, v82, v94
 v_and_b32 v171, 0xffff0000, v45
 v_mfma_f32_16x16x32_bf16 a[204:207], a[120:123], v[244:247], a[204:207]
 v_fma_f32 v171, v171, v91, -v95
 v_fma_f32 v171, v171, v82, v95
 v_mfma_f32_16x16x32_bf16 a[204:207], a[116:119], v[236:239], a[204:207]
 v_lshlrev_b32 v172, 16, v46
 v_fma_f32 v172, v172, v88, -v92
 v_mfma_f32_16x16x32_bf16 a[204:207], a[112:115], v[228:231], a[204:207]
 s_waitcnt lgkmcnt(4)
 v_mfma_f32_16x16x32_bf16 a[216:219], a[80:83], v[224:227], a[216:219]
 ds_read_b128 a[112:115], v28 offset:31232
 v_mfma_f32_16x16x32_bf16 a[216:219], a[84:87], v[232:235], a[216:219]
 ds_read_b128 a[116:119], v31 offset:31232
 v_mfma_f32_16x16x32_bf16 a[216:219], a[88:91], v[240:243], a[216:219]
 ds_read_b128 a[120:123], v27 offset:31232
 v_mfma_f32_16x16x32_bf16 a[216:219], a[92:95], v[248:251], a[216:219]
 ds_read_b128 a[124:127], v30 offset:31232
 v_mfma_f32_16x16x32_bf16 a[220:223], a[92:95], v[252:255], a[220:223]
 v_mfma_f32_16x16x32_bf16 a[220:223], a[88:91], v[244:247], a[220:223]
 v_mfma_f32_16x16x32_bf16 a[220:223], a[84:87], v[236:239], a[220:223]
 v_mfma_f32_16x16x32_bf16 a[220:223], a[80:83], v[228:231], a[220:223]
 s_waitcnt lgkmcnt(4)
 v_mfma_f32_16x16x32_bf16 a[232:235], a[96:99], v[224:227], a[232:235]
 ds_read_b128 a[80:83], v26 offset:0
 v_mfma_f32_16x16x32_bf16 a[232:235], a[100:103], v[232:235], a[232:235]
 ds_read_b128 a[84:87], v29 offset:0
 v_mfma_f32_16x16x32_bf16 a[232:235], a[104:107], v[240:243], a[232:235]
 ds_read_b128 a[88:91], v27 offset:0
 v_mfma_f32_16x16x32_bf16 a[232:235], a[108:111], v[248:251], a[232:235]
 ds_read_b128 a[92:95], v30 offset:0
 v_mfma_f32_16x16x32_bf16 a[236:239], a[108:111], v[252:255], a[236:239]
 v_mfma_f32_16x16x32_bf16 a[236:239], a[104:107], v[244:247], a[236:239]
 v_mfma_f32_16x16x32_bf16 a[236:239], a[100:103], v[236:239], a[236:239]
 v_mfma_f32_16x16x32_bf16 a[236:239], a[96:99], v[228:231], a[236:239]
 s_waitcnt lgkmcnt(4)
 v_mfma_f32_16x16x32_bf16 a[248:251], a[112:115], v[224:227], a[248:251]
 ds_read_b128 a[96:99], v26 offset:2048
 v_mfma_f32_16x16x32_bf16 a[248:251], a[116:119], v[232:235], a[248:251]
 ds_read_b128 a[100:103], v29 offset:2048
 s_waitcnt vmcnt(0)
 v_cmp_ne_u32 vcc, 1, v13
 s_cbranch_vccnz L_slow_19_b
L_back_21_b:
 v_mfma_f32_16x16x32_bf16 a[248:251], a[120:123], v[240:243], a[248:251]
 ds_read_b128 a[104:107], v27 offset:2048
 buffer_load_dwordx4 a[192:195], v64, s[48:51], s71 offen offset:0 sc1
 v_mfma_f32_16x16x32_bf16 a[248:251], a[124:127], v[248:251], a[248:251]
 ds_read_b128 a[108:111], v30 offset:2048
 v_mfma_f32_16x16x32_bf16 a[252:255], a[124:127], v[252:255], a[252:255]
 v_mfma_f32_16x16x32_bf16 a[252:255], a[120:123], v[244:247], a[252:255]
 v_mfma_f32_16x16x32_bf16 a[252:255], a[116:119], v[236:239], a[252:255]
 v_mfma_f32_16x16x32_bf16 a[252:255], a[112:115], v[228:231], a[252:255]
 s_waitcnt lgkmcnt(4)
 v_mfma_f32_16x16x32_bf16 a[136:139], a[80:83], v[112:115], a[136:139]
 ds_read_b128 a[112:115], v26 offset:4096
 buffer_load_dwordx4 a[208:211], v64, s[48:51], s71 offen offset:1024 sc1
 v_mfma_f32_16x16x32_bf16 a[136:139], a[84:87], v[120:123], a[136:139]
 ds_read_b128 a[116:119], v29 offset:4096
 v_mfma_f32_16x16x32_bf16 a[136:139], a[88:91], a[16:19], a[136:139]
 ds_read_b128 a[120:123], v27 offset:4096
 s_xor_b32 s75, s100, 2
 v_mfma_f32_16x16x32_bf16 a[136:139], a[92:95], a[24:27], a[136:139]
 ds_read_b128 a[124:127], v30 offset:4096
 s_lshl_b32 s75, s75, 7
 v_mfma_f32_16x16x32_bf16 a[140:143], a[92:95], a[28:31], a[140:143]
 s_add_u32 s75, s75, 42041352
 s_waitcnt vmcnt(3)
 v_mfma_f32_16x16x32_bf16 a[140:143], a[88:91], a[20:23], a[140:143]
 buffer_store_dword v1, v11, s[48:51], s75 offen sc1
 v_mfma_f32_16x16x32_bf16 a[140:143], a[84:87], v[124:127], a[140:143]
 v_mfma_f32_16x16x32_bf16 a[140:143], a[80:83], v[116:119], a[140:143]
 buffer_load_dwordx4 a[224:227], v64, s[48:51], s71 offen offset:2048 sc1
 s_waitcnt lgkmcnt(4)
 v_mfma_f32_16x16x32_bf16 a[152:155], a[96:99], v[112:115], a[152:155]
 ds_read_b128 a[80:83], v26 offset:6144
 s_xor_b32 s82, s100, 1
 v_mfma_f32_16x16x32_bf16 a[152:155], a[100:103], v[120:123], a[152:155]
 ds_read_b128 a[84:87], v29 offset:6144
 s_lshl_b32 s82, s82, 14
 v_mfma_f32_16x16x32_bf16 a[152:155], a[104:107], a[16:19], a[152:155]
 ds_read_b128 a[88:91], v27 offset:6144
 s_add_u32 s82, s82, 25169920
 v_mfma_f32_16x16x32_bf16 a[152:155], a[108:111], a[24:27], a[152:155]
 ds_read_b128 a[92:95], v30 offset:6144
 v_accvgpr_read_b32 v2, a200
 v_mfma_f32_16x16x32_bf16 a[156:159], a[108:111], a[28:31], a[156:159]
 buffer_load_dwordx4 a[240:243], v64, s[48:51], s71 offen offset:3072 sc1
 v_accvgpr_read_b32 v3, a201
 v_mfma_f32_16x16x32_bf16 a[156:159], a[104:107], a[20:23], a[156:159]
 v_accvgpr_read_b32 v4, a202
 v_accvgpr_read_b32 v5, a203
 v_mfma_f32_16x16x32_bf16 a[156:159], a[100:103], v[124:127], a[156:159]
 v_accvgpr_read_b32 v6, a216
 v_accvgpr_read_b32 v7, a217
 v_mfma_f32_16x16x32_bf16 a[156:159], a[96:99], v[116:119], a[156:159]
 v_accvgpr_read_b32 v8, a218
 s_waitcnt lgkmcnt(4)
 v_mfma_f32_16x16x32_bf16 a[168:171], a[112:115], v[112:115], a[168:171]
 ds_read_b128 a[96:99], v26 offset:16896
 v_accvgpr_read_b32 v9, a219
 v_mfma_f32_16x16x32_bf16 a[168:171], a[116:119], v[120:123], a[168:171]
 ds_read_b128 a[100:103], v29 offset:16896
 v_cvt_pk_bf16_f32 v32, v2, v3
 v_mfma_f32_16x16x32_bf16 a[168:171], a[120:123], a[16:19], a[168:171]
 ds_read_b128 a[104:107], v27 offset:33792
 v_cvt_pk_bf16_f32 v33, v4, v5
 v_mfma_f32_16x16x32_bf16 a[168:171], a[124:127], a[24:27], a[168:171]
 ds_read_b128 a[108:111], v30 offset:33792
 v_cvt_pk_bf16_f32 v34, v6, v7
 v_mfma_f32_16x16x32_bf16 a[172:175], a[124:127], a[28:31], a[172:175]
 v_cvt_pk_bf16_f32 v35, v8, v9
 v_mfma_f32_16x16x32_bf16 a[172:175], a[120:123], a[20:23], a[172:175]
 buffer_store_dwordx4 v[32:35], v64, s[48:51], s82 offen offset:0 sc1
 v_accvgpr_read_b32 v2, a232
 v_mfma_f32_16x16x32_bf16 a[172:175], a[116:119], v[124:127], a[172:175]
 v_accvgpr_read_b32 v3, a233
 v_accvgpr_read_b32 v4, a234
 v_mfma_f32_16x16x32_bf16 a[172:175], a[112:115], v[116:119], a[172:175]
 v_accvgpr_read_b32 v5, a235
 s_waitcnt lgkmcnt(4)
 v_mfma_f32_16x16x32_bf16 a[184:187], a[80:83], v[112:115], a[184:187]
 ds_read_b128 a[112:115], v26 offset:18944
 v_accvgpr_read_b32 v6, a248
 v_mfma_f32_16x16x32_bf16 a[184:187], a[84:87], v[120:123], a[184:187]
 ds_read_b128 a[116:119], v29 offset:18944
 v_accvgpr_read_b32 v7, a249
 v_mfma_f32_16x16x32_bf16 a[184:187], a[88:91], a[16:19], a[184:187]
 ds_read_b128 a[120:123], v27 offset:35840
 v_accvgpr_read_b32 v8, a250
 v_mfma_f32_16x16x32_bf16 a[184:187], a[92:95], a[24:27], a[184:187]
 ds_read_b128 a[124:127], v30 offset:35840
 v_accvgpr_read_b32 v9, a251
 v_mfma_f32_16x16x32_bf16 a[188:191], a[92:95], a[28:31], a[188:191]
 v_cvt_pk_bf16_f32 v36, v2, v3
 v_cvt_pk_bf16_f32 v37, v4, v5
 v_mfma_f32_16x16x32_bf16 a[188:191], a[88:91], a[20:23], a[188:191]
 v_cvt_pk_bf16_f32 v38, v6, v7
 v_cvt_pk_bf16_f32 v39, v8, v9
 v_mfma_f32_16x16x32_bf16 a[188:191], a[84:87], v[124:127], a[188:191]
 buffer_store_dwordx4 v[36:39], v64, s[48:51], s82 offen offset:1024 sc1
 v_accvgpr_read_b32 v2, a204
 v_mfma_f32_16x16x32_bf16 a[188:191], a[80:83], v[116:119], a[188:191]
 v_accvgpr_read_b32 v3, a205
 s_waitcnt lgkmcnt(4)
 v_mfma_f32_16x16x32_bf16 a[136:139], a[96:99], a[32:35], a[136:139]
 ds_read_b128 a[80:83], v26 offset:20992
 v_accvgpr_read_b32 v4, a206
 v_mfma_f32_16x16x32_bf16 a[136:139], a[100:103], a[40:43], a[136:139]
 ds_read_b128 a[84:87], v29 offset:20992
 v_accvgpr_read_b32 v5, a207
 v_mfma_f32_16x16x32_bf16 a[136:139], a[104:107], v[176:179], a[136:139]
 ds_read_b128 a[88:91], v27 offset:37888
 v_accvgpr_read_b32 v6, a220
 v_mfma_f32_16x16x32_bf16 a[136:139], a[108:111], v[184:187], a[136:139]
 ds_read_b128 a[92:95], v30 offset:37888
 v_accvgpr_read_b32 v7, a221
 v_mfma_f32_16x16x32_bf16 a[140:143], a[108:111], v[188:191], a[140:143]
 v_accvgpr_read_b32 v8, a222
 v_accvgpr_read_b32 v9, a223
 v_mfma_f32_16x16x32_bf16 a[140:143], a[104:107], v[180:183], a[140:143]
 v_cvt_pk_bf16_f32 v32, v2, v3
 v_cvt_pk_bf16_f32 v33, v4, v5
 v_mfma_f32_16x16x32_bf16 a[140:143], a[100:103], a[44:47], a[140:143]
 v_cvt_pk_bf16_f32 v34, v6, v7
 v_cvt_pk_bf16_f32 v35, v8, v9
 v_mfma_f32_16x16x32_bf16 a[140:143], a[96:99], a[36:39], a[140:143]
 buffer_store_dwordx4 v[32:35], v64, s[48:51], s82 offen offset:2048 sc1
 s_waitcnt lgkmcnt(4)
 v_mfma_f32_16x16x32_bf16 a[152:155], a[112:115], a[32:35], a[152:155]
 ds_read_b128 a[96:99], v26 offset:23040
 v_accvgpr_read_b32 v2, a236
 v_mfma_f32_16x16x32_bf16 a[152:155], a[116:119], a[40:43], a[152:155]
 ds_read_b128 a[100:103], v29 offset:23040
 v_accvgpr_read_b32 v3, a237
 v_mfma_f32_16x16x32_bf16 a[152:155], a[120:123], v[176:179], a[152:155]
 ds_read_b128 a[104:107], v27 offset:39936
 v_accvgpr_read_b32 v4, a238
 v_mfma_f32_16x16x32_bf16 a[152:155], a[124:127], v[184:187], a[152:155]
 ds_read_b128 a[108:111], v30 offset:39936
 v_accvgpr_read_b32 v5, a239
 v_mfma_f32_16x16x32_bf16 a[156:159], a[124:127], v[188:191], a[156:159]
 v_accvgpr_read_b32 v6, a252
 v_accvgpr_read_b32 v7, a253
 v_mfma_f32_16x16x32_bf16 a[156:159], a[120:123], v[180:183], a[156:159]
 v_accvgpr_read_b32 v8, a254
 v_accvgpr_read_b32 v9, a255
 v_mfma_f32_16x16x32_bf16 a[156:159], a[116:119], a[44:47], a[156:159]
 v_cvt_pk_bf16_f32 v36, v2, v3
 v_cvt_pk_bf16_f32 v37, v4, v5
 v_mfma_f32_16x16x32_bf16 a[156:159], a[112:115], a[36:39], a[156:159]
 buffer_load_dword v13, off, s[48:51], s68 offset:8 sc1
 s_waitcnt lgkmcnt(4)
 v_mfma_f32_16x16x32_bf16 a[168:171], a[80:83], a[32:35], a[168:171]
 ds_read_b128 a[112:115], v26 offset:33792
 v_cvt_pk_bf16_f32 v38, v6, v7
 v_mfma_f32_16x16x32_bf16 a[168:171], a[84:87], a[40:43], a[168:171]
 ds_read_b128 a[116:119], v29 offset:33792
 v_cvt_pk_bf16_f32 v39, v8, v9
 v_mfma_f32_16x16x32_bf16 a[168:171], a[88:91], v[176:179], a[168:171]
 ds_read_b128 a[120:123], v28 offset:0
 buffer_store_dwordx4 v[36:39], v64, s[48:51], s82 offen offset:3072 sc1
 v_mfma_f32_16x16x32_bf16 a[168:171], a[92:95], v[184:187], a[168:171]
 ds_read_b128 a[124:127], v31 offset:0
 v_fma_f32 v172, v172, v83, v92
 v_mfma_f32_16x16x32_bf16 a[172:175], a[92:95], v[188:191], a[172:175]
 v_and_b32 v173, 0xffff0000, v46
 v_fma_f32 v173, v173, v89, -v93
 v_mfma_f32_16x16x32_bf16 a[172:175], a[88:91], v[180:183], a[172:175]
 v_fma_f32 v173, v173, v83, v93
 v_lshlrev_b32 v174, 16, v47
 v_mfma_f32_16x16x32_bf16 a[172:175], a[84:87], a[44:47], a[172:175]
 v_fma_f32 v174, v174, v90, -v94
 v_fma_f32 v174, v174, v83, v94
 v_mfma_f32_16x16x32_bf16 a[172:175], a[80:83], a[36:39], a[172:175]
 v_and_b32 v175, 0xffff0000, v47
 s_waitcnt lgkmcnt(4)
 v_mfma_f32_16x16x32_bf16 a[184:187], a[96:99], a[32:35], a[184:187]
 ds_read_b128 a[80:83], v26 offset:35840
 v_fma_f32 v175, v175, v91, -v95
 v_mfma_f32_16x16x32_bf16 a[184:187], a[100:103], a[40:43], a[184:187]
 ds_read_b128 a[84:87], v29 offset:35840
 v_fma_f32 v175, v175, v83, v95
 v_mfma_f32_16x16x32_bf16 a[184:187], a[104:107], v[176:179], a[184:187]
 ds_read_b128 a[88:91], v28 offset:2048
 v_lshlrev_b32 v128, 16, v48
 v_mfma_f32_16x16x32_bf16 a[184:187], a[108:111], v[184:187], a[184:187]
 ds_read_b128 a[92:95], v31 offset:2048
 v_fma_f32 v128, v128, v88, -v92
 v_mfma_f32_16x16x32_bf16 a[188:191], a[108:111], v[188:191], a[188:191]
 v_fma_f32 v128, v128, v84, v92
 v_and_b32 v129, 0xffff0000, v48
 v_mfma_f32_16x16x32_bf16 a[188:191], a[104:107], v[180:183], a[188:191]
 v_fma_f32 v129, v129, v89, -v93
 v_fma_f32 v129, v129, v84, v93
 v_mfma_f32_16x16x32_bf16 a[188:191], a[100:103], a[44:47], a[188:191]
 v_lshlrev_b32 v130, 16, v49
 v_fma_f32 v130, v130, v90, -v94
 v_mfma_f32_16x16x32_bf16 a[188:191], a[96:99], a[36:39], a[188:191]
 v_fma_f32 v130, v130, v84, v94
 s_waitcnt lgkmcnt(4)
 v_mfma_f32_16x16x32_bf16 a[136:139], a[112:115], v[192:195], a[136:139]
 ds_read_b128 a[96:99], v26 offset:37888
 v_and_b32 v131, 0xffff0000, v49
 v_mfma_f32_16x16x32_bf16 a[136:139], a[116:119], v[200:203], a[136:139]
 ds_read_b128 a[100:103], v29 offset:37888
 v_fma_f32 v131, v131, v91, -v95
 v_mfma_f32_16x16x32_bf16 a[136:139], a[120:123], v[208:211], a[136:139]
 ds_read_b128 a[104:107], v28 offset:4096
 v_fma_f32 v131, v131, v84, v95
 v_mfma_f32_16x16x32_bf16 a[136:139], a[124:127], v[216:219], a[136:139]
 ds_read_b128 a[108:111], v31 offset:4096
 v_lshlrev_b32 v132, 16, v50
 v_mfma_f32_16x16x32_bf16 a[140:143], a[124:127], v[220:223], a[140:143]
 v_fma_f32 v132, v132, v88, -v92
 v_fma_f32 v132, v132, v85, v92
 v_mfma_f32_16x16x32_bf16 a[140:143], a[120:123], v[212:215], a[140:143]
 v_and_b32 v133, 0xffff0000, v50
 v_fma_f32 v133, v133, v89, -v93
 v_mfma_f32_16x16x32_bf16 a[140:143], a[116:119], v[204:207], a[140:143]
 v_fma_f32 v133, v133, v85, v93
 v_lshlrev_b32 v134, 16, v51
 v_mfma_f32_16x16x32_bf16 a[140:143], a[112:115], v[196:199], a[140:143]
 v_fma_f32 v134, v134, v90, -v94
 s_waitcnt lgkmcnt(4)
 v_mfma_f32_16x16x32_bf16 a[152:155], a[80:83], v[192:195], a[152:155]
 ds_read_b128 a[112:115], v26 offset:39936
 v_fma_f32 v134, v134, v85, v94
 v_mfma_f32_16x16x32_bf16 a[152:155], a[84:87], v[200:203], a[152:155]
 ds_read_b128 a[116:119], v29 offset:39936
 v_and_b32 v135, 0xffff0000, v51
 v_mfma_f32_16x16x32_bf16 a[152:155], a[88:91], v[208:211], a[152:155]
 ds_read_b128 a[120:123], v28 offset:6144
 v_fma_f32 v135, v135, v91, -v95
 v_mfma_f32_16x16x32_bf16 a[152:155], a[92:95], v[216:219], a[152:155]
 ds_read_b128 a[124:127], v31 offset:6144
 v_fma_f32 v135, v135, v85, v95
 v_mfma_f32_16x16x32_bf16 a[156:159], a[92:95], v[220:223], a[156:159]
 v_lshlrev_b32 v136, 16, v52
 v_fma_f32 v136, v136, v88, -v92
 v_mfma_f32_16x16x32_bf16 a[156:159], a[88:91], v[212:215], a[156:159]
 v_fma_f32 v136, v136, v86, v92
 v_and_b32 v137, 0xffff0000, v52
 v_mfma_f32_16x16x32_bf16 a[156:159], a[84:87], v[204:207], a[156:159]
 v_fma_f32 v137, v137, v89, -v93
 v_fma_f32 v137, v137, v86, v93
 v_mfma_f32_16x16x32_bf16 a[156:159], a[80:83], v[196:199], a[156:159]
 v_lshlrev_b32 v138, 16, v53
 s_waitcnt lgkmcnt(4)
 v_mfma_f32_16x16x32_bf16 a[168:171], a[96:99], v[192:195], a[168:171]
 ds_read_b128 a[80:83], v28 offset:16896
 v_fma_f32 v138, v138, v90, -v94
 v_mfma_f32_16x16x32_bf16 a[168:171], a[100:103], v[200:203], a[168:171]
 ds_read_b128 a[84:87], v31 offset:16896
 v_fma_f32 v138, v138, v86, v94
 v_mfma_f32_16x16x32_bf16 a[168:171], a[104:107], v[208:211], a[168:171]
 ds_read_b128 a[88:91], v27 offset:16896
 v_and_b32 v139, 0xffff0000, v53
 v_mfma_f32_16x16x32_bf16 a[168:171], a[108:111], v[216:219], a[168:171]
 ds_read_b128 a[92:95], v30 offset:16896
 v_fma_f32 v139, v139, v91, -v95
 v_mfma_f32_16x16x32_bf16 a[172:175], a[108:111], v[220:223], a[172:175]
 v_fma_f32 v139, v139, v86, v95
 v_lshlrev_b32 v140, 16, v54
 v_mfma_f32_16x16x32_bf16 a[172:175], a[104:107], v[212:215], a[172:175]
 v_fma_f32 v140, v140, v88, -v92
 v_fma_f32 v140, v140, v87, v92
 v_mfma_f32_16x16x32_bf16 a[172:175], a[100:103], v[204:207], a[172:175]
 v_and_b32 v141, 0xffff0000, v54
 v_fma_f32 v141, v141, v89, -v93
 v_mfma_f32_16x16x32_bf16 a[172:175], a[96:99], v[196:199], a[172:175]
 v_fma_f32 v141, v141, v87, v93
 s_waitcnt lgkmcnt(4)
 v_mfma_f32_16x16x32_bf16 a[184:187], a[112:115], v[192:195], a[184:187]
 ds_read_b128 a[96:99], v28 offset:18944
 v_lshlrev_b32 v142, 16, v55
 v_mfma_f32_16x16x32_bf16 a[184:187], a[116:119], v[200:203], a[184:187]
 ds_read_b128 a[100:103], v31 offset:18944
 v_fma_f32 v142, v142, v90, -v94
 v_mfma_f32_16x16x32_bf16 a[184:187], a[120:123], v[208:211], a[184:187]
 ds_read_b128 a[104:107], v27 offset:18944
 s_xor_b32 s75, s100, 1
 v_mfma_f32_16x16x32_bf16 a[184:187], a[124:127], v[216:219], a[184:187]
 ds_read_b128 a[108:111], v30 offset:18944
 s_waitcnt vmcnt(1)
 v_cmp_ne_u32 vcc, 1, v13
 s_cbranch_vccnz L_slow_22_b
L_back_24_b:
 v_mfma_f32_16x16x32_bf16 a[188:191], a[124:127], v[220:223], a[188:191]
 buffer_load_dwordx4 a[196:199], v64, s[48:51], s70 offen offset:0 sc1
 s_lshl_b32 s75, s75, 7
 v_mfma_f32_16x16x32_bf16 a[188:191], a[120:123], v[212:215], a[188:191]
 s_add_u32 s75, s75, 42041348
 s_waitcnt vmcnt(1)
 v_fma_f32 v142, v142, v87, v94
 v_mfma_f32_16x16x32_bf16 a[188:191], a[116:119], v[204:207], a[188:191]
L_pad16:
 s_cbranch_execz L_main
 v_and_b32 v143, 0xffff0000, v55
 v_fma_f32 v143, v143, v91, -v95
 v_mfma_f32_16x16x32_bf16 a[188:191], a[112:115], v[196:199], a[188:191]
 v_fma_f32 v143, v143, v87, v95
 s_waitcnt vmcnt(6)
 v_mfma_f32_16x16x32_bf16 a[136:139], v[70:73], a[192:195], a[136:139]
 buffer_store_dword v1, v11, s[48:51], s75 offen sc1
 v_mfma_f32_16x16x32_bf16 a[152:155], v[68:71], a[192:195], a[152:155]
 v_mfma_f32_16x16x32_bf16 a[168:171], v[70:73], a[208:211], a[168:171]
 buffer_load_dwordx4 a[212:215], v64, s[48:51], s70 offen offset:1024 sc1
 v_mfma_f32_16x16x32_bf16 a[184:187], v[68:71], a[208:211], a[184:187]
 v_mfma_f32_16x16x32_bf16 a[140:143], v[70:73], a[224:227], a[140:143]
 v_mfma_f32_16x16x32_bf16 a[156:159], v[68:71], a[224:227], a[156:159]
 v_mfma_f32_16x16x32_bf16 a[172:175], v[70:73], a[240:243], a[172:175]
 v_mfma_f32_16x16x32_bf16 a[188:191], v[68:71], a[240:243], a[188:191]
 s_waitcnt lgkmcnt(4)
 v_mfma_f32_16x16x32_bf16 a[136:139], a[80:83], v[224:227], a[136:139]
 ds_read_b128 a[112:115], v28 offset:20992
 buffer_load_dwordx4 a[228:231], v64, s[48:51], s70 offen offset:2048 sc1
 v_mfma_f32_16x16x32_bf16 a[136:139], a[84:87], v[232:235], a[136:139]
 ds_read_b128 a[116:119], v31 offset:20992
 v_mfma_f32_16x16x32_bf16 a[136:139], a[88:91], v[240:243], a[136:139]
 ds_read_b128 a[120:123], v27 offset:20992
 v_mfma_f32_16x16x32_bf16 a[136:139], a[92:95], v[248:251], a[136:139]
 ds_read_b128 a[124:127], v30 offset:20992
 v_mfma_f32_16x16x32_bf16 a[140:143], a[92:95], v[252:255], a[140:143]
 v_mfma_f32_16x16x32_bf16 a[140:143], a[88:91], v[244:247], a[140:143]
 v_mfma_f32_16x16x32_bf16 a[140:143], a[84:87], v[236:239], a[140:143]
 buffer_load_dwordx4 a[244:247], v64, s[48:51], s70 offen offset:3072 sc1
 v_mfma_f32_16x16x32_bf16 a[140:143], a[80:83], v[228:231], a[140:143]
 s_waitcnt lgkmcnt(4)
 v_mfma_f32_16x16x32_bf16 a[152:155], a[96:99], v[224:227], a[152:155]
 ds_read_b128 a[80:83], v28 offset:23040
 v_mfma_f32_16x16x32_bf16 a[152:155], a[100:103], v[232:235], a[152:155]
 ds_read_b128 a[84:87], v31 offset:23040
 v_mfma_f32_16x16x32_bf16 a[152:155], a[104:107], v[240:243], a[152:155]
 ds_read_b128 a[88:91], v27 offset:23040
 v_mfma_f32_16x16x32_bf16 a[152:155], a[108:111], v[248:251], a[152:155]
 ds_read_b128 a[92:95], v30 offset:23040
 v_mfma_f32_16x16x32_bf16 a[156:159], a[108:111], v[252:255], a[156:159]
 v_mfma_f32_16x16x32_bf16 a[156:159], a[104:107], v[244:247], a[156:159]
 v_mfma_f32_16x16x32_bf16 a[156:159], a[100:103], v[236:239], a[156:159]
 v_mfma_f32_16x16x32_bf16 a[156:159], a[96:99], v[228:231], a[156:159]
 s_waitcnt lgkmcnt(4)
 v_mfma_f32_16x16x32_bf16 a[168:171], a[112:115], v[224:227], a[168:171]
 v_mfma_f32_16x16x32_bf16 a[168:171], a[116:119], v[232:235], a[168:171]
 v_mfma_f32_16x16x32_bf16 a[168:171], a[120:123], v[240:243], a[168:171]
 v_mfma_f32_16x16x32_bf16 a[168:171], a[124:127], v[248:251], a[168:171]
 v_mfma_f32_16x16x32_bf16 a[172:175], a[124:127], v[252:255], a[172:175]
 buffer_load_dword v13, off, s[48:51], s68 offset:4 sc1
 v_mfma_f32_16x16x32_bf16 a[172:175], a[120:123], v[244:247], a[172:175]
 v_mfma_f32_16x16x32_bf16 a[172:175], a[116:119], v[236:239], a[172:175]
 v_mfma_f32_16x16x32_bf16 a[172:175], a[112:115], v[228:231], a[172:175]
 s_waitcnt lgkmcnt(0)
 v_mfma_f32_16x16x32_bf16 a[184:187], a[80:83], v[224:227], a[184:187]
 v_mfma_f32_16x16x32_bf16 a[184:187], a[84:87], v[232:235], a[184:187]
 v_mfma_f32_16x16x32_bf16 a[184:187], a[88:91], v[240:243], a[184:187]
 v_mfma_f32_16x16x32_bf16 a[184:187], a[92:95], v[248:251], a[184:187]
 v_mfma_f32_16x16x32_bf16 a[188:191], a[92:95], v[252:255], a[188:191]
 v_mfma_f32_16x16x32_bf16 a[188:191], a[88:91], v[244:247], a[188:191]
 v_mfma_f32_16x16x32_bf16 a[188:191], a[84:87], v[236:239], a[188:191]
 v_mfma_f32_16x16x32_bf16 a[188:191], a[80:83], v[228:231], a[188:191]
 s_waitcnt vmcnt(1)
 v_mfma_f32_16x16x32_bf16 a[136:139], v[70:73], a[196:199], a[136:139]
 v_mfma_f32_16x16x32_bf16 a[152:155], v[68:71], a[196:199], a[152:155]
 v_mfma_f32_16x16x32_bf16 a[168:171], v[70:73], a[212:215], a[168:171]
 v_mfma_f32_16x16x32_bf16 a[184:187], v[68:71], a[212:215], a[184:187]
 v_mfma_f32_16x16x32_bf16 a[140:143], v[70:73], a[228:231], a[140:143]
 v_mfma_f32_16x16x32_bf16 a[156:159], v[68:71], a[228:231], a[156:159]
 v_mfma_f32_16x16x32_bf16 a[172:175], v[70:73], a[244:247], a[172:175]
 v_mfma_f32_16x16x32_bf16 a[188:191], v[68:71], a[244:247], a[188:191]
 s_waitcnt vmcnt(0)
 v_cmp_ne_u32 vcc, 1, v13
 s_cbranch_vccnz L_slow_25_b
L_back_27_b:
 buffer_load_dwordx4 a[128:131], v64, s[48:51], s69 offen offset:0 sc1
 buffer_load_dwordx4 a[144:147], v64, s[48:51], s69 offen offset:1024 sc1
 buffer_load_dwordx4 a[160:163], v64, s[48:51], s69 offen offset:2048 sc1
 buffer_load_dwordx4 a[176:179], v64, s[48:51], s69 offen offset:3072 sc1
 s_waitcnt vmcnt(2)
 v_mfma_f32_16x16x32_bf16 a[136:139], v[70:73], a[128:131], a[136:139]
 v_mfma_f32_16x16x32_bf16 a[152:155], v[68:71], a[128:131], a[152:155]
 v_mfma_f32_16x16x32_bf16 a[168:171], v[70:73], a[144:147], a[168:171]
 v_mfma_f32_16x16x32_bf16 a[184:187], v[68:71], a[144:147], a[184:187]
 s_nop 4
 ds_write_b128 v77, a[136:139] offset:0
 ds_write_b128 v77, a[152:155] offset:64
 ds_write_b128 v77, a[168:171] offset:128
 ds_write_b128 v77, a[184:187] offset:192
 ds_read_b128 v[80:83], v78 offset:0
 ds_read_b128 v[84:87], v78 offset:1088
 ds_read_b128 v[88:91], v78 offset:2176
 ds_read_b128 v[92:95], v78 offset:3264
 s_waitcnt lgkmcnt(3)
 v_pk_add_f32 v[80:81], v[80:81], v[160:161]
 v_pk_add_f32 v[82:83], v[82:83], v[162:163]
 s_mov_b32 s72, 0
 buffer_store_dwordx4 v[80:83], v74, s[52:55], s72 offen sc1
 s_waitcnt lgkmcnt(2)
 v_pk_add_f32 v[84:85], v[84:85], v[164:165]
 v_pk_add_f32 v[86:87], v[86:87], v[166:167]
 s_mov_b32 s72, 65536
 buffer_store_dwordx4 v[84:87], v74, s[52:55], s72 offen sc1
 s_waitcnt lgkmcnt(1)
 v_pk_add_f32 v[88:89], v[88:89], v[168:169]
 v_pk_add_f32 v[90:91], v[90:91], v[170:171]
 s_mov_b32 s72, 131072
 buffer_store_dwordx4 v[88:91], v74, s[52:55], s72 offen sc1
 s_waitcnt lgkmcnt(0)
 v_pk_add_f32 v[92:93], v[92:93], v[172:173]
 v_pk_add_f32 v[94:95], v[94:95], v[174:175]
 s_mov_b32 s72, 196608
 buffer_store_dwordx4 v[92:95], v74, s[52:55], s72 offen sc1
 s_waitcnt vmcnt(4)
 v_mfma_f32_16x16x32_bf16 a[140:143], v[70:73], a[160:163], a[140:143]
 v_mfma_f32_16x16x32_bf16 a[156:159], v[68:71], a[160:163], a[156:159]
 v_mfma_f32_16x16x32_bf16 a[172:175], v[70:73], a[176:179], a[172:175]
 v_mfma_f32_16x16x32_bf16 a[188:191], v[68:71], a[176:179], a[188:191]
 s_nop 4
 ds_write_b128 v77, a[140:143] offset:0
 ds_write_b128 v77, a[156:159] offset:64
 ds_write_b128 v77, a[172:175] offset:128
 ds_write_b128 v77, a[188:191] offset:192
 ds_read_b128 v[96:99], v78 offset:0
 ds_read_b128 v[100:103], v78 offset:1088
 ds_read_b128 v[104:107], v78 offset:2176
 ds_read_b128 v[108:111], v78 offset:3264
 s_waitcnt lgkmcnt(3)
 v_pk_add_f32 v[96:97], v[96:97], v[128:129]
 v_pk_add_f32 v[98:99], v[98:99], v[130:131]
 s_mov_b32 s72, 8192
 buffer_store_dwordx4 v[96:99], v74, s[52:55], s72 offen sc1
 s_waitcnt lgkmcnt(2)
 v_pk_add_f32 v[100:101], v[100:101], v[132:133]
 v_pk_add_f32 v[102:103], v[102:103], v[134:135]
 s_mov_b32 s72, 73728
 buffer_store_dwordx4 v[100:103], v74, s[52:55], s72 offen sc1
 s_waitcnt lgkmcnt(1)
 v_pk_add_f32 v[104:105], v[104:105], v[136:137]
 v_pk_add_f32 v[106:107], v[106:107], v[138:139]
 s_mov_b32 s72, 139264
 buffer_store_dwordx4 v[104:107], v74, s[52:55], s72 offen sc1
 s_waitcnt lgkmcnt(0)
 v_pk_add_f32 v[108:109], v[108:109], v[140:141]
 v_pk_add_f32 v[110:111], v[110:111], v[142:143]
 s_mov_b32 s72, 204800
 buffer_store_dwordx4 v[108:111], v74, s[52:55], s72 offen sc1
L_exit_b:
 s_endpgm
L_slow_1:
 s_mov_b32 s81, 262144
L_spin_2:
 buffer_load_dword v78, off, s[56:59], 0 sc1
 s_waitcnt vmcnt(0)
 v_cmp_gt_u32 vcc, 0x100, v78
 s_cbranch_vccz L_back_3
 s_sub_u32 s81, s81, 1
 s_cbranch_scc0 L_spin_2
 s_branch L_back_3
L_slow_4:
 s_mov_b32 s81, 262144
L_spin_5:
 buffer_load_dword v13, v25, s[48:51], s101 offen sc1
 s_waitcnt vmcnt(0)
 v_cmp_gt_u32 vcc, 1, v13
 s_cbranch_vccz L_back_6
 s_sub_u32 s81, s81, 1
 s_cbranch_scc0 L_spin_5
 s_branch L_back_6
L_slow_7:
 s_mov_b32 s81, 262144
L_spin_8:
 s_mov_b32 s82, m0
 s_mov_b32 m0, s35
 s_nop 0
 buffer_load_dwordx4 v64, s[28:31], s33 offen offset:0 sc1 lds
 buffer_load_dwordx4 v64, s[28:31], s33 offen offset:1024 sc1 lds
 s_waitcnt vmcnt(0)
 s_mov_b32 m0, s82
 ds_read_b128 v[152:155], v65 offset:1536
 ds_read_b128 v[148:151], v65 offset:1280
 ds_read_b128 v[144:147], v65 offset:1024
 ds_read_b128 v[140:143], v65 offset:768
 ds_read_b128 v[136:139], v65 offset:512
 ds_read_b128 v[132:135], v65 offset:256
 ds_read_b128 v[128:131], v65 offset:0
 s_waitcnt lgkmcnt(0)
 s_waitcnt vmcnt(0)
 v_max3_u32 v2, v128, v129, v130
 v_max3_u32 v2, v2, v131, v132
 v_max3_u32 v2, v2, v133, v134
 v_max3_u32 v2, v2, v135, v136
 v_max3_u32 v2, v2, v137, v138
 v_max3_u32 v2, v2, v139, v140
 v_max3_u32 v2, v2, v141, v142
 v_max3_u32 v2, v2, v143, v144
 v_max3_u32 v2, v2, v145, v146
 v_max3_u32 v2, v2, v147, v148
 v_max3_u32 v2, v2, v149, v150
 v_max3_u32 v2, v2, v151, v152
 v_max3_u32 v2, v2, v153, v154
 v_max_u32 v2, v2, v155
 v_cmp_eq_u32 vcc, -1, v2
 s_cbranch_vccz L_back_9
 s_sub_u32 s81, s81, 1
 s_cbranch_scc0 L_spin_8
 s_branch L_back_9
L_slow_10:
 s_mov_b32 s81, 262144
L_spin_11:
 buffer_load_dword v13, v25, s[48:51], s101 offen sc1
 s_waitcnt vmcnt(0)
 v_cmp_gt_u32 vcc, 2, v13
 s_cbranch_vccz L_back_12
 s_sub_u32 s81, s81, 1
 s_cbranch_scc0 L_spin_11
 s_branch L_back_12
L_slow_13:
 s_mov_b32 s81, 262144
L_spin_14:
 buffer_load_dword v13, v25, s[48:51], s101 offen sc1
 s_waitcnt vmcnt(0)
 v_cmp_gt_u32 vcc, 3, v13
 s_cbranch_vccz L_back_15
 s_sub_u32 s81, s81, 1
 s_cbranch_scc0 L_spin_14
 s_branch L_back_15
L_slow_16:
 s_mov_b32 s81, 262144
L_spin_17:
 buffer_load_dword v13, v25, s[48:51], s101 offen sc1
 s_waitcnt vmcnt(0)
 v_cmp_gt_u32 vcc, 4, v13
 s_cbranch_vccz L_back_18
 s_sub_u32 s81, s81, 1
 s_cbranch_scc0 L_spin_17
 s_branch L_back_18
L_slow_19:
 s_mov_b32 s81, 262144
L_spin_20:
 buffer_load_dword v13, off, s[48:51], s68 offset:12 sc1
 s_waitcnt vmcnt(0)
 v_cmp_ne_u32 vcc, 1, v13
 s_cbranch_vccz L_back_21
 s_sub_u32 s81, s81, 1
 s_cbranch_scc0 L_spin_20
 s_branch L_back_21
L_slow_22:
 s_mov_b32 s81, 262144
L_spin_23:
 buffer_load_dword v13, off, s[48:51], s68 offset:8 sc1
 s_waitcnt vmcnt(0)
 v_cmp_ne_u32 vcc, 1, v13
 s_cbranch_vccz L_back_24
 s_sub_u32 s81, s81, 1
 s_cbranch_scc0 L_spin_23
 s_branch L_back_24
L_slow_25:
 s_mov_b32 s81, 262144
L_spin_26:
 buffer_load_dword v13, off, s[48:51], s68 offset:4 sc1
 s_waitcnt vmcnt(0)
 v_cmp_ne_u32 vcc, 1, v13
 s_cbranch_vccz L_back_27
 s_sub_u32 s81, s81, 1
 s_cbranch_scc0 L_spin_26
 s_branch L_back_27
L_slow_19_b:
 s_mov_b32 s81, 262144
L_spin_20_b:
 buffer_load_dword v13, off, s[48:51], s68 offset:12 sc1
 s_waitcnt vmcnt(0)
 v_cmp_ne_u32 vcc, 1, v13
 s_cbranch_vccz L_back_21_b
 s_sub_u32 s81, s81, 1
 s_cbranch_scc0 L_spin_20_b
 s_branch L_back_21_b
L_slow_22_b:
 s_mov_b32 s81, 262144
L_spin_23_b:
 buffer_load_dword v13, off, s[48:51], s68 offset:8 sc1
 s_waitcnt vmcnt(0)
 v_cmp_ne_u32 vcc, 1, v13
 s_cbranch_vccz L_back_24_b
 s_sub_u32 s81, s81, 1
 s_cbranch_scc0 L_spin_23_b
 s_branch L_back_24_b
L_slow_25_b:
 s_mov_b32 s81, 262144
L_spin_26_b:
 buffer_load_dword v13, off, s[48:51], s68 offset:4 sc1
 s_waitcnt vmcnt(0)
 v_cmp_ne_u32 vcc, 1, v13
 s_cbranch_vccz L_back_27_b
 s_sub_u32 s81, s81, 1
 s_cbranch_scc0 L_spin_26_b
 s_branch L_back_27_b
L_end:
.section .rodata,"a"
.p2align 6
.amdhsa_kernel gated_mix__ssm_conv_s5__dense_activation_gelu__prompt_kernel
  .amdhsa_next_free_vgpr 512
  .amdhsa_next_free_sgpr 102
  .amdhsa_accum_offset 256
  .amdhsa_group_segment_fixed_size 0
  .amdhsa_kernarg_size 144
  .amdhsa_user_sgpr_count 2
  .amdhsa_user_sgpr_kernarg_segment_ptr 1
  .amdhsa_system_sgpr_workgroup_id_x 1
  .amdhsa_float_denorm_mode_32 3
.end_amdhsa_kernel
```
